```python
import torch

def _softmax(x, axis=-1):
    return torch.softmax(x, dim=axis)
def _gelu(x):
    return torch.nn.functional.gelu(x, approximate="tanh")
def _silu(x):
    return torch.nn.functional.silu(x)
def _sigmoid(x):
    return torch.sigmoid(x)
def _layernorm(x, axis=-1, eps=1e-5):
    m = x.mean(dim=axis, keepdim=True)
    v = x.var(dim=axis, keepdim=True, unbiased=False)
    return (x - m) / torch.sqrt(v + eps)
def _scatter_add(tgt, idx, src, axis=0):
    return tgt.clone().index_add_(axis, idx, src)
def _segment_sum(src, seg, n):
    out = torch.zeros((n,) + src.shape[1:], dtype=src.dtype)
    return out.index_add_(0, seg, src)
def _pad(x, pw):
    flat = tuple(v for pair in reversed(pw) for v in pair)
    return torch.nn.functional.pad(x, flat)

kernel_name = 'parallel_sum__compressed_kv_cla__dense_activation_gelu__prompt'

def setup_inputs():

    _w = (lambda a: (lambda t: t.to(torch.bfloat16) if t.is_floating_point() else t)(torch.as_tensor(a)))
    def _A_setup():
        B, H, Sq, Sk, D, M = 1, 32, 2048, 2048, 128, 640
        Dc = 4 * D
        return {
            "x": _w((lambda *s: torch.randn(*s, dtype=torch.bfloat16) * 0.05)(B, Sq, M)),
            "c_kv": _w((lambda *s: torch.randn(*s, dtype=torch.bfloat16) * 0.4)(B, Sk, Dc)),
            "w_q": _w((lambda *s: torch.randn(*s, dtype=torch.bfloat16) * 3.2)(M, H, D) * (M ** -0.5)),
            "w_uk": _w((lambda *s: torch.randn(*s, dtype=torch.bfloat16) * 3.2)(Dc, H, D) * (Dc ** -0.5)),
            "w_uv": _w((lambda *s: torch.randn(*s, dtype=torch.bfloat16) * 0.4)(Dc, H, D) * (Dc ** -0.5)),
            "w_o": _w((lambda *s: torch.randn(*s, dtype=torch.bfloat16) * 0.4)(H, D, M) * ((H * D) ** -0.5)),
        }
    _A_in = _A_setup()

    def _B_setup():
        B, S, D, F = 1, 2048, 640, 1728
        return {
            "x": _w((lambda *s: torch.randn(*s, dtype=torch.bfloat16) * 0.05)(B, S, D)),
            "w1": _w((lambda *s: torch.randn(*s, dtype=torch.bfloat16) * 0.4)(D, F) * (D ** -0.5)),
            "b1": _w((lambda *s: torch.randn(*s, dtype=torch.bfloat16) * 12.8)(F) * 0.01),
            "w2": _w((lambda *s: torch.randn(*s, dtype=torch.bfloat16) * 0.2)(F, D) * (F ** -0.5)),
            "b2": _w((lambda *s: torch.randn(*s, dtype=torch.bfloat16) * 1.6)(D) * 0.01),
        }
    _B_in = _B_setup()

    return {
        "A_x": _A_in["x"],
        "A_c_kv": _A_in["c_kv"],
        "A_w_q": _A_in["w_q"],
        "A_w_uk": _A_in["w_uk"],
        "A_w_uv": _A_in["w_uv"],
        "A_w_o": _A_in["w_o"],
        "B_x": _B_in["x"],
        "B_w1": _B_in["w1"],
        "B_b1": _B_in["b1"],
        "B_w2": _B_in["w2"],
        "B_b2": _B_in["b2"],
    }

def reference(A_x, A_c_kv, A_w_q, A_w_uk, A_w_uv, A_w_o, B_x, B_w1, B_b1, B_w2, B_b2):
    def _A_ref(x, c_kv, w_q, w_uk, w_uv, w_o):
        B, Sq, M = x.shape[0], x.shape[1], x.shape[2]
        Sk = c_kv.shape[1]
        H, D = w_q.shape[1], w_q.shape[2]
        q = torch.einsum("bqm,mhd->bhqd", x, w_q)
        k = torch.einsum("bkc,chd->bhkd", c_kv, w_uk)
        v = torch.einsum("bkc,chd->bhkd", c_kv, w_uv)
        scores = torch.einsum("bhqd,bhkd->bhqk", q, k) * (D ** -0.5)
        off = Sk - Sq
        qi = torch.arange(Sq)[:, None]
        kj = torch.arange(Sk)[None, :]
        cmask = kj <= (qi + off)
        scores = torch.where(cmask[None, None], scores, -1e9)
        p = _softmax(scores, axis=-1)
        ctx = torch.einsum("bhqk,bhkd->bhqd", p, v)
        return torch.einsum("bhqd,hdm->bqm", ctx, w_o)

    def _B_ref(x, w1, b1, w2, b2):
        h = torch.einsum("bsd,df->bsf", x, w1) + b1
        h = _gelu(h)
        return torch.einsum("bsf,fd->bsd", h, w2) + b2

    x = A_x
    xn = _layernorm(x, axis=-1)
    return x + _A_ref(xn, A_c_kv, A_w_q, A_w_uk, A_w_uv, A_w_o) + _B_ref(xn, B_w1, B_b1, B_w2, B_b2)
```

```asm
; @launch grid=(256,1,1) block=(256,1,1) lds=163840
.amdgcn_target "amdgcn-amd-amdhsa--gfx950"
.macro dma a,r,s,o
buffer_load_dwordx4 v[\a], s[\r:\r+3], s[\s] offen offset:\o lds
.endm
.macro dmant a,r,s,o
buffer_load_dwordx4 v[\a], s[\r:\r+3], s[\s] offen offset:\o nt lds
.endm
.macro tv d,a,o
ds_read_b64_tr_b16 v[\d:\d+1], v[\a] offset:\o
.endm
.macro rv d,a,o
ds_read_b128 v[\d:\d+3], v[\a] offset:\o
.endm
.macro zavv d,a,b
v_mfma_f32_16x16x32_bf16 a[\d:\d+3], v[\a:\a+3], v[\b:\b+3], 0
.endm
.macro mavv d,a,b
v_mfma_f32_16x16x32_bf16 a[\d:\d+3], v[\a:\a+3], v[\b:\b+3], a[\d:\d+3]
.endm
.macro cv d,a,b
v_cvt_pk_bf16_f32 v[\d], v[\a], v[\b]
.endm
.macro ar d,a
v_accvgpr_read_b32 v[\d], a[\a]
.endm
.macro ta d,a,o
ds_read_b64_tr_b16 a[\d:\d+1], v[\a] offset:\o
.endm
.macro zvav d,a,b
v_mfma_f32_16x16x32_bf16 v[\d:\d+3], a[\a:\a+3], v[\b:\b+3], 0
.endm
.macro mvav d,a,b
v_mfma_f32_16x16x32_bf16 v[\d:\d+3], a[\a:\a+3], v[\b:\b+3], v[\d:\d+3]
.endm
.macro cvav d,a,b,c
v_mfma_f32_16x16x32_bf16 v[\d:\d+3], a[\a:\a+3], v[\b:\b+3], v[\c:\c+3]
.endm
.macro mvaa d,a,b
v_mfma_f32_16x16x32_bf16 v[\d:\d+3], a[\a:\a+3], a[\b:\b+3], v[\d:\d+3]
.endm
.macro aw d,a
v_accvgpr_write_b32 a[\d], v[\a]
.endm
.macro ra d,a,o
ds_read_b128 a[\d:\d+3], v[\a] offset:\o
.endm
.macro zaav d,a,b
v_mfma_f32_16x16x32_bf16 a[\d:\d+3], a[\a:\a+3], v[\b:\b+3], 0
.endm
.macro maav d,a,b
v_mfma_f32_16x16x32_bf16 a[\d:\d+3], a[\a:\a+3], v[\b:\b+3], a[\d:\d+3]
.endm
.macro cvaa d,a,b,c
v_mfma_f32_16x16x32_bf16 v[\d:\d+3], a[\a:\a+3], a[\b:\b+3], v[\c:\c+3]
.endm
.macro zvaa d,a,b
v_mfma_f32_16x16x32_bf16 v[\d:\d+3], a[\a:\a+3], a[\b:\b+3], 0
.endm
.text
.globl parallel_sum__compressed_kv_cla__dense_activation_gelu__prompt_kernel
.p2align 8
.type parallel_sum__compressed_kv_cla__dense_activation_gelu__prompt_kernel,@function
parallel_sum__compressed_kv_cla__dense_activation_gelu__prompt_kernel:
L_code_begin:
s_cmp_ge_u32 s2, 256
s_cbranch_scc1 L_exit
s_load_dwordx16 s[8:23], s[0:1], 0
s_load_dwordx8 s[24:31], s[0:1], 64
s_load_dwordx4 s[32:35], s[0:1], 96
v_lshrrev_b32 v33, 6, v0
v_and_b32 v32, 63, v0
v_readfirstlane_b32 s3, v33
v_lshlrev_b32 v0, 4, v32
s_and_b32 s6, s2, 7
s_lshr_b32 s56, s2, 3
s_and_b32 s56, s56, 3
s_lshl_b32 s4, s6, 2
s_add_u32 s4, s4, s56
s_lshr_b32 s5, s2, 5
s_mov_b32 s7, 0
s_getpc_b64 s[60:61]
s_and_b32 s60, s60, 0xffffff00
s_lshr_b32 s58, s2, 3
s_lshl_b32 s58, s58, 2
s_add_u32 s58, s58, s3
v_min_u32 v152, 9, v32
v_lshlrev_b32 v152, 14, v152
s_lshl_b32 s58, s58, 7
v_add_u32 v152, s58, v152
v_min_u32 v152, L_code_end-L_code_begin-4, v152
global_load_dword v153, v152, s[60:61]
s_mul_i32 s64, s6, 3
s_add_u32 s64, s64, s56
s_sub_u32 s57, s6, s5
s_and_b32 s57, s57, 7
s_add_u32 s57, s57, 24
s_cmp_eq_u32 s56, 3
s_cselect_b32 s64, s57, s64
v_lshrrev_b32 v37, 3, v32
v_and_b32 v38, 7, v32
v_lshrrev_b32 v39, 4, v32
v_xor_b32 v50, v38, v39
v_lshlrev_b32 v50, 4, v50
v_lshl_add_u32 v96, v37, 10, v50
v_xor_b32 v51, 64, v96
v_add_u32 v97, 7168, v51
v_add_u32 v98, 14336, v96
v_add_u32 v99, 21504, v51
v_and_b32 v52, 15, v32
v_lshlrev_b32 v53, 1, v39
v_xor_b32 v53, v52, v53
v_lshlrev_b32 v53, 4, v53
v_lshl_add_u32 v100, v39, 13, v53
v_add_u32 v101, 31744, v100
v_xor_b32 v51, 128, v100
v_add_u32 v102, 63488, v51
v_add_u32 v103, 95232, v51
s_lshl_b32 s67, s5, 18
s_lshl_b32 s57, s3, 16
s_add_u32 s67, s67, s57
s_lshl_b32 s65, s3, 13
s_and_b32 s57, s3, 1
s_lshl_b32 s68, s57, 17
s_lshl_b32 s58, s4, 8
s_add_u32 s68, s68, s58
s_lshl_b32 s66, s3, 12
s_add_u32 s66, s66, 0x10000
s_waitcnt lgkmcnt(0)
s_mov_b32 s40, s10
s_and_b32 s41, s11, 0xffff
s_mov_b32 s42, 2097152
s_mov_b32 s43, 0x20000
s_cmp_ge_u32 s3, 2
s_cselect_b32 s44, s16, s14
s_cselect_b32 s45, s17, s15
s_and_b32 s45, s45, 0xffff
s_mov_b32 s46, 4194304
s_mov_b32 s47, 0x20000
s_add_u32 m0, s65, 0
s_add_u32 s56, s67, 0
s_nop 0
dma 96,40,56,0
dma 97,40,56,1024
dma 98,40,56,2048
dma 99,40,56,3072
s_add_u32 m0, s65, 4096
s_add_u32 s56, s67, 32768
s_nop 0
dma 96,40,56,0
dma 97,40,56,1024
dma 98,40,56,2048
dma 99,40,56,3072
s_add_u32 m0, s66, 32768
s_add_u32 s57, s68, 0
s_nop 0
dmant 100,44,57,0
dmant 101,44,57,1024
dmant 102,44,57,2048
dmant 103,44,57,3072
s_add_u32 m0, s66, 49152
s_add_u32 s57, s68, 262144
s_nop 0
dmant 100,44,57,0
dmant 101,44,57,1024
dmant 102,44,57,2048
dmant 103,44,57,3072
s_add_u32 s58, s34, 88080384
s_addc_u32 s59, s35, 0
s_load_dword s88, s[58:59], 0
s_mov_b32 s52, s34
s_and_b32 s53, s35, 0xffff
s_mov_b32 s54, 94371840
s_mov_b32 s55, 0x20000
v_lshrrev_b32 v54, 1, v52
v_xor_b32 v54, v54, v39
v_lshlrev_b32 v54, 4, v54
v_lshl_add_u32 v54, v52, 7, v54
s_and_b32 s58, s3, 1
s_lshl_b32 s58, s58, 14
v_add_u32 v104, s58, v54
v_xor_b32 v105, 64, v104
v_add_u32 v124, 0x20000, v104
v_add_u32 v125, 0x20000, v105
v_lshrrev_b32 v55, 2, v52
v_and_b32 v56, 1, v39
v_lshl_add_u32 v56, v56, 2, v55
v_lshlrev_b32 v56, 5, v56
v_and_b32 v57, 3, v32
v_lshlrev_b32 v57, 3, v57
v_lshl_add_u32 v57, v55, 8, v57
v_lshl_add_u32 v58, v39, 11, v57
s_lshr_b32 s58, s3, 1
s_lshl_b32 s58, s58, 13
s_add_u32 s58, s58, 0x10000
v_add_u32 v58, s58, v58
v_mul_u32_u24 v59, 3072, v39
v_add_u32 v59, v59, v57
v_add_u32 v59, 90112, v59
v_xor_b32 v2, 0, v56
v_add_u32 v106, v2, v58
v_xor_b32 v3, 32, v56
v_add_u32 v107, v3, v58
v_xor_b32 v4, 64, v56
v_add_u32 v108, v4, v58
v_xor_b32 v5, 96, v56
v_add_u32 v109, v5, v58
v_xor_b32 v6, 128, v56
v_add_u32 v110, v6, v58
v_xor_b32 v7, 160, v56
v_add_u32 v111, v7, v58
v_xor_b32 v8, 192, v56
v_add_u32 v112, v8, v58
v_xor_b32 v9, 224, v56
v_add_u32 v113, v9, v58
s_mov_b32 s7, 1
s_cmp_eq_u32 s3, 0
s_cbranch_scc1 HOP_a_0
s_cmp_eq_u32 s3, 1
s_cbranch_scc1 HOP_a_1
s_cmp_eq_u32 s3, 2
s_cbranch_scc1 HOP_a_2
s_branch HOP_a_3
HOP_a_ret:
s_mov_b32 s7, 0
s_add_u32 m0, s65, 32768
s_add_u32 s56, s67, 128
s_nop 0
dma 96,40,56,0
dma 97,40,56,1024
dma 98,40,56,2048
dma 99,40,56,3072
s_add_u32 m0, s65, 36864
s_add_u32 s56, s67, 32896
s_nop 0
dma 96,40,56,0
dma 97,40,56,1024
dma 98,40,56,2048
dma 99,40,56,3072
s_add_u32 m0, s66, 0
s_add_u32 s57, s68, 524288
s_nop 0
dmant 100,44,57,0
dmant 101,44,57,1024
dmant 102,44,57,2048
dmant 103,44,57,3072
s_waitcnt vmcnt(12) lgkmcnt(0)
s_barrier
tv 176,106,32768
tv 178,106,33792
tv 180,106,49152
tv 182,106,50176
rv 224,104,0
rv 192,105,0
rv 196,105,2048
rv 228,104,2048
rv 232,104,4096
rv 200,105,4096
rv 204,105,6144
rv 236,104,6144
rv 240,104,8192
rv 208,105,8192
rv 212,105,10240
s_waitcnt lgkmcnt(11)
rv 244,104,10240
rv 248,104,12288
rv 216,105,12288
rv 220,105,14336
s_waitcnt lgkmcnt(11)
rv 252,104,14336
s_cmp_ge_u32 s3, 2
s_cbranch_scc1 L_p1V
s_branch L_p1K
.p2align 12
L_p1K:
HOP_a_0:
HS_a_0:
s_cmp_eq_u32 s7, 1
s_cbranch_scc1 HS_a_4
zavv 0,176,224
tv 184,107,32768
s_mov_b32 s36, s8
s_and_b32 s37, s9, 0xffff
mavv 0,180,192
s_add_u32 s57, s68, 786432
s_add_u32 m0, s66, 16384
s_mov_b32 s38, 2621440
s_mov_b32 s39, 0x20000
zavv 32,180,196
dmant 100,44,57,0
tv 186,107,33792
s_mov_b32 s48, s24
s_and_b32 s49, s25, 0xffff
mavv 32,176,228
s_waitcnt lgkmcnt(13)
s_mov_b32 s50, 3456
s_mov_b32 s51, 0x20000
v_lshrrev_b32 v34, 5, v32
zavv 8,176,232
s_waitcnt lgkmcnt(12)
tv 188,107,49152
v_and_b32 v35, 31, v32
mavv 8,180,200
s_waitcnt lgkmcnt(12)
dmant 101,44,57,1024
v_mul_u32_u24 v36, 1280, v34
zavv 40,180,204
s_waitcnt lgkmcnt(11)
tv 190,107,50176
v_lshl_add_u32 v36, v35, 3, v36
mavv 40,176,236
s_waitcnt lgkmcnt(11)
s_lshl_b32 s89, s2, 2
s_add_u32 s89, s89, s3
zavv 16,176,240
s_waitcnt lgkmcnt(10)
dmant 102,44,57,2048
s_mul_i32 s89, s89, 2560
v_lshlrev_b32 v151, 3, v39
mavv 16,180,208
s_waitcnt lgkmcnt(9)
s_lshl_b32 s90, s64, 7
s_lshl_b32 s60, s4, 8
zavv 48,180,212
s_waitcnt lgkmcnt(8)
s_mul_i32 s58, s5, 80
s_mul_i32 s59, s3, 20
mavv 48,176,244
s_waitcnt lgkmcnt(7)
dmant 103,44,57,3072
s_add_u32 s58, s58, s59
s_lshl_b32 s59, s58, 13
zavv 24,176,248
s_waitcnt lgkmcnt(6)
s_add_u32 s59, s59, s60
s_mul_i32 s58, s58, 3456
mavv 24,180,216
s_waitcnt lgkmcnt(5)
s_lshl_b32 s60, s64, 7
s_add_u32 s58, s58, s60
v_min_u32 v140, 7, v32
zavv 56,180,220
s_waitcnt lgkmcnt(4)
v_and_b32 v144, 1, v140
mavv 56,176,252
s_waitcnt lgkmcnt(2)
s_waitcnt lgkmcnt(0)
s_barrier
v_lshlrev_b32 v144, 7, v144
zavv 4,184,224
s_add_u32 s57, s68, 1048576
s_add_u32 m0, s66, 65536
tv 176,108,32768
v_lshrrev_b32 v140, 1, v140
mavv 4,188,192
dmant 100,44,57,0
v_lshl_add_u32 v140, v140, 13, v144
zavv 36,188,196
tv 178,108,33792
v_min_u32 v145, 3, v32
mavv 36,184,228
v_mul_u32_u24 v145, 3456, v145
zavv 12,184,232
dmant 101,44,57,1024
tv 180,108,49152
s_mov_b32 s84, s12
s_and_b32 s85, s13, 0xffff
mavv 12,188,200
s_mov_b32 s86, 5242880
s_mov_b32 s87, 0x20000
zavv 44,188,204
tv 182,108,50176
s_mov_b32 s93, s59
s_mov_b32 s94, s58
v_add_u32 v2, v2, v59
mavv 44,184,236
dmant 102,44,57,2048
v_add_u32 v3, v3, v59
zavv 20,184,240
v_add_u32 v4, v4, v59
mavv 20,188,208
v_add_u32 v5, v5, v59
zavv 52,188,212
dmant 103,44,57,3072
v_add_u32 v6, v6, v59
mavv 52,184,244
v_add_u32 v7, v7, v59
zavv 28,184,248
s_add_u32 s57, s68, 1310720
s_add_u32 m0, s66, 81920
v_add_u32 v8, v8, v59
mavv 28,188,216
dmant 100,44,57,0
v_add_u32 v9, v9, v59
zavv 60,188,220
v_add_u32 v160, 0x10000, v106
mavv 60,184,252
s_waitcnt lgkmcnt(2)
v_add_u32 v161, 0x10000, v107
zavv 64,176,224
s_waitcnt lgkmcnt(0)
dmant 101,44,57,1024
tv 184,109,32768
v_add_u32 v162, 0x10000, v108
mavv 64,180,192
v_add_u32 v163, 0x10000, v109
zavv 96,180,196
tv 186,109,33792
v_add_u32 v164, 0x10000, v110
mavv 96,176,228
dmant 102,44,57,2048
v_add_u32 v165, 0x10000, v111
zavv 72,176,232
tv 188,109,49152
v_add_u32 v166, 0x10000, v112
mavv 72,180,200
v_add_u32 v167, 0x10000, v113
zavv 104,180,204
dmant 103,44,57,3072
tv 190,109,50176
v_lshrrev_b32 v60, 1, v55
mavv 104,176,236
v_and_b32 v61, 1, v39
zavv 80,176,240
s_add_u32 s56, s67, 256
s_add_u32 m0, s65, 0
v_lshl_add_u32 v60, v61, 1, v60
mavv 80,180,208
dma 96,40,56,0
v_lshlrev_b32 v60, 5, v60
zavv 112,180,212
v_and_b32 v61, 3, v32
mavv 112,176,244
v_lshlrev_b32 v61, 3, v61
zavv 88,176,248
dma 97,40,56,1024
v_lshl_add_u32 v61, v55, 7, v61
mavv 88,180,216
v_mul_u32_u24 v62, 3072, v39
zavv 120,180,220
v_add3_u32 v61, v61, v62, 0
mavv 120,176,252
s_waitcnt lgkmcnt(2)
dma 98,40,56,2048
v_add_u32 v61, 92160, v61
zavv 68,184,224
s_waitcnt lgkmcnt(0)
tv 176,110,32768
v_xor_b32 v62, 0, v60
mavv 68,188,192
v_add_u32 v10, v62, v61
zavv 100,188,196
dma 99,40,56,3072
tv 178,110,33792
v_xor_b32 v62, 32, v60
mavv 100,184,228
v_add_u32 v11, v62, v61
zavv 76,184,232
s_add_u32 s56, s67, 33024
s_add_u32 m0, s65, 4096
tv 180,110,49152
v_xor_b32 v62, 64, v60
mavv 76,188,200
dma 96,40,56,0
v_add_u32 v12, v62, v61
zavv 108,188,204
tv 182,110,50176
v_xor_b32 v62, 96, v60
mavv 108,184,236
v_add_u32 v13, v62, v61
zavv 84,184,240
dma 97,40,56,1024
s_mul_i32 s88, s88, 0x9E3779B1
s_add_u32 s88, s88, 0x7F4A7C15
mavv 84,188,208
s_cmp_eq_u32 s3, 0
s_cselect_b32 s71, s88, 0
v_lshrrev_b32 v88, 1, v35
zavv 116,188,212
v_mul_u32_u24 v88, 144, v88
mavv 116,184,244
dma 98,40,56,2048
v_and_b32 v89, 1, v35
zavv 92,184,248
v_lshl_add_u32 v88, v89, 3, v88
mavv 92,188,216
v_lshl_add_u32 v88, v34, 4, v88
zavv 124,188,220
dma 99,40,56,3072
s_lshl_b32 s58, s3, 5
s_add_u32 s58, s58, 0x20000
v_add_u32 v76, s58, v88
mavv 124,184,252
s_waitcnt lgkmcnt(2)
v_lshlrev_b32 v126, 8, v37
zavv 128,176,224
s_waitcnt lgkmcnt(0)
tv 184,111,32768
v_lshl_add_u32 v126, v38, 4, v126
mavv 128,180,192
buffer_load_dwordx2 v[40:41], v36, s[36:39], s89 offen offset:0
s_lshr_b32 s80, s2, 1
s_mul_i32 s80, s80, 20480
zavv 160,180,196
tv 186,111,33792
s_and_b32 s59, s2, 1
s_lshl_b32 s59, s59, 7
mavv 160,176,228
s_add_u32 s80, s80, s59
s_lshl_b32 s59, s3, 11
zavv 136,176,232
buffer_load_dwordx2 v[42:43], v36, s[36:39], s89 offen offset:256
tv 188,111,49152
s_add_u32 s80, s80, s59
s_add_u32 s80, s80, 65536
mavv 136,180,200
s_add_u32 s81, s80, 8192
s_add_u32 s82, s80, 16384
zavv 168,180,204
tv 190,111,50176
s_cmp_ge_u32 s3, 2
s_cselect_b32 s82, 94371840, s82
mavv 168,176,236
buffer_load_dwordx2 v[44:45], v36, s[36:39], s89 offen offset:512
s_mul_i32 s61, s3, 1152
s_add_u32 s61, s61, 0x20000
v_mul_u32_u24 v77, 144, v37
zavv 144,176,240
v_lshl_add_u32 v77, v38, 4, v77
mavv 144,180,208
v_add_u32 v77, s61, v77
zavv 176,180,212
buffer_load_dwordx2 v[46:47], v36, s[36:39], s89 offen offset:768
s_lshl_b32 s72, s4, 3
s_add_u32 s72, s72, s5
mavv 176,176,244
s_mul_i32 s72, s72, 128
s_add_u32 s72, s72, 88145920
zavv 152,176,248
s_lshl_b32 s73, s5, 5
s_add_u32 s73, s73, s4
mavv 152,180,216
buffer_load_dwordx2 v[48:49], v36, s[36:39], s89 offen offset:1024
s_mul_i32 s73, s73, 128
s_add_u32 s73, s73, 88178688
zavv 184,180,220
s_mul_i32 s74, s2, 128
s_add_u32 s74, s74, 88113152
mavv 184,176,252
s_waitcnt lgkmcnt(2)
s_sub_u32 s75, s64, 27
s_mul_i32 s61, s6, 5
zavv 132,184,224
s_waitcnt lgkmcnt(0)
buffer_load_dwordx2 v[114:115], v151, s[48:51], s90 offen offset:0
tv 176,112,32768
s_add_u32 s75, s75, s61
v_mov_b32 v91, 0
mavv 132,188,192
v_mov_b32 v92, 0x10000000
zavv 164,188,196
tv 178,112,33792
v_lshl_add_u32 v93, v33, 6, v32
mavv 164,184,228
buffer_load_dwordx2 v[116:117], v151, s[48:51], s90 offen offset:32
v_cmp_eq_u32 vcc, 0, v93
v_mov_b32 v23, s88
v_and_b32 v127, 15, v32
v_cndmask_b32 v21, v92, v91, vcc
zavv 140,184,232
tv 180,112,49152
s_lshl_b32 s61, s5, 4
s_sub_u32 s60, 240, s61
v_and_b32 v93, 16, v32
mavv 140,188,200
v_cmp_eq_u32 vcc, 0, v93
v_mov_b32 v91, s61
v_mov_b32 v92, s60
v_cndmask_b32 v91, v92, v91, vcc
zavv 172,188,204
buffer_load_dwordx2 v[118:119], v151, s[48:51], s90 offen offset:64
tv 182,112,50176
v_add_u32 v127, v127, v91
mavv 172,184,236
v_lshlrev_b32 v127, 7, v127
zavv 148,184,240
s_mul_i32 s70, s4, 524288
s_lshl_b32 s58, s5, 16
mavv 148,188,208
buffer_load_dwordx2 v[120:121], v151, s[48:51], s90 offen offset:96
s_add_u32 s70, s70, s58
s_and_b32 s58, s3, 1
zavv 180,188,212
s_lshl_b32 s58, s58, 15
s_add_u32 s70, s70, s58
mavv 180,184,244
s_cmp_ge_u32 s3, 2
s_cselect_b32 s58, 17825792, 0
zavv 156,184,248
s_add_u32 s70, s70, s58
s_add_u32 s70, s70, 4194304
mavv 156,188,216
s_lshl_b32 s58, s3, 12
v_add_u32 v1, s58, v0
zavv 188,188,220
s_and_b32 s58, s3, 1
s_lshl_b32 s59, s58, 7
v_xor_b32 v94, s59, v100
mavv 188,184,252
s_waitcnt lgkmcnt(2)
s_lshl_b32 s59, s3, 16
s_lshl_b32 s60, s4, 8
zavv 192,176,224
s_waitcnt lgkmcnt(0)
tv 184,113,32768
s_add_u32 s59, s59, s60
v_add_u32 v18, s59, v94
mavv 192,180,192
v_add_u32 v19, 31744, v18
zavv 224,180,196
tv 186,113,33792
v_and_b32 v94, 1, v39
mavv 224,176,228
v_lshlrev_b32 v94, 1, v94
zavv 200,176,232
tv 188,113,49152
s_lshl_b32 s59, s58, 2
v_or_b32 v94, s59, v94
mavv 200,180,200
v_xor_b32 v94, v94, v38
zavv 232,180,204
tv 190,113,50176
v_lshlrev_b32 v94, 4, v94
mavv 232,176,236
v_mul_u32_u24 v95, 3456, v37
zavv 208,176,240
v_add_u32 v94, v94, v95
mavv 208,180,208
s_mul_i32 s59, s3, 27648
s_lshl_b32 s60, s64, 7
zavv 240,180,212
s_add_u32 s59, s59, s60
v_add_u32 v20, s59, v94
mavv 240,176,244
s_lshl_b32 s76, s5, 3
s_add_u32 s76, s76, s3
zavv 216,176,248
s_mul_i32 s76, s76, 20480
s_sub_u32 s77, 15, s5
mavv 216,180,216
s_lshl_b32 s77, s77, 3
s_add_u32 s77, s77, s3
zavv 248,180,220
s_mul_i32 s77, s77, 20480
v_add_u32 v14, s76, v0
mavv 248,176,252
s_waitcnt lgkmcnt(2)
s_waitcnt vmcnt(25) lgkmcnt(0)
s_barrier
v_add_u32 v15, 80896, v14
zavv 196,184,224
s_add_u32 s57, s68, 1572864
s_add_u32 m0, s66, 32768
tv 176,106,0
rv 224,104,32768
v_add_u32 v16, s77, v0
mavv 196,188,192
dmant 100,44,57,0
rv 192,105,32768
v_add_u32 v17, 78848, v16
zavv 228,188,196
tv 178,106,1024
rv 196,105,34816
v_subrev_u32 v16, 2048, v16
mavv 228,184,228
rv 228,104,34816
zavv 204,184,232
dmant 101,44,57,1024
tv 180,106,16384
rv 232,104,36864
mavv 204,188,200
rv 200,105,36864
zavv 236,188,204
tv 182,106,17408
rv 204,105,38912
mavv 236,184,236
dmant 102,44,57,2048
rv 236,104,38912
zavv 212,184,240
rv 240,104,40960
mavv 212,188,208
rv 208,105,40960
zavv 244,188,212
dmant 103,44,57,3072
rv 212,105,43008
mavv 244,184,244
s_waitcnt lgkmcnt(11)
rv 244,104,43008
zavv 220,184,248
s_add_u32 s57, s68, 1835008
s_add_u32 m0, s66, 49152
rv 248,104,45056
mavv 220,188,216
dmant 100,44,57,0
rv 216,105,45056
zavv 252,188,220
rv 220,105,47104
mavv 252,184,252
s_waitcnt lgkmcnt(11)
rv 252,104,47104
mavv 0,176,224
s_waitcnt lgkmcnt(10)
dmant 101,44,57,1024
tv 184,107,0
mavv 0,180,192
mavv 32,180,196
tv 186,107,1024
mavv 32,176,228
dmant 102,44,57,2048
mavv 8,176,232
tv 188,107,16384
mavv 8,180,200
s_waitcnt lgkmcnt(12)
mavv 40,180,204
s_waitcnt lgkmcnt(11)
dmant 103,44,57,3072
tv 190,107,17408
mavv 40,176,236
s_waitcnt lgkmcnt(11)
mavv 16,176,240
s_waitcnt lgkmcnt(10)
s_waitcnt vmcnt(16)
v_lshlrev_b32 v50, 16, v40
mavv 16,180,208
s_waitcnt lgkmcnt(9)
v_and_b32 v51, 0xffff0000, v40
mavv 48,180,212
s_waitcnt lgkmcnt(8)
v_lshlrev_b32 v52, 16, v41
mavv 48,176,244
s_waitcnt lgkmcnt(7)
v_and_b32 v53, 0xffff0000, v41
mavv 24,176,248
s_waitcnt lgkmcnt(6)
s_waitcnt vmcnt(15)
v_lshlrev_b32 v54, 16, v42
mavv 24,180,216
s_waitcnt lgkmcnt(5)
v_and_b32 v55, 0xffff0000, v42
mavv 56,180,220
s_waitcnt lgkmcnt(4)
v_lshlrev_b32 v56, 16, v43
mavv 56,176,252
s_waitcnt lgkmcnt(2)
s_waitcnt lgkmcnt(0)
s_barrier
v_and_b32 v57, 0xffff0000, v43
mavv 4,184,224
s_add_u32 s56, s67, 384
s_add_u32 m0, s65, 32768
tv 176,108,0
s_waitcnt vmcnt(14)
v_lshlrev_b32 v58, 16, v44
mavv 4,188,192
dma 96,40,56,0
v_and_b32 v59, 0xffff0000, v44
mavv 36,188,196
tv 178,108,1024
v_lshlrev_b32 v60, 16, v45
mavv 36,184,228
v_and_b32 v61, 0xffff0000, v45
mavv 12,184,232
tv 180,108,16384
s_waitcnt vmcnt(14)
v_lshlrev_b32 v62, 16, v46
mavv 12,188,200
v_and_b32 v63, 0xffff0000, v46
mavv 44,188,204
dma 97,40,56,1024
tv 182,108,17408
v_lshlrev_b32 v64, 16, v47
mavv 44,184,236
v_and_b32 v65, 0xffff0000, v47
mavv 20,184,240
s_waitcnt vmcnt(14)
v_lshlrev_b32 v66, 16, v48
mavv 20,188,208
v_and_b32 v67, 0xffff0000, v48
mavv 52,188,212
v_lshlrev_b32 v68, 16, v49
mavv 52,184,244
dma 98,40,56,2048
v_and_b32 v69, 0xffff0000, v49
mavv 28,184,248
v_add_f32 v70, v50, v51
mavv 28,188,216
v_add_f32 v70, v70, v52
mavv 60,188,220
v_add_f32 v70, v70, v53
mavv 60,184,252
s_waitcnt lgkmcnt(2)
v_add_f32 v70, v70, v54
mavv 64,176,224
s_waitcnt lgkmcnt(0)
dma 99,40,56,3072
tv 184,109,0
v_add_f32 v70, v70, v55
mavv 64,180,192
v_add_f32 v70, v70, v56
mavv 96,180,196
tv 186,109,1024
v_add_f32 v70, v70, v57
mavv 96,176,228
v_add_f32 v70, v70, v58
mavv 72,176,232
s_add_u32 s56, s67, 33152
s_add_u32 m0, s65, 36864
tv 188,109,16384
v_add_f32 v70, v70, v59
mavv 72,180,200
dma 96,40,56,0
v_add_f32 v70, v70, v60
mavv 104,180,204
tv 190,109,17408
v_add_f32 v70, v70, v61
mavv 104,176,236
v_add_f32 v70, v70, v62
mavv 80,176,240
v_add_f32 v70, v70, v63
mavv 80,180,208
v_add_f32 v70, v70, v64
mavv 112,180,212
dma 97,40,56,1024
v_add_f32 v70, v70, v65
mavv 112,176,244
v_add_f32 v70, v70, v66
mavv 88,176,248
v_add_f32 v70, v70, v67
mavv 88,180,216
v_add_f32 v70, v70, v68
mavv 120,180,220
v_add_f32 v70, v70, v69
mavv 120,176,252
s_waitcnt lgkmcnt(2)
dma 98,40,56,2048
s_nop 0
v_add_f32_dpp v70, v70, v70 quad_perm:[1,0,3,2] row_mask:0xf bank_mask:0xf
mavv 68,184,224
s_waitcnt lgkmcnt(0)
tv 176,110,0
s_nop 0
v_add_f32_dpp v70, v70, v70 quad_perm:[2,3,0,1] row_mask:0xf bank_mask:0xf
mavv 68,188,192
s_nop 0
v_add_f32_dpp v70, v70, v70 row_half_mirror row_mask:0xf bank_mask:0xf
mavv 100,188,196
tv 178,110,1024
s_nop 0
v_add_f32_dpp v70, v70, v70 row_mirror row_mask:0xf bank_mask:0xf
mavv 100,184,228
v_mov_b32 v71, v70
mavv 76,184,232
dma 99,40,56,3072
tv 180,110,16384
s_nop 0
v_permlane16_swap_b32 v70, v71
mavv 76,188,200
v_add_f32 v70, v70, v71
mavv 108,188,204
tv 182,110,17408
v_mul_f32 v70, 0x3acccccd, v70
mavv 108,184,236
v_sub_f32 v50, v50, v70
mavv 84,184,240
v_sub_f32 v51, v51, v70
mavv 84,188,208
buffer_load_dword v149, v140, s[84:87], s93 offen
v_sub_f32 v52, v52, v70
mavv 116,188,212
v_sub_f32 v53, v53, v70
mavv 116,184,244
v_sub_f32 v54, v54, v70
mavv 92,184,248
v_sub_f32 v55, v55, v70
mavv 92,188,216
s_mov_b32 s48, s22
s_and_b32 s49, s23, 0xffff
s_mov_b32 s50, 2211840
s_mov_b32 s51, 0x20000
v_sub_f32 v56, v56, v70
mavv 124,188,220
buffer_load_dword v150, v145, s[48:51], s94 offen
v_sub_f32 v57, v57, v70
mavv 124,184,252
s_waitcnt lgkmcnt(2)
v_sub_f32 v58, v58, v70
mavv 128,176,224
HOP_a_1:
HS_a_1:
s_cmp_eq_u32 s7, 1
s_cbranch_scc1 HS_a_5
s_waitcnt lgkmcnt(0)
tv 184,111,0
v_sub_f32 v59, v59, v70
mavv 128,180,192
v_sub_f32 v60, v60, v70
mavv 160,180,196
s_add_u32 s93, s93, 32768
tv 186,111,1024
v_sub_f32 v61, v61, v70
mavv 160,176,228
buffer_load_dword v149, v140, s[84:87], s93 offen
v_sub_f32 v62, v62, v70
mavv 136,176,232
tv 188,111,16384
v_sub_f32 v63, v63, v70
mavv 136,180,200
v_sub_f32 v64, v64, v70
mavv 168,180,204
tv 190,111,17408
v_sub_f32 v65, v65, v70
mavv 168,176,236
s_add_u32 s94, s94, 13824
v_sub_f32 v66, v66, v70
mavv 144,176,240
buffer_load_dword v150, v145, s[48:51], s94 offen
v_sub_f32 v67, v67, v70
mavv 144,180,208
v_sub_f32 v68, v68, v70
mavv 176,180,212
v_sub_f32 v69, v69, v70
mavv 176,176,244
v_mul_f32 v72, v50, v50
mavv 152,176,248
v_fmac_f32 v72, v51, v51
mavv 152,180,216
v_fmac_f32 v72, v52, v52
mavv 184,180,220
v_fmac_f32 v72, v53, v53
mavv 184,176,252
s_waitcnt lgkmcnt(2)
v_fmac_f32 v72, v54, v54
mavv 132,184,224
s_waitcnt lgkmcnt(0)
tv 176,112,0
v_fmac_f32 v72, v55, v55
mavv 132,188,192
v_fmac_f32 v72, v56, v56
mavv 164,188,196
tv 178,112,1024
v_fmac_f32 v72, v57, v57
mavv 164,184,228
v_fmac_f32 v72, v58, v58
mavv 140,184,232
tv 180,112,16384
v_fmac_f32 v72, v59, v59
mavv 140,188,200
v_fmac_f32 v72, v60, v60
mavv 172,188,204
tv 182,112,17408
v_fmac_f32 v72, v61, v61
mavv 172,184,236
v_fmac_f32 v72, v62, v62
mavv 148,184,240
v_fmac_f32 v72, v63, v63
mavv 148,188,208
v_fmac_f32 v72, v64, v64
mavv 180,188,212
v_fmac_f32 v72, v65, v65
mavv 180,184,244
v_fmac_f32 v72, v66, v66
mavv 156,184,248
v_fmac_f32 v72, v67, v67
mavv 156,188,216
v_fmac_f32 v72, v68, v68
mavv 188,188,220
v_fmac_f32 v72, v69, v69
mavv 188,184,252
s_waitcnt lgkmcnt(2)
s_nop 0
v_add_f32_dpp v72, v72, v72 quad_perm:[1,0,3,2] row_mask:0xf bank_mask:0xf
mavv 192,176,224
s_waitcnt lgkmcnt(0)
tv 184,113,0
s_nop 0
v_add_f32_dpp v72, v72, v72 quad_perm:[2,3,0,1] row_mask:0xf bank_mask:0xf
mavv 192,180,192
s_nop 0
v_add_f32_dpp v72, v72, v72 row_half_mirror row_mask:0xf bank_mask:0xf
mavv 224,180,196
tv 186,113,1024
s_nop 0
v_add_f32_dpp v72, v72, v72 row_mirror row_mask:0xf bank_mask:0xf
mavv 224,176,228
v_mov_b32 v73, v72
mavv 200,176,232
tv 188,113,16384
s_nop 0
v_permlane16_swap_b32 v72, v73
mavv 200,180,200
v_add_f32 v72, v72, v73
mavv 232,180,204
tv 190,113,17408
v_mov_b32 v73, 0x3727c5ac
mavv 232,176,236
v_fmac_f32 v73, 0x3acccccd, v72
mavv 208,176,240
v_rsq_f32 v73, v73
mavv 208,180,208
v_mul_f32 v73, 0x3e0293ee, v73
mavv 240,180,212
v_mul_f32 v50, v50, v73
mavv 240,176,244
v_mul_f32 v51, v51, v73
mavv 216,176,248
v_mul_f32 v52, v52, v73
mavv 216,180,216
v_mul_f32 v53, v53, v73
mavv 248,180,220
v_mul_f32 v54, v54, v73
mavv 248,176,252
s_waitcnt lgkmcnt(2)
s_waitcnt lgkmcnt(0)
s_barrier
v_mul_f32 v55, v55, v73
mavv 196,184,224
s_add_u32 s57, s68, 2097152
s_add_u32 m0, s66, 0
tv 176,160,0
rv 224,104,0
v_mul_f32 v56, v56, v73
mavv 196,188,192
dmant 100,44,57,0
rv 192,105,0
v_mul_f32 v57, v57, v73
mavv 228,188,196
tv 178,160,1024
rv 196,105,2048
v_mul_f32 v58, v58, v73
mavv 228,184,228
rv 228,104,2048
v_mul_f32 v59, v59, v73
mavv 204,184,232
dmant 101,44,57,1024
tv 180,160,16384
rv 232,104,4096
v_mul_f32 v60, v60, v73
mavv 204,188,200
rv 200,105,4096
v_mul_f32 v61, v61, v73
mavv 236,188,204
tv 182,160,17408
rv 204,105,6144
v_mul_f32 v62, v62, v73
mavv 236,184,236
dmant 102,44,57,2048
rv 236,104,6144
v_mul_f32 v63, v63, v73
mavv 212,184,240
rv 240,104,8192
v_mul_f32 v64, v64, v73
mavv 212,188,208
rv 208,105,8192
v_mul_f32 v65, v65, v73
mavv 244,188,212
dmant 103,44,57,3072
rv 212,105,10240
v_mul_f32 v66, v66, v73
mavv 244,184,244
s_waitcnt lgkmcnt(11)
rv 244,104,10240
v_mul_f32 v67, v67, v73
mavv 220,184,248
s_add_u32 s57, s68, 2359296
s_add_u32 m0, s66, 16384
rv 248,104,12288
v_mul_f32 v68, v68, v73
mavv 220,188,216
dmant 100,44,57,0
rv 216,105,12288
v_mul_f32 v69, v69, v73
mavv 252,188,220
rv 220,105,14336
cv 40,50,51
mavv 252,184,252
s_waitcnt lgkmcnt(11)
rv 252,104,14336
cv 41,52,53
mavv 0,176,224
s_waitcnt lgkmcnt(10)
dmant 101,44,57,1024
tv 184,161,0
cv 42,54,55
mavv 0,180,192
cv 43,56,57
mavv 32,180,196
tv 186,161,1024
cv 44,58,59
mavv 32,176,228
dmant 102,44,57,2048
cv 45,60,61
mavv 8,176,232
tv 188,161,16384
cv 46,62,63
mavv 8,180,200
s_waitcnt lgkmcnt(12)
cv 47,64,65
mavv 40,180,204
s_waitcnt lgkmcnt(11)
dmant 103,44,57,3072
tv 190,161,17408
cv 48,66,67
mavv 40,176,236
s_waitcnt lgkmcnt(11)
cv 49,68,69
mavv 16,176,240
s_waitcnt lgkmcnt(10)
mavv 16,180,208
s_waitcnt lgkmcnt(9)
mavv 48,180,212
s_waitcnt lgkmcnt(8)
mavv 48,176,244
s_waitcnt lgkmcnt(7)
mavv 24,176,248
s_waitcnt lgkmcnt(6)
mavv 24,180,216
s_waitcnt lgkmcnt(5)
mavv 56,180,220
s_waitcnt lgkmcnt(4)
mavv 56,176,252
s_waitcnt lgkmcnt(2)
s_waitcnt lgkmcnt(0)
s_barrier
mavv 4,184,224
s_add_u32 s56, s67, 512
s_add_u32 m0, s65, 0
tv 176,162,0
mavv 4,188,192
dma 96,40,56,0
mavv 36,188,196
tv 178,162,1024
mavv 36,184,228
mavv 12,184,232
tv 180,162,16384
mavv 12,188,200
mavv 44,188,204
dma 97,40,56,1024
tv 182,162,17408
mavv 44,184,236
mavv 20,184,240
mavv 20,188,208
mavv 52,188,212
mavv 52,184,244
dma 98,40,56,2048
mavv 28,184,248
mavv 28,188,216
mavv 60,188,220
mavv 60,184,252
s_waitcnt lgkmcnt(2)
mavv 64,176,224
s_waitcnt lgkmcnt(0)
dma 99,40,56,3072
tv 184,163,0
mavv 64,180,192
mavv 96,180,196
tv 186,163,1024
mavv 96,176,228
mavv 72,176,232
s_add_u32 s56, s67, 33280
s_add_u32 m0, s65, 4096
tv 188,163,16384
mavv 72,180,200
dma 96,40,56,0
mavv 104,180,204
tv 190,163,17408
mavv 104,176,236
mavv 80,176,240
mavv 80,180,208
mavv 112,180,212
dma 97,40,56,1024
mavv 112,176,244
mavv 88,176,248
mavv 88,180,216
mavv 120,180,220
mavv 120,176,252
s_waitcnt lgkmcnt(2)
dma 98,40,56,2048
mavv 68,184,224
s_waitcnt lgkmcnt(0)
tv 176,164,0
mavv 68,188,192
mavv 100,188,196
tv 178,164,1024
mavv 100,184,228
mavv 76,184,232
dma 99,40,56,3072
tv 180,164,16384
mavv 76,188,200
mavv 108,188,204
tv 182,164,17408
mavv 108,184,236
mavv 84,184,240
s_add_u32 s93, s93, 32768
mavv 84,188,208
buffer_load_dword v149, v140, s[84:87], s93 offen
mavv 116,188,212
mavv 116,184,244
mavv 92,184,248
mavv 92,188,216
s_add_u32 s94, s94, 13824
mavv 124,188,220
buffer_load_dword v150, v145, s[48:51], s94 offen
mavv 124,184,252
s_waitcnt lgkmcnt(2)
mavv 128,176,224
s_waitcnt lgkmcnt(0)
tv 184,165,0
mavv 128,180,192
mavv 160,180,196
s_add_u32 s93, s93, 32768
tv 186,165,1024
mavv 160,176,228
buffer_load_dword v149, v140, s[84:87], s93 offen
mavv 136,176,232
tv 188,165,16384
mavv 136,180,200
mavv 168,180,204
tv 190,165,17408
mavv 168,176,236
s_add_u32 s94, s94, 13824
mavv 144,176,240
buffer_load_dword v150, v145, s[48:51], s94 offen
mavv 144,180,208
mavv 176,180,212
mavv 176,176,244
mavv 152,176,248
mavv 152,180,216
mavv 184,180,220
mavv 184,176,252
s_waitcnt lgkmcnt(2)
mavv 132,184,224
s_waitcnt lgkmcnt(0)
tv 176,166,0
mavv 132,188,192
mavv 164,188,196
tv 178,166,1024
mavv 164,184,228
mavv 140,184,232
tv 180,166,16384
mavv 140,188,200
mavv 172,188,204
tv 182,166,17408
mavv 172,184,236
mavv 148,184,240
mavv 148,188,208
mavv 180,188,212
mavv 180,184,244
mavv 156,184,248
mavv 156,188,216
mavv 188,188,220
mavv 188,184,252
s_waitcnt lgkmcnt(2)
mavv 192,176,224
s_waitcnt lgkmcnt(0)
tv 184,167,0
mavv 192,180,192
mavv 224,180,196
tv 186,167,1024
mavv 224,176,228
mavv 200,176,232
tv 188,167,16384
mavv 200,180,200
mavv 232,180,204
tv 190,167,17408
mavv 232,176,236
mavv 208,176,240
mavv 208,180,208
mavv 240,180,212
mavv 240,176,244
mavv 216,176,248
mavv 216,180,216
mavv 248,180,220
mavv 248,176,252
s_waitcnt lgkmcnt(2)
s_waitcnt vmcnt(24) lgkmcnt(0)
s_barrier
mavv 196,184,224
s_add_u32 s93, s93, 32768
tv 176,106,32768
rv 224,104,32768
mavv 196,188,192
buffer_load_dword v149, v140, s[84:87], s93 offen
rv 192,105,32768
mavv 228,188,196
tv 178,106,33792
rv 196,105,34816
mavv 228,184,228
rv 228,104,34816
mavv 204,184,232
s_add_u32 s94, s94, 13824
tv 180,106,49152
rv 232,104,36864
mavv 204,188,200
buffer_load_dword v150, v145, s[48:51], s94 offen
rv 200,105,36864
mavv 236,188,204
tv 182,106,50176
rv 204,105,38912
mavv 236,184,236
rv 236,104,38912
mavv 212,184,240
rv 240,104,40960
mavv 212,188,208
rv 208,105,40960
mavv 244,188,212
rv 212,105,43008
mavv 244,184,244
s_waitcnt lgkmcnt(11)
rv 244,104,43008
mavv 220,184,248
rv 248,104,45056
mavv 220,188,216
rv 216,105,45056
mavv 252,188,220
rv 220,105,47104
mavv 252,184,252
s_waitcnt lgkmcnt(11)
rv 252,104,47104
mavv 0,176,224
s_waitcnt lgkmcnt(10)
tv 184,107,32768
mavv 0,180,192
ds_write_b64 v76, v[40:41] offset:0
mavv 32,180,196
tv 186,107,33792
mavv 32,176,228
ds_write_b64 v76, v[42:43] offset:2304
mavv 8,176,232
tv 188,107,49152
mavv 8,180,200
s_waitcnt lgkmcnt(14)
ds_write_b64 v76, v[44:45] offset:4608
mavv 40,180,204
s_waitcnt lgkmcnt(14)
tv 190,107,50176
mavv 40,176,236
s_waitcnt lgkmcnt(14)
ds_write_b64 v76, v[46:47] offset:6912
mavv 16,176,240
s_waitcnt lgkmcnt(14)
mavv 16,180,208
s_waitcnt lgkmcnt(13)
ds_write_b64 v76, v[48:49] offset:9216
mavv 48,180,212
s_waitcnt lgkmcnt(13)
mavv 48,176,244
s_waitcnt lgkmcnt(12)
mavv 24,176,248
s_waitcnt lgkmcnt(11)
mavv 24,180,216
s_waitcnt lgkmcnt(10)
mavv 56,180,220
s_waitcnt lgkmcnt(9)
mavv 56,176,252
s_waitcnt lgkmcnt(6)
s_waitcnt lgkmcnt(0)
s_barrier
mavv 4,184,224
s_add_u32 s56, s67, 640
s_add_u32 m0, s65, 32768
tv 176,108,32768
mavv 4,188,192
dma 96,40,56,0
mavv 36,188,196
tv 178,108,33792
mavv 36,184,228
mavv 12,184,232
tv 180,108,49152
mavv 12,188,200
dma 97,40,56,1024
mavv 44,188,204
tv 182,108,50176
mavv 44,184,236
mavv 20,184,240
mavv 20,188,208
dma 98,40,56,2048
rv 128,77,0
mavv 52,188,212
mavv 52,184,244
rv 132,77,4608
mavv 28,184,248
mavv 28,188,216
dma 99,40,56,3072
rv 136,77,9216
mavv 60,188,220
mavv 60,184,252
s_waitcnt lgkmcnt(5)
mavv 64,176,224
s_waitcnt lgkmcnt(3)
s_add_u32 s56, s67, 33408
s_add_u32 m0, s65, 36864
tv 184,109,32768
mavv 64,180,192
dma 96,40,56,0
mavv 96,180,196
tv 186,109,33792
mavv 96,176,228
mavv 72,176,232
tv 188,109,49152
mavv 72,180,200
dma 97,40,56,1024
mavv 104,180,204
tv 190,109,50176
mavv 104,176,236
mavv 80,176,240
mavv 80,180,208
dma 98,40,56,2048
mavv 112,180,212
mavv 112,176,244
mavv 88,176,248
mavv 88,180,216
dma 99,40,56,3072
mavv 120,180,220
mavv 120,176,252
s_waitcnt lgkmcnt(2)
mavv 68,184,224
s_waitcnt lgkmcnt(0)
tv 176,110,32768
mavv 68,188,192
buffer_store_dwordx4 v[128:131], v126, s[52:55], s80 offen sc1
mavv 100,188,196
tv 178,110,33792
mavv 100,184,228
mavv 76,184,232
tv 180,110,49152
mavv 76,188,200
buffer_store_dwordx4 v[132:135], v126, s[52:55], s81 offen sc1
mavv 108,188,204
tv 182,110,50176
mavv 108,184,236
mavv 84,184,240
mavv 84,188,208
buffer_store_dwordx4 v[136:139], v126, s[52:55], s82 offen sc1
mavv 116,188,212
mavv 116,184,244
mavv 92,184,248
mavv 92,188,216
mavv 124,188,220
mavv 124,184,252
s_waitcnt lgkmcnt(2)
mavv 128,176,224
s_waitcnt lgkmcnt(0)
tv 184,111,32768
mavv 128,180,192
mavv 160,180,196
tv 186,111,33792
mavv 160,176,228
mavv 136,176,232
tv 188,111,49152
mavv 136,180,200
mavv 168,180,204
tv 190,111,50176
mavv 168,176,236
mavv 144,176,240
mavv 144,180,208
mavv 176,180,212
mavv 176,176,244
mavv 152,176,248
mavv 152,180,216
mavv 184,180,220
mavv 184,176,252
s_waitcnt lgkmcnt(2)
mavv 132,184,224
HOP_a_2:
HS_a_2:
s_cmp_eq_u32 s7, 1
s_cbranch_scc1 HS_a_6
s_waitcnt lgkmcnt(0)
tv 176,112,32768
mavv 132,188,192
mavv 164,188,196
tv 178,112,33792
mavv 164,184,228
mavv 140,184,232
tv 180,112,49152
mavv 140,188,200
mavv 172,188,204
tv 182,112,50176
mavv 172,184,236
mavv 148,184,240
mavv 148,188,208
mavv 180,188,212
mavv 180,184,244
mavv 156,184,248
mavv 156,188,216
mavv 188,188,220
mavv 188,184,252
s_waitcnt lgkmcnt(2)
mavv 192,176,224
s_waitcnt lgkmcnt(0)
tv 184,113,32768
mavv 192,180,192
mavv 224,180,196
tv 186,113,33792
mavv 224,176,228
mavv 200,176,232
tv 188,113,49152
mavv 200,180,200
mavv 232,180,204
tv 190,113,50176
mavv 232,176,236
mavv 208,176,240
mavv 208,180,208
mavv 240,180,212
mavv 240,176,244
mavv 216,176,248
mavv 216,180,216
mavv 248,180,220
mavv 248,176,252
s_waitcnt lgkmcnt(2)
s_waitcnt vmcnt(17) lgkmcnt(0)
s_barrier
mavv 196,184,224
s_add_u32 s57, s68, 2621440
s_add_u32 m0, s66, 65536
tv 176,106,0
rv 224,104,0
mavv 196,188,192
dmant 100,44,57,0
rv 192,105,0
mavv 228,188,196
tv 178,106,1024
rv 196,105,2048
mavv 228,184,228
rv 228,104,2048
mavv 204,184,232
dmant 101,44,57,1024
tv 180,106,16384
rv 232,104,4096
mavv 204,188,200
rv 200,105,4096
mavv 236,188,204
tv 182,106,17408
rv 204,105,6144
mavv 236,184,236
dmant 102,44,57,2048
rv 236,104,6144
mavv 212,184,240
rv 240,104,8192
mavv 212,188,208
rv 208,105,8192
mavv 244,188,212
dmant 103,44,57,3072
rv 212,105,10240
mavv 244,184,244
s_waitcnt lgkmcnt(11)
rv 244,104,10240
mavv 220,184,248
s_add_u32 s57, s68, 2883584
s_add_u32 m0, s66, 81920
rv 248,104,12288
mavv 220,188,216
dmant 100,44,57,0
rv 216,105,12288
mavv 252,188,220
rv 220,105,14336
mavv 252,184,252
s_waitcnt lgkmcnt(11)
rv 252,104,14336
mavv 0,176,224
s_waitcnt lgkmcnt(10)
dmant 101,44,57,1024
tv 184,107,0
mavv 0,180,192
mavv 32,180,196
tv 186,107,1024
mavv 32,176,228
dmant 102,44,57,2048
mavv 8,176,232
tv 188,107,16384
mavv 8,180,200
s_waitcnt lgkmcnt(12)
mavv 40,180,204
s_waitcnt lgkmcnt(11)
dmant 103,44,57,3072
tv 190,107,17408
mavv 40,176,236
s_waitcnt lgkmcnt(11)
mavv 16,176,240
s_waitcnt lgkmcnt(10)
mavv 16,180,208
s_waitcnt lgkmcnt(9)
mavv 48,180,212
s_waitcnt lgkmcnt(8)
mavv 48,176,244
s_waitcnt lgkmcnt(7)
mavv 24,176,248
s_waitcnt lgkmcnt(6)
mavv 24,180,216
s_waitcnt lgkmcnt(5)
mavv 56,180,220
s_waitcnt lgkmcnt(4)
mavv 56,176,252
s_waitcnt lgkmcnt(2)
s_waitcnt vmcnt(8) lgkmcnt(0)
s_barrier
mavv 4,184,224
tv 176,108,0
mavv 4,188,192
buffer_store_dword v23, v21, s[52:55], s74 offen sc1
mavv 36,188,196
tv 178,108,1024
mavv 36,184,228
mavv 12,184,232
s_add_u32 s57, s68, 3145728
s_add_u32 m0, s66, 32768
tv 180,108,16384
v_lshlrev_b32 v80, 16, v114
mavv 12,188,200
dmant 100,44,57,0
mavv 44,188,204
tv 182,108,17408
v_and_b32 v81, 0xffff0000, v114
mavv 44,184,236
mavv 20,184,240
v_mul_f32 v80, 0x3e0293ee, v80
mavv 20,188,208
dmant 101,44,57,1024
mavv 52,188,212
v_mul_f32 v81, 0x3e0293ee, v81
mavv 52,184,244
mavv 28,184,248
v_lshlrev_b32 v82, 16, v115
mavv 28,188,216
dmant 102,44,57,2048
mavv 60,188,220
v_and_b32 v83, 0xffff0000, v115
mavv 60,184,252
s_waitcnt lgkmcnt(2)
mavv 64,176,224
s_waitcnt lgkmcnt(0)
tv 184,109,0
v_mul_f32 v82, 0x3e0293ee, v82
mavv 64,180,192
dmant 103,44,57,3072
mavv 96,180,196
tv 186,109,1024
v_mul_f32 v83, 0x3e0293ee, v83
mavv 96,176,228
mavv 72,176,232
s_add_u32 s57, s68, 3407872
s_add_u32 m0, s66, 49152
tv 188,109,16384
v_lshlrev_b32 v84, 16, v116
mavv 72,180,200
dmant 100,44,57,0
mavv 104,180,204
tv 190,109,17408
v_and_b32 v85, 0xffff0000, v116
mavv 104,176,236
mavv 80,176,240
v_mul_f32 v84, 0x3e0293ee, v84
mavv 80,180,208
dmant 101,44,57,1024
mavv 112,180,212
v_mul_f32 v85, 0x3e0293ee, v85
mavv 112,176,244
mavv 88,176,248
v_lshlrev_b32 v86, 16, v117
mavv 88,180,216
dmant 102,44,57,2048
mavv 120,180,220
v_and_b32 v87, 0xffff0000, v117
mavv 120,176,252
s_waitcnt lgkmcnt(2)
mavv 68,184,224
s_waitcnt lgkmcnt(0)
tv 176,110,0
v_mul_f32 v86, 0x3e0293ee, v86
mavv 68,188,192
dmant 103,44,57,3072
mavv 100,188,196
tv 178,110,1024
v_mul_f32 v87, 0x3e0293ee, v87
mavv 100,184,228
mavv 76,184,232
s_add_u32 s56, s67, 768
s_add_u32 m0, s65, 0
tv 180,110,16384
mavv 76,188,200
dma 96,40,56,0
mavv 108,188,204
tv 182,110,17408
mavv 108,184,236
mavv 84,184,240
mavv 84,188,208
dma 97,40,56,1024
mavv 116,188,212
mavv 116,184,244
mavv 92,184,248
mavv 92,188,216
dma 98,40,56,2048
mavv 124,188,220
mavv 124,184,252
s_waitcnt lgkmcnt(2)
mavv 128,176,224
s_waitcnt lgkmcnt(0)
tv 184,111,0
mavv 128,180,192
dma 99,40,56,3072
mavv 160,180,196
tv 186,111,1024
mavv 160,176,228
mavv 136,176,232
s_add_u32 s56, s67, 33536
s_add_u32 m0, s65, 4096
tv 188,111,16384
mavv 136,180,200
dma 96,40,56,0
mavv 168,180,204
tv 190,111,17408
mavv 168,176,236
mavv 144,176,240
mavv 144,180,208
dma 97,40,56,1024
mavv 176,180,212
mavv 176,176,244
mavv 152,176,248
mavv 152,180,216
dma 98,40,56,2048
mavv 184,180,220
mavv 184,176,252
s_waitcnt lgkmcnt(2)
mavv 132,184,224
s_waitcnt lgkmcnt(0)
tv 176,112,0
mavv 132,188,192
dma 99,40,56,3072
mavv 164,188,196
tv 178,112,1024
mavv 164,184,228
mavv 140,184,232
tv 180,112,16384
v_lshlrev_b32 v88, 16, v118
mavv 140,188,200
mavv 172,188,204
tv 182,112,17408
v_and_b32 v89, 0xffff0000, v118
mavv 172,184,236
mavv 148,184,240
v_mul_f32 v88, 0x3e0293ee, v88
mavv 148,188,208
mavv 180,188,212
v_mul_f32 v89, 0x3e0293ee, v89
mavv 180,184,244
mavv 156,184,248
v_lshlrev_b32 v90, 16, v119
mavv 156,188,216
mavv 188,188,220
v_and_b32 v91, 0xffff0000, v119
mavv 188,184,252
s_waitcnt lgkmcnt(2)
mavv 192,176,224
s_waitcnt lgkmcnt(0)
tv 184,113,0
v_mul_f32 v90, 0x3e0293ee, v90
mavv 192,180,192
mavv 224,180,196
tv 186,113,1024
v_mul_f32 v91, 0x3e0293ee, v91
mavv 224,176,228
mavv 200,176,232
tv 188,113,16384
v_lshlrev_b32 v92, 16, v120
mavv 200,180,200
mavv 232,180,204
tv 190,113,17408
v_and_b32 v93, 0xffff0000, v120
mavv 232,176,236
mavv 208,176,240
v_mul_f32 v92, 0x3e0293ee, v92
mavv 208,180,208
mavv 240,180,212
v_mul_f32 v93, 0x3e0293ee, v93
mavv 240,176,244
mavv 216,176,248
v_lshlrev_b32 v94, 16, v121
mavv 216,180,216
mavv 248,180,220
v_and_b32 v95, 0xffff0000, v121
mavv 248,176,252
s_waitcnt lgkmcnt(2)
s_waitcnt vmcnt(17) lgkmcnt(0)
s_barrier
mavv 196,184,224
s_add_u32 s57, s68, 3670016
s_add_u32 m0, s66, 0
tv 176,160,0
rv 224,104,32768
v_mul_f32 v94, 0x3e0293ee, v94
mavv 196,188,192
dmant 100,44,57,0
rv 192,105,32768
mavv 228,188,196
tv 178,160,1024
rv 196,105,34816
v_mul_f32 v95, 0x3e0293ee, v95
mavv 228,184,228
rv 228,104,34816
mavv 204,184,232
dmant 101,44,57,1024
tv 180,160,16384
rv 232,104,36864
mavv 204,188,200
rv 200,105,36864
mavv 236,188,204
tv 182,160,17408
rv 204,105,38912
mavv 236,184,236
dmant 102,44,57,2048
rv 236,104,38912
mavv 212,184,240
rv 240,104,40960
mavv 212,188,208
rv 208,105,40960
mavv 244,188,212
dmant 103,44,57,3072
rv 212,105,43008
mavv 244,184,244
s_waitcnt lgkmcnt(11)
rv 244,104,43008
mavv 220,184,248
s_add_u32 s57, s68, 3932160
s_add_u32 m0, s66, 16384
rv 248,104,45056
mavv 220,188,216
dmant 100,44,57,0
rv 216,105,45056
mavv 252,188,220
rv 220,105,47104
mavv 252,184,252
s_waitcnt lgkmcnt(11)
rv 252,104,47104
mavv 0,176,224
s_waitcnt lgkmcnt(10)
dmant 101,44,57,1024
tv 184,161,0
mavv 0,180,192
mavv 32,180,196
tv 186,161,1024
mavv 32,176,228
dmant 102,44,57,2048
mavv 8,176,232
tv 188,161,16384
mavv 8,180,200
s_waitcnt lgkmcnt(12)
mavv 40,180,204
s_waitcnt lgkmcnt(11)
dmant 103,44,57,3072
tv 190,161,17408
mavv 40,176,236
s_waitcnt lgkmcnt(11)
mavv 16,176,240
s_waitcnt lgkmcnt(10)
mavv 16,180,208
s_waitcnt lgkmcnt(9)
mavv 48,180,212
s_waitcnt lgkmcnt(8)
mavv 48,176,244
s_waitcnt lgkmcnt(7)
mavv 24,176,248
s_waitcnt lgkmcnt(6)
mavv 24,180,216
s_waitcnt lgkmcnt(5)
mavv 56,180,220
s_waitcnt lgkmcnt(4)
mavv 56,176,252
s_waitcnt lgkmcnt(2)
s_waitcnt lgkmcnt(0)
s_barrier
mavv 4,184,224
s_add_u32 s56, s67, 896
s_add_u32 m0, s65, 32768
tv 176,162,0
mavv 4,188,192
dma 96,40,56,0
mavv 36,188,196
tv 178,162,1024
mavv 36,184,228
mavv 12,184,232
tv 180,162,16384
mavv 12,188,200
mavv 44,188,204
dma 97,40,56,1024
tv 182,162,17408
mavv 44,184,236
mavv 20,184,240
mavv 20,188,208
mavv 52,188,212
mavv 52,184,244
dma 98,40,56,2048
mavv 28,184,248
mavv 28,188,216
mavv 60,188,220
mavv 60,184,252
s_waitcnt lgkmcnt(2)
mavv 64,176,224
s_waitcnt lgkmcnt(0)
dma 99,40,56,3072
tv 184,163,0
mavv 64,180,192
mavv 96,180,196
tv 186,163,1024
mavv 96,176,228
mavv 72,176,232
s_add_u32 s56, s67, 33664
s_add_u32 m0, s65, 36864
tv 188,163,16384
mavv 72,180,200
dma 96,40,56,0
mavv 104,180,204
tv 190,163,17408
mavv 104,176,236
mavv 80,176,240
mavv 80,180,208
mavv 112,180,212
dma 97,40,56,1024
mavv 112,176,244
mavv 88,176,248
mavv 88,180,216
mavv 120,180,220
mavv 120,176,252
s_waitcnt lgkmcnt(2)
dma 98,40,56,2048
mavv 68,184,224
s_waitcnt lgkmcnt(0)
tv 176,164,0
mavv 68,188,192
mavv 100,188,196
tv 178,164,1024
mavv 100,184,228
mavv 76,184,232
dma 99,40,56,3072
tv 180,164,16384
mavv 76,188,200
mavv 108,188,204
tv 182,164,17408
mavv 108,184,236
mavv 84,184,240
mavv 84,188,208
mavv 116,188,212
mavv 116,184,244
mavv 92,184,248
mavv 92,188,216
mavv 124,188,220
mavv 124,184,252
s_waitcnt lgkmcnt(2)
mavv 128,176,224
s_waitcnt lgkmcnt(0)
tv 184,165,0
mavv 128,180,192
mavv 160,180,196
tv 186,165,1024
mavv 160,176,228
mavv 136,176,232
tv 188,165,16384
mavv 136,180,200
mavv 168,180,204
tv 190,165,17408
mavv 168,176,236
mavv 144,176,240
mavv 144,180,208
mavv 176,180,212
mavv 176,176,244
mavv 152,176,248
mavv 152,180,216
mavv 184,180,220
mavv 184,176,252
s_waitcnt lgkmcnt(2)
mavv 132,184,224
s_waitcnt lgkmcnt(0)
s_mov_b32 s61, 94371840
s_cmp_eq_u32 s3, 0
s_cselect_b32 s61, 88113152, s61
tv 176,166,0
mavv 132,188,192
buffer_load_dword v122, v127, s[52:55], s61 offen sc1
mavv 164,188,196
tv 178,166,1024
mavv 164,184,228
mavv 140,184,232
tv 180,166,16384
mavv 140,188,200
mavv 172,188,204
tv 182,166,17408
mavv 172,184,236
mavv 148,184,240
mavv 148,188,208
mavv 180,188,212
mavv 180,184,244
mavv 156,184,248
mavv 156,188,216
mavv 188,188,220
mavv 188,184,252
s_waitcnt lgkmcnt(2)
mavv 192,176,224
s_waitcnt lgkmcnt(0)
tv 184,167,0
mavv 192,180,192
mavv 224,180,196
tv 186,167,1024
mavv 224,176,228
mavv 200,176,232
tv 188,167,16384
mavv 200,180,200
mavv 232,180,204
tv 190,167,17408
mavv 232,176,236
mavv 208,176,240
mavv 208,180,208
mavv 240,180,212
mavv 240,176,244
mavv 216,176,248
mavv 216,180,216
HOP_a_3:
HS_a_3:
s_cmp_eq_u32 s7, 1
s_cbranch_scc1 HS_a_7
mavv 248,180,220
mavv 248,176,252
s_waitcnt lgkmcnt(2)
s_waitcnt vmcnt(17) lgkmcnt(0)
s_barrier
mavv 196,184,224
tv 176,106,32768
rv 224,104,0
mavv 196,188,192
rv 192,105,0
mavv 228,188,196
tv 178,106,33792
rv 196,105,2048
mavv 228,184,228
rv 228,104,2048
mavv 204,184,232
tv 180,106,49152
rv 232,104,4096
mavv 204,188,200
rv 200,105,4096
mavv 236,188,204
tv 182,106,50176
rv 204,105,6144
mavv 236,184,236
rv 236,104,6144
mavv 212,184,240
rv 240,104,8192
mavv 212,188,208
rv 208,105,8192
mavv 244,188,212
rv 212,105,10240
mavv 244,184,244
s_waitcnt lgkmcnt(11)
rv 244,104,10240
mavv 220,184,248
rv 248,104,12288
mavv 220,188,216
rv 216,105,12288
mavv 252,188,220
rv 220,105,14336
mavv 252,184,252
s_waitcnt lgkmcnt(11)
rv 252,104,14336
mavv 0,176,224
s_waitcnt lgkmcnt(10)
tv 184,107,32768
mavv 0,180,192
mavv 32,180,196
s_mov_b32 s36, s12
s_and_b32 s37, s13, 0xffff
s_mov_b32 s38, 5242880
s_mov_b32 s39, 0x20000
tv 186,107,33792
mavv 32,176,228
mavv 8,176,232
tv 188,107,49152
mavv 8,180,200
s_waitcnt lgkmcnt(12)
mavv 40,180,204
s_waitcnt lgkmcnt(11)
s_sub_u32 s40, s22, 2048
s_subb_u32 s41, s23, 0
s_and_b32 s41, s41, 0xffff
s_cmp_lt_u32 s64, 27
s_cselect_b32 s42, 2213888, 0
s_mov_b32 s43, 0x20000
tv 190,107,50176
mavv 40,176,236
s_waitcnt lgkmcnt(11)
mavv 16,176,240
s_waitcnt lgkmcnt(10)
mavv 16,180,208
s_waitcnt lgkmcnt(9)
mavv 48,180,212
s_waitcnt lgkmcnt(8)
s_lshl_b32 s65, s3, 12
s_mul_i32 s66, s3, 3072
s_add_u32 s66, s66, 90112
mavv 48,176,244
s_waitcnt lgkmcnt(7)
mavv 24,176,248
s_waitcnt lgkmcnt(6)
mavv 24,180,216
s_waitcnt lgkmcnt(5)
mavv 56,180,220
s_waitcnt lgkmcnt(4)
mavv 56,176,252
s_waitcnt lgkmcnt(2)
s_waitcnt vmcnt(0)
v_cmp_ne_u32 vcc, s71, v122
s_cbranch_vccz L_saK_ok
s_mov_b32 s62, 1000000
L_saK:
buffer_load_dword v122, v127, s[52:55], s61 offen sc1
s_waitcnt vmcnt(0)
v_cmp_ne_u32 vcc, s71, v122
s_cbranch_vccz L_saK_ok
s_sub_u32 s62, s62, 1
s_cmp_eq_u32 s62, 0
s_cbranch_scc1 L_saK_ok
s_sleep 4
s_branch L_saK
L_saK_ok:
s_waitcnt lgkmcnt(0)
s_barrier
mavv 4,184,224
tv 176,108,32768
mavv 4,188,192
s_mov_b32 s56, 65536
s_add_u32 m0, s65, 0
mavv 36,188,196
dma 14,52,56,0
tv 178,108,33792
mavv 36,184,228
mavv 12,184,232
tv 180,108,49152
mavv 12,188,200
mavv 44,188,204
tv 182,108,50176
mavv 44,184,236
dma 15,52,56,1024
mavv 20,184,240
mavv 20,188,208
mavv 52,188,212
mavv 52,184,244
mavv 28,184,248
dma 16,52,56,2048
mavv 28,188,216
mavv 60,188,220
mavv 60,184,252
s_waitcnt lgkmcnt(2)
mavv 64,176,224
s_waitcnt lgkmcnt(0)
tv 184,109,32768
mavv 64,180,192
dma 17,52,56,3072
mavv 96,180,196
tv 186,109,33792
mavv 96,176,228
mavv 72,176,232
tv 188,109,49152
mavv 72,180,200
s_mov_b32 s57, 0
s_add_u32 m0, s66, 49152
mavv 104,180,204
dma 18,36,57,0
tv 190,109,50176
mavv 104,176,236
mavv 80,176,240
mavv 80,180,208
mavv 112,180,212
mavv 112,176,244
dma 19,36,57,1024
mavv 88,176,248
mavv 88,180,216
mavv 120,180,220
mavv 120,176,252
s_waitcnt lgkmcnt(2)
s_mov_b32 s58, 0
mavv 68,184,224
s_waitcnt lgkmcnt(0)
dma 20,40,58,2048
tv 176,110,32768
mavv 68,188,192
mavv 100,188,196
tv 178,110,33792
mavv 100,184,228
mavv 76,184,232
s_mov_b32 s56, 66560
s_add_u32 m0, s65, 16384
tv 180,110,49152
mavv 76,188,200
dma 14,52,56,0
mavv 108,188,204
tv 182,110,50176
mavv 108,184,236
mavv 84,184,240
mavv 84,188,208
mavv 116,188,212
dma 15,52,56,1024
mavv 116,184,244
mavv 92,184,248
mavv 92,188,216
mavv 124,188,220
mavv 124,184,252
s_waitcnt lgkmcnt(2)
dma 16,52,56,2048
mavv 128,176,224
s_waitcnt lgkmcnt(0)
tv 184,111,32768
mavv 128,180,192
mavv 160,180,196
tv 186,111,33792
mavv 160,176,228
mavv 136,176,232
dma 17,52,56,3072
tv 188,111,49152
mavv 136,180,200
mavv 168,180,204
tv 190,111,50176
mavv 168,176,236
mavv 144,176,240
s_mov_b32 s57, 262144
s_add_u32 m0, s66, 61440
mavv 144,180,208
dma 18,36,57,0
mavv 176,180,212
mavv 176,176,244
mavv 152,176,248
mavv 152,180,216
mavv 184,180,220
dma 19,36,57,1024
mavv 184,176,252
s_waitcnt lgkmcnt(2)
mavv 132,184,224
s_waitcnt lgkmcnt(0)
tv 176,112,32768
mavv 132,188,192
mavv 164,188,196
s_mov_b32 s58, 110592
tv 178,112,33792
mavv 164,184,228
dma 20,40,58,2048
mavv 140,184,232
tv 180,112,49152
mavv 140,188,200
mavv 172,188,204
tv 182,112,50176
mavv 172,184,236
mavv 148,184,240
mavv 148,188,208
mavv 180,188,212
mavv 180,184,244
mavv 156,184,248
mavv 156,188,216
mavv 188,188,220
mavv 188,184,252
s_waitcnt lgkmcnt(2)
mavv 192,176,224
s_waitcnt lgkmcnt(0)
tv 184,113,32768
mavv 192,180,192
mavv 224,180,196
tv 186,113,33792
mavv 224,176,228
mavv 200,176,232
tv 188,113,49152
mavv 200,180,200
mavv 232,180,204
tv 190,113,50176
mavv 232,176,236
mavv 208,176,240
mavv 208,180,208
mavv 240,180,212
mavv 240,176,244
mavv 216,176,248
mavv 216,180,216
mavv 248,180,220
mavv 248,176,252
s_waitcnt lgkmcnt(2)
s_waitcnt lgkmcnt(0)
s_barrier
mavv 196,184,224
tv 176,106,0
rv 224,104,32768
mavv 196,188,192
rv 192,105,32768
mavv 228,188,196
tv 178,106,1024
rv 196,105,34816
mavv 228,184,228
rv 228,104,34816
mavv 204,184,232
tv 180,106,16384
rv 232,104,36864
mavv 204,188,200
rv 200,105,36864
mavv 236,188,204
tv 182,106,17408
rv 204,105,38912
mavv 236,184,236
rv 236,104,38912
mavv 212,184,240
rv 240,104,40960
mavv 212,188,208
rv 208,105,40960
mavv 244,188,212
rv 212,105,43008
mavv 244,184,244
s_waitcnt lgkmcnt(11)
rv 244,104,43008
mavv 220,184,248
rv 248,104,45056
mavv 220,188,216
rv 216,105,45056
mavv 252,188,220
rv 220,105,47104
mavv 252,184,252
s_waitcnt lgkmcnt(11)
rv 252,104,47104
mavv 0,176,224
s_waitcnt lgkmcnt(10)
tv 184,107,0
mavv 0,180,192
mavv 32,180,196
tv 186,107,1024
mavv 32,176,228
mavv 8,176,232
tv 188,107,16384
mavv 8,180,200
s_waitcnt lgkmcnt(12)
mavv 40,180,204
s_waitcnt lgkmcnt(11)
tv 190,107,17408
mavv 40,176,236
s_waitcnt lgkmcnt(11)
mavv 16,176,240
s_waitcnt lgkmcnt(10)
mavv 16,180,208
s_waitcnt lgkmcnt(9)
mavv 48,180,212
s_waitcnt lgkmcnt(8)
mavv 48,176,244
s_waitcnt lgkmcnt(7)
mavv 24,176,248
s_waitcnt lgkmcnt(6)
mavv 24,180,216
s_waitcnt lgkmcnt(5)
mavv 56,180,220
s_waitcnt lgkmcnt(4)
mavv 56,176,252
s_waitcnt lgkmcnt(2)
s_waitcnt lgkmcnt(0)
s_barrier
mavv 4,184,224
s_mov_b32 s56, 67584
s_add_u32 m0, s65, 32768
tv 176,108,0
mavv 4,188,192
dma 14,52,56,0
mavv 36,188,196
tv 178,108,1024
mavv 36,184,228
mavv 12,184,232
dma 15,52,56,1024
tv 180,108,16384
mavv 12,188,200
mavv 44,188,204
tv 182,108,17408
mavv 44,184,236
dma 16,52,56,2048
mavv 20,184,240
mavv 20,188,208
mavv 52,188,212
dma 17,52,56,3072
mavv 52,184,244
mavv 28,184,248
s_mov_b32 s57, 524288
s_add_u32 m0, s66, 36864
mavv 28,188,216
dma 18,36,57,0
mavv 60,188,220
mavv 60,184,252
s_waitcnt lgkmcnt(2)
mavv 64,176,224
s_waitcnt lgkmcnt(0)
dma 19,36,57,1024
tv 184,109,0
mavv 64,180,192
mavv 96,180,196
s_mov_b32 s58, 221184
tv 186,109,1024
mavv 96,176,228
dma 20,40,58,2048
mavv 72,176,232
tv 188,109,16384
mavv 72,180,200
s_mov_b32 s56, 68608
s_add_u32 m0, s65, 49152
mavv 104,180,204
dma 14,52,56,0
tv 190,109,17408
mavv 104,176,236
mavv 80,176,240
mavv 80,180,208
dma 15,52,56,1024
mavv 112,180,212
mavv 112,176,244
mavv 88,176,248
dma 16,52,56,2048
mavv 88,180,216
mavv 120,180,220
mavv 120,176,252
s_waitcnt lgkmcnt(2)
dma 17,52,56,3072
mavv 68,184,224
s_waitcnt lgkmcnt(0)
tv 176,110,0
mavv 68,188,192
s_mov_b32 s57, 786432
s_add_u32 m0, s66, 24576
mavv 100,188,196
dma 18,36,57,0
tv 178,110,1024
mavv 100,184,228
mavv 76,184,232
tv 180,110,16384
mavv 76,188,200
dma 19,36,57,1024
mavv 108,188,204
tv 182,110,17408
mavv 108,184,236
s_mov_b32 s58, 331776
mavv 84,184,240
dma 20,40,58,2048
mavv 84,188,208
mavv 116,188,212
mavv 116,184,244
mavv 92,184,248
ar 24,0
mavv 92,188,216
ar 25,1
mavv 124,188,220
cv 28,24,25
mavv 124,184,252
s_waitcnt lgkmcnt(2)
ar 26,2
mavv 128,176,224
s_waitcnt lgkmcnt(0)
tv 184,111,0
ar 27,3
mavv 128,180,192
cv 29,26,27
mavv 160,180,196
tv 186,111,1024
s_add_u32 s63, s70, 0
ar 24,4
mavv 160,176,228
ar 25,5
mavv 136,176,232
tv 188,111,16384
cv 30,24,25
mavv 136,180,200
ar 26,6
mavv 168,180,204
tv 190,111,17408
ar 27,7
mavv 168,176,236
cv 31,26,27
mavv 144,176,240
buffer_store_dwordx4 v[28:31], v0, s[52:55], s63 offen offset:0 sc1
mavv 144,180,208
ar 24,8
mavv 176,180,212
ar 25,9
mavv 176,176,244
cv 28,24,25
mavv 152,176,248
ar 26,10
mavv 152,180,216
ar 27,11
mavv 184,180,220
cv 29,26,27
mavv 184,176,252
s_waitcnt lgkmcnt(2)
s_add_u32 s63, s70, 8192
ar 24,12
mavv 132,184,224
s_waitcnt lgkmcnt(0)
tv 176,112,0
ar 25,13
mavv 132,188,192
cv 30,24,25
mavv 164,188,196
tv 178,112,1024
ar 26,14
mavv 164,184,228
ar 27,15
mavv 140,184,232
tv 180,112,16384
cv 31,26,27
mavv 140,188,200
buffer_store_dwordx4 v[28:31], v0, s[52:55], s63 offen offset:0 sc1
mavv 172,188,204
tv 182,112,17408
ar 24,16
mavv 172,184,236
ar 25,17
mavv 148,184,240
cv 28,24,25
mavv 148,188,208
ar 26,18
mavv 180,188,212
ar 27,19
mavv 180,184,244
cv 29,26,27
mavv 156,184,248
s_add_u32 s63, s70, 16384
ar 24,20
mavv 156,188,216
ar 25,21
mavv 188,188,220
cv 30,24,25
mavv 188,184,252
s_waitcnt lgkmcnt(2)
ar 26,22
mavv 192,176,224
s_waitcnt lgkmcnt(0)
tv 184,113,0
ar 27,23
mavv 192,180,192
cv 31,26,27
mavv 224,180,196
tv 186,113,1024
buffer_store_dwordx4 v[28:31], v0, s[52:55], s63 offen offset:0 sc1
mavv 224,176,228
ar 24,24
mavv 200,176,232
tv 188,113,16384
ar 25,25
mavv 200,180,200
cv 28,24,25
mavv 232,180,204
tv 190,113,17408
ar 26,26
mavv 232,176,236
ar 27,27
mavv 208,176,240
cv 29,26,27
mavv 208,180,208
s_add_u32 s63, s70, 24576
ar 24,28
mavv 240,180,212
ar 25,29
mavv 240,176,244
cv 30,24,25
mavv 216,176,248
ar 26,30
mavv 216,180,216
ar 27,31
mavv 248,180,220
cv 31,26,27
mavv 248,176,252
s_waitcnt lgkmcnt(2)
s_waitcnt vmcnt(17) lgkmcnt(0)
s_barrier
buffer_store_dwordx4 v[28:31], v0, s[52:55], s63 offen offset:0 sc1
mavv 196,184,224
rv 224,1,0
ar 24,32
mavv 196,188,192
ta 0,2,49152
ar 25,33
HS_a_4:
s_cmp_eq_u32 s7, 1
s_cbranch_scc1 HS_a_8
mavv 228,188,196
ta 2,2,50176
cv 28,24,25
mavv 228,184,228
rv 228,1,1024
ar 26,34
mavv 204,184,232
rv 232,1,2048
ar 27,35
mavv 204,188,200
ta 4,2,61440
cv 29,26,27
mavv 236,188,204
ta 6,2,62464
s_add_u32 s63, s70, 0
ar 24,36
mavv 236,184,236
rv 236,1,3072
ar 25,37
mavv 212,184,240
rv 240,1,16384
cv 30,24,25
mavv 212,188,208
ta 8,3,49152
ar 26,38
mavv 244,188,212
ta 10,3,50176
ar 27,39
mavv 244,184,244
rv 244,1,17408
cv 31,26,27
mavv 220,184,248
rv 248,1,18432
buffer_store_dwordx4 v[28:31], v0, s[52:55], s63 offen offset:1024 sc1
mavv 220,188,216
ta 12,3,61440
ar 24,40
mavv 252,188,220
ta 14,3,62464
ar 25,41
mavv 252,184,252
s_waitcnt lgkmcnt(11)
rv 252,1,19456
cv 28,24,25
s_cmp_ge_u32 s64, 27
s_cbranch_scc1 L_qhNK
s_branch L_qhH
L_p1V:
zavv 0,224,176
tv 184,107,32768
s_mov_b32 s36, s8
s_and_b32 s37, s9, 0xffff
mavv 0,192,180
s_add_u32 s57, s68, 786432
s_add_u32 m0, s66, 16384
s_mov_b32 s38, 2621440
s_mov_b32 s39, 0x20000
zavv 4,196,180
dmant 100,44,57,0
tv 186,107,33792
s_mov_b32 s48, s24
s_and_b32 s49, s25, 0xffff
mavv 4,228,176
s_waitcnt lgkmcnt(13)
s_mov_b32 s50, 3456
s_mov_b32 s51, 0x20000
v_lshrrev_b32 v34, 5, v32
zavv 8,232,176
s_waitcnt lgkmcnt(12)
tv 188,107,49152
v_and_b32 v35, 31, v32
mavv 8,200,180
s_waitcnt lgkmcnt(12)
dmant 101,44,57,1024
v_mul_u32_u24 v36, 1280, v34
zavv 12,204,180
s_waitcnt lgkmcnt(11)
tv 190,107,50176
v_lshl_add_u32 v36, v35, 3, v36
mavv 12,236,176
s_waitcnt lgkmcnt(11)
s_lshl_b32 s89, s2, 2
s_add_u32 s89, s89, s3
zavv 16,240,176
s_waitcnt lgkmcnt(10)
dmant 102,44,57,2048
s_mul_i32 s89, s89, 2560
v_lshlrev_b32 v151, 3, v39
mavv 16,208,180
s_waitcnt lgkmcnt(9)
s_lshl_b32 s90, s64, 7
s_lshl_b32 s60, s4, 8
zavv 20,212,180
s_waitcnt lgkmcnt(8)
s_mul_i32 s58, s5, 80
s_mul_i32 s59, s3, 20
mavv 20,244,176
s_waitcnt lgkmcnt(7)
dmant 103,44,57,3072
s_add_u32 s58, s58, s59
s_lshl_b32 s59, s58, 13
zavv 24,248,176
s_waitcnt lgkmcnt(6)
s_add_u32 s59, s59, s60
s_mul_i32 s58, s58, 3456
mavv 24,216,180
s_waitcnt lgkmcnt(5)
s_lshl_b32 s60, s64, 7
s_add_u32 s58, s58, s60
v_min_u32 v140, 7, v32
zavv 28,220,180
s_waitcnt lgkmcnt(4)
v_and_b32 v144, 1, v140
mavv 28,252,176
s_waitcnt lgkmcnt(2)
s_waitcnt lgkmcnt(0)
s_barrier
v_lshlrev_b32 v144, 7, v144
zavv 32,224,184
s_add_u32 s57, s68, 1048576
s_add_u32 m0, s66, 65536
tv 176,108,32768
v_lshrrev_b32 v140, 1, v140
mavv 32,192,188
dmant 100,44,57,0
v_lshl_add_u32 v140, v140, 13, v144
zavv 36,196,188
tv 178,108,33792
v_min_u32 v145, 3, v32
mavv 36,228,184
v_mul_u32_u24 v145, 3456, v145
zavv 40,232,184
dmant 101,44,57,1024
tv 180,108,49152
s_mov_b32 s84, s12
s_and_b32 s85, s13, 0xffff
mavv 40,200,188
s_mov_b32 s86, 5242880
s_mov_b32 s87, 0x20000
zavv 44,204,188
tv 182,108,50176
s_mov_b32 s93, s59
s_mov_b32 s94, s58
v_add_u32 v2, v2, v59
mavv 44,236,184
dmant 102,44,57,2048
v_add_u32 v3, v3, v59
zavv 48,240,184
v_add_u32 v4, v4, v59
mavv 48,208,188
v_add_u32 v5, v5, v59
zavv 52,212,188
dmant 103,44,57,3072
v_add_u32 v6, v6, v59
mavv 52,244,184
v_add_u32 v7, v7, v59
zavv 56,248,184
s_add_u32 s57, s68, 1310720
s_add_u32 m0, s66, 81920
v_add_u32 v8, v8, v59
mavv 56,216,188
dmant 100,44,57,0
v_add_u32 v9, v9, v59
zavv 60,220,188
v_add_u32 v160, 0x10000, v106
mavv 60,252,184
s_waitcnt lgkmcnt(2)
v_add_u32 v161, 0x10000, v107
zavv 64,224,176
s_waitcnt lgkmcnt(0)
dmant 101,44,57,1024
tv 184,109,32768
v_add_u32 v162, 0x10000, v108
mavv 64,192,180
v_add_u32 v163, 0x10000, v109
zavv 68,196,180
tv 186,109,33792
v_add_u32 v164, 0x10000, v110
mavv 68,228,176
dmant 102,44,57,2048
v_add_u32 v165, 0x10000, v111
zavv 72,232,176
tv 188,109,49152
v_add_u32 v166, 0x10000, v112
mavv 72,200,180
v_add_u32 v167, 0x10000, v113
zavv 76,204,180
dmant 103,44,57,3072
tv 190,109,50176
v_lshrrev_b32 v60, 1, v55
mavv 76,236,176
v_and_b32 v61, 1, v39
zavv 80,240,176
s_add_u32 s56, s67, 256
s_add_u32 m0, s65, 0
v_lshl_add_u32 v60, v61, 1, v60
mavv 80,208,180
dma 96,40,56,0
v_lshlrev_b32 v60, 5, v60
zavv 84,212,180
v_and_b32 v61, 3, v32
mavv 84,244,176
v_lshlrev_b32 v61, 3, v61
zavv 88,248,176
dma 97,40,56,1024
v_lshl_add_u32 v61, v55, 7, v61
mavv 88,216,180
v_mul_u32_u24 v62, 3072, v39
zavv 92,220,180
v_add3_u32 v61, v61, v62, 0
mavv 92,252,176
s_waitcnt lgkmcnt(2)
dma 98,40,56,2048
v_add_u32 v61, 92160, v61
zavv 96,224,184
s_waitcnt lgkmcnt(0)
tv 176,110,32768
v_xor_b32 v62, 0, v60
mavv 96,192,188
v_add_u32 v10, v62, v61
zavv 100,196,188
dma 99,40,56,3072
tv 178,110,33792
v_xor_b32 v62, 32, v60
mavv 100,228,184
v_add_u32 v11, v62, v61
zavv 104,232,184
s_add_u32 s56, s67, 33024
s_add_u32 m0, s65, 4096
tv 180,110,49152
v_xor_b32 v62, 64, v60
mavv 104,200,188
dma 96,40,56,0
v_add_u32 v12, v62, v61
zavv 108,204,188
tv 182,110,50176
v_xor_b32 v62, 96, v60
mavv 108,236,184
v_add_u32 v13, v62, v61
zavv 112,240,184
dma 97,40,56,1024
s_mul_i32 s88, s88, 0x9E3779B1
s_add_u32 s88, s88, 0x7F4A7C15
mavv 112,208,188
s_cmp_eq_u32 s3, 0
s_cselect_b32 s71, s88, 0
v_lshrrev_b32 v88, 1, v35
zavv 116,212,188
v_mul_u32_u24 v88, 144, v88
mavv 116,244,184
dma 98,40,56,2048
v_and_b32 v89, 1, v35
zavv 120,248,184
v_lshl_add_u32 v88, v89, 3, v88
mavv 120,216,188
v_lshl_add_u32 v88, v34, 4, v88
zavv 124,220,188
dma 99,40,56,3072
s_lshl_b32 s58, s3, 5
s_add_u32 s58, s58, 0x20000
v_add_u32 v76, s58, v88
mavv 124,252,184
s_waitcnt lgkmcnt(2)
v_lshlrev_b32 v126, 8, v37
zavv 128,224,176
s_waitcnt lgkmcnt(0)
tv 184,111,32768
v_lshl_add_u32 v126, v38, 4, v126
mavv 128,192,180
buffer_load_dwordx2 v[40:41], v36, s[36:39], s89 offen offset:0
s_lshr_b32 s80, s2, 1
s_mul_i32 s80, s80, 20480
zavv 132,196,180
tv 186,111,33792
s_and_b32 s59, s2, 1
s_lshl_b32 s59, s59, 7
mavv 132,228,176
s_add_u32 s80, s80, s59
s_lshl_b32 s59, s3, 11
zavv 136,232,176
buffer_load_dwordx2 v[42:43], v36, s[36:39], s89 offen offset:256
tv 188,111,49152
s_add_u32 s80, s80, s59
s_add_u32 s80, s80, 65536
mavv 136,200,180
s_add_u32 s81, s80, 8192
s_add_u32 s82, s80, 16384
zavv 140,204,180
tv 190,111,50176
s_cmp_ge_u32 s3, 2
s_cselect_b32 s82, 94371840, s82
mavv 140,236,176
buffer_load_dwordx2 v[44:45], v36, s[36:39], s89 offen offset:512
s_mul_i32 s61, s3, 1152
s_add_u32 s61, s61, 0x20000
v_mul_u32_u24 v77, 144, v37
zavv 144,240,176
v_lshl_add_u32 v77, v38, 4, v77
mavv 144,208,180
v_add_u32 v77, s61, v77
zavv 148,212,180
buffer_load_dwordx2 v[46:47], v36, s[36:39], s89 offen offset:768
s_lshl_b32 s72, s4, 3
s_add_u32 s72, s72, s5
mavv 148,244,176
s_mul_i32 s72, s72, 128
s_add_u32 s72, s72, 88145920
zavv 152,248,176
s_lshl_b32 s73, s5, 5
s_add_u32 s73, s73, s4
mavv 152,216,180
buffer_load_dwordx2 v[48:49], v36, s[36:39], s89 offen offset:1024
s_mul_i32 s73, s73, 128
s_add_u32 s73, s73, 88178688
zavv 156,220,180
s_mul_i32 s74, s2, 128
s_add_u32 s74, s74, 88113152
mavv 156,252,176
s_waitcnt lgkmcnt(2)
s_sub_u32 s75, s64, 27
s_mul_i32 s61, s6, 5
zavv 160,224,184
s_waitcnt lgkmcnt(0)
buffer_load_dwordx2 v[114:115], v151, s[48:51], s90 offen offset:0
tv 176,112,32768
s_add_u32 s75, s75, s61
v_mov_b32 v91, 0
mavv 160,192,188
v_mov_b32 v92, 0x10000000
zavv 164,196,188
tv 178,112,33792
v_lshl_add_u32 v93, v33, 6, v32
mavv 164,228,184
buffer_load_dwordx2 v[116:117], v151, s[48:51], s90 offen offset:32
v_cmp_eq_u32 vcc, 0, v93
v_mov_b32 v23, s88
v_and_b32 v127, 15, v32
v_cndmask_b32 v21, v92, v91, vcc
zavv 168,232,184
tv 180,112,49152
s_lshl_b32 s61, s5, 4
s_sub_u32 s60, 240, s61
v_and_b32 v93, 16, v32
mavv 168,200,188
v_cmp_eq_u32 vcc, 0, v93
v_mov_b32 v91, s61
v_mov_b32 v92, s60
v_cndmask_b32 v91, v92, v91, vcc
zavv 172,204,188
buffer_load_dwordx2 v[118:119], v151, s[48:51], s90 offen offset:64
tv 182,112,50176
v_add_u32 v127, v127, v91
mavv 172,236,184
v_lshlrev_b32 v127, 7, v127
zavv 176,240,184
s_mul_i32 s70, s4, 524288
s_lshl_b32 s58, s5, 16
mavv 176,208,188
buffer_load_dwordx2 v[120:121], v151, s[48:51], s90 offen offset:96
s_add_u32 s70, s70, s58
s_and_b32 s58, s3, 1
zavv 180,212,188
s_lshl_b32 s58, s58, 15
s_add_u32 s70, s70, s58
mavv 180,244,184
s_cmp_ge_u32 s3, 2
s_cselect_b32 s58, 17825792, 0
zavv 184,248,184
s_add_u32 s70, s70, s58
s_add_u32 s70, s70, 4194304
mavv 184,216,188
s_lshl_b32 s58, s3, 12
v_add_u32 v1, s58, v0
zavv 188,220,188
s_and_b32 s58, s3, 1
s_lshl_b32 s59, s58, 7
v_xor_b32 v94, s59, v100
mavv 188,252,184
s_waitcnt lgkmcnt(2)
s_lshl_b32 s59, s3, 16
s_lshl_b32 s60, s4, 8
zavv 192,224,176
s_waitcnt lgkmcnt(0)
tv 184,113,32768
s_add_u32 s59, s59, s60
v_add_u32 v18, s59, v94
mavv 192,192,180
v_add_u32 v19, 31744, v18
zavv 196,196,180
tv 186,113,33792
v_and_b32 v94, 1, v39
mavv 196,228,176
v_lshlrev_b32 v94, 1, v94
zavv 200,232,176
tv 188,113,49152
s_lshl_b32 s59, s58, 2
v_or_b32 v94, s59, v94
mavv 200,200,180
v_xor_b32 v94, v94, v38
zavv 204,204,180
tv 190,113,50176
v_lshlrev_b32 v94, 4, v94
mavv 204,236,176
v_mul_u32_u24 v95, 3456, v37
zavv 208,240,176
v_add_u32 v94, v94, v95
mavv 208,208,180
s_mul_i32 s59, s3, 27648
s_lshl_b32 s60, s64, 7
zavv 212,212,180
s_add_u32 s59, s59, s60
v_add_u32 v20, s59, v94
mavv 212,244,176
s_lshl_b32 s76, s5, 3
s_add_u32 s76, s76, s3
zavv 216,248,176
s_mul_i32 s76, s76, 20480
s_sub_u32 s77, 15, s5
mavv 216,216,180
s_lshl_b32 s77, s77, 3
s_add_u32 s77, s77, s3
zavv 220,220,180
s_mul_i32 s77, s77, 20480
v_add_u32 v14, s76, v0
mavv 220,252,176
s_waitcnt lgkmcnt(2)
s_waitcnt vmcnt(25) lgkmcnt(0)
s_barrier
v_add_u32 v15, 80896, v14
zavv 224,224,184
s_add_u32 s57, s68, 1572864
s_add_u32 m0, s66, 32768
tv 176,106,0
rv 224,104,32768
v_add_u32 v16, s77, v0
mavv 224,192,188
dmant 100,44,57,0
rv 192,105,32768
v_add_u32 v17, 78848, v16
zavv 228,196,188
tv 178,106,1024
rv 196,105,34816
v_subrev_u32 v16, 2048, v16
mavv 228,228,184
rv 228,104,34816
zavv 232,232,184
dmant 101,44,57,1024
tv 180,106,16384
rv 232,104,36864
mavv 232,200,188
rv 200,105,36864
zavv 236,204,188
tv 182,106,17408
rv 204,105,38912
mavv 236,236,184
dmant 102,44,57,2048
rv 236,104,38912
zavv 240,240,184
rv 240,104,40960
mavv 240,208,188
rv 208,105,40960
zavv 244,212,188
dmant 103,44,57,3072
rv 212,105,43008
mavv 244,244,184
s_waitcnt lgkmcnt(11)
rv 244,104,43008
zavv 248,248,184
s_add_u32 s57, s68, 1835008
s_add_u32 m0, s66, 49152
rv 248,104,45056
mavv 248,216,188
dmant 100,44,57,0
rv 216,105,45056
zavv 252,220,188
rv 220,105,47104
mavv 252,252,184
s_waitcnt lgkmcnt(11)
rv 252,104,47104
mavv 0,224,176
s_waitcnt lgkmcnt(10)
dmant 101,44,57,1024
tv 184,107,0
mavv 0,192,180
mavv 4,196,180
tv 186,107,1024
mavv 4,228,176
dmant 102,44,57,2048
mavv 8,232,176
tv 188,107,16384
mavv 8,200,180
s_waitcnt lgkmcnt(12)
mavv 12,204,180
s_waitcnt lgkmcnt(11)
dmant 103,44,57,3072
tv 190,107,17408
mavv 12,236,176
s_waitcnt lgkmcnt(11)
mavv 16,240,176
s_waitcnt lgkmcnt(10)
s_waitcnt vmcnt(16)
v_lshlrev_b32 v50, 16, v40
mavv 16,208,180
s_waitcnt lgkmcnt(9)
v_and_b32 v51, 0xffff0000, v40
mavv 20,212,180
s_waitcnt lgkmcnt(8)
v_lshlrev_b32 v52, 16, v41
mavv 20,244,176
s_waitcnt lgkmcnt(7)
v_and_b32 v53, 0xffff0000, v41
mavv 24,248,176
s_waitcnt lgkmcnt(6)
s_waitcnt vmcnt(15)
v_lshlrev_b32 v54, 16, v42
mavv 24,216,180
s_waitcnt lgkmcnt(5)
v_and_b32 v55, 0xffff0000, v42
mavv 28,220,180
s_waitcnt lgkmcnt(4)
v_lshlrev_b32 v56, 16, v43
mavv 28,252,176
s_waitcnt lgkmcnt(2)
s_waitcnt lgkmcnt(0)
s_barrier
v_and_b32 v57, 0xffff0000, v43
mavv 32,224,184
s_add_u32 s56, s67, 384
s_add_u32 m0, s65, 32768
tv 176,108,0
s_waitcnt vmcnt(14)
v_lshlrev_b32 v58, 16, v44
mavv 32,192,188
dma 96,40,56,0
v_and_b32 v59, 0xffff0000, v44
mavv 36,196,188
tv 178,108,1024
v_lshlrev_b32 v60, 16, v45
mavv 36,228,184
v_and_b32 v61, 0xffff0000, v45
mavv 40,232,184
tv 180,108,16384
s_waitcnt vmcnt(14)
v_lshlrev_b32 v62, 16, v46
mavv 40,200,188
v_and_b32 v63, 0xffff0000, v46
mavv 44,204,188
dma 97,40,56,1024
tv 182,108,17408
v_lshlrev_b32 v64, 16, v47
mavv 44,236,184
v_and_b32 v65, 0xffff0000, v47
mavv 48,240,184
s_waitcnt vmcnt(14)
v_lshlrev_b32 v66, 16, v48
mavv 48,208,188
v_and_b32 v67, 0xffff0000, v48
mavv 52,212,188
v_lshlrev_b32 v68, 16, v49
mavv 52,244,184
dma 98,40,56,2048
v_and_b32 v69, 0xffff0000, v49
mavv 56,248,184
v_add_f32 v70, v50, v51
mavv 56,216,188
v_add_f32 v70, v70, v52
mavv 60,220,188
v_add_f32 v70, v70, v53
mavv 60,252,184
s_waitcnt lgkmcnt(2)
v_add_f32 v70, v70, v54
mavv 64,224,176
s_waitcnt lgkmcnt(0)
dma 99,40,56,3072
tv 184,109,0
v_add_f32 v70, v70, v55
mavv 64,192,180
v_add_f32 v70, v70, v56
mavv 68,196,180
tv 186,109,1024
v_add_f32 v70, v70, v57
mavv 68,228,176
v_add_f32 v70, v70, v58
mavv 72,232,176
s_add_u32 s56, s67, 33152
s_add_u32 m0, s65, 36864
tv 188,109,16384
v_add_f32 v70, v70, v59
mavv 72,200,180
dma 96,40,56,0
v_add_f32 v70, v70, v60
mavv 76,204,180
tv 190,109,17408
v_add_f32 v70, v70, v61
mavv 76,236,176
v_add_f32 v70, v70, v62
mavv 80,240,176
v_add_f32 v70, v70, v63
mavv 80,208,180
v_add_f32 v70, v70, v64
mavv 84,212,180
dma 97,40,56,1024
v_add_f32 v70, v70, v65
mavv 84,244,176
v_add_f32 v70, v70, v66
mavv 88,248,176
v_add_f32 v70, v70, v67
mavv 88,216,180
v_add_f32 v70, v70, v68
mavv 92,220,180
HS_a_5:
s_cmp_eq_u32 s7, 1
s_cbranch_scc1 HS_a_9
v_add_f32 v70, v70, v69
mavv 92,252,176
s_waitcnt lgkmcnt(2)
dma 98,40,56,2048
s_nop 0
v_add_f32_dpp v70, v70, v70 quad_perm:[1,0,3,2] row_mask:0xf bank_mask:0xf
mavv 96,224,184
s_waitcnt lgkmcnt(0)
tv 176,110,0
s_nop 0
v_add_f32_dpp v70, v70, v70 quad_perm:[2,3,0,1] row_mask:0xf bank_mask:0xf
mavv 96,192,188
s_nop 0
v_add_f32_dpp v70, v70, v70 row_half_mirror row_mask:0xf bank_mask:0xf
mavv 100,196,188
tv 178,110,1024
s_nop 0
v_add_f32_dpp v70, v70, v70 row_mirror row_mask:0xf bank_mask:0xf
mavv 100,228,184
v_mov_b32 v71, v70
mavv 104,232,184
dma 99,40,56,3072
tv 180,110,16384
s_nop 0
v_permlane16_swap_b32 v70, v71
mavv 104,200,188
v_add_f32 v70, v70, v71
mavv 108,204,188
tv 182,110,17408
v_mul_f32 v70, 0x3acccccd, v70
mavv 108,236,184
v_sub_f32 v50, v50, v70
mavv 112,240,184
v_sub_f32 v51, v51, v70
mavv 112,208,188
buffer_load_dword v149, v140, s[84:87], s93 offen
v_sub_f32 v52, v52, v70
mavv 116,212,188
v_sub_f32 v53, v53, v70
mavv 116,244,184
v_sub_f32 v54, v54, v70
mavv 120,248,184
v_sub_f32 v55, v55, v70
mavv 120,216,188
s_mov_b32 s48, s22
s_and_b32 s49, s23, 0xffff
s_mov_b32 s50, 2211840
s_mov_b32 s51, 0x20000
v_sub_f32 v56, v56, v70
mavv 124,220,188
buffer_load_dword v150, v145, s[48:51], s94 offen
v_sub_f32 v57, v57, v70
mavv 124,252,184
s_waitcnt lgkmcnt(2)
v_sub_f32 v58, v58, v70
mavv 128,224,176
s_waitcnt lgkmcnt(0)
tv 184,111,0
v_sub_f32 v59, v59, v70
mavv 128,192,180
v_sub_f32 v60, v60, v70
mavv 132,196,180
s_add_u32 s93, s93, 32768
tv 186,111,1024
v_sub_f32 v61, v61, v70
mavv 132,228,176
buffer_load_dword v149, v140, s[84:87], s93 offen
v_sub_f32 v62, v62, v70
mavv 136,232,176
tv 188,111,16384
v_sub_f32 v63, v63, v70
mavv 136,200,180
v_sub_f32 v64, v64, v70
mavv 140,204,180
tv 190,111,17408
v_sub_f32 v65, v65, v70
mavv 140,236,176
s_add_u32 s94, s94, 13824
v_sub_f32 v66, v66, v70
mavv 144,240,176
buffer_load_dword v150, v145, s[48:51], s94 offen
v_sub_f32 v67, v67, v70
mavv 144,208,180
v_sub_f32 v68, v68, v70
mavv 148,212,180
v_sub_f32 v69, v69, v70
mavv 148,244,176
v_mul_f32 v72, v50, v50
mavv 152,248,176
v_fmac_f32 v72, v51, v51
mavv 152,216,180
v_fmac_f32 v72, v52, v52
mavv 156,220,180
v_fmac_f32 v72, v53, v53
mavv 156,252,176
s_waitcnt lgkmcnt(2)
v_fmac_f32 v72, v54, v54
mavv 160,224,184
s_waitcnt lgkmcnt(0)
tv 176,112,0
v_fmac_f32 v72, v55, v55
mavv 160,192,188
v_fmac_f32 v72, v56, v56
mavv 164,196,188
tv 178,112,1024
v_fmac_f32 v72, v57, v57
mavv 164,228,184
v_fmac_f32 v72, v58, v58
mavv 168,232,184
tv 180,112,16384
v_fmac_f32 v72, v59, v59
mavv 168,200,188
v_fmac_f32 v72, v60, v60
mavv 172,204,188
tv 182,112,17408
v_fmac_f32 v72, v61, v61
mavv 172,236,184
v_fmac_f32 v72, v62, v62
mavv 176,240,184
v_fmac_f32 v72, v63, v63
mavv 176,208,188
v_fmac_f32 v72, v64, v64
mavv 180,212,188
v_fmac_f32 v72, v65, v65
mavv 180,244,184
v_fmac_f32 v72, v66, v66
mavv 184,248,184
v_fmac_f32 v72, v67, v67
mavv 184,216,188
v_fmac_f32 v72, v68, v68
mavv 188,220,188
v_fmac_f32 v72, v69, v69
mavv 188,252,184
s_waitcnt lgkmcnt(2)
s_nop 0
v_add_f32_dpp v72, v72, v72 quad_perm:[1,0,3,2] row_mask:0xf bank_mask:0xf
mavv 192,224,176
s_waitcnt lgkmcnt(0)
tv 184,113,0
s_nop 0
v_add_f32_dpp v72, v72, v72 quad_perm:[2,3,0,1] row_mask:0xf bank_mask:0xf
mavv 192,192,180
s_nop 0
v_add_f32_dpp v72, v72, v72 row_half_mirror row_mask:0xf bank_mask:0xf
mavv 196,196,180
tv 186,113,1024
s_nop 0
v_add_f32_dpp v72, v72, v72 row_mirror row_mask:0xf bank_mask:0xf
mavv 196,228,176
v_mov_b32 v73, v72
mavv 200,232,176
tv 188,113,16384
s_nop 0
v_permlane16_swap_b32 v72, v73
mavv 200,200,180
v_add_f32 v72, v72, v73
mavv 204,204,180
tv 190,113,17408
v_mov_b32 v73, 0x3727c5ac
mavv 204,236,176
v_fmac_f32 v73, 0x3acccccd, v72
mavv 208,240,176
v_rsq_f32 v73, v73
mavv 208,208,180
v_mul_f32 v73, 0x3e0293ee, v73
mavv 212,212,180
v_mul_f32 v50, v50, v73
mavv 212,244,176
v_mul_f32 v51, v51, v73
mavv 216,248,176
v_mul_f32 v52, v52, v73
mavv 216,216,180
v_mul_f32 v53, v53, v73
mavv 220,220,180
v_mul_f32 v54, v54, v73
mavv 220,252,176
s_waitcnt lgkmcnt(2)
s_waitcnt lgkmcnt(0)
s_barrier
v_mul_f32 v55, v55, v73
mavv 224,224,184
s_add_u32 s57, s68, 2097152
s_add_u32 m0, s66, 0
tv 176,160,0
rv 224,104,0
v_mul_f32 v56, v56, v73
mavv 224,192,188
dmant 100,44,57,0
rv 192,105,0
v_mul_f32 v57, v57, v73
mavv 228,196,188
tv 178,160,1024
rv 196,105,2048
v_mul_f32 v58, v58, v73
mavv 228,228,184
rv 228,104,2048
v_mul_f32 v59, v59, v73
mavv 232,232,184
dmant 101,44,57,1024
tv 180,160,16384
rv 232,104,4096
v_mul_f32 v60, v60, v73
mavv 232,200,188
rv 200,105,4096
v_mul_f32 v61, v61, v73
mavv 236,204,188
tv 182,160,17408
rv 204,105,6144
v_mul_f32 v62, v62, v73
mavv 236,236,184
dmant 102,44,57,2048
rv 236,104,6144
v_mul_f32 v63, v63, v73
mavv 240,240,184
rv 240,104,8192
v_mul_f32 v64, v64, v73
mavv 240,208,188
rv 208,105,8192
v_mul_f32 v65, v65, v73
mavv 244,212,188
dmant 103,44,57,3072
rv 212,105,10240
v_mul_f32 v66, v66, v73
mavv 244,244,184
s_waitcnt lgkmcnt(11)
rv 244,104,10240
v_mul_f32 v67, v67, v73
mavv 248,248,184
s_add_u32 s57, s68, 2359296
s_add_u32 m0, s66, 16384
rv 248,104,12288
v_mul_f32 v68, v68, v73
mavv 248,216,188
dmant 100,44,57,0
rv 216,105,12288
v_mul_f32 v69, v69, v73
mavv 252,220,188
rv 220,105,14336
cv 40,50,51
mavv 252,252,184
s_waitcnt lgkmcnt(11)
rv 252,104,14336
cv 41,52,53
mavv 0,224,176
s_waitcnt lgkmcnt(10)
dmant 101,44,57,1024
tv 184,161,0
cv 42,54,55
mavv 0,192,180
cv 43,56,57
mavv 4,196,180
tv 186,161,1024
cv 44,58,59
mavv 4,228,176
dmant 102,44,57,2048
cv 45,60,61
mavv 8,232,176
tv 188,161,16384
cv 46,62,63
mavv 8,200,180
s_waitcnt lgkmcnt(12)
cv 47,64,65
mavv 12,204,180
s_waitcnt lgkmcnt(11)
dmant 103,44,57,3072
tv 190,161,17408
cv 48,66,67
mavv 12,236,176
s_waitcnt lgkmcnt(11)
cv 49,68,69
mavv 16,240,176
s_waitcnt lgkmcnt(10)
mavv 16,208,180
s_waitcnt lgkmcnt(9)
mavv 20,212,180
s_waitcnt lgkmcnt(8)
mavv 20,244,176
s_waitcnt lgkmcnt(7)
mavv 24,248,176
s_waitcnt lgkmcnt(6)
mavv 24,216,180
s_waitcnt lgkmcnt(5)
mavv 28,220,180
s_waitcnt lgkmcnt(4)
mavv 28,252,176
s_waitcnt lgkmcnt(2)
s_waitcnt lgkmcnt(0)
s_barrier
mavv 32,224,184
s_add_u32 s56, s67, 512
s_add_u32 m0, s65, 0
tv 176,162,0
mavv 32,192,188
dma 96,40,56,0
mavv 36,196,188
tv 178,162,1024
mavv 36,228,184
mavv 40,232,184
tv 180,162,16384
mavv 40,200,188
mavv 44,204,188
dma 97,40,56,1024
tv 182,162,17408
mavv 44,236,184
mavv 48,240,184
mavv 48,208,188
mavv 52,212,188
mavv 52,244,184
dma 98,40,56,2048
mavv 56,248,184
mavv 56,216,188
mavv 60,220,188
mavv 60,252,184
s_waitcnt lgkmcnt(2)
mavv 64,224,176
s_waitcnt lgkmcnt(0)
dma 99,40,56,3072
tv 184,163,0
mavv 64,192,180
mavv 68,196,180
tv 186,163,1024
mavv 68,228,176
mavv 72,232,176
s_add_u32 s56, s67, 33280
s_add_u32 m0, s65, 4096
tv 188,163,16384
mavv 72,200,180
dma 96,40,56,0
mavv 76,204,180
tv 190,163,17408
mavv 76,236,176
mavv 80,240,176
mavv 80,208,180
mavv 84,212,180
dma 97,40,56,1024
mavv 84,244,176
mavv 88,248,176
mavv 88,216,180
mavv 92,220,180
mavv 92,252,176
s_waitcnt lgkmcnt(2)
dma 98,40,56,2048
mavv 96,224,184
s_waitcnt lgkmcnt(0)
tv 176,164,0
mavv 96,192,188
mavv 100,196,188
tv 178,164,1024
mavv 100,228,184
mavv 104,232,184
dma 99,40,56,3072
tv 180,164,16384
mavv 104,200,188
mavv 108,204,188
tv 182,164,17408
mavv 108,236,184
mavv 112,240,184
s_add_u32 s93, s93, 32768
mavv 112,208,188
buffer_load_dword v149, v140, s[84:87], s93 offen
mavv 116,212,188
mavv 116,244,184
mavv 120,248,184
mavv 120,216,188
s_add_u32 s94, s94, 13824
mavv 124,220,188
buffer_load_dword v150, v145, s[48:51], s94 offen
mavv 124,252,184
s_waitcnt lgkmcnt(2)
mavv 128,224,176
s_waitcnt lgkmcnt(0)
tv 184,165,0
mavv 128,192,180
mavv 132,196,180
s_add_u32 s93, s93, 32768
tv 186,165,1024
mavv 132,228,176
buffer_load_dword v149, v140, s[84:87], s93 offen
mavv 136,232,176
tv 188,165,16384
mavv 136,200,180
mavv 140,204,180
tv 190,165,17408
mavv 140,236,176
s_add_u32 s94, s94, 13824
mavv 144,240,176
buffer_load_dword v150, v145, s[48:51], s94 offen
mavv 144,208,180
mavv 148,212,180
mavv 148,244,176
mavv 152,248,176
mavv 152,216,180
mavv 156,220,180
mavv 156,252,176
s_waitcnt lgkmcnt(2)
mavv 160,224,184
s_waitcnt lgkmcnt(0)
tv 176,166,0
mavv 160,192,188
mavv 164,196,188
tv 178,166,1024
mavv 164,228,184
mavv 168,232,184
tv 180,166,16384
mavv 168,200,188
mavv 172,204,188
tv 182,166,17408
mavv 172,236,184
mavv 176,240,184
mavv 176,208,188
mavv 180,212,188
mavv 180,244,184
mavv 184,248,184
mavv 184,216,188
mavv 188,220,188
mavv 188,252,184
s_waitcnt lgkmcnt(2)
mavv 192,224,176
s_waitcnt lgkmcnt(0)
tv 184,167,0
mavv 192,192,180
mavv 196,196,180
tv 186,167,1024
mavv 196,228,176
mavv 200,232,176
tv 188,167,16384
mavv 200,200,180
mavv 204,204,180
tv 190,167,17408
mavv 204,236,176
mavv 208,240,176
mavv 208,208,180
mavv 212,212,180
mavv 212,244,176
mavv 216,248,176
mavv 216,216,180
mavv 220,220,180
mavv 220,252,176
s_waitcnt lgkmcnt(2)
s_waitcnt vmcnt(24) lgkmcnt(0)
s_barrier
mavv 224,224,184
s_add_u32 s93, s93, 32768
tv 176,106,32768
rv 224,104,32768
mavv 224,192,188
buffer_load_dword v149, v140, s[84:87], s93 offen
rv 192,105,32768
mavv 228,196,188
tv 178,106,33792
rv 196,105,34816
mavv 228,228,184
rv 228,104,34816
mavv 232,232,184
s_add_u32 s94, s94, 13824
tv 180,106,49152
rv 232,104,36864
mavv 232,200,188
buffer_load_dword v150, v145, s[48:51], s94 offen
rv 200,105,36864
mavv 236,204,188
tv 182,106,50176
rv 204,105,38912
mavv 236,236,184
rv 236,104,38912
mavv 240,240,184
rv 240,104,40960
mavv 240,208,188
rv 208,105,40960
mavv 244,212,188
rv 212,105,43008
mavv 244,244,184
s_waitcnt lgkmcnt(11)
rv 244,104,43008
mavv 248,248,184
rv 248,104,45056
mavv 248,216,188
rv 216,105,45056
mavv 252,220,188
rv 220,105,47104
mavv 252,252,184
s_waitcnt lgkmcnt(11)
rv 252,104,47104
mavv 0,224,176
s_waitcnt lgkmcnt(10)
tv 184,107,32768
mavv 0,192,180
ds_write_b64 v76, v[40:41] offset:0
mavv 4,196,180
tv 186,107,33792
mavv 4,228,176
ds_write_b64 v76, v[42:43] offset:2304
mavv 8,232,176
tv 188,107,49152
mavv 8,200,180
s_waitcnt lgkmcnt(14)
ds_write_b64 v76, v[44:45] offset:4608
mavv 12,204,180
s_waitcnt lgkmcnt(14)
tv 190,107,50176
mavv 12,236,176
s_waitcnt lgkmcnt(14)
ds_write_b64 v76, v[46:47] offset:6912
mavv 16,240,176
s_waitcnt lgkmcnt(14)
mavv 16,208,180
s_waitcnt lgkmcnt(13)
ds_write_b64 v76, v[48:49] offset:9216
mavv 20,212,180
s_waitcnt lgkmcnt(13)
mavv 20,244,176
s_waitcnt lgkmcnt(12)
mavv 24,248,176
s_waitcnt lgkmcnt(11)
mavv 24,216,180
s_waitcnt lgkmcnt(10)
mavv 28,220,180
s_waitcnt lgkmcnt(9)
mavv 28,252,176
s_waitcnt lgkmcnt(6)
s_waitcnt lgkmcnt(0)
s_barrier
mavv 32,224,184
s_add_u32 s56, s67, 640
s_add_u32 m0, s65, 32768
tv 176,108,32768
mavv 32,192,188
dma 96,40,56,0
mavv 36,196,188
tv 178,108,33792
mavv 36,228,184
mavv 40,232,184
tv 180,108,49152
mavv 40,200,188
dma 97,40,56,1024
mavv 44,204,188
tv 182,108,50176
mavv 44,236,184
mavv 48,240,184
mavv 48,208,188
dma 98,40,56,2048
rv 128,77,0
mavv 52,212,188
mavv 52,244,184
rv 132,77,4608
mavv 56,248,184
mavv 56,216,188
dma 99,40,56,3072
rv 136,77,9216
mavv 60,220,188
mavv 60,252,184
s_waitcnt lgkmcnt(5)
mavv 64,224,176
s_waitcnt lgkmcnt(3)
s_add_u32 s56, s67, 33408
s_add_u32 m0, s65, 36864
tv 184,109,32768
mavv 64,192,180
dma 96,40,56,0
mavv 68,196,180
tv 186,109,33792
mavv 68,228,176
mavv 72,232,176
tv 188,109,49152
mavv 72,200,180
dma 97,40,56,1024
mavv 76,204,180
tv 190,109,50176
mavv 76,236,176
mavv 80,240,176
mavv 80,208,180
dma 98,40,56,2048
mavv 84,212,180
mavv 84,244,176
mavv 88,248,176
mavv 88,216,180
dma 99,40,56,3072
mavv 92,220,180
mavv 92,252,176
s_waitcnt lgkmcnt(2)
mavv 96,224,184
HS_a_6:
s_cmp_eq_u32 s7, 1
s_cbranch_scc1 HS_a_10
s_waitcnt lgkmcnt(0)
tv 176,110,32768
mavv 96,192,188
buffer_store_dwordx4 v[128:131], v126, s[52:55], s80 offen sc1
mavv 100,196,188
tv 178,110,33792
mavv 100,228,184
mavv 104,232,184
tv 180,110,49152
mavv 104,200,188
buffer_store_dwordx4 v[132:135], v126, s[52:55], s81 offen sc1
mavv 108,204,188
tv 182,110,50176
mavv 108,236,184
mavv 112,240,184
mavv 112,208,188
buffer_store_dwordx4 v[136:139], v126, s[52:55], s82 offen sc1
mavv 116,212,188
mavv 116,244,184
mavv 120,248,184
mavv 120,216,188
mavv 124,220,188
mavv 124,252,184
s_waitcnt lgkmcnt(2)
mavv 128,224,176
s_waitcnt lgkmcnt(0)
tv 184,111,32768
mavv 128,192,180
mavv 132,196,180
tv 186,111,33792
mavv 132,228,176
mavv 136,232,176
tv 188,111,49152
mavv 136,200,180
mavv 140,204,180
tv 190,111,50176
mavv 140,236,176
mavv 144,240,176
mavv 144,208,180
mavv 148,212,180
mavv 148,244,176
mavv 152,248,176
mavv 152,216,180
mavv 156,220,180
mavv 156,252,176
s_waitcnt lgkmcnt(2)
mavv 160,224,184
s_waitcnt lgkmcnt(0)
tv 176,112,32768
mavv 160,192,188
mavv 164,196,188
tv 178,112,33792
mavv 164,228,184
mavv 168,232,184
tv 180,112,49152
mavv 168,200,188
mavv 172,204,188
tv 182,112,50176
mavv 172,236,184
mavv 176,240,184
mavv 176,208,188
mavv 180,212,188
mavv 180,244,184
mavv 184,248,184
mavv 184,216,188
mavv 188,220,188
mavv 188,252,184
s_waitcnt lgkmcnt(2)
mavv 192,224,176
s_waitcnt lgkmcnt(0)
tv 184,113,32768
mavv 192,192,180
mavv 196,196,180
tv 186,113,33792
mavv 196,228,176
mavv 200,232,176
tv 188,113,49152
mavv 200,200,180
mavv 204,204,180
tv 190,113,50176
mavv 204,236,176
mavv 208,240,176
mavv 208,208,180
mavv 212,212,180
mavv 212,244,176
mavv 216,248,176
mavv 216,216,180
mavv 220,220,180
mavv 220,252,176
s_waitcnt lgkmcnt(2)
s_waitcnt vmcnt(17) lgkmcnt(0)
s_barrier
mavv 224,224,184
s_add_u32 s57, s68, 2621440
s_add_u32 m0, s66, 65536
tv 176,106,0
rv 224,104,0
mavv 224,192,188
dmant 100,44,57,0
rv 192,105,0
mavv 228,196,188
tv 178,106,1024
rv 196,105,2048
mavv 228,228,184
rv 228,104,2048
mavv 232,232,184
dmant 101,44,57,1024
tv 180,106,16384
rv 232,104,4096
mavv 232,200,188
rv 200,105,4096
mavv 236,204,188
tv 182,106,17408
rv 204,105,6144
mavv 236,236,184
dmant 102,44,57,2048
rv 236,104,6144
mavv 240,240,184
rv 240,104,8192
mavv 240,208,188
rv 208,105,8192
mavv 244,212,188
dmant 103,44,57,3072
rv 212,105,10240
mavv 244,244,184
s_waitcnt lgkmcnt(11)
rv 244,104,10240
mavv 248,248,184
s_add_u32 s57, s68, 2883584
s_add_u32 m0, s66, 81920
rv 248,104,12288
mavv 248,216,188
dmant 100,44,57,0
rv 216,105,12288
mavv 252,220,188
rv 220,105,14336
mavv 252,252,184
s_waitcnt lgkmcnt(11)
rv 252,104,14336
mavv 0,224,176
s_waitcnt lgkmcnt(10)
dmant 101,44,57,1024
tv 184,107,0
mavv 0,192,180
mavv 4,196,180
tv 186,107,1024
mavv 4,228,176
dmant 102,44,57,2048
mavv 8,232,176
tv 188,107,16384
mavv 8,200,180
s_waitcnt lgkmcnt(12)
mavv 12,204,180
s_waitcnt lgkmcnt(11)
dmant 103,44,57,3072
tv 190,107,17408
mavv 12,236,176
s_waitcnt lgkmcnt(11)
mavv 16,240,176
s_waitcnt lgkmcnt(10)
mavv 16,208,180
s_waitcnt lgkmcnt(9)
mavv 20,212,180
s_waitcnt lgkmcnt(8)
mavv 20,244,176
s_waitcnt lgkmcnt(7)
mavv 24,248,176
s_waitcnt lgkmcnt(6)
mavv 24,216,180
s_waitcnt lgkmcnt(5)
mavv 28,220,180
s_waitcnt lgkmcnt(4)
mavv 28,252,176
s_waitcnt lgkmcnt(2)
s_waitcnt vmcnt(8) lgkmcnt(0)
s_barrier
mavv 32,224,184
tv 176,108,0
mavv 32,192,188
buffer_store_dword v23, v21, s[52:55], s74 offen sc1
mavv 36,196,188
tv 178,108,1024
mavv 36,228,184
mavv 40,232,184
s_add_u32 s57, s68, 3145728
s_add_u32 m0, s66, 32768
tv 180,108,16384
v_lshlrev_b32 v80, 16, v114
mavv 40,200,188
dmant 100,44,57,0
mavv 44,204,188
tv 182,108,17408
v_and_b32 v81, 0xffff0000, v114
mavv 44,236,184
mavv 48,240,184
v_mul_f32 v80, 0x3e0293ee, v80
mavv 48,208,188
dmant 101,44,57,1024
mavv 52,212,188
v_mul_f32 v81, 0x3e0293ee, v81
mavv 52,244,184
mavv 56,248,184
v_lshlrev_b32 v82, 16, v115
mavv 56,216,188
dmant 102,44,57,2048
mavv 60,220,188
v_and_b32 v83, 0xffff0000, v115
mavv 60,252,184
s_waitcnt lgkmcnt(2)
mavv 64,224,176
s_waitcnt lgkmcnt(0)
tv 184,109,0
v_mul_f32 v82, 0x3e0293ee, v82
mavv 64,192,180
dmant 103,44,57,3072
mavv 68,196,180
tv 186,109,1024
v_mul_f32 v83, 0x3e0293ee, v83
mavv 68,228,176
mavv 72,232,176
s_add_u32 s57, s68, 3407872
s_add_u32 m0, s66, 49152
tv 188,109,16384
v_lshlrev_b32 v84, 16, v116
mavv 72,200,180
dmant 100,44,57,0
mavv 76,204,180
tv 190,109,17408
v_and_b32 v85, 0xffff0000, v116
mavv 76,236,176
mavv 80,240,176
v_mul_f32 v84, 0x3e0293ee, v84
mavv 80,208,180
dmant 101,44,57,1024
mavv 84,212,180
v_mul_f32 v85, 0x3e0293ee, v85
mavv 84,244,176
mavv 88,248,176
v_lshlrev_b32 v86, 16, v117
mavv 88,216,180
dmant 102,44,57,2048
mavv 92,220,180
v_and_b32 v87, 0xffff0000, v117
mavv 92,252,176
s_waitcnt lgkmcnt(2)
mavv 96,224,184
s_waitcnt lgkmcnt(0)
tv 176,110,0
v_mul_f32 v86, 0x3e0293ee, v86
mavv 96,192,188
dmant 103,44,57,3072
mavv 100,196,188
tv 178,110,1024
v_mul_f32 v87, 0x3e0293ee, v87
mavv 100,228,184
mavv 104,232,184
s_add_u32 s56, s67, 768
s_add_u32 m0, s65, 0
tv 180,110,16384
mavv 104,200,188
dma 96,40,56,0
mavv 108,204,188
tv 182,110,17408
mavv 108,236,184
mavv 112,240,184
mavv 112,208,188
dma 97,40,56,1024
mavv 116,212,188
mavv 116,244,184
mavv 120,248,184
mavv 120,216,188
dma 98,40,56,2048
mavv 124,220,188
mavv 124,252,184
s_waitcnt lgkmcnt(2)
mavv 128,224,176
s_waitcnt lgkmcnt(0)
tv 184,111,0
mavv 128,192,180
dma 99,40,56,3072
mavv 132,196,180
tv 186,111,1024
mavv 132,228,176
mavv 136,232,176
s_add_u32 s56, s67, 33536
s_add_u32 m0, s65, 4096
tv 188,111,16384
mavv 136,200,180
dma 96,40,56,0
mavv 140,204,180
tv 190,111,17408
mavv 140,236,176
mavv 144,240,176
mavv 144,208,180
dma 97,40,56,1024
mavv 148,212,180
mavv 148,244,176
mavv 152,248,176
mavv 152,216,180
dma 98,40,56,2048
mavv 156,220,180
mavv 156,252,176
s_waitcnt lgkmcnt(2)
mavv 160,224,184
s_waitcnt lgkmcnt(0)
tv 176,112,0
mavv 160,192,188
dma 99,40,56,3072
mavv 164,196,188
tv 178,112,1024
mavv 164,228,184
mavv 168,232,184
tv 180,112,16384
v_lshlrev_b32 v88, 16, v118
mavv 168,200,188
mavv 172,204,188
tv 182,112,17408
v_and_b32 v89, 0xffff0000, v118
mavv 172,236,184
mavv 176,240,184
v_mul_f32 v88, 0x3e0293ee, v88
mavv 176,208,188
mavv 180,212,188
v_mul_f32 v89, 0x3e0293ee, v89
mavv 180,244,184
mavv 184,248,184
v_lshlrev_b32 v90, 16, v119
mavv 184,216,188
mavv 188,220,188
v_and_b32 v91, 0xffff0000, v119
mavv 188,252,184
s_waitcnt lgkmcnt(2)
mavv 192,224,176
s_waitcnt lgkmcnt(0)
tv 184,113,0
v_mul_f32 v90, 0x3e0293ee, v90
mavv 192,192,180
mavv 196,196,180
tv 186,113,1024
v_mul_f32 v91, 0x3e0293ee, v91
mavv 196,228,176
mavv 200,232,176
tv 188,113,16384
v_lshlrev_b32 v92, 16, v120
mavv 200,200,180
mavv 204,204,180
tv 190,113,17408
v_and_b32 v93, 0xffff0000, v120
mavv 204,236,176
mavv 208,240,176
v_mul_f32 v92, 0x3e0293ee, v92
mavv 208,208,180
mavv 212,212,180
v_mul_f32 v93, 0x3e0293ee, v93
mavv 212,244,176
mavv 216,248,176
v_lshlrev_b32 v94, 16, v121
mavv 216,216,180
mavv 220,220,180
v_and_b32 v95, 0xffff0000, v121
mavv 220,252,176
s_waitcnt lgkmcnt(2)
s_waitcnt vmcnt(17) lgkmcnt(0)
s_barrier
mavv 224,224,184
s_add_u32 s57, s68, 3670016
s_add_u32 m0, s66, 0
tv 176,160,0
rv 224,104,32768
v_mul_f32 v94, 0x3e0293ee, v94
mavv 224,192,188
dmant 100,44,57,0
rv 192,105,32768
mavv 228,196,188
tv 178,160,1024
rv 196,105,34816
v_mul_f32 v95, 0x3e0293ee, v95
mavv 228,228,184
rv 228,104,34816
mavv 232,232,184
dmant 101,44,57,1024
tv 180,160,16384
rv 232,104,36864
mavv 232,200,188
rv 200,105,36864
mavv 236,204,188
tv 182,160,17408
rv 204,105,38912
mavv 236,236,184
dmant 102,44,57,2048
rv 236,104,38912
mavv 240,240,184
rv 240,104,40960
mavv 240,208,188
rv 208,105,40960
mavv 244,212,188
dmant 103,44,57,3072
rv 212,105,43008
mavv 244,244,184
s_waitcnt lgkmcnt(11)
rv 244,104,43008
mavv 248,248,184
s_add_u32 s57, s68, 3932160
s_add_u32 m0, s66, 16384
rv 248,104,45056
mavv 248,216,188
dmant 100,44,57,0
rv 216,105,45056
mavv 252,220,188
rv 220,105,47104
mavv 252,252,184
s_waitcnt lgkmcnt(11)
rv 252,104,47104
mavv 0,224,176
s_waitcnt lgkmcnt(10)
dmant 101,44,57,1024
tv 184,161,0
mavv 0,192,180
mavv 4,196,180
tv 186,161,1024
mavv 4,228,176
dmant 102,44,57,2048
mavv 8,232,176
tv 188,161,16384
mavv 8,200,180
s_waitcnt lgkmcnt(12)
mavv 12,204,180
s_waitcnt lgkmcnt(11)
dmant 103,44,57,3072
tv 190,161,17408
mavv 12,236,176
s_waitcnt lgkmcnt(11)
mavv 16,240,176
s_waitcnt lgkmcnt(10)
mavv 16,208,180
s_waitcnt lgkmcnt(9)
mavv 20,212,180
s_waitcnt lgkmcnt(8)
mavv 20,244,176
s_waitcnt lgkmcnt(7)
mavv 24,248,176
s_waitcnt lgkmcnt(6)
mavv 24,216,180
s_waitcnt lgkmcnt(5)
mavv 28,220,180
s_waitcnt lgkmcnt(4)
mavv 28,252,176
s_waitcnt lgkmcnt(2)
s_waitcnt lgkmcnt(0)
s_barrier
mavv 32,224,184
s_add_u32 s56, s67, 896
s_add_u32 m0, s65, 32768
tv 176,162,0
mavv 32,192,188
dma 96,40,56,0
mavv 36,196,188
tv 178,162,1024
mavv 36,228,184
mavv 40,232,184
tv 180,162,16384
mavv 40,200,188
mavv 44,204,188
dma 97,40,56,1024
tv 182,162,17408
mavv 44,236,184
mavv 48,240,184
mavv 48,208,188
mavv 52,212,188
mavv 52,244,184
dma 98,40,56,2048
mavv 56,248,184
mavv 56,216,188
mavv 60,220,188
mavv 60,252,184
s_waitcnt lgkmcnt(2)
mavv 64,224,176
s_waitcnt lgkmcnt(0)
dma 99,40,56,3072
tv 184,163,0
mavv 64,192,180
mavv 68,196,180
tv 186,163,1024
mavv 68,228,176
mavv 72,232,176
s_add_u32 s56, s67, 33664
s_add_u32 m0, s65, 36864
tv 188,163,16384
mavv 72,200,180
dma 96,40,56,0
mavv 76,204,180
tv 190,163,17408
mavv 76,236,176
mavv 80,240,176
mavv 80,208,180
mavv 84,212,180
dma 97,40,56,1024
mavv 84,244,176
mavv 88,248,176
mavv 88,216,180
mavv 92,220,180
mavv 92,252,176
s_waitcnt lgkmcnt(2)
dma 98,40,56,2048
mavv 96,224,184
s_waitcnt lgkmcnt(0)
tv 176,164,0
mavv 96,192,188
mavv 100,196,188
tv 178,164,1024
mavv 100,228,184
mavv 104,232,184
dma 99,40,56,3072
tv 180,164,16384
mavv 104,200,188
mavv 108,204,188
tv 182,164,17408
mavv 108,236,184
mavv 112,240,184
mavv 112,208,188
mavv 116,212,188
mavv 116,244,184
mavv 120,248,184
mavv 120,216,188
mavv 124,220,188
mavv 124,252,184
s_waitcnt lgkmcnt(2)
mavv 128,224,176
s_waitcnt lgkmcnt(0)
tv 184,165,0
mavv 128,192,180
mavv 132,196,180
tv 186,165,1024
mavv 132,228,176
mavv 136,232,176
tv 188,165,16384
mavv 136,200,180
mavv 140,204,180
tv 190,165,17408
mavv 140,236,176
mavv 144,240,176
mavv 144,208,180
mavv 148,212,180
mavv 148,244,176
mavv 152,248,176
mavv 152,216,180
HS_a_7:
s_cmp_eq_u32 s7, 1
s_cbranch_scc1 HS_a_11
mavv 156,220,180
mavv 156,252,176
s_waitcnt lgkmcnt(2)
mavv 160,224,184
s_waitcnt lgkmcnt(0)
s_mov_b32 s61, 94371840
s_cmp_eq_u32 s3, 0
s_cselect_b32 s61, 88113152, s61
tv 176,166,0
mavv 160,192,188
buffer_load_dword v122, v127, s[52:55], s61 offen sc1
mavv 164,196,188
tv 178,166,1024
mavv 164,228,184
mavv 168,232,184
tv 180,166,16384
mavv 168,200,188
mavv 172,204,188
tv 182,166,17408
mavv 172,236,184
mavv 176,240,184
mavv 176,208,188
mavv 180,212,188
mavv 180,244,184
mavv 184,248,184
mavv 184,216,188
mavv 188,220,188
mavv 188,252,184
s_waitcnt lgkmcnt(2)
mavv 192,224,176
s_waitcnt lgkmcnt(0)
tv 184,167,0
mavv 192,192,180
mavv 196,196,180
tv 186,167,1024
mavv 196,228,176
mavv 200,232,176
tv 188,167,16384
mavv 200,200,180
mavv 204,204,180
tv 190,167,17408
mavv 204,236,176
mavv 208,240,176
mavv 208,208,180
mavv 212,212,180
mavv 212,244,176
mavv 216,248,176
mavv 216,216,180
mavv 220,220,180
mavv 220,252,176
s_waitcnt lgkmcnt(2)
s_waitcnt vmcnt(17) lgkmcnt(0)
s_barrier
mavv 224,224,184
tv 176,106,32768
rv 224,104,0
mavv 224,192,188
rv 192,105,0
mavv 228,196,188
tv 178,106,33792
rv 196,105,2048
mavv 228,228,184
rv 228,104,2048
mavv 232,232,184
tv 180,106,49152
rv 232,104,4096
mavv 232,200,188
rv 200,105,4096
mavv 236,204,188
tv 182,106,50176
rv 204,105,6144
mavv 236,236,184
rv 236,104,6144
mavv 240,240,184
rv 240,104,8192
mavv 240,208,188
rv 208,105,8192
mavv 244,212,188
rv 212,105,10240
mavv 244,244,184
s_waitcnt lgkmcnt(11)
rv 244,104,10240
mavv 248,248,184
rv 248,104,12288
mavv 248,216,188
rv 216,105,12288
mavv 252,220,188
rv 220,105,14336
mavv 252,252,184
s_waitcnt lgkmcnt(11)
rv 252,104,14336
mavv 0,224,176
s_waitcnt lgkmcnt(10)
tv 184,107,32768
mavv 0,192,180
mavv 4,196,180
s_mov_b32 s36, s12
s_and_b32 s37, s13, 0xffff
s_mov_b32 s38, 5242880
s_mov_b32 s39, 0x20000
tv 186,107,33792
mavv 4,228,176
mavv 8,232,176
tv 188,107,49152
mavv 8,200,180
s_waitcnt lgkmcnt(12)
mavv 12,204,180
s_waitcnt lgkmcnt(11)
s_sub_u32 s40, s22, 2048
s_subb_u32 s41, s23, 0
s_and_b32 s41, s41, 0xffff
s_cmp_lt_u32 s64, 27
s_cselect_b32 s42, 2213888, 0
s_mov_b32 s43, 0x20000
tv 190,107,50176
mavv 12,236,176
s_waitcnt lgkmcnt(11)
mavv 16,240,176
s_waitcnt lgkmcnt(10)
mavv 16,208,180
s_waitcnt lgkmcnt(9)
mavv 20,212,180
s_waitcnt lgkmcnt(8)
s_lshl_b32 s65, s3, 12
s_mul_i32 s66, s3, 3072
s_add_u32 s66, s66, 90112
mavv 20,244,176
s_waitcnt lgkmcnt(7)
mavv 24,248,176
s_waitcnt lgkmcnt(6)
mavv 24,216,180
s_waitcnt lgkmcnt(5)
mavv 28,220,180
s_waitcnt lgkmcnt(4)
mavv 28,252,176
s_waitcnt lgkmcnt(2)
s_waitcnt vmcnt(0)
v_cmp_ne_u32 vcc, s71, v122
s_cbranch_vccz L_saV_ok
s_mov_b32 s62, 1000000
L_saV:
buffer_load_dword v122, v127, s[52:55], s61 offen sc1
s_waitcnt vmcnt(0)
v_cmp_ne_u32 vcc, s71, v122
s_cbranch_vccz L_saV_ok
s_sub_u32 s62, s62, 1
s_cmp_eq_u32 s62, 0
s_cbranch_scc1 L_saV_ok
s_sleep 4
s_branch L_saV
L_saV_ok:
s_waitcnt lgkmcnt(0)
s_barrier
mavv 32,224,184
tv 176,108,32768
mavv 32,192,188
s_mov_b32 s56, 65536
s_add_u32 m0, s65, 0
mavv 36,196,188
dma 14,52,56,0
tv 178,108,33792
mavv 36,228,184
mavv 40,232,184
tv 180,108,49152
mavv 40,200,188
mavv 44,204,188
tv 182,108,50176
mavv 44,236,184
dma 15,52,56,1024
mavv 48,240,184
mavv 48,208,188
mavv 52,212,188
mavv 52,244,184
mavv 56,248,184
dma 16,52,56,2048
mavv 56,216,188
mavv 60,220,188
mavv 60,252,184
s_waitcnt lgkmcnt(2)
mavv 64,224,176
s_waitcnt lgkmcnt(0)
tv 184,109,32768
mavv 64,192,180
dma 17,52,56,3072
mavv 68,196,180
tv 186,109,33792
mavv 68,228,176
mavv 72,232,176
tv 188,109,49152
mavv 72,200,180
s_mov_b32 s57, 0
s_add_u32 m0, s66, 49152
mavv 76,204,180
dma 18,36,57,0
tv 190,109,50176
mavv 76,236,176
mavv 80,240,176
mavv 80,208,180
mavv 84,212,180
mavv 84,244,176
dma 19,36,57,1024
mavv 88,248,176
mavv 88,216,180
mavv 92,220,180
mavv 92,252,176
s_waitcnt lgkmcnt(2)
s_mov_b32 s58, 0
mavv 96,224,184
s_waitcnt lgkmcnt(0)
dma 20,40,58,2048
tv 176,110,32768
mavv 96,192,188
mavv 100,196,188
tv 178,110,33792
mavv 100,228,184
mavv 104,232,184
s_mov_b32 s56, 66560
s_add_u32 m0, s65, 16384
tv 180,110,49152
mavv 104,200,188
dma 14,52,56,0
mavv 108,204,188
tv 182,110,50176
mavv 108,236,184
mavv 112,240,184
mavv 112,208,188
mavv 116,212,188
dma 15,52,56,1024
mavv 116,244,184
mavv 120,248,184
mavv 120,216,188
mavv 124,220,188
mavv 124,252,184
s_waitcnt lgkmcnt(2)
dma 16,52,56,2048
mavv 128,224,176
s_waitcnt lgkmcnt(0)
tv 184,111,32768
mavv 128,192,180
mavv 132,196,180
tv 186,111,33792
mavv 132,228,176
mavv 136,232,176
dma 17,52,56,3072
tv 188,111,49152
mavv 136,200,180
mavv 140,204,180
tv 190,111,50176
mavv 140,236,176
mavv 144,240,176
s_mov_b32 s57, 262144
s_add_u32 m0, s66, 61440
mavv 144,208,180
dma 18,36,57,0
mavv 148,212,180
mavv 148,244,176
mavv 152,248,176
mavv 152,216,180
mavv 156,220,180
dma 19,36,57,1024
mavv 156,252,176
s_waitcnt lgkmcnt(2)
mavv 160,224,184
s_waitcnt lgkmcnt(0)
tv 176,112,32768
mavv 160,192,188
mavv 164,196,188
s_mov_b32 s58, 110592
tv 178,112,33792
mavv 164,228,184
dma 20,40,58,2048
mavv 168,232,184
tv 180,112,49152
mavv 168,200,188
mavv 172,204,188
tv 182,112,50176
mavv 172,236,184
mavv 176,240,184
mavv 176,208,188
mavv 180,212,188
mavv 180,244,184
mavv 184,248,184
mavv 184,216,188
mavv 188,220,188
mavv 188,252,184
s_waitcnt lgkmcnt(2)
mavv 192,224,176
s_waitcnt lgkmcnt(0)
tv 184,113,32768
mavv 192,192,180
mavv 196,196,180
tv 186,113,33792
mavv 196,228,176
mavv 200,232,176
tv 188,113,49152
mavv 200,200,180
mavv 204,204,180
tv 190,113,50176
mavv 204,236,176
mavv 208,240,176
mavv 208,208,180
mavv 212,212,180
mavv 212,244,176
mavv 216,248,176
mavv 216,216,180
mavv 220,220,180
mavv 220,252,176
s_waitcnt lgkmcnt(2)
s_waitcnt lgkmcnt(0)
s_barrier
mavv 224,224,184
tv 176,106,0
rv 224,104,32768
mavv 224,192,188
rv 192,105,32768
mavv 228,196,188
tv 178,106,1024
rv 196,105,34816
mavv 228,228,184
rv 228,104,34816
mavv 232,232,184
tv 180,106,16384
rv 232,104,36864
mavv 232,200,188
rv 200,105,36864
mavv 236,204,188
tv 182,106,17408
rv 204,105,38912
mavv 236,236,184
rv 236,104,38912
mavv 240,240,184
rv 240,104,40960
mavv 240,208,188
rv 208,105,40960
mavv 244,212,188
rv 212,105,43008
mavv 244,244,184
s_waitcnt lgkmcnt(11)
rv 244,104,43008
mavv 248,248,184
rv 248,104,45056
mavv 248,216,188
rv 216,105,45056
mavv 252,220,188
rv 220,105,47104
mavv 252,252,184
s_waitcnt lgkmcnt(11)
rv 252,104,47104
mavv 0,224,176
s_waitcnt lgkmcnt(10)
tv 184,107,0
mavv 0,192,180
mavv 4,196,180
tv 186,107,1024
mavv 4,228,176
mavv 8,232,176
tv 188,107,16384
mavv 8,200,180
s_waitcnt lgkmcnt(12)
mavv 12,204,180
s_waitcnt lgkmcnt(11)
tv 190,107,17408
mavv 12,236,176
s_waitcnt lgkmcnt(11)
mavv 16,240,176
s_waitcnt lgkmcnt(10)
mavv 16,208,180
s_waitcnt lgkmcnt(9)
mavv 20,212,180
s_waitcnt lgkmcnt(8)
mavv 20,244,176
s_waitcnt lgkmcnt(7)
mavv 24,248,176
s_waitcnt lgkmcnt(6)
mavv 24,216,180
s_waitcnt lgkmcnt(5)
mavv 28,220,180
s_waitcnt lgkmcnt(4)
mavv 28,252,176
s_waitcnt lgkmcnt(2)
s_waitcnt lgkmcnt(0)
s_barrier
mavv 32,224,184
s_mov_b32 s56, 67584
s_add_u32 m0, s65, 32768
tv 176,108,0
mavv 32,192,188
dma 14,52,56,0
mavv 36,196,188
tv 178,108,1024
mavv 36,228,184
mavv 40,232,184
dma 15,52,56,1024
tv 180,108,16384
mavv 40,200,188
mavv 44,204,188
tv 182,108,17408
mavv 44,236,184
dma 16,52,56,2048
mavv 48,240,184
mavv 48,208,188
mavv 52,212,188
dma 17,52,56,3072
mavv 52,244,184
mavv 56,248,184
s_mov_b32 s57, 524288
s_add_u32 m0, s66, 36864
mavv 56,216,188
dma 18,36,57,0
mavv 60,220,188
mavv 60,252,184
s_waitcnt lgkmcnt(2)
mavv 64,224,176
s_waitcnt lgkmcnt(0)
dma 19,36,57,1024
tv 184,109,0
mavv 64,192,180
mavv 68,196,180
s_mov_b32 s58, 221184
tv 186,109,1024
mavv 68,228,176
dma 20,40,58,2048
mavv 72,232,176
tv 188,109,16384
mavv 72,200,180
s_mov_b32 s56, 68608
s_add_u32 m0, s65, 49152
mavv 76,204,180
dma 14,52,56,0
tv 190,109,17408
mavv 76,236,176
mavv 80,240,176
mavv 80,208,180
dma 15,52,56,1024
mavv 84,212,180
mavv 84,244,176
mavv 88,248,176
dma 16,52,56,2048
mavv 88,216,180
mavv 92,220,180
mavv 92,252,176
s_waitcnt lgkmcnt(2)
dma 17,52,56,3072
mavv 96,224,184
s_waitcnt lgkmcnt(0)
tv 176,110,0
mavv 96,192,188
s_mov_b32 s57, 786432
s_add_u32 m0, s66, 24576
mavv 100,196,188
dma 18,36,57,0
tv 178,110,1024
mavv 100,228,184
mavv 104,232,184
tv 180,110,16384
mavv 104,200,188
dma 19,36,57,1024
mavv 108,204,188
tv 182,110,17408
mavv 108,236,184
s_mov_b32 s58, 331776
mavv 112,240,184
dma 20,40,58,2048
mavv 112,208,188
mavv 116,212,188
mavv 116,244,184
mavv 120,248,184
ar 24,0
mavv 120,216,188
ar 25,1
mavv 124,220,188
cv 28,24,25
mavv 124,252,184
s_waitcnt lgkmcnt(2)
ar 26,2
mavv 128,224,176
s_waitcnt lgkmcnt(0)
tv 184,111,0
ar 27,3
mavv 128,192,180
cv 29,26,27
mavv 132,196,180
tv 186,111,1024
s_add_u32 s63, s70, 0
ar 24,4
mavv 132,228,176
ar 25,5
mavv 136,232,176
tv 188,111,16384
cv 30,24,25
mavv 136,200,180
ar 26,6
mavv 140,204,180
tv 190,111,17408
ar 27,7
mavv 140,236,176
cv 31,26,27
mavv 144,240,176
buffer_store_dwordx4 v[28:31], v0, s[52:55], s63 offen offset:0 sc1
mavv 144,208,180
ar 24,8
mavv 148,212,180
ar 25,9
mavv 148,244,176
cv 28,24,25
mavv 152,248,176
ar 26,10
mavv 152,216,180
ar 27,11
mavv 156,220,180
cv 29,26,27
mavv 156,252,176
s_waitcnt lgkmcnt(2)
s_add_u32 s63, s70, 8192
ar 24,12
mavv 160,224,184
s_waitcnt lgkmcnt(0)
tv 176,112,0
ar 25,13
mavv 160,192,188
cv 30,24,25
mavv 164,196,188
tv 178,112,1024
ar 26,14
mavv 164,228,184
ar 27,15
mavv 168,232,184
tv 180,112,16384
cv 31,26,27
mavv 168,200,188
buffer_store_dwordx4 v[28:31], v0, s[52:55], s63 offen offset:0 sc1
mavv 172,204,188
tv 182,112,17408
ar 24,16
mavv 172,236,184
ar 25,17
mavv 176,240,184
cv 28,24,25
mavv 176,208,188
ar 26,18
mavv 180,212,188
ar 27,19
mavv 180,244,184
cv 29,26,27
mavv 184,248,184
s_add_u32 s63, s70, 16384
ar 24,20
mavv 184,216,188
ar 25,21
mavv 188,220,188
cv 30,24,25
mavv 188,252,184
s_waitcnt lgkmcnt(2)
ar 26,22
HS_a_8:
s_cmp_eq_u32 s7, 1
s_cbranch_scc1 HS_a_12
mavv 192,224,176
s_waitcnt lgkmcnt(0)
tv 184,113,0
ar 27,23
mavv 192,192,180
cv 31,26,27
mavv 196,196,180
tv 186,113,1024
buffer_store_dwordx4 v[28:31], v0, s[52:55], s63 offen offset:0 sc1
mavv 196,228,176
ar 24,24
mavv 200,232,176
tv 188,113,16384
ar 25,25
mavv 200,200,180
cv 28,24,25
mavv 204,204,180
tv 190,113,17408
ar 26,26
mavv 204,236,176
ar 27,27
mavv 208,240,176
cv 29,26,27
mavv 208,208,180
s_add_u32 s63, s70, 24576
ar 24,28
mavv 212,212,180
ar 25,29
mavv 212,244,176
cv 30,24,25
mavv 216,248,176
ar 26,30
mavv 216,216,180
ar 27,31
mavv 220,220,180
cv 31,26,27
mavv 220,252,176
s_waitcnt lgkmcnt(2)
s_waitcnt vmcnt(17) lgkmcnt(0)
s_barrier
buffer_store_dwordx4 v[28:31], v0, s[52:55], s63 offen offset:0 sc1
mavv 224,224,184
rv 224,1,0
ar 24,32
mavv 224,192,188
ta 0,2,49152
ar 25,33
mavv 228,196,188
ta 2,2,50176
cv 28,24,25
mavv 228,228,184
rv 228,1,1024
ar 26,34
mavv 232,232,184
rv 232,1,2048
ar 27,35
mavv 232,200,188
ta 4,2,61440
cv 29,26,27
mavv 236,204,188
ta 6,2,62464
s_add_u32 s63, s70, 0
ar 24,36
mavv 236,236,184
rv 236,1,3072
ar 25,37
mavv 240,240,184
rv 240,1,16384
cv 30,24,25
mavv 240,208,188
ta 8,3,49152
ar 26,38
mavv 244,212,188
ta 10,3,50176
ar 27,39
mavv 244,244,184
rv 244,1,17408
cv 31,26,27
mavv 248,248,184
rv 248,1,18432
buffer_store_dwordx4 v[28:31], v0, s[52:55], s63 offen offset:1024 sc1
mavv 248,216,188
ta 12,3,61440
ar 24,40
mavv 252,220,188
ta 14,3,62464
ar 25,41
mavv 252,252,184
s_waitcnt lgkmcnt(11)
rv 252,1,19456
cv 28,24,25
s_cmp_ge_u32 s64, 27
s_cbranch_scc1 L_qhNV
L_qhH:
zvav 96,0,224
s_waitcnt lgkmcnt(7)
ta 16,4,49152
ar 26,42
mvav 96,4,240
s_waitcnt lgkmcnt(5)
s_mov_b32 s57, 1048576
s_add_u32 m0, s66, 12288
ar 27,43
zvav 128,4,244
dma 18,36,57,0
ta 18,4,50176
cv 29,26,27
mvav 128,0,228
s_add_u32 s63, s70, 8192
ar 24,44
zvav 160,0,232
s_waitcnt lgkmcnt(5)
ta 20,4,61440
ar 25,45
mvav 160,4,248
s_waitcnt lgkmcnt(3)
cv 30,24,25
zvav 192,4,252
ta 22,4,62464
ar 26,46
mvav 192,0,236
dma 19,36,57,1024
ar 27,47
zvav 100,8,224
ta 0,5,49152
cv 31,26,27
mvav 100,12,240
buffer_store_dwordx4 v[28:31], v0, s[52:55], s63 offen offset:1024 sc1
zvav 132,12,244
ta 2,5,50176
ar 24,48
mvav 132,8,228
s_mov_b32 s58, 442368
ar 25,49
zvav 164,8,232
dma 20,40,58,2048
ta 4,5,61440
cv 28,24,25
mvav 164,12,248
ar 26,50
zvav 196,12,252
ta 6,5,62464
ar 27,51
mvav 196,8,236
s_waitcnt lgkmcnt(6)
cv 29,26,27
zvav 104,16,224
s_waitcnt lgkmcnt(4)
s_mov_b32 s57, 1310720
s_add_u32 m0, s66, 0
ta 8,6,49152
s_add_u32 s63, s70, 16384
ar 24,52
mvav 104,20,240
dma 18,36,57,0
ar 25,53
zvav 136,20,244
ta 10,6,50176
cv 30,24,25
mvav 136,16,228
ar 26,54
zvav 168,16,232
ta 12,6,61440
ar 27,55
mvav 168,20,248
cv 31,26,27
zvav 200,20,252
dma 19,36,57,1024
ta 14,6,62464
mvav 200,16,236
s_waitcnt lgkmcnt(6)
buffer_store_dwordx4 v[28:31], v0, s[52:55], s63 offen offset:1024 sc1
zvav 108,0,224
s_waitcnt lgkmcnt(4)
ta 16,7,49152
ar 24,56
mvav 108,4,240
ar 25,57
zvav 140,4,244
s_mov_b32 s58, 552960
ta 18,7,50176
cv 28,24,25
mvav 140,0,228
dma 20,40,58,2048
ar 26,58
zvav 172,0,232
ta 20,7,61440
ar 27,59
mvav 172,4,248
cv 29,26,27
zvav 204,4,252
ta 22,7,62464
s_add_u32 s63, s70, 24576
ar 24,60
mvav 204,0,236
s_waitcnt lgkmcnt(6)
ar 25,61
zvav 112,8,224
s_waitcnt lgkmcnt(4)
ta 0,8,49152
cv 30,24,25
mvav 112,12,240
ar 26,62
zvav 144,12,244
ta 2,8,50176
ar 27,63
mvav 144,8,228
cv 31,26,27
zvav 176,8,232
ta 4,8,61440
buffer_store_dwordx4 v[28:31], v0, s[52:55], s63 offen offset:1024 sc1
mvav 176,12,248
ar 24,64
zvav 208,12,252
ta 6,8,62464
ar 25,65
mvav 208,8,236
s_waitcnt lgkmcnt(6)
cv 28,24,25
zvav 116,16,224
s_waitcnt lgkmcnt(4)
ta 8,9,49152
ar 26,66
mvav 116,20,240
ar 27,67
zvav 148,20,244
ta 10,9,50176
cv 29,26,27
mvav 148,16,228
s_add_u32 s63, s70, 0
ar 24,68
zvav 180,16,232
ta 12,9,61440
ar 25,69
mvav 180,20,248
cv 30,24,25
zvav 212,20,252
ta 14,9,62464
ar 26,70
mvav 212,16,236
s_waitcnt lgkmcnt(6)
ar 27,71
zvav 120,0,224
s_waitcnt lgkmcnt(4)
ta 16,10,49152
cv 31,26,27
mvav 120,4,240
zvav 152,4,244
ta 18,10,49664
buffer_store_dwordx4 v[28:31], v0, s[52:55], s63 offen offset:2048 sc1
mvav 152,0,228
zvav 184,0,232
ta 20,10,61440
ar 24,72
mvav 184,4,248
s_mov_b32 s56, 69632
zvav 216,4,252
buffer_load_dwordx4 a[32:35], v14, s[52:55], s56 offen offset:0
ta 22,10,61952
ar 25,73
mvav 216,0,236
s_waitcnt lgkmcnt(6)
zvav 124,8,224
s_waitcnt lgkmcnt(4)
ta 0,11,49152
cv 28,24,25
mvav 124,12,240
buffer_load_dwordx4 a[36:39], v15, s[52:55], s56 offen offset:1024
zvav 156,12,244
ta 2,11,49664
ar 26,74
mvav 156,8,228
zvav 188,8,232
buffer_load_dwordx4 a[40:43], v16, s[52:55], s56 offen offset:2048
ta 4,11,61440
ar 27,75
mvav 188,12,248
zvav 220,12,252
ta 6,11,61952
cv 29,26,27
mvav 220,8,236
s_waitcnt lgkmcnt(6)
buffer_load_dwordx4 a[44:47], v17, s[52:55], s56 offen offset:3072
cvav 32,16,224,80
s_waitcnt lgkmcnt(4)
ta 8,12,49152
s_add_u32 s63, s70, 8192
ar 24,76
mvav 32,20,240
s_mov_b32 s56, 70656
cvav 48,20,244,80
buffer_load_dwordx4 a[48:51], v14, s[52:55], s56 offen offset:0
ta 10,12,49664
ar 25,77
mvav 48,16,228
cvav 64,16,232,80
ta 12,12,61440
cv 30,24,25
mvav 64,20,248
buffer_load_dwordx4 a[52:55], v15, s[52:55], s56 offen offset:1024
mvav 80,20,252
ta 14,12,61952
ar 26,78
mvav 80,16,236
s_waitcnt lgkmcnt(6)
cvav 36,0,224,84
s_waitcnt lgkmcnt(4)
buffer_load_dwordx4 a[56:59], v16, s[52:55], s56 offen offset:2048
ta 16,13,49152
ar 27,79
mvav 36,4,240
cvav 52,4,244,84
ta 18,13,49664
cv 31,26,27
mvav 52,0,228
buffer_load_dwordx4 a[60:63], v17, s[52:55], s56 offen offset:3072
cvav 68,0,232,84
ta 20,13,61440
buffer_store_dwordx4 v[28:31], v0, s[52:55], s63 offen offset:2048 sc1
mvav 68,4,248
mvav 84,4,252
ta 22,13,61952
ar 24,80
mvav 84,0,236
s_waitcnt lgkmcnt(6)
s_waitcnt vmcnt(24) lgkmcnt(0)
s_barrier
cvav 40,8,224,88
ta 0,2,36864
ar 25,81
mvav 40,12,240
s_mov_b32 s57, 1572864
s_add_u32 m0, s66, 49152
cvav 56,12,244,88
dma 18,36,57,0
ta 2,2,37888
cv 28,24,25
mvav 56,8,228
cvav 72,8,232,88
ta 4,2,24576
ar 26,82
mvav 72,12,248
mvav 88,12,252
ta 6,2,25600
ar 27,83
mvav 88,8,236
cvav 44,16,224,92
dma 19,36,57,1024
ta 8,3,36864
rv 224,1,32768
cv 29,26,27
mvav 44,20,240
rv 240,1,49152
cvav 60,20,244,92
ta 10,3,37888
rv 244,1,50176
s_add_u32 s63, s70, 16384
ar 24,84
mvav 60,16,228
rv 228,1,33792
cvav 76,16,232,92
ta 12,3,24576
rv 232,1,34816
ar 25,85
mvav 76,20,248
s_mov_b32 s58, 663552
rv 248,1,51200
mvav 92,20,252
dma 20,40,58,2048
ta 14,3,25600
rv 252,1,52224
cv 30,24,25
mvav 92,16,236
s_waitcnt lgkmcnt(9)
rv 236,1,35840
mvav 96,0,224
s_waitcnt lgkmcnt(9)
ta 16,4,36864
ar 26,86
mvav 96,4,240
s_waitcnt lgkmcnt(8)
mvav 128,4,244
s_waitcnt lgkmcnt(7)
ta 18,4,37888
ar 27,87
mvav 128,0,228
s_waitcnt lgkmcnt(6)
s_mov_b32 s57, 1835008
s_add_u32 m0, s66, 61440
mvav 160,0,232
s_waitcnt lgkmcnt(5)
dma 18,36,57,0
ta 20,4,24576
cv 31,26,27
mvav 160,4,248
s_waitcnt lgkmcnt(4)
mvav 192,4,252
s_waitcnt lgkmcnt(3)
ta 22,4,25600
buffer_store_dwordx4 v[28:31], v0, s[52:55], s63 offen offset:2048 sc1
mvav 192,0,236
mvav 100,8,224
ta 0,5,36864
ar 24,88
mvav 100,12,240
mvav 132,12,244
dma 19,36,57,1024
ta 2,5,37888
ar 25,89
mvav 132,8,228
mvav 164,8,232
ta 4,5,24576
cv 28,24,25
mvav 164,12,248
mvav 196,12,252
ta 6,5,25600
ar 26,90
mvav 196,8,236
s_waitcnt lgkmcnt(6)
s_mov_b32 s58, 774144
mvav 104,16,224
s_waitcnt lgkmcnt(4)
dma 20,40,58,2048
ta 8,6,36864
ar 27,91
mvav 104,20,240
mvav 136,20,244
ta 10,6,37888
cv 29,26,27
mvav 136,16,228
mvav 168,16,232
ta 12,6,24576
s_add_u32 s63, s70, 24576
ar 24,92
mvav 168,20,248
mvav 200,20,252
ta 14,6,25600
ar 25,93
mvav 200,16,236
s_waitcnt lgkmcnt(6)
mvav 108,0,224
s_waitcnt lgkmcnt(4)
ta 16,7,36864
cv 30,24,25
mvav 108,4,240
mvav 140,4,244
ta 18,7,37888
ar 26,94
mvav 140,0,228
mvav 172,0,232
ta 20,7,24576
ar 27,95
mvav 172,4,248
mvav 204,4,252
ta 22,7,25600
cv 31,26,27
mvav 204,0,236
s_waitcnt lgkmcnt(6)
mvav 112,8,224
s_waitcnt lgkmcnt(4)
ta 0,8,36864
buffer_store_dwordx4 v[28:31], v0, s[52:55], s63 offen offset:2048 sc1
mvav 112,12,240
mvav 144,12,244
ta 2,8,37888
ar 24,96
mvav 144,8,228
mvav 176,8,232
ta 4,8,24576
ar 25,97
mvav 176,12,248
mvav 208,12,252
ta 6,8,25600
cv 28,24,25
mvav 208,8,236
s_waitcnt lgkmcnt(6)
mvav 116,16,224
s_waitcnt lgkmcnt(4)
ta 8,9,36864
ar 26,98
mvav 116,20,240
mvav 148,20,244
ta 10,9,37888
ar 27,99
mvav 148,16,228
mvav 180,16,232
ta 12,9,24576
cv 29,26,27
mvav 180,20,248
mvav 212,20,252
ta 14,9,25600
s_add_u32 s63, s70, 0
ar 24,100
mvav 212,16,236
s_waitcnt lgkmcnt(6)
mvav 120,0,224
s_waitcnt lgkmcnt(4)
ta 16,10,36864
ar 25,101
mvav 120,4,240
mvav 152,4,244
ta 18,10,37376
cv 30,24,25
mvav 152,0,228
mvav 184,0,232
ta 20,10,24576
ar 26,102
mvav 184,4,248
s_mov_b32 s56, 71680
mvav 216,4,252
buffer_load_dwordx4 a[64:67], v14, s[52:55], s56 offen offset:0
ta 22,10,25088
ar 27,103
mvav 216,0,236
s_waitcnt lgkmcnt(6)
mvav 124,8,224
s_waitcnt lgkmcnt(4)
ta 0,11,36864
cv 31,26,27
mvav 124,12,240
buffer_load_dwordx4 a[68:71], v15, s[52:55], s56 offen offset:1024
mvav 156,12,244
ta 2,11,37376
buffer_store_dwordx4 v[28:31], v0, s[52:55], s63 offen offset:3072 sc1
mvav 156,8,228
mvav 188,8,232
buffer_load_dwordx4 a[72:75], v16, s[52:55], s56 offen offset:2048
ta 4,11,24576
ar 24,104
mvav 188,12,248
mvav 220,12,252
ta 6,11,25088
ar 25,105
mvav 220,8,236
s_waitcnt lgkmcnt(6)
buffer_load_dwordx4 a[76:79], v17, s[52:55], s56 offen offset:3072
mvav 32,16,224
s_waitcnt lgkmcnt(4)
ta 8,12,36864
cv 28,24,25
HS_a_9:
s_cmp_eq_u32 s7, 1
s_cbranch_scc1 HS_a_13
mvav 32,20,240
s_mov_b32 s56, 72704
mvav 48,20,244
buffer_load_dwordx4 a[80:83], v14, s[52:55], s56 offen offset:0
ta 10,12,37376
ar 26,106
mvav 48,16,228
mvav 64,16,232
ta 12,12,24576
ar 27,107
mvav 64,20,248
buffer_load_dwordx4 a[84:87], v15, s[52:55], s56 offen offset:1024
mvav 80,20,252
ta 14,12,25088
cv 29,26,27
mvav 80,16,236
s_waitcnt lgkmcnt(6)
mvav 36,0,224
s_waitcnt lgkmcnt(4)
buffer_load_dwordx4 a[88:91], v16, s[52:55], s56 offen offset:2048
ta 16,13,36864
s_add_u32 s63, s70, 8192
ar 24,108
mvav 36,4,240
mvav 52,4,244
ta 18,13,37376
ar 25,109
mvav 52,0,228
buffer_load_dwordx4 a[92:95], v17, s[52:55], s56 offen offset:3072
mvav 68,0,232
ta 20,13,24576
cv 30,24,25
mvav 68,4,248
mvav 84,4,252
ta 22,13,25088
ar 26,110
mvav 84,0,236
s_waitcnt lgkmcnt(6)
s_waitcnt vmcnt(28) lgkmcnt(0)
s_barrier
mvav 40,8,224
ta 0,2,12288
ar 27,111
mvav 40,12,240
s_mov_b32 s57, 2097152
s_add_u32 m0, s66, 36864
mvav 56,12,244
dma 18,36,57,0
ta 2,2,13312
cv 31,26,27
mvav 56,8,228
mvav 72,8,232
ta 4,2,0
buffer_store_dwordx4 v[28:31], v0, s[52:55], s63 offen offset:3072 sc1
mvav 72,12,248
mvav 88,12,252
ta 6,2,1024
ar 24,112
mvav 88,8,236
mvav 44,16,224
dma 19,36,57,1024
ta 8,3,12288
ar 25,113
mvav 44,20,240
mvav 60,20,244
ta 10,3,13312
cv 28,24,25
mvav 60,16,228
mvav 76,16,232
ta 12,3,0
ar 26,114
mvav 76,20,248
s_mov_b32 s58, 884736
mvav 92,20,252
dma 20,40,58,2048
ta 14,3,1024
ar 27,115
mvav 92,16,236
s_waitcnt vmcnt(29) lgkmcnt(6)
mvaa 96,0,32
s_waitcnt vmcnt(25) lgkmcnt(4)
ta 16,4,12288
cv 29,26,27
mvaa 96,4,48
s_waitcnt vmcnt(24)
mvaa 128,4,52
ta 18,4,13312
s_add_u32 s63, s70, 16384
ar 24,116
mvaa 128,0,36
s_mov_b32 s57, 2359296
s_add_u32 m0, s66, 24576
mvaa 160,0,40
s_waitcnt vmcnt(23)
dma 18,36,57,0
ta 20,4,0
ar 25,117
mvaa 160,4,56
s_waitcnt vmcnt(23)
mvaa 192,4,60
ta 22,4,1024
cv 30,24,25
mvaa 192,0,44
s_waitcnt lgkmcnt(6)
mvaa 100,8,32
s_waitcnt lgkmcnt(4)
ta 0,5,12288
ar 26,118
mvaa 100,12,48
mvaa 132,12,52
dma 19,36,57,1024
ta 2,5,13312
ar 27,119
mvaa 132,8,36
mvaa 164,8,40
ta 4,5,0
cv 31,26,27
mvaa 164,12,56
mvaa 196,12,60
ta 6,5,1024
buffer_store_dwordx4 v[28:31], v0, s[52:55], s63 offen offset:3072 sc1
mvaa 196,8,44
s_waitcnt lgkmcnt(6)
s_mov_b32 s58, 995328
mvaa 104,16,32
s_waitcnt lgkmcnt(4)
dma 20,40,58,2048
ta 8,6,12288
ar 24,120
mvaa 104,20,48
mvaa 136,20,52
ta 10,6,13312
ar 25,121
mvaa 136,16,36
mvaa 168,16,40
ta 12,6,0
cv 28,24,25
mvaa 168,20,56
mvaa 200,20,60
ta 14,6,1024
ar 26,122
mvaa 200,16,44
s_waitcnt lgkmcnt(6)
mvaa 108,0,32
s_waitcnt lgkmcnt(4)
ta 16,7,12288
ar 27,123
mvaa 108,4,48
mvaa 140,4,52
ta 18,7,13312
cv 29,26,27
mvaa 140,0,36
mvaa 172,0,40
ta 20,7,0
s_add_u32 s63, s70, 24576
ar 24,124
mvaa 172,4,56
mvaa 204,4,60
ta 22,7,1024
ar 25,125
mvaa 204,0,44
s_waitcnt lgkmcnt(6)
mvaa 112,8,32
s_waitcnt lgkmcnt(4)
ta 0,8,12288
cv 30,24,25
mvaa 112,12,48
mvaa 144,12,52
ta 2,8,13312
ar 26,126
mvaa 144,8,36
mvaa 176,8,40
ta 4,8,0
ar 27,127
mvaa 176,12,56
mvaa 208,12,60
ta 6,8,1024
cv 31,26,27
mvaa 208,8,44
s_waitcnt lgkmcnt(6)
mvaa 116,16,32
s_waitcnt lgkmcnt(4)
ta 8,9,12288
buffer_store_dwordx4 v[28:31], v0, s[52:55], s63 offen offset:3072 sc1
mvaa 116,20,48
mvaa 148,20,52
ta 10,9,13312
ar 24,128
mvaa 148,16,36
mvaa 180,16,40
ta 12,9,0
ar 25,129
mvaa 180,20,56
mvaa 212,20,60
ta 14,9,1024
cv 28,24,25
mvaa 212,16,44
s_waitcnt lgkmcnt(6)
mvaa 120,0,32
s_waitcnt lgkmcnt(4)
ta 16,10,12288
ar 26,130
mvaa 120,4,48
mvaa 152,4,52
ta 18,10,12800
ar 27,131
mvaa 152,0,36
mvaa 184,0,40
ta 20,10,0
cv 29,26,27
mvaa 184,4,56
s_mov_b32 s56, 73728
mvaa 216,4,60
buffer_load_dwordx4 a[96:99], v14, s[52:55], s56 offen offset:0
ta 22,10,512
s_add_u32 s63, s70, 4096
ar 24,132
mvaa 216,0,44
s_waitcnt lgkmcnt(6)
mvaa 124,8,32
s_waitcnt lgkmcnt(4)
ta 0,11,12288
ar 25,133
mvaa 124,12,48
buffer_load_dwordx4 a[100:103], v15, s[52:55], s56 offen offset:1024
mvaa 156,12,52
ta 2,11,12800
cv 30,24,25
mvaa 156,8,36
mvaa 188,8,40
buffer_load_dwordx4 a[104:107], v16, s[52:55], s56 offen offset:2048
ta 4,11,0
ar 26,134
mvaa 188,12,56
mvaa 220,12,60
ta 6,11,512
ar 27,135
mvaa 220,8,44
s_waitcnt lgkmcnt(6)
buffer_load_dwordx4 a[108:111], v17, s[52:55], s56 offen offset:3072
mvaa 32,16,32
s_waitcnt lgkmcnt(4)
ta 8,12,12288
cv 31,26,27
mvaa 32,20,48
s_mov_b32 s56, 74752
mvaa 48,20,52
buffer_load_dwordx4 a[112:115], v14, s[52:55], s56 offen offset:0
ta 10,12,12800
mvaa 48,16,36
mvaa 64,16,40
ta 12,12,0
buffer_store_dwordx4 v[28:31], v0, s[52:55], s63 offen offset:0 sc1
mvaa 64,20,56
buffer_load_dwordx4 a[116:119], v15, s[52:55], s56 offen offset:1024
mvaa 80,20,60
ta 14,12,512
ar 24,136
mvaa 80,16,44
s_waitcnt lgkmcnt(6)
mvaa 36,0,32
s_waitcnt lgkmcnt(4)
buffer_load_dwordx4 a[120:123], v16, s[52:55], s56 offen offset:2048
ta 16,13,12288
ar 25,137
mvaa 36,4,48
mvaa 52,4,52
ta 18,13,12800
cv 28,24,25
mvaa 52,0,36
buffer_load_dwordx4 a[124:127], v17, s[52:55], s56 offen offset:3072
mvaa 68,0,40
ta 20,13,0
ar 26,138
mvaa 68,4,56
mvaa 84,4,60
ta 22,13,512
ar 27,139
mvaa 84,0,44
s_waitcnt lgkmcnt(6)
s_waitcnt vmcnt(28) lgkmcnt(0)
s_barrier
mvaa 40,8,32
ta 0,2,49152
cv 29,26,27
mvaa 40,12,48
s_mov_b32 s57, 2621440
s_add_u32 m0, s66, 12288
mvaa 56,12,52
dma 18,36,57,0
ta 2,2,50176
s_add_u32 s63, s70, 12288
ar 24,140
mvaa 56,8,36
mvaa 72,8,40
ta 4,2,61440
ar 25,141
mvaa 72,12,56
mvaa 88,12,60
ta 6,2,62464
cv 30,24,25
mvaa 88,8,44
mvaa 44,16,32
dma 19,36,57,1024
ta 8,3,49152
ar 26,142
mvaa 44,20,48
mvaa 60,20,52
ta 10,3,50176
ar 27,143
mvaa 60,16,36
mvaa 76,16,40
ta 12,3,61440
cv 31,26,27
mvaa 76,20,56
s_mov_b32 s58, 1105920
mvaa 92,20,60
dma 20,40,58,2048
ta 14,3,62464
mvaa 92,16,44
s_waitcnt vmcnt(29) lgkmcnt(6)
mvaa 96,0,64
s_waitcnt vmcnt(24) lgkmcnt(4)
ta 16,4,49152
buffer_store_dwordx4 v[28:31], v0, s[52:55], s63 offen offset:0 sc1
mvaa 96,4,80
s_waitcnt vmcnt(24)
mvaa 128,4,84
ta 18,4,50176
ar 24,144
mvaa 128,0,68
s_mov_b32 s57, 2883584
s_add_u32 m0, s66, 0
mvaa 160,0,72
s_waitcnt vmcnt(23)
dma 18,36,57,0
ta 20,4,61440
ar 25,145
mvaa 160,4,88
s_waitcnt vmcnt(23)
mvaa 192,4,92
ta 22,4,62464
cv 28,24,25
mvaa 192,0,76
s_waitcnt lgkmcnt(6)
mvaa 100,8,64
s_waitcnt lgkmcnt(4)
ta 0,5,49152
ar 26,146
mvaa 100,12,80
mvaa 132,12,84
dma 19,36,57,1024
ta 2,5,50176
ar 27,147
mvaa 132,8,68
mvaa 164,8,72
ta 4,5,61440
cv 29,26,27
mvaa 164,12,88
mvaa 196,12,92
ta 6,5,62464
s_add_u32 s63, s70, 20480
ar 24,148
mvaa 196,8,76
s_waitcnt lgkmcnt(6)
s_mov_b32 s58, 1216512
mvaa 104,16,64
s_waitcnt lgkmcnt(4)
dma 20,40,58,2048
ta 8,6,49152
ar 25,149
mvaa 104,20,80
mvaa 136,20,84
ta 10,6,50176
cv 30,24,25
mvaa 136,16,68
mvaa 168,16,72
ta 12,6,61440
ar 26,150
mvaa 168,20,88
mvaa 200,20,92
ta 14,6,62464
ar 27,151
mvaa 200,16,76
s_waitcnt lgkmcnt(6)
mvaa 108,0,64
s_waitcnt lgkmcnt(4)
ta 16,7,49152
cv 31,26,27
mvaa 108,4,80
mvaa 140,4,84
ta 18,7,50176
buffer_store_dwordx4 v[28:31], v0, s[52:55], s63 offen offset:0 sc1
mvaa 140,0,68
mvaa 172,0,72
ta 20,7,61440
ar 24,152
mvaa 172,4,88
mvaa 204,4,92
ta 22,7,62464
ar 25,153
mvaa 204,0,76
s_waitcnt lgkmcnt(6)
mvaa 112,8,64
s_waitcnt lgkmcnt(4)
ta 0,8,49152
cv 28,24,25
mvaa 112,12,80
mvaa 144,12,84
ta 2,8,50176
ar 26,154
mvaa 144,8,68
mvaa 176,8,72
ta 4,8,61440
ar 27,155
mvaa 176,12,88
mvaa 208,12,92
ta 6,8,62464
cv 29,26,27
mvaa 208,8,76
s_waitcnt lgkmcnt(6)
mvaa 116,16,64
s_waitcnt lgkmcnt(4)
ta 8,9,49152
s_add_u32 s63, s70, 28672
ar 24,156
mvaa 116,20,80
mvaa 148,20,84
ta 10,9,50176
ar 25,157
mvaa 148,16,68
mvaa 180,16,72
ta 12,9,61440
cv 30,24,25
mvaa 180,20,88
mvaa 212,20,92
ta 14,9,62464
ar 26,158
mvaa 212,16,76
s_waitcnt lgkmcnt(6)
mvaa 120,0,64
s_waitcnt lgkmcnt(4)
ta 16,10,49152
ar 27,159
mvaa 120,4,80
mvaa 152,4,84
ta 18,10,49664
cv 31,26,27
mvaa 152,0,68
mvaa 184,0,72
ta 20,10,61440
buffer_store_dwordx4 v[28:31], v0, s[52:55], s63 offen offset:0 sc1
mvaa 184,4,88
s_mov_b32 s56, 75776
mvaa 216,4,92
buffer_load_dwordx4 a[32:35], v14, s[52:55], s56 offen offset:0
ta 22,10,61952
ar 24,160
mvaa 216,0,76
s_waitcnt lgkmcnt(6)
mvaa 124,8,64
s_waitcnt lgkmcnt(4)
ta 0,11,49152
ar 25,161
mvaa 124,12,80
buffer_load_dwordx4 a[36:39], v15, s[52:55], s56 offen offset:1024
mvaa 156,12,84
ta 2,11,49664
cv 28,24,25
mvaa 156,8,68
mvaa 188,8,72
buffer_load_dwordx4 a[40:43], v16, s[52:55], s56 offen offset:2048
ta 4,11,61440
ar 26,162
mvaa 188,12,88
mvaa 220,12,92
ta 6,11,61952
ar 27,163
mvaa 220,8,76
s_waitcnt lgkmcnt(6)
buffer_load_dwordx4 a[44:47], v17, s[52:55], s56 offen offset:3072
mvaa 32,16,64
s_waitcnt lgkmcnt(4)
ta 8,12,49152
cv 29,26,27
mvaa 32,20,80
s_mov_b32 s56, 76800
mvaa 48,20,84
buffer_load_dwordx4 a[48:51], v14, s[52:55], s56 offen offset:0
ta 10,12,49664
s_add_u32 s63, s70, 4096
ar 24,164
mvaa 48,16,68
mvaa 64,16,72
ta 12,12,61440
ar 25,165
mvaa 64,20,88
buffer_load_dwordx4 a[52:55], v15, s[52:55], s56 offen offset:1024
mvaa 80,20,92
ta 14,12,61952
cv 30,24,25
mvaa 80,16,76
s_waitcnt lgkmcnt(6)
mvaa 36,0,64
s_waitcnt lgkmcnt(4)
buffer_load_dwordx4 a[56:59], v16, s[52:55], s56 offen offset:2048
ta 16,13,49152
ar 26,166
mvaa 36,4,80
mvaa 52,4,84
ta 18,13,49664
ar 27,167
mvaa 52,0,68
buffer_load_dwordx4 a[60:63], v17, s[52:55], s56 offen offset:3072
mvaa 68,0,72
ta 20,13,61440
cv 31,26,27
mvaa 68,4,88
mvaa 84,4,92
ta 22,13,61952
buffer_store_dwordx4 v[28:31], v0, s[52:55], s63 offen offset:1024 sc1
mvaa 84,0,76
s_waitcnt lgkmcnt(6)
s_waitcnt vmcnt(28) lgkmcnt(0)
s_barrier
mvaa 40,8,64
ta 0,2,36864
ar 24,168
mvaa 40,12,80
s_mov_b32 s57, 3145728
s_add_u32 m0, s66, 49152
mvaa 56,12,84
dma 18,36,57,0
ta 2,2,37888
ar 25,169
mvaa 56,8,68
mvaa 72,8,72
ta 4,2,24576
cv 28,24,25
mvaa 72,12,88
HS_a_10:
s_cmp_eq_u32 s7, 1
s_cbranch_scc1 HOP_a_ret
mvaa 88,12,92
ta 6,2,25600
ar 26,170
mvaa 88,8,76
mvaa 44,16,64
dma 19,36,57,1024
ta 8,3,36864
ar 27,171
mvaa 44,20,80
mvaa 60,20,84
ta 10,3,37888
cv 29,26,27
mvaa 60,16,68
mvaa 76,16,72
ta 12,3,24576
s_add_u32 s63, s70, 12288
ar 24,172
mvaa 76,20,88
s_mov_b32 s58, 1327104
mvaa 92,20,92
dma 20,40,58,2048
ta 14,3,25600
ar 25,173
mvaa 92,16,76
s_waitcnt vmcnt(29) lgkmcnt(6)
mvaa 96,0,96
s_waitcnt vmcnt(25) lgkmcnt(4)
ta 16,4,36864
cv 30,24,25
mvaa 96,4,112
s_waitcnt vmcnt(23)
mvaa 128,4,116
ta 18,4,37888
ar 26,174
mvaa 128,0,100
s_mov_b32 s57, 3407872
s_add_u32 m0, s66, 61440
mvaa 160,0,104
s_waitcnt vmcnt(22)
dma 18,36,57,0
ta 20,4,24576
ar 27,175
mvaa 160,4,120
s_waitcnt vmcnt(22)
mvaa 192,4,124
ta 22,4,25600
cv 31,26,27
mvaa 192,0,108
s_waitcnt lgkmcnt(6)
mvaa 100,8,96
s_waitcnt lgkmcnt(4)
ta 0,5,36864
buffer_store_dwordx4 v[28:31], v0, s[52:55], s63 offen offset:1024 sc1
mvaa 100,12,112
mvaa 132,12,116
dma 19,36,57,1024
ta 2,5,37888
ar 24,176
mvaa 132,8,100
mvaa 164,8,104
ta 4,5,24576
ar 25,177
mvaa 164,12,120
mvaa 196,12,124
ta 6,5,25600
cv 28,24,25
mvaa 196,8,108
s_waitcnt lgkmcnt(6)
s_mov_b32 s58, 1437696
mvaa 104,16,96
s_waitcnt lgkmcnt(4)
dma 20,40,58,2048
ta 8,6,36864
ar 26,178
mvaa 104,20,112
mvaa 136,20,116
ta 10,6,37888
ar 27,179
mvaa 136,16,100
mvaa 168,16,104
ta 12,6,24576
cv 29,26,27
mvaa 168,20,120
mvaa 200,20,124
ta 14,6,25600
s_add_u32 s63, s70, 20480
ar 24,180
mvaa 200,16,108
s_waitcnt lgkmcnt(6)
mvaa 108,0,96
s_waitcnt lgkmcnt(4)
ta 16,7,36864
ar 25,181
mvaa 108,4,112
mvaa 140,4,116
ta 18,7,37888
cv 30,24,25
mvaa 140,0,100
mvaa 172,0,104
ta 20,7,24576
ar 26,182
mvaa 172,4,120
mvaa 204,4,124
ta 22,7,25600
ar 27,183
mvaa 204,0,108
s_waitcnt lgkmcnt(6)
mvaa 112,8,96
s_waitcnt lgkmcnt(4)
ta 0,8,36864
cv 31,26,27
mvaa 112,12,112
mvaa 144,12,116
ta 2,8,37888
buffer_store_dwordx4 v[28:31], v0, s[52:55], s63 offen offset:1024 sc1
mvaa 144,8,100
mvaa 176,8,104
ta 4,8,24576
ar 24,184
mvaa 176,12,120
mvaa 208,12,124
ta 6,8,25600
ar 25,185
mvaa 208,8,108
s_waitcnt lgkmcnt(6)
mvaa 116,16,96
s_waitcnt lgkmcnt(4)
ta 8,9,36864
cv 28,24,25
mvaa 116,20,112
mvaa 148,20,116
ta 10,9,37888
ar 26,186
mvaa 148,16,100
mvaa 180,16,104
ta 12,9,24576
ar 27,187
mvaa 180,20,120
mvaa 212,20,124
ta 14,9,25600
cv 29,26,27
mvaa 212,16,108
s_waitcnt lgkmcnt(6)
mvaa 120,0,96
s_waitcnt lgkmcnt(4)
ta 16,10,36864
s_add_u32 s63, s70, 28672
ar 24,188
mvaa 120,4,112
mvaa 152,4,116
ta 18,10,37376
ar 25,189
mvaa 152,0,100
mvaa 184,0,104
ta 20,10,24576
cv 30,24,25
mvaa 184,4,120
s_mov_b32 s56, 77824
mvaa 216,4,124
buffer_load_dwordx4 a[64:67], v14, s[52:55], s56 offen offset:0
ta 22,10,25088
ar 26,190
mvaa 216,0,108
s_waitcnt lgkmcnt(6)
mvaa 124,8,96
s_waitcnt lgkmcnt(4)
ta 0,11,36864
ar 27,191
mvaa 124,12,112
buffer_load_dwordx4 a[68:71], v15, s[52:55], s56 offen offset:1024
mvaa 156,12,116
ta 2,11,37376
cv 31,26,27
mvaa 156,8,100
mvaa 188,8,104
buffer_load_dwordx4 a[72:75], v16, s[52:55], s56 offen offset:2048
ta 4,11,24576
mvaa 188,12,120
mvaa 220,12,124
ta 6,11,25088
buffer_store_dwordx4 v[28:31], v0, s[52:55], s63 offen offset:1024 sc1
mvaa 220,8,108
s_waitcnt lgkmcnt(6)
buffer_load_dwordx4 a[76:79], v17, s[52:55], s56 offen offset:3072
mvaa 32,16,96
s_waitcnt lgkmcnt(4)
ta 8,12,36864
ar 24,192
mvaa 32,20,112
s_mov_b32 s56, 78848
mvaa 48,20,116
buffer_load_dwordx4 a[80:83], v14, s[52:55], s56 offen offset:0
ta 10,12,37376
ar 25,193
mvaa 48,16,100
mvaa 64,16,104
ta 12,12,24576
cv 28,24,25
mvaa 64,20,120
buffer_load_dwordx4 a[84:87], v15, s[52:55], s56 offen offset:1024
mvaa 80,20,124
ta 14,12,25088
ar 26,194
mvaa 80,16,108
s_waitcnt lgkmcnt(6)
mvaa 36,0,96
s_waitcnt lgkmcnt(4)
buffer_load_dwordx4 a[88:91], v16, s[52:55], s56 offen offset:2048
ta 16,13,36864
ar 27,195
mvaa 36,4,112
mvaa 52,4,116
ta 18,13,37376
cv 29,26,27
mvaa 52,0,100
buffer_load_dwordx4 a[92:95], v17, s[52:55], s56 offen offset:3072
mvaa 68,0,104
ta 20,13,24576
s_add_u32 s63, s70, 4096
ar 24,196
mvaa 68,4,120
mvaa 84,4,124
ta 22,13,25088
ar 25,197
mvaa 84,0,108
s_waitcnt lgkmcnt(6)
s_waitcnt vmcnt(28) lgkmcnt(0)
s_barrier
mvaa 40,8,96
ta 0,2,12288
cv 30,24,25
mvaa 40,12,112
s_mov_b32 s57, 3670016
s_add_u32 m0, s66, 36864
mvaa 56,12,116
dma 18,36,57,0
ta 2,2,13312
ar 26,198
mvaa 56,8,100
mvaa 72,8,104
ta 4,2,0
ar 27,199
mvaa 72,12,120
mvaa 88,12,124
ta 6,2,1024
cv 31,26,27
mvaa 88,8,108
mvaa 44,16,96
dma 19,36,57,1024
ta 8,3,12288
mvaa 44,20,112
mvaa 60,20,116
ta 10,3,13312
buffer_store_dwordx4 v[28:31], v0, s[52:55], s63 offen offset:2048 sc1
mvaa 60,16,100
mvaa 76,16,104
ta 12,3,0
ar 24,200
mvaa 76,20,120
s_mov_b32 s58, 1548288
mvaa 92,20,124
dma 20,40,58,2048
ta 14,3,1024
ar 25,201
mvaa 92,16,108
s_waitcnt vmcnt(29) lgkmcnt(6)
mvaa 96,0,32
s_waitcnt vmcnt(25) lgkmcnt(4)
ta 16,4,12288
cv 28,24,25
mvaa 96,4,48
s_waitcnt vmcnt(24)
mvaa 128,4,52
ta 18,4,13312
ar 26,202
mvaa 128,0,36
s_mov_b32 s57, 3932160
s_add_u32 m0, s66, 24576
mvaa 160,0,40
s_waitcnt vmcnt(23)
dma 18,36,57,0
ta 20,4,0
ar 27,203
mvaa 160,4,56
s_waitcnt vmcnt(23)
mvaa 192,4,60
ta 22,4,1024
cv 29,26,27
mvaa 192,0,44
s_waitcnt lgkmcnt(6)
mvaa 100,8,32
s_waitcnt lgkmcnt(4)
ta 0,5,12288
s_add_u32 s63, s70, 12288
ar 24,204
mvaa 100,12,48
mvaa 132,12,52
dma 19,36,57,1024
ta 2,5,13312
ar 25,205
mvaa 132,8,36
mvaa 164,8,40
ta 4,5,0
cv 30,24,25
mvaa 164,12,56
mvaa 196,12,60
ta 6,5,1024
ar 26,206
mvaa 196,8,44
s_waitcnt lgkmcnt(6)
s_mov_b32 s58, 1658880
mvaa 104,16,32
s_waitcnt lgkmcnt(4)
dma 20,40,58,2048
ta 8,6,12288
ar 27,207
mvaa 104,20,48
mvaa 136,20,52
ta 10,6,13312
cv 31,26,27
mvaa 136,16,36
mvaa 168,16,40
ta 12,6,0
buffer_store_dwordx4 v[28:31], v0, s[52:55], s63 offen offset:2048 sc1
mvaa 168,20,56
mvaa 200,20,60
ta 14,6,1024
ar 24,208
mvaa 200,16,44
s_waitcnt lgkmcnt(6)
mvaa 108,0,32
s_waitcnt lgkmcnt(4)
ta 16,7,12288
ar 25,209
mvaa 108,4,48
mvaa 140,4,52
ta 18,7,13312
cv 28,24,25
mvaa 140,0,36
mvaa 172,0,40
ta 20,7,0
ar 26,210
mvaa 172,4,56
mvaa 204,4,60
ta 22,7,1024
ar 27,211
mvaa 204,0,44
s_waitcnt lgkmcnt(6)
mvaa 112,8,32
s_waitcnt lgkmcnt(4)
ta 0,8,12288
cv 29,26,27
mvaa 112,12,48
mvaa 144,12,52
ta 2,8,13312
s_add_u32 s63, s70, 20480
ar 24,212
mvaa 144,8,36
mvaa 176,8,40
ta 4,8,0
ar 25,213
mvaa 176,12,56
mvaa 208,12,60
ta 6,8,1024
cv 30,24,25
mvaa 208,8,44
s_waitcnt lgkmcnt(6)
mvaa 116,16,32
s_waitcnt lgkmcnt(4)
ta 8,9,12288
ar 26,214
mvaa 116,20,48
mvaa 148,20,52
ta 10,9,13312
ar 27,215
mvaa 148,16,36
mvaa 180,16,40
ta 12,9,0
cv 31,26,27
mvaa 180,20,56
mvaa 212,20,60
ta 14,9,1024
buffer_store_dwordx4 v[28:31], v0, s[52:55], s63 offen offset:2048 sc1
mvaa 212,16,44
s_waitcnt lgkmcnt(6)
mvaa 120,0,32
s_waitcnt lgkmcnt(4)
ta 16,10,12288
ar 24,216
mvaa 120,4,48
mvaa 152,4,52
ta 18,10,12800
ar 25,217
mvaa 152,0,36
mvaa 184,0,40
ta 20,10,0
cv 28,24,25
mvaa 184,4,56
s_mov_b32 s56, 79872
mvaa 216,4,60
buffer_load_dwordx4 a[96:99], v14, s[52:55], s56 offen offset:0
ta 22,10,512
ar 26,218
mvaa 216,0,44
s_waitcnt lgkmcnt(6)
mvaa 124,8,32
s_waitcnt lgkmcnt(4)
ta 0,11,12288
ar 27,219
mvaa 124,12,48
buffer_load_dwordx4 a[100:103], v15, s[52:55], s56 offen offset:1024
mvaa 156,12,52
ta 2,11,12800
cv 29,26,27
mvaa 156,8,36
mvaa 188,8,40
buffer_load_dwordx4 a[104:107], v16, s[52:55], s56 offen offset:2048
ta 4,11,0
s_add_u32 s63, s70, 28672
ar 24,220
mvaa 188,12,56
mvaa 220,12,60
ta 6,11,512
ar 25,221
mvaa 220,8,44
s_waitcnt lgkmcnt(6)
buffer_load_dwordx4 a[108:111], v17, s[52:55], s56 offen offset:3072
mvaa 32,16,32
s_waitcnt lgkmcnt(4)
ta 8,12,12288
cv 30,24,25
mvaa 32,20,48
s_mov_b32 s56, 80896
mvaa 48,20,52
buffer_load_dwordx4 a[112:115], v14, s[52:55], s56 offen offset:0
ta 10,12,12800
ar 26,222
mvaa 48,16,36
mvaa 64,16,40
ta 12,12,0
ar 27,223
mvaa 64,20,56
buffer_load_dwordx4 a[116:119], v15, s[52:55], s56 offen offset:1024
mvaa 80,20,60
ta 14,12,512
cv 31,26,27
mvaa 80,16,44
s_waitcnt lgkmcnt(6)
mvaa 36,0,32
s_waitcnt lgkmcnt(4)
buffer_load_dwordx4 a[120:123], v16, s[52:55], s56 offen offset:2048
ta 16,13,12288
mvaa 36,4,48
mvaa 52,4,52
ta 18,13,12800
buffer_store_dwordx4 v[28:31], v0, s[52:55], s63 offen offset:2048 sc1
mvaa 52,0,36
buffer_load_dwordx4 a[124:127], v17, s[52:55], s56 offen offset:3072
mvaa 68,0,40
ta 20,13,0
ar 24,224
mvaa 68,4,56
mvaa 84,4,60
ta 22,13,512
ar 25,225
mvaa 84,0,44
s_waitcnt lgkmcnt(6)
s_waitcnt vmcnt(28) lgkmcnt(0)
s_barrier
mvaa 40,8,32
ta 0,2,49152
cv 28,24,25
mvaa 40,12,48
s_mov_b32 s57, 4194304
s_add_u32 m0, s66, 12288
mvaa 56,12,52
dma 18,36,57,0
ta 2,2,50176
ar 26,226
mvaa 56,8,36
mvaa 72,8,40
ta 4,2,61440
ar 27,227
mvaa 72,12,56
mvaa 88,12,60
ta 6,2,62464
cv 29,26,27
mvaa 88,8,44
mvaa 44,16,32
dma 19,36,57,1024
ta 8,3,49152
s_add_u32 s63, s70, 4096
ar 24,228
mvaa 44,20,48
mvaa 60,20,52
ta 10,3,50176
ar 25,229
mvaa 60,16,36
mvaa 76,16,40
ta 12,3,61440
cv 30,24,25
mvaa 76,20,56
s_mov_b32 s58, 1769472
mvaa 92,20,60
dma 20,40,58,2048
ta 14,3,62464
ar 26,230
mvaa 92,16,44
s_waitcnt vmcnt(29) lgkmcnt(6)
mvaa 96,0,64
s_waitcnt vmcnt(24) lgkmcnt(4)
ta 16,4,49152
ar 27,231
mvaa 96,4,80
s_waitcnt vmcnt(23)
mvaa 128,4,84
ta 18,4,50176
cv 31,26,27
mvaa 128,0,68
s_mov_b32 s57, 4456448
s_add_u32 m0, s66, 0
mvaa 160,0,72
s_waitcnt vmcnt(22)
dma 18,36,57,0
ta 20,4,61440
mvaa 160,4,88
s_waitcnt vmcnt(22)
mvaa 192,4,92
ta 22,4,62464
buffer_store_dwordx4 v[28:31], v0, s[52:55], s63 offen offset:3072 sc1
mvaa 192,0,76
s_waitcnt lgkmcnt(6)
mvaa 100,8,64
s_waitcnt lgkmcnt(4)
ta 0,5,49152
ar 24,232
mvaa 100,12,80
mvaa 132,12,84
dma 19,36,57,1024
ta 2,5,50176
ar 25,233
HS_a_11:
s_cmp_eq_u32 s7, 1
s_cbranch_scc1 HOP_a_ret
mvaa 132,8,68
mvaa 164,8,72
ta 4,5,61440
cv 28,24,25
mvaa 164,12,88
mvaa 196,12,92
ta 6,5,62464
ar 26,234
mvaa 196,8,76
s_waitcnt lgkmcnt(6)
s_mov_b32 s58, 1880064
mvaa 104,16,64
s_waitcnt lgkmcnt(4)
dma 20,40,58,2048
ta 8,6,49152
ar 27,235
mvaa 104,20,80
mvaa 136,20,84
ta 10,6,50176
cv 29,26,27
mvaa 136,16,68
mvaa 168,16,72
ta 12,6,61440
s_add_u32 s63, s70, 12288
ar 24,236
mvaa 168,20,88
mvaa 200,20,92
ta 14,6,62464
ar 25,237
mvaa 200,16,76
s_waitcnt lgkmcnt(6)
mvaa 108,0,64
s_waitcnt lgkmcnt(4)
ta 16,7,49152
cv 30,24,25
mvaa 108,4,80
mvaa 140,4,84
ta 18,7,50176
ar 26,238
mvaa 140,0,68
mvaa 172,0,72
ta 20,7,61440
ar 27,239
mvaa 172,4,88
mvaa 204,4,92
ta 22,7,62464
cv 31,26,27
mvaa 204,0,76
s_waitcnt lgkmcnt(6)
mvaa 112,8,64
s_waitcnt lgkmcnt(4)
ta 0,8,49152
buffer_store_dwordx4 v[28:31], v0, s[52:55], s63 offen offset:3072 sc1
mvaa 112,12,80
mvaa 144,12,84
ta 2,8,50176
ar 24,240
mvaa 144,8,68
mvaa 176,8,72
ta 4,8,61440
ar 25,241
mvaa 176,12,88
mvaa 208,12,92
ta 6,8,62464
cv 28,24,25
mvaa 208,8,76
s_waitcnt lgkmcnt(6)
mvaa 116,16,64
s_waitcnt lgkmcnt(4)
ta 8,9,49152
ar 26,242
mvaa 116,20,80
mvaa 148,20,84
ta 10,9,50176
ar 27,243
mvaa 148,16,68
mvaa 180,16,72
ta 12,9,61440
cv 29,26,27
mvaa 180,20,88
mvaa 212,20,92
ta 14,9,62464
s_add_u32 s63, s70, 20480
ar 24,244
mvaa 212,16,76
s_waitcnt lgkmcnt(6)
mvaa 120,0,64
s_waitcnt lgkmcnt(4)
ta 16,10,49152
ar 25,245
mvaa 120,4,80
mvaa 152,4,84
ta 18,10,49664
cv 30,24,25
mvaa 152,0,68
mvaa 184,0,72
ta 20,10,61440
ar 26,246
mvaa 184,4,88
s_mov_b32 s56, 81920
mvaa 216,4,92
buffer_load_dwordx4 a[32:35], v14, s[52:55], s56 offen offset:0
ta 22,10,61952
ar 27,247
mvaa 216,0,76
s_waitcnt lgkmcnt(6)
mvaa 124,8,64
s_waitcnt lgkmcnt(4)
ta 0,11,49152
cv 31,26,27
mvaa 124,12,80
buffer_load_dwordx4 a[36:39], v15, s[52:55], s56 offen offset:1024
mvaa 156,12,84
ta 2,11,49664
buffer_store_dwordx4 v[28:31], v0, s[52:55], s63 offen offset:3072 sc1
mvaa 156,8,68
mvaa 188,8,72
buffer_load_dwordx4 a[40:43], v16, s[52:55], s56 offen offset:2048
ta 4,11,61440
ar 24,248
mvaa 188,12,88
mvaa 220,12,92
ta 6,11,61952
ar 25,249
mvaa 220,8,76
s_waitcnt lgkmcnt(6)
buffer_load_dwordx4 a[44:47], v17, s[52:55], s56 offen offset:3072
mvaa 32,16,64
s_waitcnt lgkmcnt(4)
ta 8,12,49152
cv 28,24,25
mvaa 32,20,80
s_mov_b32 s56, 82944
mvaa 48,20,84
buffer_load_dwordx4 a[48:51], v14, s[52:55], s56 offen offset:0
ta 10,12,49664
ar 26,250
mvaa 48,16,68
mvaa 64,16,72
ta 12,12,61440
ar 27,251
mvaa 64,20,88
buffer_load_dwordx4 a[52:55], v15, s[52:55], s56 offen offset:1024
mvaa 80,20,92
ta 14,12,61952
cv 29,26,27
mvaa 80,16,76
s_waitcnt lgkmcnt(6)
mvaa 36,0,64
s_waitcnt lgkmcnt(4)
buffer_load_dwordx4 a[56:59], v16, s[52:55], s56 offen offset:2048
ta 16,13,49152
s_add_u32 s63, s70, 28672
ar 24,252
mvaa 36,4,80
mvaa 52,4,84
ta 18,13,49664
ar 25,253
mvaa 52,0,68
buffer_load_dwordx4 a[60:63], v17, s[52:55], s56 offen offset:3072
mvaa 68,0,72
ta 20,13,61440
cv 30,24,25
mvaa 68,4,88
mvaa 84,4,92
ta 22,13,61952
ar 26,254
mvaa 84,0,76
s_waitcnt lgkmcnt(6)
s_waitcnt vmcnt(28) lgkmcnt(0)
s_barrier
mvaa 40,8,64
ta 0,2,36864
ar 27,255
mvaa 40,12,80
s_mov_b32 s57, 4718592
s_add_u32 m0, s66, 49152
mvaa 56,12,84
dma 18,36,57,0
ta 2,2,37888
cv 31,26,27
mvaa 56,8,68
mvaa 72,8,72
ta 4,2,24576
buffer_store_dwordx4 v[28:31], v0, s[52:55], s63 offen offset:3072 sc1
mvaa 72,12,88
mvaa 88,12,92
ta 6,2,25600
mvaa 88,8,76
mvaa 44,16,64
dma 19,36,57,1024
ta 8,3,36864
mvaa 44,20,80
mvaa 60,20,84
ta 10,3,37888
mvaa 60,16,68
mvaa 76,16,72
ta 12,3,24576
mvaa 76,20,88
s_mov_b32 s58, 1990656
mvaa 92,20,92
dma 20,40,58,2048
ta 14,3,25600
mvaa 92,16,76
s_waitcnt vmcnt(29) lgkmcnt(6)
mvaa 96,0,96
s_waitcnt vmcnt(25) lgkmcnt(4)
ta 16,4,36864
mvaa 96,4,112
s_waitcnt vmcnt(24)
mvaa 128,4,116
ta 18,4,37888
mvaa 128,0,100
s_mov_b32 s57, 4980736
s_add_u32 m0, s66, 61440
mvaa 160,0,104
s_waitcnt vmcnt(23)
dma 18,36,57,0
ta 20,4,24576
mvaa 160,4,120
s_waitcnt vmcnt(22)
mvaa 192,4,124
ta 22,4,25600
mvaa 192,0,108
s_waitcnt lgkmcnt(6)
mvaa 100,8,96
s_waitcnt lgkmcnt(4)
ta 0,5,36864
mvaa 100,12,112
mvaa 132,12,116
dma 19,36,57,1024
ta 2,5,37888
mvaa 132,8,100
mvaa 164,8,104
ta 4,5,24576
mvaa 164,12,120
mvaa 196,12,124
ta 6,5,25600
mvaa 196,8,108
s_waitcnt lgkmcnt(6)
s_mov_b32 s58, 2101248
mvaa 104,16,96
s_waitcnt lgkmcnt(4)
dma 20,40,58,2048
ta 8,6,36864
mvaa 104,20,112
mvaa 136,20,116
ta 10,6,37888
mvaa 136,16,100
mvaa 168,16,104
ta 12,6,24576
mvaa 168,20,120
mvaa 200,20,124
ta 14,6,25600
mvaa 200,16,108
s_waitcnt lgkmcnt(6)
mvaa 108,0,96
s_waitcnt lgkmcnt(4)
ta 16,7,36864
mvaa 108,4,112
mvaa 140,4,116
ta 18,7,37888
mvaa 140,0,100
mvaa 172,0,104
ta 20,7,24576
mvaa 172,4,120
mvaa 204,4,124
ta 22,7,25600
mvaa 204,0,108
s_waitcnt lgkmcnt(6)
mvaa 112,8,96
s_waitcnt lgkmcnt(4)
ta 0,8,36864
mvaa 112,12,112
mvaa 144,12,116
ta 2,8,37888
mvaa 144,8,100
mvaa 176,8,104
ta 4,8,24576
mvaa 176,12,120
mvaa 208,12,124
ta 6,8,25600
mvaa 208,8,108
s_waitcnt lgkmcnt(6)
mvaa 116,16,96
s_waitcnt lgkmcnt(4)
ta 8,9,36864
mvaa 116,20,112
mvaa 148,20,116
ta 10,9,37888
mvaa 148,16,100
mvaa 180,16,104
ta 12,9,24576
mvaa 180,20,120
mvaa 212,20,124
ta 14,9,25600
mvaa 212,16,108
s_waitcnt lgkmcnt(6)
mvaa 120,0,96
s_waitcnt lgkmcnt(4)
ta 16,10,36864
mvaa 120,4,112
mvaa 152,4,116
ta 18,10,37376
mvaa 152,0,100
mvaa 184,0,104
ta 20,10,24576
mvaa 184,4,120
s_mov_b32 s56, 83968
mvaa 216,4,124
buffer_load_dwordx4 a[64:67], v14, s[52:55], s56 offen offset:0
ta 22,10,25088
mvaa 216,0,108
s_waitcnt lgkmcnt(6)
mvaa 124,8,96
s_waitcnt lgkmcnt(4)
ta 0,11,36864
mvaa 124,12,112
buffer_load_dwordx4 a[68:71], v15, s[52:55], s56 offen offset:1024
mvaa 156,12,116
ta 2,11,37376
mvaa 156,8,100
mvaa 188,8,104
buffer_load_dwordx4 a[72:75], v16, s[52:55], s56 offen offset:2048
ta 4,11,24576
mvaa 188,12,120
mvaa 220,12,124
ta 6,11,25088
mvaa 220,8,108
s_waitcnt lgkmcnt(6)
buffer_load_dwordx4 a[76:79], v17, s[52:55], s56 offen offset:3072
mvaa 32,16,96
s_waitcnt lgkmcnt(4)
ta 8,12,36864
mvaa 32,20,112
s_mov_b32 s56, 84992
mvaa 48,20,116
buffer_load_dwordx4 a[80:83], v14, s[52:55], s56 offen offset:0
ta 10,12,37376
mvaa 48,16,100
mvaa 64,16,104
ta 12,12,24576
mvaa 64,20,120
buffer_load_dwordx4 a[84:87], v15, s[52:55], s56 offen offset:1024
mvaa 80,20,124
ta 14,12,25088
mvaa 80,16,108
s_waitcnt lgkmcnt(6)
mvaa 36,0,96
s_waitcnt lgkmcnt(4)
buffer_load_dwordx4 a[88:91], v16, s[52:55], s56 offen offset:2048
ta 16,13,36864
mvaa 36,4,112
mvaa 52,4,116
ta 18,13,37376
mvaa 52,0,100
buffer_load_dwordx4 a[92:95], v17, s[52:55], s56 offen offset:3072
mvaa 68,0,104
ta 20,13,24576
mvaa 68,4,120
mvaa 84,4,124
ta 22,13,25088
mvaa 84,0,108
s_waitcnt lgkmcnt(6)
s_waitcnt vmcnt(13) lgkmcnt(0)
s_barrier
mvaa 40,8,96
ta 0,2,12288
mvaa 40,12,112
buffer_store_dword v23, v21, s[52:55], s72 offen sc1
mvaa 56,12,116
ta 2,2,13312
mvaa 56,8,100
mvaa 72,8,104
ta 4,2,0
mvaa 72,12,120
mvaa 88,12,124
ta 6,2,1024
mvaa 88,8,108
mvaa 44,16,96
ta 8,3,12288
mvaa 44,20,112
mvaa 60,20,116
ta 10,3,13312
mvaa 60,16,100
mvaa 76,16,104
ta 12,3,0
mvaa 76,20,120
mvaa 92,20,124
ta 14,3,1024
mvaa 92,16,108
s_waitcnt lgkmcnt(6)
mvaa 96,0,32
s_waitcnt lgkmcnt(4)
ta 16,4,12288
mvaa 96,4,48
mvaa 128,4,52
s_mul_i32 s60, s4, 524288
s_add_u32 s61, s60, 4194304
s_add_u32 s44, s34, s61
s_addc_u32 s45, s35, 0
s_and_b32 s45, s45, 0xffff
s_sub_u32 s46, 16, s5
s_lshl_b32 s46, s46, 15
s_mov_b32 s47, 0x20000
ta 18,4,13312
mvaa 128,0,36
mvaa 160,0,40
ta 20,4,0
mvaa 160,4,56
mvaa 192,4,60
s_add_u32 s61, s60, 22020096
s_add_u32 s48, s34, s61
s_addc_u32 s49, s35, 0
s_and_b32 s49, s49, 0xffff
s_mov_b32 s50, s46
s_mov_b32 s51, 0x20000
ta 22,4,1024
mvaa 192,0,44
s_waitcnt lgkmcnt(6)
mvaa 100,8,32
s_waitcnt lgkmcnt(4)
ta 0,5,12288
mvaa 100,12,48
mvaa 132,12,52
s_mov_b32 s76, 0
s_mov_b32 s77, 0
s_lshl_b32 s78, s3, 12
s_add_u32 s79, s78, 0x10000
s_mul_i32 s83, s4, 1024
s_add_u32 s83, s83, 88145920
ta 2,5,13312
mvaa 132,8,36
mvaa 164,8,40
ta 4,5,0
mvaa 164,12,56
mvaa 196,12,60
s_mul_i32 s74, s5, 442368
s_lshl_b32 s61, s64, 14
s_add_u32 s61, s61, 39845888
s_lshl_b32 s60, s3, 10
s_add_u32 s61, s61, s60
s_add_u32 s74, s74, s61
s_sub_u32 s75, 15, s5
s_mul_i32 s75, s75, 442368
s_add_u32 s75, s75, s61
ta 6,5,1024
mvaa 196,8,44
s_waitcnt lgkmcnt(6)
mvaa 104,16,32
s_waitcnt lgkmcnt(4)
ta 8,6,12288
mvaa 104,20,48
mvaa 136,20,52
ta 10,6,13312
mvaa 136,16,36
mvaa 168,16,40
ta 12,6,0
mvaa 168,20,56
mvaa 200,20,60
ta 14,6,1024
mvaa 200,16,44
s_waitcnt lgkmcnt(6)
mvaa 108,0,32
s_waitcnt lgkmcnt(4)
ta 16,7,12288
mvaa 108,4,48
mvaa 140,4,52
ta 18,7,13312
mvaa 140,0,36
mvaa 172,0,40
ta 20,7,0
mvaa 172,4,56
mvaa 204,4,60
ta 22,7,1024
mvaa 204,0,44
s_waitcnt lgkmcnt(6)
mvaa 112,8,32
s_waitcnt lgkmcnt(4)
ta 0,8,12288
mvaa 112,12,48
mvaa 144,12,52
ta 2,8,13312
mvaa 144,8,36
mvaa 176,8,40
ta 4,8,0
mvaa 176,12,56
mvaa 208,12,60
ta 6,8,1024
mvaa 208,8,44
s_waitcnt lgkmcnt(6)
mvaa 116,16,32
s_waitcnt lgkmcnt(4)
ta 8,9,12288
mvaa 116,20,48
mvaa 148,20,52
ta 10,9,13312
s_lshl_b32 s58, s4, 15
s_lshl_b32 s60, s3, 10
mvaa 148,16,36
s_add_u32 s58, s58, s60
s_add_u32 s58, s58, 48234496
mvaa 180,16,40
ta 12,9,0
s_lshl_b32 s94, s5, 20
s_add_u32 s94, s94, s58
mvaa 180,20,56
s_sub_u32 s95, 15, s5
s_lshl_b32 s95, s95, 20
mvaa 212,20,60
ta 14,9,1024
s_add_u32 s95, s95, s58
s_mov_b32 s90, 0x53800000
mvaa 212,16,44
s_waitcnt lgkmcnt(6)
s_and_b32 s58, s3, 1
s_lshl_b32 s89, s58, 13
mvaa 120,0,32
s_waitcnt lgkmcnt(4)
ta 16,10,12288
s_xor_b32 s60, s3, 1
s_lshl_b32 s58, s58, 1
mvaa 120,4,48
s_sub_i32 s61, s3, 0
s_cmp_eq_u32 s61, 0
s_cselect_b32 s10, 1.0, 0
mvaa 152,4,52
ta 18,10,12800
s_cmp_lt_i32 s61, 0
s_cselect_b32 s11, 0xf149f2ca, 0
mvaa 152,0,36
s_sub_i32 s61, s3, 1
s_cmp_eq_u32 s61, 0
s_cselect_b32 s12, 1.0, 0
mvaa 184,0,40
ta 20,10,0
s_cmp_lt_i32 s61, 0
s_cselect_b32 s13, 0xf149f2ca, 0
mvaa 184,4,56
s_sub_i32 s61, s3, 2
s_cmp_eq_u32 s61, 0
s_cselect_b32 s14, 1.0, 0
mvaa 216,4,60
ta 22,10,512
s_cmp_lt_i32 s61, 0
s_cselect_b32 s15, 0xf149f2ca, 0
mvaa 216,0,44
s_waitcnt lgkmcnt(6)
s_sub_i32 s61, s3, 3
s_cmp_eq_u32 s61, 0
s_cselect_b32 s16, 1.0, 0
mvaa 124,8,32
s_waitcnt lgkmcnt(4)
ta 0,11,12288
s_cmp_lt_i32 s61, 0
s_cselect_b32 s17, 0xf149f2ca, 0
mvaa 124,12,48
s_sub_i32 s61, s3, s58
s_sub_i32 s61, s61, 0
mvaa 156,12,52
ta 2,11,12800
s_cmp_eq_u32 s61, 0
s_cselect_b32 s20, 1.0, 0
mvaa 156,8,36
s_cmp_lt_i32 s61, 0
s_cselect_b32 s21, 0xf149f2ca, 0
HS_a_12:
s_cmp_eq_u32 s7, 1
s_cbranch_scc1 HOP_a_ret
mvaa 188,8,40
ta 4,11,0
s_sub_i32 s61, s3, s58
s_sub_i32 s61, s61, 1
mvaa 188,12,56
s_cmp_eq_u32 s61, 0
s_cselect_b32 s22, 1.0, 0
mvaa 220,12,60
ta 6,11,512
s_cmp_lt_i32 s61, 0
s_cselect_b32 s23, 0xf149f2ca, 0
mvaa 220,8,44
s_waitcnt lgkmcnt(6)
s_sub_i32 s61, s60, s58
s_sub_i32 s61, s61, 0
mvaa 32,16,32
s_waitcnt lgkmcnt(4)
ta 8,12,12288
s_cmp_eq_u32 s61, 0
s_cselect_b32 s24, 1.0, 0
mvaa 32,20,48
s_cmp_lt_i32 s61, 0
s_cselect_b32 s25, 0xf149f2ca, 0
mvaa 48,20,52
ta 10,12,12800
s_sub_i32 s61, s60, s58
s_sub_i32 s61, s61, 1
mvaa 48,16,36
s_cmp_eq_u32 s61, 0
s_cselect_b32 s32, 1.0, 0
mvaa 64,16,40
ta 12,12,0
s_cmp_lt_i32 s61, 0
s_cselect_b32 s33, 0xf149f2ca, 0
mvaa 64,20,56
s_mov_b32 s36, s18
s_and_b32 s37, s19, 0xffff
mvaa 80,20,60
ta 14,12,512
s_mov_b32 s38, 5242880
s_mov_b32 s39, 0x20000
mvaa 80,16,44
s_waitcnt lgkmcnt(6)
s_mov_b32 s40, s26
s_and_b32 s41, s27, 0xffff
mvaa 36,0,32
s_waitcnt lgkmcnt(4)
ta 16,13,12288
s_mov_b32 s42, 2211840
s_mov_b32 s43, 0x20000
v_lshrrev_b32 v28, 4, v0
mvaa 36,4,48
s_lshl_b32 s58, s2, 2
s_add_u32 s58, s58, s3
mvaa 52,4,52
ta 18,13,12800
s_mul_i32 s60, s58, 40
v_min_u32 v19, 39, v28
mvaa 52,0,36
v_add_u32 v19, s60, v19
mvaa 68,0,40
ta 20,13,0
v_lshlrev_b32 v19, 7, v19
mvaa 68,4,56
s_mul_i32 s60, s58, 17
v_min_u32 v20, 16, v28
mvaa 84,4,60
ta 22,13,512
v_add_u32 v20, s60, v20
mvaa 84,0,44
s_waitcnt lgkmcnt(6)
s_waitcnt vmcnt(9) lgkmcnt(0)
s_barrier
v_lshlrev_b32 v20, 7, v20
mvaa 40,8,32
ta 0,2,49152
s_lshr_b32 s56, s6, 2
s_lshl_b32 s56, s56, 3
mvaa 40,12,48
s_lshr_b32 s58, s2, 3
s_and_b32 s58, s58, 7
mvaa 56,12,52
ta 2,2,50176
s_add_u32 s56, s56, s58
s_lshr_b32 s57, s2, 6
mvaa 56,8,36
s_and_b32 s65, s6, 3
s_sub_u32 s60, 15, s56
mvaa 72,8,40
ta 4,2,61440
s_min_u32 s58, s56, s60
s_mul_i32 s58, s58, 4096
mvaa 72,12,56
s_add_u32 s80, s58, 88178688
s_mul_i32 s60, s65, 1024
mvaa 88,12,60
ta 6,2,62464
s_add_u32 s81, s58, s60
s_add_u32 s81, s81, 88211456
mvaa 88,8,44
s_cmp_eq_u32 s3, 0
s_cselect_b32 s80, s80, 94371840
s_cselect_b32 s81, s81, 94371840
mvaa 44,16,32
ta 8,3,49152
s_mul_i32 s4, s56, 442368
s_add_u32 s4, s4, 39845888
mvaa 44,20,48
s_lshl_b32 s6, s56, 20
s_add_u32 s6, s6, 48234496
mvaa 60,20,52
ta 10,3,50176
s_lshl_b32 s58, s3, 12
s_lshr_b32 s66, s65, 1
mvaa 60,16,36
s_mul_i32 s66, s66, 28
s_and_b32 s68, s65, 1
mvaa 76,16,40
ta 12,3,61440
s_mul_i32 s68, s68, 14
s_add_u32 s68, s68, s66
mvaa 76,20,56
s_lshl_b32 s66, s68, 13
s_add_u32 s66, s66, s58
mvaa 92,20,60
ta 14,3,62464
s_lshl_b32 s67, s65, 18
s_add_u32 s67, s67, s58
mvaa 92,16,44
s_waitcnt vmcnt(8) lgkmcnt(6)
s_mul_i32 s82, s3, 5120
s_add_u32 s82, s82, 16384
mvaa 96,0,64
s_waitcnt vmcnt(4) lgkmcnt(4)
ta 16,4,49152
s_mul_i32 s58, s3, 20480
s_mul_i32 s84, s57, 320
mvaa 96,4,80
s_waitcnt vmcnt(3)
s_add_u32 s58, s58, s84
s_mul_i32 s68, s68, 40960
mvaa 128,4,84
ta 18,4,50176
s_add_u32 s68, s68, s58
s_mul_i32 s69, s65, 1310720
mvaa 128,0,68
s_add_u32 s69, s69, s58
v_add_u32 v26, 0, v28
mvaa 160,0,72
s_waitcnt vmcnt(2)
ta 20,4,61440
v_mul_u32_u24 v27, 3277, v26
mvaa 160,4,88
s_waitcnt vmcnt(1)
v_lshrrev_b32 v27, 16, v27
mvaa 192,4,92
ta 22,4,62464
v_mul_u32_u24 v29, 20, v27
mvaa 192,0,76
s_waitcnt lgkmcnt(6)
v_sub_u32 v26, v26, v29
mvaa 100,8,64
s_waitcnt lgkmcnt(4)
ta 0,5,49152
v_lshrrev_b32 v29, 1, v27
mvaa 100,12,80
v_and_b32 v29, 2, v29
mvaa 132,12,84
ta 2,5,50176
v_xor_b32 v26, v26, v29
mvaa 132,8,68
v_mul_u32_u24 v27, 1280, v27
mvaa 164,8,72
ta 4,5,61440
v_lshl_add_u32 v14, v26, 4, v27
mvaa 164,12,88
v_add_u32 v26, 64, v28
mvaa 196,12,92
ta 6,5,62464
v_mul_u32_u24 v27, 3277, v26
mvaa 196,8,76
s_waitcnt lgkmcnt(6)
v_lshrrev_b32 v27, 16, v27
mvaa 104,16,64
s_waitcnt lgkmcnt(4)
ta 8,6,49152
v_mul_u32_u24 v29, 20, v27
mvaa 104,20,80
v_sub_u32 v26, v26, v29
mvaa 136,20,84
ta 10,6,50176
v_lshrrev_b32 v29, 1, v27
mvaa 136,16,68
v_and_b32 v29, 2, v29
mvaa 168,16,72
ta 12,6,61440
v_xor_b32 v26, v26, v29
mvaa 168,20,88
v_mul_u32_u24 v27, 1280, v27
mvaa 200,20,92
ta 14,6,62464
v_lshl_add_u32 v15, v26, 4, v27
mvaa 200,16,76
s_waitcnt lgkmcnt(6)
v_subrev_u32 v15, 1024, v15
mvaa 108,0,64
s_waitcnt lgkmcnt(4)
ta 16,7,49152
v_add_u32 v26, 128, v28
mvaa 108,4,80
v_mul_u32_u24 v27, 3277, v26
mvaa 140,4,84
ta 18,7,50176
v_lshrrev_b32 v27, 16, v27
mvaa 140,0,68
v_mul_u32_u24 v29, 20, v27
mvaa 172,0,72
ta 20,7,61440
v_sub_u32 v26, v26, v29
mvaa 172,4,88
v_lshrrev_b32 v29, 1, v27
mvaa 204,4,92
ta 22,7,62464
v_and_b32 v29, 2, v29
mvaa 204,0,76
s_waitcnt lgkmcnt(6)
v_xor_b32 v26, v26, v29
mvaa 112,8,64
s_waitcnt lgkmcnt(4)
ta 0,8,49152
v_mul_u32_u24 v27, 1280, v27
mvaa 112,12,80
v_lshl_add_u32 v16, v26, 4, v27
mvaa 144,12,84
ta 2,8,50176
v_subrev_u32 v16, 2048, v16
mvaa 144,8,68
v_add_u32 v26, 192, v28
mvaa 176,8,72
ta 4,8,61440
v_mul_u32_u24 v27, 3277, v26
mvaa 176,12,88
v_lshrrev_b32 v27, 16, v27
mvaa 208,12,92
ta 6,8,62464
v_mul_u32_u24 v29, 20, v27
mvaa 208,8,76
s_waitcnt lgkmcnt(6)
v_sub_u32 v26, v26, v29
mvaa 116,16,64
s_waitcnt lgkmcnt(4)
ta 8,9,49152
v_lshrrev_b32 v29, 1, v27
mvaa 116,20,80
v_and_b32 v29, 2, v29
mvaa 148,20,84
ta 10,9,50176
v_xor_b32 v26, v26, v29
mvaa 148,16,68
v_mul_u32_u24 v27, 1280, v27
mvaa 180,16,72
ta 12,9,61440
v_lshl_add_u32 v17, v26, 4, v27
mvaa 180,20,88
v_subrev_u32 v17, 3072, v17
mvaa 212,20,92
ta 14,9,62464
v_add_u32 v26, 256, v28
mvaa 212,16,76
s_waitcnt lgkmcnt(6)
v_mul_u32_u24 v27, 3277, v26
mvaa 120,0,64
s_waitcnt lgkmcnt(4)
ta 16,10,49152
v_lshrrev_b32 v27, 16, v27
mvaa 120,4,80
v_mul_u32_u24 v29, 20, v27
mvaa 152,4,84
ta 18,10,49664
v_lshlrev_b32 v24, 3, v0
v_sub_u32 v26, v26, v29
mvaa 152,0,68
v_lshrrev_b32 v29, 1, v27
mvaa 184,0,72
ta 20,10,61440
v_and_b32 v29, 2, v29
mvaa 184,4,88
v_xor_b32 v26, v26, v29
mvaa 216,4,92
ta 22,10,61952
v_and_b32 v24, 896, v24
v_mul_u32_u24 v27, 1280, v27
mvaa 216,0,76
s_waitcnt lgkmcnt(6)
v_lshl_add_u32 v18, v26, 4, v27
mvaa 124,8,64
s_waitcnt lgkmcnt(4)
ta 0,11,49152
s_lshr_b32 s60, s3, 1
s_mul_i32 s61, s60, 160
mvaa 124,12,80
s_add_u32 s84, s84, s61
s_add_u32 s61, s61, 16384
v_lshrrev_b32 v26, 2, v28
mvaa 156,12,84
ta 2,11,49664
v_mul_u32_u24 v26, 320, v26
mvaa 156,8,68
v_and_b32 v27, 3, v28
mvaa 188,8,72
ta 4,11,61440
v_lshl_add_u32 v26, v27, 3, v26
mvaa 188,12,88
v_add_u32 v26, s61, v26
mvaa 220,12,92
ta 6,11,61952
v_lshlrev_b32 v29, 1, v28
mvaa 220,8,76
s_waitcnt lgkmcnt(6)
v_and_b32 v29, 32, v29
mvaa 32,16,64
s_waitcnt lgkmcnt(4)
ta 8,12,49152
s_cmp_eq_u32 s60, 0
s_cselect_b32 s58, 1, -1
v_mul_i32_i24 v29, s58, v29
mvaa 32,20,80
v_sub_u32 v27, v26, v29
mvaa 48,20,84
ta 10,12,49664
v_add_u32 v26, v26, v29
mvaa 48,16,68
s_and_b32 s58, s3, 1
s_lshl_b32 s70, s56, 3
mvaa 64,16,72
ta 12,12,61440
s_lshl_b32 s58, s58, 2
s_add_u32 s70, s70, s58
mvaa 64,20,88
s_add_u32 s70, s70, s65
s_mul_i32 s70, s70, 20480
mvaa 80,20,92
ta 14,12,61952
s_add_u32 s70, s70, s84
v_lshrrev_b32 v29, 4, v28
mvaa 80,16,76
s_waitcnt lgkmcnt(6)
v_lshlrev_b32 v29, 3, v29
mvaa 36,0,64
s_waitcnt lgkmcnt(4)
ta 16,13,49152
v_and_b32 v28, 15, v28
mvaa 36,4,80
v_mul_u32_u24 v28, 1280, v28
mvaa 52,4,84
ta 18,13,49664
v_add_u32 v28, v28, v29
mvaa 52,0,68
v_lshlrev_b32 v30, 3, v0
mvaa 68,0,72
ta 20,13,61440
v_and_b32 v31, 896, v30
mvaa 68,4,88
v_and_b32 v30, 3968, v30
mvaa 84,4,92
ta 22,13,61952
s_lshl_b32 s58, s56, 2
s_add_u32 s58, s58, s57
mvaa 84,0,76
s_waitcnt lgkmcnt(6)
s_lshl_b32 s72, s58, 2
s_add_u32 s72, s72, s3
mvaa 40,8,64
s_waitcnt lgkmcnt(4)
s_mul_i32 s72, s72, 512
s_add_u32 s72, s72, 88604672
mvaa 40,12,80
s_mul_i32 s58, s58, 327680
s_mul_i32 s60, s3, 5120
mvaa 56,12,84
s_add_u32 s58, s58, s60
s_add_u32 s58, s58, 66060288
mvaa 56,8,68
s_mul_i32 s60, s65, 20480
s_add_u32 s56, s58, s60
mvaa 72,8,72
s_lshl_b32 s60, s60, 2
s_add_u32 s64, s58, s60
mvaa 72,12,88
s_add_u32 s58, s65, 1
s_and_b32 s58, s58, 3
mvaa 88,12,92
s_mul_i32 s58, s58, 81920
s_add_u32 s85, s56, s58
mvaa 88,8,76
s_waitcnt lgkmcnt(2)
s_add_u32 s58, s65, 2
s_and_b32 s58, s58, 3
mvaa 44,16,64
s_waitcnt lgkmcnt(0)
buffer_load_dword v25, v24, s[52:55], s83 offen sc1
s_mul_i32 s58, s58, 81920
s_add_u32 s86, s56, s58
mvaa 44,20,80
s_add_u32 s58, s65, 3
s_and_b32 s58, s58, 3
mvaa 60,20,84
s_mul_i32 s58, s58, 81920
s_add_u32 s87, s56, s58
mvaa 60,16,68
mvaa 76,16,72
mvaa 76,20,88
mvaa 92,20,92
mvaa 92,16,76
L_postH:
s_nop 7
cv 96,96,97
cv 97,98,99
cv 98,100,101
cv 99,102,103
cv 100,104,105
cv 101,106,107
cv 102,108,109
cv 103,110,111
cv 104,112,113
cv 105,114,115
cv 106,116,117
cv 107,118,119
cv 108,120,121
cv 109,122,123
cv 110,124,125
cv 111,126,127
cv 112,128,129
cv 113,130,131
cv 114,132,133
cv 115,134,135
cv 116,136,137
cv 117,138,139
cv 118,140,141
cv 119,142,143
cv 120,144,145
cv 121,146,147
cv 122,148,149
cv 123,150,151
cv 124,152,153
cv 125,154,155
cv 126,156,157
cv 127,158,159
cv 128,160,161
cv 129,162,163
cv 130,164,165
cv 131,166,167
cv 132,168,169
cv 133,170,171
cv 134,172,173
cv 135,174,175
cv 136,176,177
cv 137,178,179
cv 138,180,181
cv 139,182,183
cv 140,184,185
cv 141,186,187
cv 142,188,189
cv 143,190,191
cv 144,192,193
cv 145,194,195
cv 146,196,197
cv 147,198,199
cv 148,200,201
cv 149,202,203
cv 150,204,205
cv 151,206,207
cv 152,208,209
cv 153,210,211
cv 154,212,213
cv 155,214,215
cv 156,216,217
cv 157,218,219
cv 158,220,221
cv 159,222,223
s_mov_b32 s56, 0xc2469614
s_mov_b32 s57, 0xc2469614
s_mov_b32 s60, 0x3e0293ee
s_mov_b32 s61, 0x3e0293ee
v_mov_b32 v160, 0xc1906ebb
v_mov_b32 v161, 0xc1906ebb
v_mov_b32 v162, 0x3e0293ee
v_mov_b32 v163, 0x3e0293ee
v_pk_mul_f32 v[164:165], v[32:33], v[32:33]
v_pk_mul_f32 v[166:167], v[34:35], v[34:35]
v_pk_mul_f32 v[168:169], v[36:37], v[36:37]
v_pk_mul_f32 v[170:171], v[38:39], v[38:39]
v_pk_fma_f32 v[164:165], v[164:165], s[56:57], v[160:161]
v_pk_fma_f32 v[166:167], v[166:167], s[56:57], v[160:161]
v_pk_fma_f32 v[168:169], v[168:169], s[56:57], v[160:161]
v_pk_fma_f32 v[170:171], v[170:171], s[56:57], v[160:161]
v_pk_mul_f32 v[164:165], v[164:165], v[32:33]
v_pk_mul_f32 v[166:167], v[166:167], v[34:35]
v_pk_mul_f32 v[168:169], v[168:169], v[36:37]
v_pk_mul_f32 v[170:171], v[170:171], v[38:39]
v_exp_f32 v164, v164
v_exp_f32 v165, v165
v_exp_f32 v166, v166
v_exp_f32 v167, v167
v_exp_f32 v168, v168
v_exp_f32 v169, v169
v_exp_f32 v170, v170
v_exp_f32 v171, v171
v_pk_fma_f32 v[164:165], v[164:165], s[60:61], v[162:163]
v_pk_fma_f32 v[166:167], v[166:167], s[60:61], v[162:163]
v_pk_fma_f32 v[168:169], v[168:169], s[60:61], v[162:163]
v_pk_fma_f32 v[170:171], v[170:171], s[60:61], v[162:163]
v_rcp_f32 v164, v164
v_rcp_f32 v165, v165
v_rcp_f32 v166, v166
v_rcp_f32 v167, v167
v_rcp_f32 v168, v168
v_rcp_f32 v169, v169
v_rcp_f32 v170, v170
v_rcp_f32 v171, v171
v_pk_mul_f32 v[164:165], v[164:165], v[32:33]
v_pk_mul_f32 v[166:167], v[166:167], v[34:35]
v_pk_mul_f32 v[168:169], v[168:169], v[36:37]
v_pk_mul_f32 v[170:171], v[170:171], v[38:39]
cv 164,164,165
cv 165,166,167
cv 166,168,169
cv 167,170,171
aw 192,164
aw 193,165
aw 194,166
aw 195,167
s_waitcnt vmcnt(0)
v_cmp_ne_u32 vcc, s88, v25
s_cbranch_vccz L_skH_ok
s_mov_b32 s62, 1000000
L_skH:
buffer_load_dword v25, v24, s[52:55], s83 offen sc1
s_waitcnt vmcnt(0)
v_cmp_ne_u32 vcc, s88, v25
s_cbranch_vccz L_skH_ok
s_sub_u32 s62, s62, 1
s_cmp_eq_u32 s62, 0
s_cbranch_scc1 L_skH_ok
s_sleep 4
s_branch L_skH
L_skH_ok:
s_and_b32 s59, s76, 0xc000
s_add_u32 m0, s59, s78
v_pk_mul_f32 v[172:173], v[40:41], v[40:41]
dma 1,44,76,0
v_pk_mul_f32 v[174:175], v[42:43], v[42:43]
v_pk_mul_f32 v[176:177], v[44:45], v[44:45]
v_pk_mul_f32 v[178:179], v[46:47], v[46:47]
v_pk_fma_f32 v[172:173], v[172:173], s[56:57], v[160:161]
v_pk_fma_f32 v[174:175], v[174:175], s[56:57], v[160:161]
v_pk_fma_f32 v[176:177], v[176:177], s[56:57], v[160:161]
v_pk_fma_f32 v[178:179], v[178:179], s[56:57], v[160:161]
v_pk_mul_f32 v[172:173], v[172:173], v[40:41]
v_pk_mul_f32 v[174:175], v[174:175], v[42:43]
v_pk_mul_f32 v[176:177], v[176:177], v[44:45]
v_pk_mul_f32 v[178:179], v[178:179], v[46:47]
dma 1,44,76,1024
v_exp_f32 v172, v172
v_exp_f32 v173, v173
v_exp_f32 v174, v174
v_exp_f32 v175, v175
v_exp_f32 v176, v176
v_exp_f32 v177, v177
v_exp_f32 v178, v178
v_exp_f32 v179, v179
v_pk_fma_f32 v[172:173], v[172:173], s[60:61], v[162:163]
v_pk_fma_f32 v[174:175], v[174:175], s[60:61], v[162:163]
v_pk_fma_f32 v[176:177], v[176:177], s[60:61], v[162:163]
dma 1,44,76,2048
v_pk_fma_f32 v[178:179], v[178:179], s[60:61], v[162:163]
v_rcp_f32 v172, v172
v_rcp_f32 v173, v173
v_rcp_f32 v174, v174
v_rcp_f32 v175, v175
v_rcp_f32 v176, v176
v_rcp_f32 v177, v177
v_rcp_f32 v178, v178
v_rcp_f32 v179, v179
v_pk_mul_f32 v[172:173], v[172:173], v[40:41]
v_pk_mul_f32 v[174:175], v[174:175], v[42:43]
dma 1,44,76,3072
s_add_u32 s76, s76, 16384
v_pk_mul_f32 v[176:177], v[176:177], v[44:45]
v_pk_mul_f32 v[178:179], v[178:179], v[46:47]
cv 172,172,173
cv 173,174,175
cv 174,176,177
cv 175,178,179
aw 196,172
aw 197,173
aw 198,174
aw 199,175
s_and_b32 s59, s77, 0xc000
s_add_u32 m0, s59, s79
v_pk_mul_f32 v[164:165], v[48:49], v[48:49]
dma 1,48,77,0
v_pk_mul_f32 v[166:167], v[50:51], v[50:51]
v_pk_mul_f32 v[168:169], v[52:53], v[52:53]
v_pk_mul_f32 v[170:171], v[54:55], v[54:55]
v_pk_fma_f32 v[164:165], v[164:165], s[56:57], v[160:161]
v_pk_fma_f32 v[166:167], v[166:167], s[56:57], v[160:161]
v_pk_fma_f32 v[168:169], v[168:169], s[56:57], v[160:161]
v_pk_fma_f32 v[170:171], v[170:171], s[56:57], v[160:161]
v_pk_mul_f32 v[164:165], v[164:165], v[48:49]
v_pk_mul_f32 v[166:167], v[166:167], v[50:51]
v_pk_mul_f32 v[168:169], v[168:169], v[52:53]
v_pk_mul_f32 v[170:171], v[170:171], v[54:55]
dma 1,48,77,1024
v_exp_f32 v164, v164
v_exp_f32 v165, v165
v_exp_f32 v166, v166
v_exp_f32 v167, v167
v_exp_f32 v168, v168
HS_a_13:
s_cmp_eq_u32 s7, 1
s_cbranch_scc1 HOP_a_ret
v_exp_f32 v169, v169
v_exp_f32 v170, v170
v_exp_f32 v171, v171
v_pk_fma_f32 v[164:165], v[164:165], s[60:61], v[162:163]
v_pk_fma_f32 v[166:167], v[166:167], s[60:61], v[162:163]
v_pk_fma_f32 v[168:169], v[168:169], s[60:61], v[162:163]
dma 1,48,77,2048
v_pk_fma_f32 v[170:171], v[170:171], s[60:61], v[162:163]
v_rcp_f32 v164, v164
v_rcp_f32 v165, v165
v_rcp_f32 v166, v166
v_rcp_f32 v167, v167
v_rcp_f32 v168, v168
v_rcp_f32 v169, v169
v_rcp_f32 v170, v170
v_rcp_f32 v171, v171
v_pk_mul_f32 v[164:165], v[164:165], v[48:49]
v_pk_mul_f32 v[166:167], v[166:167], v[50:51]
dma 1,48,77,3072
s_add_u32 s77, s77, 16384
v_pk_mul_f32 v[168:169], v[168:169], v[52:53]
v_pk_mul_f32 v[170:171], v[170:171], v[54:55]
cv 164,164,165
cv 165,166,167
cv 166,168,169
cv 167,170,171
aw 200,164
aw 201,165
aw 202,166
aw 203,167
s_and_b32 s59, s76, 0xc000
s_add_u32 m0, s59, s78
v_pk_mul_f32 v[172:173], v[56:57], v[56:57]
dma 1,44,76,0
v_pk_mul_f32 v[174:175], v[58:59], v[58:59]
v_pk_mul_f32 v[176:177], v[60:61], v[60:61]
v_pk_mul_f32 v[178:179], v[62:63], v[62:63]
v_pk_fma_f32 v[172:173], v[172:173], s[56:57], v[160:161]
v_pk_fma_f32 v[174:175], v[174:175], s[56:57], v[160:161]
v_pk_fma_f32 v[176:177], v[176:177], s[56:57], v[160:161]
v_pk_fma_f32 v[178:179], v[178:179], s[56:57], v[160:161]
v_pk_mul_f32 v[172:173], v[172:173], v[56:57]
v_pk_mul_f32 v[174:175], v[174:175], v[58:59]
v_pk_mul_f32 v[176:177], v[176:177], v[60:61]
v_pk_mul_f32 v[178:179], v[178:179], v[62:63]
dma 1,44,76,1024
v_exp_f32 v172, v172
v_exp_f32 v173, v173
v_exp_f32 v174, v174
v_exp_f32 v175, v175
v_exp_f32 v176, v176
v_exp_f32 v177, v177
v_exp_f32 v178, v178
v_exp_f32 v179, v179
v_pk_fma_f32 v[172:173], v[172:173], s[60:61], v[162:163]
v_pk_fma_f32 v[174:175], v[174:175], s[60:61], v[162:163]
v_pk_fma_f32 v[176:177], v[176:177], s[60:61], v[162:163]
dma 1,44,76,2048
v_pk_fma_f32 v[178:179], v[178:179], s[60:61], v[162:163]
v_rcp_f32 v172, v172
v_rcp_f32 v173, v173
v_rcp_f32 v174, v174
v_rcp_f32 v175, v175
v_rcp_f32 v176, v176
v_rcp_f32 v177, v177
v_rcp_f32 v178, v178
v_rcp_f32 v179, v179
v_pk_mul_f32 v[172:173], v[172:173], v[56:57]
v_pk_mul_f32 v[174:175], v[174:175], v[58:59]
dma 1,44,76,3072
s_add_u32 s76, s76, 16384
v_pk_mul_f32 v[176:177], v[176:177], v[60:61]
v_pk_mul_f32 v[178:179], v[178:179], v[62:63]
cv 172,172,173
cv 173,174,175
cv 174,176,177
cv 175,178,179
aw 204,172
aw 205,173
aw 206,174
aw 207,175
s_and_b32 s59, s76, 0xc000
s_add_u32 m0, s59, s78
v_pk_mul_f32 v[164:165], v[64:65], v[64:65]
dma 1,44,76,0
v_pk_mul_f32 v[166:167], v[66:67], v[66:67]
v_pk_mul_f32 v[168:169], v[68:69], v[68:69]
v_pk_mul_f32 v[170:171], v[70:71], v[70:71]
v_pk_fma_f32 v[164:165], v[164:165], s[56:57], v[160:161]
v_pk_fma_f32 v[166:167], v[166:167], s[56:57], v[160:161]
v_pk_fma_f32 v[168:169], v[168:169], s[56:57], v[160:161]
v_pk_fma_f32 v[170:171], v[170:171], s[56:57], v[160:161]
v_pk_mul_f32 v[164:165], v[164:165], v[64:65]
v_pk_mul_f32 v[166:167], v[166:167], v[66:67]
v_pk_mul_f32 v[168:169], v[168:169], v[68:69]
v_pk_mul_f32 v[170:171], v[170:171], v[70:71]
dma 1,44,76,1024
v_exp_f32 v164, v164
v_exp_f32 v165, v165
v_exp_f32 v166, v166
v_exp_f32 v167, v167
v_exp_f32 v168, v168
v_exp_f32 v169, v169
v_exp_f32 v170, v170
v_exp_f32 v171, v171
v_pk_fma_f32 v[164:165], v[164:165], s[60:61], v[162:163]
v_pk_fma_f32 v[166:167], v[166:167], s[60:61], v[162:163]
v_pk_fma_f32 v[168:169], v[168:169], s[60:61], v[162:163]
dma 1,44,76,2048
v_pk_fma_f32 v[170:171], v[170:171], s[60:61], v[162:163]
v_rcp_f32 v164, v164
v_rcp_f32 v165, v165
v_rcp_f32 v166, v166
v_rcp_f32 v167, v167
v_rcp_f32 v168, v168
v_rcp_f32 v169, v169
v_rcp_f32 v170, v170
v_rcp_f32 v171, v171
v_pk_mul_f32 v[164:165], v[164:165], v[64:65]
v_pk_mul_f32 v[166:167], v[166:167], v[66:67]
dma 1,44,76,3072
s_add_u32 s76, s76, 16384
v_pk_mul_f32 v[168:169], v[168:169], v[68:69]
v_pk_mul_f32 v[170:171], v[170:171], v[70:71]
cv 164,164,165
cv 165,166,167
cv 166,168,169
cv 167,170,171
aw 208,164
aw 209,165
aw 210,166
aw 211,167
s_and_b32 s59, s77, 0xc000
s_add_u32 m0, s59, s79
v_pk_mul_f32 v[172:173], v[72:73], v[72:73]
dma 1,48,77,0
v_pk_mul_f32 v[174:175], v[74:75], v[74:75]
v_pk_mul_f32 v[176:177], v[76:77], v[76:77]
v_pk_mul_f32 v[178:179], v[78:79], v[78:79]
v_pk_fma_f32 v[172:173], v[172:173], s[56:57], v[160:161]
v_pk_fma_f32 v[174:175], v[174:175], s[56:57], v[160:161]
v_pk_fma_f32 v[176:177], v[176:177], s[56:57], v[160:161]
v_pk_fma_f32 v[178:179], v[178:179], s[56:57], v[160:161]
v_pk_mul_f32 v[172:173], v[172:173], v[72:73]
v_pk_mul_f32 v[174:175], v[174:175], v[74:75]
v_pk_mul_f32 v[176:177], v[176:177], v[76:77]
v_pk_mul_f32 v[178:179], v[178:179], v[78:79]
dma 1,48,77,1024
v_exp_f32 v172, v172
v_exp_f32 v173, v173
v_exp_f32 v174, v174
v_exp_f32 v175, v175
v_exp_f32 v176, v176
v_exp_f32 v177, v177
v_exp_f32 v178, v178
v_exp_f32 v179, v179
v_pk_fma_f32 v[172:173], v[172:173], s[60:61], v[162:163]
v_pk_fma_f32 v[174:175], v[174:175], s[60:61], v[162:163]
v_pk_fma_f32 v[176:177], v[176:177], s[60:61], v[162:163]
dma 1,48,77,2048
v_pk_fma_f32 v[178:179], v[178:179], s[60:61], v[162:163]
v_rcp_f32 v172, v172
v_rcp_f32 v173, v173
v_rcp_f32 v174, v174
v_rcp_f32 v175, v175
v_rcp_f32 v176, v176
v_rcp_f32 v177, v177
v_rcp_f32 v178, v178
v_rcp_f32 v179, v179
v_pk_mul_f32 v[172:173], v[172:173], v[72:73]
v_pk_mul_f32 v[174:175], v[174:175], v[74:75]
dma 1,48,77,3072
s_add_u32 s77, s77, 16384
v_pk_mul_f32 v[176:177], v[176:177], v[76:77]
v_pk_mul_f32 v[178:179], v[178:179], v[78:79]
cv 172,172,173
cv 173,174,175
cv 174,176,177
cv 175,178,179
aw 212,172
aw 213,173
aw 214,174
aw 215,175
s_and_b32 s59, s76, 0xc000
s_add_u32 m0, s59, s78
v_pk_mul_f32 v[164:165], v[80:81], v[80:81]
dma 1,44,76,0
v_pk_mul_f32 v[166:167], v[82:83], v[82:83]
v_pk_mul_f32 v[168:169], v[84:85], v[84:85]
v_pk_mul_f32 v[170:171], v[86:87], v[86:87]
v_pk_fma_f32 v[164:165], v[164:165], s[56:57], v[160:161]
v_pk_fma_f32 v[166:167], v[166:167], s[56:57], v[160:161]
v_pk_fma_f32 v[168:169], v[168:169], s[56:57], v[160:161]
v_pk_fma_f32 v[170:171], v[170:171], s[56:57], v[160:161]
v_pk_mul_f32 v[164:165], v[164:165], v[80:81]
v_pk_mul_f32 v[166:167], v[166:167], v[82:83]
v_pk_mul_f32 v[168:169], v[168:169], v[84:85]
v_pk_mul_f32 v[170:171], v[170:171], v[86:87]
dma 1,44,76,1024
v_exp_f32 v164, v164
v_exp_f32 v165, v165
v_exp_f32 v166, v166
v_exp_f32 v167, v167
v_exp_f32 v168, v168
v_exp_f32 v169, v169
v_exp_f32 v170, v170
v_exp_f32 v171, v171
v_pk_fma_f32 v[164:165], v[164:165], s[60:61], v[162:163]
v_pk_fma_f32 v[166:167], v[166:167], s[60:61], v[162:163]
v_pk_fma_f32 v[168:169], v[168:169], s[60:61], v[162:163]
dma 1,44,76,2048
v_pk_fma_f32 v[170:171], v[170:171], s[60:61], v[162:163]
v_rcp_f32 v164, v164
v_rcp_f32 v165, v165
v_rcp_f32 v166, v166
v_rcp_f32 v167, v167
v_rcp_f32 v168, v168
v_rcp_f32 v169, v169
v_rcp_f32 v170, v170
v_rcp_f32 v171, v171
v_pk_mul_f32 v[164:165], v[164:165], v[80:81]
v_pk_mul_f32 v[166:167], v[166:167], v[82:83]
dma 1,44,76,3072
s_add_u32 s76, s76, 16384
v_pk_mul_f32 v[168:169], v[168:169], v[84:85]
v_pk_mul_f32 v[170:171], v[170:171], v[86:87]
cv 164,164,165
cv 165,166,167
cv 166,168,169
cv 167,170,171
aw 216,164
aw 217,165
aw 218,166
aw 219,167
v_pk_mul_f32 v[172:173], v[88:89], v[88:89]
v_pk_mul_f32 v[174:175], v[90:91], v[90:91]
v_pk_mul_f32 v[176:177], v[92:93], v[92:93]
v_pk_mul_f32 v[178:179], v[94:95], v[94:95]
v_pk_fma_f32 v[172:173], v[172:173], s[56:57], v[160:161]
v_pk_fma_f32 v[174:175], v[174:175], s[56:57], v[160:161]
v_pk_fma_f32 v[176:177], v[176:177], s[56:57], v[160:161]
v_pk_fma_f32 v[178:179], v[178:179], s[56:57], v[160:161]
v_pk_mul_f32 v[172:173], v[172:173], v[88:89]
v_pk_mul_f32 v[174:175], v[174:175], v[90:91]
v_pk_mul_f32 v[176:177], v[176:177], v[92:93]
v_pk_mul_f32 v[178:179], v[178:179], v[94:95]
v_exp_f32 v172, v172
v_exp_f32 v173, v173
v_exp_f32 v174, v174
v_exp_f32 v175, v175
v_exp_f32 v176, v176
v_exp_f32 v177, v177
v_exp_f32 v178, v178
v_exp_f32 v179, v179
v_pk_fma_f32 v[172:173], v[172:173], s[60:61], v[162:163]
v_pk_fma_f32 v[174:175], v[174:175], s[60:61], v[162:163]
v_pk_fma_f32 v[176:177], v[176:177], s[60:61], v[162:163]
v_pk_fma_f32 v[178:179], v[178:179], s[60:61], v[162:163]
v_rcp_f32 v172, v172
v_rcp_f32 v173, v173
v_rcp_f32 v174, v174
v_rcp_f32 v175, v175
v_rcp_f32 v176, v176
v_rcp_f32 v177, v177
v_rcp_f32 v178, v178
v_rcp_f32 v179, v179
v_pk_mul_f32 v[172:173], v[172:173], v[88:89]
v_pk_mul_f32 v[174:175], v[174:175], v[90:91]
v_pk_mul_f32 v[176:177], v[176:177], v[92:93]
v_pk_mul_f32 v[178:179], v[178:179], v[94:95]
cv 172,172,173
cv 173,174,175
cv 174,176,177
cv 175,178,179
aw 220,172
aw 221,173
aw 222,174
aw 223,175
v_lshrrev_b32 v89, 4, v0
v_and_b32 v90, 15, v89
v_lshrrev_b32 v89, 4, v89
v_lshlrev_b32 v89, 2, v89
v_sub_u32 v89, v89, v90
v_mov_b32 v90, 0xf149f2ca
v_mov_b32 v91, 0
v_mov_b32 v2, v0
v_add_u32 v3, 0x18000, v0
v_cmp_ge_i32 vcc, 0, v89
s_nop 1
v_cndmask_b32 v48, v90, v91, vcc
v_cmp_ge_i32 vcc, -1, v89
s_nop 1
v_cndmask_b32 v49, v90, v91, vcc
v_cmp_ge_i32 vcc, -2, v89
s_nop 1
v_cndmask_b32 v50, v90, v91, vcc
v_cmp_ge_i32 vcc, -3, v89
s_nop 1
v_cndmask_b32 v51, v90, v91, vcc
s_lshl_b32 s58, s3, 13
s_add_u32 s58, s58, 0x20000
v_add_u32 v8, s58, v0
v_xor_b32 v9, 0x2000, v8
s_lshl_b32 s58, s3, 9
s_add_u32 s58, s58, 114688
v_lshrrev_b32 v12, 1, v0
v_add_u32 v12, s58, v12
v_xor_b32 v13, 0x200, v12
s_lshr_b32 s58, s3, 1
s_mul_i32 s58, s58, 94208
s_add_u32 s58, s58, 36864
s_lshl_b32 s60, s89, 1
s_add_u32 s61, s58, s60
v_add_u32 v60, s61, v0
s_xor_b32 s60, s60, 0x4000
s_add_u32 s61, s58, s60
v_add_u32 v61, s61, v0
s_lshl_b32 s58, s3, 10
s_add_u32 s58, s58, 69632
v_add_u32 v62, s58, v0
v_xor_b32 v63, 0x400, v62
s_waitcnt vmcnt(20)
s_barrier
ra 128,2,0
ra 132,2,2048
ra 136,2,4096
ra 140,2,6144
ra 144,2,1024
ra 148,2,3072
ra 152,2,5120
ra 156,2,7168
L_attn:
s_cmp_eq_u32 s5, 0
s_cbranch_scc1 L_fDF
s_waitcnt lgkmcnt(4)
zvav 184,128,144
mvav 184,132,148
ds_write_b128 v8, v[128:131] offset:0
mvav 184,136,152
mvav 184,140,156
zvav 176,140,140
mvav 176,136,136
ds_write_b128 v8, v[132:135] offset:1024
mvav 176,132,132
mvav 176,128,128
zvav 168,128,112
mvav 168,132,116
ds_write_b128 v8, v[136:139] offset:2048
mvav 168,136,120
mvav 168,140,124
zvav 160,140,108
mvav 160,136,104
ds_write_b128 v8, v[140:143] offset:3072
mvav 160,132,100
mvav 160,128,96
s_waitcnt lgkmcnt(7)
zvav 188,144,144
s_waitcnt lgkmcnt(6)
mvav 188,148,148
s_waitcnt lgkmcnt(5)
ra 128,2,8192
ds_write_b128 v8, v[144:147] offset:4096
mvav 188,152,152
s_waitcnt lgkmcnt(6)
mvav 188,156,156
ra 132,2,10240
zvav 180,156,140
mvav 180,152,136
ra 136,2,12288
ds_write_b128 v8, v[148:151] offset:5120
mvav 180,148,132
mvav 180,144,128
ra 140,2,14336
zvav 172,144,112
mvav 172,148,116
ds_write_b128 v8, v[152:155] offset:6144
mvav 172,152,120
mvav 172,156,124
zvav 164,156,108
mvav 164,152,104
ds_write_b128 v8, v[156:159] offset:7168
mvav 164,148,100
mvav 164,144,96
ra 144,2,9216
ra 148,2,11264
ra 152,2,13312
s_waitcnt lgkmcnt(11)
ra 156,2,15360
s_nop 7
v_max3_f32 v32, v160, v161, v162
v_max3_f32 v32, v32, v163, v164
v_max3_f32 v32, v32, v165, v166
v_max_f32 v32, v32, v167
v_max3_f32 v36, v168, v169, v170
v_max3_f32 v36, v36, v171, v172
v_max3_f32 v36, v36, v173, v174
v_max_f32 v36, v36, v175
v_max3_f32 v40, v176, v177, v178
v_max3_f32 v40, v40, v179, v180
v_max3_f32 v40, v40, v181, v182
v_max_f32 v40, v40, v183
v_max3_f32 v44, v184, v185, v186
v_max3_f32 v44, v44, v187, v188
v_max3_f32 v44, v44, v189, v190
v_max_f32 v44, v44, v191
v_mov_b32 v33, v32
v_mov_b32 v37, v36
v_mov_b32 v41, v40
v_mov_b32 v45, v44
s_nop 1
v_permlane16_swap_b32 v32, v33
v_permlane16_swap_b32 v36, v37
v_permlane16_swap_b32 v40, v41
v_permlane16_swap_b32 v44, v45
s_nop 0
v_max_f32 v32, v32, v33
v_max_f32 v36, v36, v37
v_max_f32 v40, v40, v41
v_max_f32 v44, v44, v45
v_mov_b32 v33, v32
v_mov_b32 v37, v36
v_mov_b32 v41, v40
v_mov_b32 v45, v44
s_nop 1
v_permlane32_swap_b32 v32, v33
v_permlane32_swap_b32 v36, v37
v_permlane32_swap_b32 v40, v41
v_permlane32_swap_b32 v44, v45
s_nop 0
v_max_f32 v32, v32, v33
v_max_f32 v36, v36, v37
v_max_f32 v40, v40, v41
v_max_f32 v44, v44, v45
v_sub_f32 v32, 0, v32
v_mov_b32 v33, v32
v_mov_b32 v34, v32
v_mov_b32 v35, v32
v_sub_f32 v36, 0, v36
v_mov_b32 v37, v36
v_mov_b32 v38, v36
v_mov_b32 v39, v36
v_sub_f32 v40, 0, v40
v_mov_b32 v41, v40
v_mov_b32 v42, v40
v_mov_b32 v43, v40
v_sub_f32 v44, 0, v44
v_mov_b32 v45, v44
v_mov_b32 v46, v44
v_mov_b32 v47, v44
v_mov_b32 v10, v40
v_mov_b32 v11, v44
ds_write_b64 v12, v[10:11]
v_add_f32 v184, v184, v44
v_add_f32 v185, v185, v44
v_add_f32 v186, v186, v44
v_add_f32 v187, v187, v44
v_add_f32 v188, v188, v44
v_add_f32 v189, v189, v44
v_add_f32 v190, v190, v44
v_add_f32 v191, v191, v44
v_add_f32 v176, v176, v40
v_add_f32 v177, v177, v40
v_add_f32 v178, v178, v40
v_add_f32 v179, v179, v40
v_add_f32 v180, v180, v40
v_add_f32 v181, v181, v40
v_add_f32 v182, v182, v40
v_add_f32 v183, v183, v40
v_add_f32 v168, v168, v36
v_add_f32 v169, v169, v36
v_add_f32 v170, v170, v36
v_add_f32 v171, v171, v36
v_add_f32 v172, v172, v36
v_add_f32 v173, v173, v36
v_add_f32 v174, v174, v36
v_add_f32 v175, v175, v36
v_add_f32 v160, v160, v32
v_add_f32 v161, v161, v32
v_add_f32 v162, v162, v32
v_add_f32 v163, v163, v32
v_add_f32 v164, v164, v32
v_add_f32 v165, v165, v32
v_add_f32 v166, v166, v32
v_add_f32 v167, v167, v32
v_exp_f32 v72, v184
v_exp_f32 v73, v185
s_nop 0
v_add_f32 v79, v72, v73
cv 236,72,73
s_waitcnt vmcnt(12) lgkmcnt(0)
s_barrier
s_nop 1
cvav 216,128,144,44
s_and_b32 s59, s77, 0xc000
s_add_u32 m0, s59, s79
v_exp_f32 v74, v186
v_exp_f32 v75, v187
mvav 216,132,148
dma 1,48,77,0
v_xor_b32 v3, 0x8000, v3
v_add_f32 v79, v79, v74
v_add_f32 v79, v79, v75
cv 237,74,75
v_exp_f32 v72, v188
mvav 216,136,152
ds_read_b64 v[6:7], v13
v_add_f32 v79, v79, v72
v_exp_f32 v73, v189
mvav 216,140,156
v_add_f32 v79, v79, v73
cv 238,72,73
v_exp_f32 v74, v190
cvav 208,140,140,40
v_add_f32 v79, v79, v74
v_exp_f32 v75, v191
mvav 208,136,136
v_add_f32 v79, v79, v75
cv 239,74,75
v_exp_f32 v72, v176
mvav 208,132,132
v_exp_f32 v73, v177
mvav 208,128,128
v_add_f32 v78, v72, v73
cv 232,72,73
v_exp_f32 v74, v178
cvav 200,128,112,36
v_add_f32 v78, v78, v74
v_exp_f32 v75, v179
mvav 200,132,116
dma 1,48,77,1024
v_add_f32 v78, v78, v75
cv 233,74,75
v_exp_f32 v72, v180
mvav 200,136,120
v_add_f32 v78, v78, v72
v_exp_f32 v73, v181
mvav 200,140,124
v_add_f32 v78, v78, v73
cv 234,72,73
v_exp_f32 v74, v182
cvav 192,140,108,32
v_add_f32 v78, v78, v74
v_exp_f32 v75, v183
mvav 192,136,104
v_add_f32 v78, v78, v75
cv 235,74,75
v_exp_f32 v72, v168
mvav 192,132,100
v_exp_f32 v73, v169
v_exp_f32 v74, v170
mvav 192,128,96
v_add_f32 v77, v72, v73
cv 228,72,73
v_add_f32 v77, v77, v74
v_exp_f32 v75, v171
cvav 220,144,144,44
v_add_f32 v77, v77, v75
cv 229,74,75
v_exp_f32 v72, v172
mvav 220,148,148
dma 1,48,77,2048
ra 128,2,16384
v_add_f32 v77, v77, v72
v_exp_f32 v73, v173
mvav 220,152,152
v_add_f32 v77, v77, v73
cv 230,72,73
v_exp_f32 v74, v174
mvav 220,156,156
ra 132,2,18432
v_add_f32 v77, v77, v74
v_exp_f32 v75, v175
cvav 212,156,140,40
v_add_f32 v77, v77, v75
cv 231,74,75
v_exp_f32 v72, v160
mvav 212,152,136
ra 136,2,20480
v_exp_f32 v73, v161
mvav 212,148,132
v_add_f32 v76, v72, v73
cv 224,72,73
v_exp_f32 v74, v162
v_max3_f32 v88, v79, v78, v77
mvav 212,144,128
ra 140,2,22528
v_add_f32 v76, v76, v74
v_exp_f32 v75, v163
cvav 204,144,112,36
v_add_f32 v76, v76, v75
cv 225,74,75
v_exp_f32 v72, v164
mvav 204,148,116
dma 1,48,77,3072
v_add_f32 v76, v76, v72
v_exp_f32 v73, v165
mvav 204,152,120
s_add_u32 s77, s77, 16384
v_add_f32 v76, v76, v73
cv 226,72,73
v_exp_f32 v74, v166
mvav 204,156,124
v_add_f32 v76, v76, v74
v_exp_f32 v75, v167
cvav 196,156,108,32
v_add_f32 v76, v76, v75
cv 227,74,75
v_exp_f32 v72, v216
mvav 196,152,104
v_max_f32 v88, v88, v76
v_cmp_lt_f32 vcc, s90, v88
mvav 196,148,100
v_exp_f32 v73, v217
mvav 196,144,96
s_cbranch_vccnz L_fFF_1_fb
L_fFF_1_ret:
v_add_f32 v83, v72, v73
cv 252,72,73
ra 144,2,17408
ra 148,2,19456
ra 152,2,21504
ra 156,2,23552
s_waitcnt lgkmcnt(7)
cvav 184,128,144,44
s_waitcnt lgkmcnt(6)
s_and_b32 s59, s76, 0xc000
s_add_u32 m0, s59, s78
v_exp_f32 v74, v218
mvav 184,132,148
s_waitcnt lgkmcnt(5)
dma 1,44,76,0
ra 160,3,0
v_add_f32 v83, v83, v74
v_mov_b32 v87, v79
mvav 184,136,152
s_waitcnt lgkmcnt(5)
ra 224,9,0
v_exp_f32 v75, v219
mvav 184,140,156
v_add_f32 v83, v83, v75
cv 253,74,75
cvav 176,140,140,40
s_add_u32 s63, s74, 0
v_exp_f32 v72, v220
mvav 176,136,136
buffer_store_dwordx4 a[192:195], v0, s[52:55], s63 offen sc1
ra 164,3,1024
v_add_f32 v83, v83, v72
mvav 176,132,132
ra 228,9,1024
v_exp_f32 v73, v221
mvav 176,128,128
v_add_f32 v83, v83, v73
cv 254,72,73
cvav 168,128,112,36
v_exp_f32 v74, v222
mvav 168,132,116
dma 1,44,76,1024
ra 168,3,2048
v_add_f32 v83, v83, v74
mvav 168,136,120
ra 232,9,2048
v_exp_f32 v75, v223
mvav 168,140,124
v_add_f32 v83, v83, v75
cv 255,74,75
cvav 160,140,108,32
v_exp_f32 v72, v208
mvav 160,136,104
ra 172,3,3072
v_mov_b32 v86, v78
mvav 160,132,100
s_waitcnt lgkmcnt(7)
ra 236,9,3072
v_exp_f32 v73, v209
mvav 160,128,96
v_add_f32 v82, v72, v73
cv 248,72,73
cvav 188,144,144,44
v_exp_f32 v74, v210
mvav 188,148,148
dma 1,44,76,2048
ra 176,3,4096
v_add_f32 v82, v82, v74
mvav 188,152,152
s_add_u32 s63, s74, 8192
ra 240,9,4096
v_exp_f32 v75, v211
mvav 188,156,156
buffer_store_dwordx4 a[196:199], v0, s[52:55], s63 offen sc1
v_add_f32 v82, v82, v75
cv 249,74,75
cvav 180,156,140,40
v_exp_f32 v72, v212
mvav 180,152,136
ra 180,3,5120
v_add_f32 v82, v82, v72
mvav 180,148,132
ra 244,9,5120
v_exp_f32 v73, v213
mvav 180,144,128
v_add_f32 v82, v82, v73
cv 250,72,73
cvav 172,144,112,36
v_exp_f32 v74, v214
mvav 172,148,116
dma 1,44,76,3072
ra 184,3,6144
v_add_f32 v82, v82, v74
mvav 172,152,120
s_add_u32 s76, s76, 16384
ra 248,9,6144
v_exp_f32 v75, v215
mvav 172,156,124
v_add_f32 v82, v82, v75
cv 251,74,75
cvav 164,156,108,32
v_exp_f32 v72, v200
mvav 164,152,104
ra 188,3,7168
v_mov_b32 v85, v77
mvav 164,148,100
s_waitcnt lgkmcnt(8)
ra 252,9,7168
v_exp_f32 v73, v201
mvav 164,144,96
v_add_f32 v81, v72, v73
cv 244,72,73
zaav 96,160,236
s_add_u32 s63, s74, 4096
v_exp_f32 v74, v202
zaav 64,160,232
buffer_store_dwordx4 a[200:203], v0, s[52:55], s63 offen sc1
ra 128,2,24576
v_add_f32 v81, v81, v74
zaav 32,160,228
v_exp_f32 v75, v203
zaav 0,160,224
v_add_f32 v81, v81, v75
cv 245,74,75
zaav 100,164,236
v_exp_f32 v72, v204
zaav 68,164,232
ra 132,2,26624
v_add_f32 v81, v81, v72
zaav 36,164,228
v_exp_f32 v73, v205
zaav 4,164,224
v_add_f32 v81, v81, v73
cv 246,72,73
zaav 104,168,236
v_exp_f32 v74, v206
zaav 72,168,232
ra 136,2,28672
v_add_f32 v81, v81, v74
zaav 40,168,228
v_exp_f32 v75, v207
zaav 8,168,224
v_add_f32 v81, v81, v75
cv 247,74,75
zaav 108,172,236
v_exp_f32 v72, v192
zaav 76,172,232
ra 140,2,30720
v_max3_f32 v88, v83, v82, v81
v_mov_b32 v84, v76
zaav 44,172,228
s_waitcnt lgkmcnt(5)
s_add_u32 s63, s74, 12288
v_exp_f32 v73, v193
zaav 12,172,224
buffer_store_dwordx4 a[204:207], v0, s[52:55], s63 offen sc1
v_add_f32 v80, v72, v73
cv 240,72,73
zaav 112,176,236
v_exp_f32 v74, v194
zaav 80,176,232
ra 144,2,25600
v_add_f32 v80, v80, v74
zaav 48,176,228
v_exp_f32 v75, v195
zaav 16,176,224
v_add_f32 v80, v80, v75
cv 241,74,75
zaav 116,180,236
v_exp_f32 v72, v196
zaav 84,180,232
ra 148,2,27648
v_add_f32 v80, v80, v72
zaav 52,180,228
v_exp_f32 v73, v197
zaav 20,180,224
v_add_f32 v80, v80, v73
cv 242,72,73
zaav 120,184,236
v_exp_f32 v74, v198
zaav 88,184,232
ra 152,2,29696
v_add_f32 v80, v80, v74
zaav 56,184,228
v_exp_f32 v75, v199
zaav 24,184,224
v_add_f32 v80, v80, v75
cv 243,74,75
zaav 124,188,236
v_exp_f32 v72, v184
zaav 92,188,232
ra 156,2,31744
v_max_f32 v88, v88, v80
v_cmp_lt_f32 vcc, s90, v88
zaav 60,188,228
s_waitcnt lgkmcnt(4)
v_exp_f32 v73, v185
zaav 28,188,224
s_cbranch_vccnz L_fFF_2_fb
L_fFF_2_ret:
v_add_f32 v79, v72, v73
cv 236,72,73
cvav 216,128,144,44
v_exp_f32 v74, v186
mvav 216,132,148
ra 160,3,8192
v_add_f32 v79, v79, v74
v_add_f32 v87, v87, v83
mvav 216,136,152
v_exp_f32 v75, v187
mvav 216,140,156
v_add_f32 v79, v79, v75
cv 237,74,75
cvav 208,140,140,40
s_add_u32 s63, s75, 0
v_exp_f32 v72, v188
mvav 208,136,136
buffer_store_dwordx4 a[208:211], v0, s[52:55], s63 offen sc1
ra 164,3,9216
v_xor_b32 v2, 0x8000, v2
v_add_f32 v79, v79, v72
mvav 208,132,132
v_exp_f32 v73, v189
mvav 208,128,128
v_add_f32 v79, v79, v73
cv 238,72,73
cvav 200,128,112,36
v_exp_f32 v74, v190
mvav 200,132,116
ra 168,3,10240
v_add_f32 v79, v79, v74
mvav 200,136,120
v_exp_f32 v75, v191
mvav 200,140,124
v_add_f32 v79, v79, v75
cv 239,74,75
cvav 192,140,108,32
v_exp_f32 v72, v176
mvav 192,136,104
ra 172,3,11264
v_add_f32 v86, v86, v82
mvav 192,132,100
s_waitcnt lgkmcnt(4)
v_exp_f32 v73, v177
mvav 192,128,96
v_add_f32 v78, v72, v73
cv 232,72,73
cvav 220,144,144,44
v_exp_f32 v74, v178
mvav 220,148,148
ra 176,3,12288
v_add_f32 v78, v78, v74
mvav 220,152,152
s_add_u32 s63, s75, 8192
v_exp_f32 v75, v179
mvav 220,156,156
buffer_store_dwordx4 a[212:215], v0, s[52:55], s63 offen sc1
v_add_f32 v78, v78, v75
cv 233,74,75
cvav 212,156,140,40
v_exp_f32 v72, v180
mvav 212,152,136
ra 180,3,13312
v_add_f32 v78, v78, v72
mvav 212,148,132
v_exp_f32 v73, v181
mvav 212,144,128
v_add_f32 v78, v78, v73
cv 234,72,73
cvav 204,144,112,36
v_exp_f32 v74, v182
mvav 204,148,116
ra 184,3,14336
v_add_f32 v78, v78, v74
mvav 204,152,120
v_exp_f32 v75, v183
mvav 204,156,124
v_add_f32 v78, v78, v75
cv 235,74,75
cvav 196,156,108,32
s_and_b32 s59, s77, 0xc000
s_add_u32 m0, s59, s79
v_exp_f32 v72, v168
mvav 196,152,104
ra 188,3,15360
v_add_f32 v85, v85, v81
mvav 196,148,100
s_waitcnt lgkmcnt(4)
v_exp_f32 v73, v169
mvav 196,144,96
v_add_f32 v77, v72, v73
cv 228,72,73
maav 96,160,252
s_waitcnt vmcnt(18)
s_barrier
v_exp_f32 v74, v170
maav 64,160,248
dma 1,48,77,0
ra 128,2,0
v_add_f32 v77, v77, v74
maav 32,160,244
s_add_u32 s63, s75, 4096
v_exp_f32 v75, v171
maav 0,160,240
buffer_store_dwordx4 a[216:219], v0, s[52:55], s63 offen sc1
v_add_f32 v77, v77, v75
cv 229,74,75
maav 100,164,252
v_exp_f32 v72, v172
maav 68,164,248
ra 132,2,2048
v_add_f32 v77, v77, v72
maav 36,164,244
v_exp_f32 v73, v173
maav 4,164,240
v_add_f32 v77, v77, v73
cv 230,72,73
maav 104,168,252
v_exp_f32 v74, v174
maav 72,168,248
dma 1,48,77,1024
ra 136,2,4096
v_add_f32 v77, v77, v74
maav 40,168,244
v_exp_f32 v75, v175
maav 8,168,240
v_add_f32 v77, v77, v75
cv 231,74,75
maav 108,172,252
v_exp_f32 v72, v160
maav 76,172,248
ra 140,2,6144
v_max3_f32 v88, v79, v78, v77
v_add_f32 v84, v84, v80
maav 44,172,244
s_waitcnt lgkmcnt(4)
s_add_u32 s63, s75, 12288
v_exp_f32 v73, v161
maav 12,172,240
buffer_store_dwordx4 a[220:223], v0, s[52:55], s63 offen sc1
v_add_f32 v76, v72, v73
cv 224,72,73
maav 112,176,252
v_exp_f32 v74, v162
maav 80,176,248
dma 1,48,77,2048
ra 144,2,1024
v_add_f32 v76, v76, v74
maav 48,176,244
v_exp_f32 v75, v163
maav 16,176,240
v_add_f32 v76, v76, v75
cv 225,74,75
maav 116,180,252
v_exp_f32 v72, v164
maav 84,180,248
ra 148,2,3072
v_add_f32 v76, v76, v72
maav 52,180,244
v_exp_f32 v73, v165
maav 20,180,240
v_add_f32 v76, v76, v73
cv 226,72,73
maav 120,184,252
v_exp_f32 v74, v166
maav 88,184,248
dma 1,48,77,3072
ra 152,2,5120
v_add_f32 v76, v76, v74
maav 56,184,244
s_add_u32 s77, s77, 16384
v_exp_f32 v75, v167
maav 24,184,240
v_add_f32 v76, v76, v75
cv 227,74,75
maav 124,188,252
v_exp_f32 v72, v216
maav 92,188,248
ra 156,2,7168
v_max_f32 v88, v88, v76
v_cmp_lt_f32 vcc, s90, v88
maav 60,188,244
s_waitcnt lgkmcnt(4)
v_exp_f32 v73, v217
maav 28,188,240
s_cbranch_vccnz L_fFF_3_fb
L_fFF_3_ret:
v_add_f32 v83, v72, v73
cv 252,72,73
s_sub_u32 s91, s5, 1
s_cmp_eq_u32 s91, 0
s_cbranch_scc1 L_DF
L_FF:
cvav 184,128,144,44
s_and_b32 s59, s76, 0xc000
s_add_u32 m0, s59, s78
v_exp_f32 v74, v218
mvav 184,132,148
dma 1,44,76,0
ra 160,3,16384
v_add_f32 v83, v83, v74
v_add_f32 v87, v87, v79
mvav 184,136,152
v_exp_f32 v75, v219
mvav 184,140,156
v_add_f32 v83, v83, v75
cv 253,74,75
cvav 176,140,140,40
v_exp_f32 v72, v220
mvav 176,136,136
ra 164,3,17408
v_add_f32 v83, v83, v72
mvav 176,132,132
v_exp_f32 v73, v221
mvav 176,128,128
v_add_f32 v83, v83, v73
cv 254,72,73
cvav 168,128,112,36
v_exp_f32 v74, v222
mvav 168,132,116
dma 1,44,76,1024
ra 168,3,18432
v_add_f32 v83, v83, v74
mvav 168,136,120
v_exp_f32 v75, v223
mvav 168,140,124
v_add_f32 v83, v83, v75
cv 255,74,75
cvav 160,140,108,32
v_exp_f32 v72, v208
mvav 160,136,104
ra 172,3,19456
v_add_f32 v86, v86, v78
mvav 160,132,100
s_waitcnt lgkmcnt(4)
v_exp_f32 v73, v209
mvav 160,128,96
v_add_f32 v82, v72, v73
cv 248,72,73
cvav 188,144,144,44
v_exp_f32 v74, v210
mvav 188,148,148
dma 1,44,76,2048
ra 176,3,20480
v_add_f32 v82, v82, v74
mvav 188,152,152
v_exp_f32 v75, v211
mvav 188,156,156
v_add_f32 v82, v82, v75
cv 249,74,75
cvav 180,156,140,40
v_exp_f32 v72, v212
mvav 180,152,136
ra 180,3,21504
v_add_f32 v82, v82, v72
mvav 180,148,132
v_exp_f32 v73, v213
mvav 180,144,128
v_add_f32 v82, v82, v73
cv 250,72,73
cvav 172,144,112,36
v_exp_f32 v74, v214
mvav 172,148,116
dma 1,44,76,3072
ra 184,3,22528
v_add_f32 v82, v82, v74
mvav 172,152,120
s_add_u32 s76, s76, 16384
v_exp_f32 v75, v215
mvav 172,156,124
v_add_f32 v82, v82, v75
cv 251,74,75
cvav 164,156,108,32
v_exp_f32 v72, v200
mvav 164,152,104
ra 188,3,23552
v_add_f32 v85, v85, v77
mvav 164,148,100
s_waitcnt lgkmcnt(4)
v_exp_f32 v73, v201
mvav 164,144,96
v_add_f32 v81, v72, v73
cv 244,72,73
maav 96,160,236
v_exp_f32 v74, v202
maav 64,160,232
ra 128,2,8192
v_add_f32 v81, v81, v74
maav 32,160,228
v_exp_f32 v75, v203
maav 0,160,224
v_add_f32 v81, v81, v75
cv 245,74,75
maav 100,164,236
v_exp_f32 v72, v204
maav 68,164,232
ra 132,2,10240
v_add_f32 v81, v81, v72
maav 36,164,228
v_exp_f32 v73, v205
maav 4,164,224
v_add_f32 v81, v81, v73
cv 246,72,73
maav 104,168,236
v_exp_f32 v74, v206
maav 72,168,232
ra 136,2,12288
v_add_f32 v81, v81, v74
maav 40,168,228
v_exp_f32 v75, v207
maav 8,168,224
v_add_f32 v81, v81, v75
cv 247,74,75
maav 108,172,236
v_exp_f32 v72, v192
maav 76,172,232
ra 140,2,14336
v_max3_f32 v88, v83, v82, v81
v_add_f32 v84, v84, v76
maav 44,172,228
s_waitcnt lgkmcnt(4)
v_exp_f32 v73, v193
maav 12,172,224
v_add_f32 v80, v72, v73
cv 240,72,73
maav 112,176,236
v_exp_f32 v74, v194
maav 80,176,232
ra 144,2,9216
v_add_f32 v80, v80, v74
maav 48,176,228
v_exp_f32 v75, v195
maav 16,176,224
v_add_f32 v80, v80, v75
cv 241,74,75
maav 116,180,236
v_exp_f32 v72, v196
maav 84,180,232
ra 148,2,11264
v_add_f32 v80, v80, v72
maav 52,180,228
v_exp_f32 v73, v197
maav 20,180,224
v_add_f32 v80, v80, v73
cv 242,72,73
maav 120,184,236
v_exp_f32 v74, v198
maav 88,184,232
ra 152,2,13312
v_add_f32 v80, v80, v74
maav 56,184,228
v_exp_f32 v75, v199
maav 24,184,224
v_add_f32 v80, v80, v75
cv 243,74,75
maav 124,188,236
v_exp_f32 v72, v184
maav 92,188,232
ra 156,2,15360
v_max_f32 v88, v88, v80
v_cmp_lt_f32 vcc, s90, v88
maav 60,188,228
s_waitcnt lgkmcnt(4)
v_exp_f32 v73, v185
maav 28,188,224
s_cbranch_vccnz L_FF_0_fb
L_FF_0_ret:
v_add_f32 v79, v72, v73
cv 236,72,73
cvav 216,128,144,44
v_exp_f32 v74, v186
mvav 216,132,148
ra 160,3,24576
v_add_f32 v79, v79, v74
v_add_f32 v87, v87, v83
mvav 216,136,152
v_exp_f32 v75, v187
mvav 216,140,156
v_add_f32 v79, v79, v75
cv 237,74,75
cvav 208,140,140,40
v_exp_f32 v72, v188
mvav 208,136,136
ra 164,3,25600
v_add_f32 v79, v79, v72
mvav 208,132,132
v_exp_f32 v73, v189
mvav 208,128,128
v_add_f32 v79, v79, v73
cv 238,72,73
cvav 200,128,112,36
v_exp_f32 v74, v190
mvav 200,132,116
ra 168,3,26624
v_add_f32 v79, v79, v74
mvav 200,136,120
v_exp_f32 v75, v191
mvav 200,140,124
v_add_f32 v79, v79, v75
cv 239,74,75
cvav 192,140,108,32
v_exp_f32 v72, v176
mvav 192,136,104
ra 172,3,27648
v_add_f32 v86, v86, v82
mvav 192,132,100
s_waitcnt lgkmcnt(4)
v_exp_f32 v73, v177
mvav 192,128,96
v_add_f32 v78, v72, v73
cv 232,72,73
cvav 220,144,144,44
v_exp_f32 v74, v178
mvav 220,148,148
ra 176,3,28672
v_add_f32 v78, v78, v74
mvav 220,152,152
v_exp_f32 v75, v179
mvav 220,156,156
v_add_f32 v78, v78, v75
cv 233,74,75
cvav 212,156,140,40
v_exp_f32 v72, v180
mvav 212,152,136
ra 180,3,29696
v_add_f32 v78, v78, v72
mvav 212,148,132
v_exp_f32 v73, v181
mvav 212,144,128
v_add_f32 v78, v78, v73
cv 234,72,73
cvav 204,144,112,36
v_exp_f32 v74, v182
mvav 204,148,116
ra 184,3,30720
v_add_f32 v78, v78, v74
mvav 204,152,120
v_exp_f32 v75, v183
mvav 204,156,124
v_add_f32 v78, v78, v75
cv 235,74,75
cvav 196,156,108,32
s_and_b32 s59, s77, 0xc000
s_add_u32 m0, s59, s79
v_exp_f32 v72, v168
mvav 196,152,104
ra 188,3,31744
v_add_f32 v85, v85, v81
mvav 196,148,100
s_waitcnt lgkmcnt(4)
v_exp_f32 v73, v169
mvav 196,144,96
v_add_f32 v77, v72, v73
cv 228,72,73
maav 96,160,252
s_waitcnt vmcnt(12)
s_barrier
v_exp_f32 v74, v170
maav 64,160,248
dma 1,48,77,0
ra 128,2,16384
v_add_f32 v77, v77, v74
maav 32,160,244
v_exp_f32 v75, v171
maav 0,160,240
v_add_f32 v77, v77, v75
cv 229,74,75
maav 100,164,252
v_exp_f32 v72, v172
maav 68,164,248
ra 132,2,18432
v_xor_b32 v3, 0x8000, v3
v_add_f32 v77, v77, v72
maav 36,164,244
v_exp_f32 v73, v173
maav 4,164,240
v_add_f32 v77, v77, v73
cv 230,72,73
maav 104,168,252
v_exp_f32 v74, v174
maav 72,168,248
dma 1,48,77,1024
ra 136,2,20480
v_add_f32 v77, v77, v74
maav 40,168,244
v_exp_f32 v75, v175
maav 8,168,240
v_add_f32 v77, v77, v75
cv 231,74,75
maav 108,172,252
v_exp_f32 v72, v160
maav 76,172,248
ra 140,2,22528
v_max3_f32 v88, v79, v78, v77
v_add_f32 v84, v84, v80
maav 44,172,244
s_waitcnt lgkmcnt(4)
v_exp_f32 v73, v161
maav 12,172,240
v_add_f32 v76, v72, v73
cv 224,72,73
maav 112,176,252
v_exp_f32 v74, v162
maav 80,176,248
dma 1,48,77,2048
ra 144,2,17408
v_add_f32 v76, v76, v74
maav 48,176,244
v_exp_f32 v75, v163
maav 16,176,240
v_add_f32 v76, v76, v75
cv 225,74,75
maav 116,180,252
v_exp_f32 v72, v164
maav 84,180,248
ra 148,2,19456
v_add_f32 v76, v76, v72
maav 52,180,244
v_exp_f32 v73, v165
maav 20,180,240
v_add_f32 v76, v76, v73
cv 226,72,73
maav 120,184,252
v_exp_f32 v74, v166
maav 88,184,248
dma 1,48,77,3072
ra 152,2,21504
v_add_f32 v76, v76, v74
maav 56,184,244
s_add_u32 s77, s77, 16384
v_exp_f32 v75, v167
maav 24,184,240
v_add_f32 v76, v76, v75
cv 227,74,75
maav 124,188,252
v_exp_f32 v72, v216
maav 92,188,248
ra 156,2,23552
v_max_f32 v88, v88, v76
v_cmp_lt_f32 vcc, s90, v88
maav 60,188,244
s_waitcnt lgkmcnt(4)
v_exp_f32 v73, v217
maav 28,188,240
s_cbranch_vccnz L_FF_1_fb
L_FF_1_ret:
v_add_f32 v83, v72, v73
cv 252,72,73
cvav 184,128,144,44
s_and_b32 s59, s76, 0xc000
s_add_u32 m0, s59, s78
v_exp_f32 v74, v218
mvav 184,132,148
dma 1,44,76,0
ra 160,3,0
v_add_f32 v83, v83, v74
v_add_f32 v87, v87, v79
mvav 184,136,152
v_exp_f32 v75, v219
mvav 184,140,156
v_add_f32 v83, v83, v75
cv 253,74,75
cvav 176,140,140,40
v_exp_f32 v72, v220
mvav 176,136,136
ra 164,3,1024
v_add_f32 v83, v83, v72
mvav 176,132,132
v_exp_f32 v73, v221
mvav 176,128,128
v_add_f32 v83, v83, v73
cv 254,72,73
cvav 168,128,112,36
v_exp_f32 v74, v222
mvav 168,132,116
dma 1,44,76,1024
ra 168,3,2048
v_add_f32 v83, v83, v74
mvav 168,136,120
v_exp_f32 v75, v223
mvav 168,140,124
v_add_f32 v83, v83, v75
cv 255,74,75
cvav 160,140,108,32
v_exp_f32 v72, v208
mvav 160,136,104
ra 172,3,3072
v_add_f32 v86, v86, v78
mvav 160,132,100
s_waitcnt lgkmcnt(4)
v_exp_f32 v73, v209
mvav 160,128,96
v_add_f32 v82, v72, v73
cv 248,72,73
cvav 188,144,144,44
v_exp_f32 v74, v210
mvav 188,148,148
dma 1,44,76,2048
ra 176,3,4096
v_add_f32 v82, v82, v74
mvav 188,152,152
v_exp_f32 v75, v211
mvav 188,156,156
v_add_f32 v82, v82, v75
cv 249,74,75
cvav 180,156,140,40
v_exp_f32 v72, v212
mvav 180,152,136
ra 180,3,5120
v_add_f32 v82, v82, v72
mvav 180,148,132
v_exp_f32 v73, v213
mvav 180,144,128
v_add_f32 v82, v82, v73
cv 250,72,73
cvav 172,144,112,36
v_exp_f32 v74, v214
mvav 172,148,116
dma 1,44,76,3072
ra 184,3,6144
v_add_f32 v82, v82, v74
mvav 172,152,120
s_add_u32 s76, s76, 16384
v_exp_f32 v75, v215
mvav 172,156,124
v_add_f32 v82, v82, v75
cv 251,74,75
cvav 164,156,108,32
v_exp_f32 v72, v200
mvav 164,152,104
ra 188,3,7168
v_add_f32 v85, v85, v77
mvav 164,148,100
s_waitcnt lgkmcnt(4)
v_exp_f32 v73, v201
mvav 164,144,96
v_add_f32 v81, v72, v73
cv 244,72,73
maav 96,160,236
v_exp_f32 v74, v202
maav 64,160,232
ra 128,2,24576
v_add_f32 v81, v81, v74
maav 32,160,228
v_exp_f32 v75, v203
maav 0,160,224
v_add_f32 v81, v81, v75
cv 245,74,75
maav 100,164,236
v_exp_f32 v72, v204
maav 68,164,232
ra 132,2,26624
v_add_f32 v81, v81, v72
maav 36,164,228
v_exp_f32 v73, v205
maav 4,164,224
v_add_f32 v81, v81, v73
cv 246,72,73
maav 104,168,236
v_exp_f32 v74, v206
maav 72,168,232
ra 136,2,28672
v_add_f32 v81, v81, v74
maav 40,168,228
v_exp_f32 v75, v207
maav 8,168,224
v_add_f32 v81, v81, v75
cv 247,74,75
maav 108,172,236
v_exp_f32 v72, v192
maav 76,172,232
ra 140,2,30720
v_max3_f32 v88, v83, v82, v81
v_add_f32 v84, v84, v76
maav 44,172,228
s_waitcnt lgkmcnt(4)
v_exp_f32 v73, v193
maav 12,172,224
v_add_f32 v80, v72, v73
cv 240,72,73
maav 112,176,236
v_exp_f32 v74, v194
maav 80,176,232
ra 144,2,25600
v_add_f32 v80, v80, v74
maav 48,176,228
v_exp_f32 v75, v195
maav 16,176,224
v_add_f32 v80, v80, v75
cv 241,74,75
maav 116,180,236
v_exp_f32 v72, v196
maav 84,180,232
ra 148,2,27648
v_add_f32 v80, v80, v72
maav 52,180,228
v_exp_f32 v73, v197
maav 20,180,224
v_add_f32 v80, v80, v73
cv 242,72,73
maav 120,184,236
v_exp_f32 v74, v198
maav 88,184,232
ra 152,2,29696
v_add_f32 v80, v80, v74
maav 56,184,228
v_exp_f32 v75, v199
maav 24,184,224
v_add_f32 v80, v80, v75
cv 243,74,75
maav 124,188,236
v_exp_f32 v72, v184
maav 92,188,232
ra 156,2,31744
v_max_f32 v88, v88, v80
v_cmp_lt_f32 vcc, s90, v88
maav 60,188,228
s_waitcnt lgkmcnt(4)
v_exp_f32 v73, v185
maav 28,188,224
s_cbranch_vccnz L_FF_2_fb
L_FF_2_ret:
v_add_f32 v79, v72, v73
cv 236,72,73
cvav 216,128,144,44
v_exp_f32 v74, v186
mvav 216,132,148
ra 160,3,8192
v_add_f32 v79, v79, v74
v_add_f32 v87, v87, v83
mvav 216,136,152
v_exp_f32 v75, v187
mvav 216,140,156
v_add_f32 v79, v79, v75
cv 237,74,75
cvav 208,140,140,40
v_exp_f32 v72, v188
mvav 208,136,136
ra 164,3,9216
v_xor_b32 v2, 0x8000, v2
v_add_f32 v79, v79, v72
mvav 208,132,132
v_exp_f32 v73, v189
mvav 208,128,128
v_add_f32 v79, v79, v73
cv 238,72,73
cvav 200,128,112,36
v_exp_f32 v74, v190
mvav 200,132,116
ra 168,3,10240
v_add_f32 v79, v79, v74
mvav 200,136,120
v_exp_f32 v75, v191
mvav 200,140,124
v_add_f32 v79, v79, v75
cv 239,74,75
cvav 192,140,108,32
v_exp_f32 v72, v176
mvav 192,136,104
ra 172,3,11264
v_add_f32 v86, v86, v82
mvav 192,132,100
s_waitcnt lgkmcnt(4)
v_exp_f32 v73, v177
mvav 192,128,96
v_add_f32 v78, v72, v73
cv 232,72,73
cvav 220,144,144,44
v_exp_f32 v74, v178
mvav 220,148,148
ra 176,3,12288
v_add_f32 v78, v78, v74
mvav 220,152,152
v_exp_f32 v75, v179
mvav 220,156,156
v_add_f32 v78, v78, v75
cv 233,74,75
cvav 212,156,140,40
v_exp_f32 v72, v180
mvav 212,152,136
ra 180,3,13312
v_add_f32 v78, v78, v72
mvav 212,148,132
v_exp_f32 v73, v181
mvav 212,144,128
v_add_f32 v78, v78, v73
cv 234,72,73
cvav 204,144,112,36
v_exp_f32 v74, v182
mvav 204,148,116
ra 184,3,14336
v_add_f32 v78, v78, v74
mvav 204,152,120
v_exp_f32 v75, v183
mvav 204,156,124
v_add_f32 v78, v78, v75
cv 235,74,75
cvav 196,156,108,32
s_and_b32 s59, s77, 0xc000
s_add_u32 m0, s59, s79
v_exp_f32 v72, v168
mvav 196,152,104
ra 188,3,15360
v_add_f32 v85, v85, v81
mvav 196,148,100
s_waitcnt lgkmcnt(4)
v_exp_f32 v73, v169
mvav 196,144,96
v_add_f32 v77, v72, v73
cv 228,72,73
maav 96,160,252
s_waitcnt vmcnt(12)
s_barrier
v_exp_f32 v74, v170
maav 64,160,248
dma 1,48,77,0
ra 128,2,0
v_add_f32 v77, v77, v74
maav 32,160,244
v_exp_f32 v75, v171
maav 0,160,240
v_add_f32 v77, v77, v75
cv 229,74,75
maav 100,164,252
v_exp_f32 v72, v172
maav 68,164,248
ra 132,2,2048
v_add_f32 v77, v77, v72
maav 36,164,244
v_exp_f32 v73, v173
maav 4,164,240
v_add_f32 v77, v77, v73
cv 230,72,73
maav 104,168,252
v_exp_f32 v74, v174
maav 72,168,248
dma 1,48,77,1024
ra 136,2,4096
v_add_f32 v77, v77, v74
maav 40,168,244
v_exp_f32 v75, v175
maav 8,168,240
v_add_f32 v77, v77, v75
cv 231,74,75
maav 108,172,252
v_exp_f32 v72, v160
maav 76,172,248
ra 140,2,6144
v_max3_f32 v88, v79, v78, v77
v_add_f32 v84, v84, v80
maav 44,172,244
s_waitcnt lgkmcnt(4)
v_exp_f32 v73, v161
maav 12,172,240
v_add_f32 v76, v72, v73
cv 224,72,73
maav 112,176,252
v_exp_f32 v74, v162
maav 80,176,248
dma 1,48,77,2048
ra 144,2,1024
v_add_f32 v76, v76, v74
maav 48,176,244
v_exp_f32 v75, v163
maav 16,176,240
v_add_f32 v76, v76, v75
cv 225,74,75
maav 116,180,252
v_exp_f32 v72, v164
maav 84,180,248
ra 148,2,3072
v_add_f32 v76, v76, v72
maav 52,180,244
v_exp_f32 v73, v165
maav 20,180,240
v_add_f32 v76, v76, v73
cv 226,72,73
maav 120,184,252
v_exp_f32 v74, v166
maav 88,184,248
dma 1,48,77,3072
ra 152,2,5120
v_add_f32 v76, v76, v74
maav 56,184,244
s_add_u32 s77, s77, 16384
v_exp_f32 v75, v167
maav 24,184,240
v_add_f32 v76, v76, v75
cv 227,74,75
maav 124,188,252
v_exp_f32 v72, v216
maav 92,188,248
ra 156,2,7168
v_max_f32 v88, v88, v76
v_cmp_lt_f32 vcc, s90, v88
maav 60,188,244
s_waitcnt lgkmcnt(4)
v_exp_f32 v73, v217
maav 28,188,240
s_cbranch_vccnz L_FF_3_fb
L_FF_3_ret:
v_add_f32 v83, v72, v73
cv 252,72,73
s_sub_u32 s91, s91, 1
s_cmp_lg_u32 s91, 0
s_cbranch_scc1 L_FF
L_DF:
v_add_f32 v67, s11, v32
v_fma_f32 v64, v48, s10, v67
v_fma_f32 v65, v49, s10, v67
v_fma_f32 v66, v50, s10, v67
v_fma_f32 v67, v51, s10, v67
v_add_f32 v71, s13, v32
v_fma_f32 v68, v48, s12, v71
v_fma_f32 v69, v49, s12, v71
v_fma_f32 v70, v50, s12, v71
v_fma_f32 v71, v51, s12, v71
s_nop 1
cvav 184,128,144,44
s_and_b32 s59, s76, 0xc000
s_add_u32 m0, s59, s78
v_exp_f32 v74, v218
mvav 184,132,148
dma 1,44,76,0
ra 160,3,16384
v_add_f32 v83, v83, v74
v_add_f32 v87, v87, v79
mvav 184,136,152
v_exp_f32 v75, v219
mvav 184,140,156
v_add_f32 v83, v83, v75
cv 253,74,75
cvav 176,140,140,40
v_exp_f32 v72, v220
mvav 176,136,136
ra 164,3,17408
v_add_f32 v83, v83, v72
mvav 176,132,132
v_exp_f32 v73, v221
mvav 176,128,128
v_add_f32 v83, v83, v73
cv 254,72,73
cvav 168,128,112,36
v_exp_f32 v74, v222
mvav 168,132,116
dma 1,44,76,1024
ra 168,3,18432
v_add_f32 v83, v83, v74
mvav 168,136,120
v_exp_f32 v75, v223
mvav 168,140,124
v_add_f32 v83, v83, v75
cv 255,74,75
cvav 160,140,108,64
v_exp_f32 v72, v208
mvav 160,136,104
ra 172,3,19456
v_add_f32 v86, v86, v78
mvav 160,132,100
s_waitcnt lgkmcnt(4)
v_exp_f32 v73, v209
mvav 160,128,96
v_add_f32 v82, v72, v73
cv 248,72,73
cvav 188,144,144,44
v_exp_f32 v74, v210
mvav 188,148,148
dma 1,44,76,2048
ra 176,3,20480
v_add_f32 v82, v82, v74
mvav 188,152,152
v_exp_f32 v75, v211
mvav 188,156,156
v_add_f32 v82, v82, v75
cv 249,74,75
cvav 180,156,140,40
v_exp_f32 v72, v212
mvav 180,152,136
ra 180,3,21504
v_add_f32 v82, v82, v72
mvav 180,148,132
v_exp_f32 v73, v213
mvav 180,144,128
v_add_f32 v82, v82, v73
cv 250,72,73
cvav 172,144,112,36
v_exp_f32 v74, v214
mvav 172,148,116
dma 1,44,76,3072
ra 184,3,22528
v_add_f32 v82, v82, v74
mvav 172,152,120
s_add_u32 s76, s76, 16384
v_exp_f32 v75, v215
mvav 172,156,124
v_add_f32 v82, v82, v75
cv 251,74,75
cvav 164,156,108,68
v_exp_f32 v72, v200
mvav 164,152,104
ra 188,3,23552
v_add_f32 v85, v85, v77
mvav 164,148,100
s_waitcnt lgkmcnt(4)
v_exp_f32 v73, v201
mvav 164,144,96
v_add_f32 v81, v72, v73
cv 244,72,73
maav 96,160,236
v_exp_f32 v74, v202
maav 64,160,232
ra 128,2,8192
v_add_f32 v81, v81, v74
maav 32,160,228
v_exp_f32 v75, v203
maav 0,160,224
v_add_f32 v81, v81, v75
cv 245,74,75
maav 100,164,236
v_exp_f32 v72, v204
maav 68,164,232
ra 132,2,10240
v_add_f32 v81, v81, v72
maav 36,164,228
v_exp_f32 v73, v205
maav 4,164,224
v_add_f32 v81, v81, v73
cv 246,72,73
maav 104,168,236
v_exp_f32 v74, v206
maav 72,168,232
ra 136,2,12288
v_add_f32 v81, v81, v74
maav 40,168,228
v_exp_f32 v75, v207
maav 8,168,224
v_add_f32 v81, v81, v75
cv 247,74,75
maav 108,172,236
v_exp_f32 v72, v192
maav 76,172,232
ra 140,2,14336
v_max3_f32 v88, v83, v82, v81
v_add_f32 v84, v84, v76
maav 44,172,228
s_waitcnt lgkmcnt(4)
v_exp_f32 v73, v193
maav 12,172,224
v_add_f32 v80, v72, v73
cv 240,72,73
maav 112,176,236
v_exp_f32 v74, v194
maav 80,176,232
ra 144,2,9216
v_add_f32 v80, v80, v74
maav 48,176,228
v_exp_f32 v75, v195
maav 16,176,224
v_add_f32 v80, v80, v75
cv 241,74,75
maav 116,180,236
v_exp_f32 v72, v196
maav 84,180,232
ra 148,2,11264
v_add_f32 v80, v80, v72
maav 52,180,228
v_exp_f32 v73, v197
maav 20,180,224
buffer_load_dword a192, v19, s[36:39], 0 offen
v_add_f32 v80, v80, v73
cv 242,72,73
maav 120,184,236
v_exp_f32 v74, v198
maav 88,184,232
ra 152,2,13312
v_add_f32 v80, v80, v74
maav 56,184,228
v_exp_f32 v75, v199
maav 24,184,224
buffer_load_dword a193, v20, s[40:43], 0 offen
v_add_f32 v80, v80, v75
cv 243,74,75
maav 124,188,236
v_exp_f32 v72, v184
maav 92,188,232
ra 156,2,15360
v_max_f32 v88, v88, v80
v_cmp_lt_f32 vcc, s90, v88
maav 60,188,228
s_waitcnt lgkmcnt(4)
v_exp_f32 v73, v185
maav 28,188,224
s_cbranch_vccnz L_DF_0_fb
L_DF_0_ret:
v_add_f32 v79, v72, v73
cv 236,72,73
v_add_f32 v67, s15, v32
v_fma_f32 v64, v48, s14, v67
v_fma_f32 v65, v49, s14, v67
v_fma_f32 v66, v50, s14, v67
v_fma_f32 v67, v51, s14, v67
v_add_f32 v71, s17, v32
v_fma_f32 v68, v48, s16, v71
v_fma_f32 v69, v49, s16, v71
v_fma_f32 v70, v50, s16, v71
v_fma_f32 v71, v51, s16, v71
s_nop 1
cvav 216,128,144,44
v_exp_f32 v74, v186
mvav 216,132,148
ra 160,3,24576
v_add_f32 v79, v79, v74
v_add_f32 v87, v87, v83
mvav 216,136,152
v_exp_f32 v75, v187
mvav 216,140,156
v_add_f32 v79, v79, v75
cv 237,74,75
cvav 208,140,140,40
v_exp_f32 v72, v188
mvav 208,136,136
ra 164,3,25600
v_add_f32 v79, v79, v72
mvav 208,132,132
v_exp_f32 v73, v189
mvav 208,128,128
v_add_f32 v79, v79, v73
cv 238,72,73
cvav 200,128,112,36
v_exp_f32 v74, v190
mvav 200,132,116
ra 168,3,26624
v_add_f32 v79, v79, v74
mvav 200,136,120
v_exp_f32 v75, v191
mvav 200,140,124
v_add_f32 v79, v79, v75
cv 239,74,75
cvav 192,140,108,64
v_exp_f32 v72, v176
mvav 192,136,104
ra 172,3,27648
v_add_f32 v86, v86, v82
mvav 192,132,100
s_waitcnt lgkmcnt(4)
v_exp_f32 v73, v177
mvav 192,128,96
v_add_f32 v78, v72, v73
cv 232,72,73
cvav 220,144,144,44
v_exp_f32 v74, v178
mvav 220,148,148
ra 176,3,28672
v_add_f32 v78, v78, v74
mvav 220,152,152
v_exp_f32 v75, v179
mvav 220,156,156
v_add_f32 v78, v78, v75
cv 233,74,75
cvav 212,156,140,40
v_exp_f32 v72, v180
mvav 212,152,136
ra 180,3,29696
v_add_f32 v78, v78, v72
mvav 212,148,132
v_exp_f32 v73, v181
mvav 212,144,128
v_add_f32 v78, v78, v73
cv 234,72,73
cvav 204,144,112,36
v_exp_f32 v74, v182
mvav 204,148,116
ra 184,3,30720
v_add_f32 v78, v78, v74
mvav 204,152,120
v_exp_f32 v75, v183
mvav 204,156,124
v_add_f32 v78, v78, v75
cv 235,74,75
cvav 196,156,108,68
s_and_b32 s59, s77, 0xc000
s_add_u32 m0, s59, s79
v_exp_f32 v72, v168
mvav 196,152,104
ra 188,3,31744
v_add_f32 v85, v85, v81
mvav 196,148,100
s_waitcnt lgkmcnt(4)
v_exp_f32 v73, v169
mvav 196,144,96
v_add_f32 v77, v72, v73
cv 228,72,73
maav 96,160,252
s_waitcnt vmcnt(12)
s_barrier
v_exp_f32 v74, v170
maav 64,160,248
dma 1,48,77,0
ra 128,2,16384
v_add_f32 v77, v77, v74
maav 32,160,244
v_exp_f32 v75, v171
maav 0,160,240
v_add_f32 v77, v77, v75
cv 229,74,75
maav 100,164,252
v_exp_f32 v72, v172
maav 68,164,248
ra 132,2,18432
v_xor_b32 v3, 0x8000, v3
v_add_f32 v77, v77, v72
maav 36,164,244
v_exp_f32 v73, v173
maav 4,164,240
v_add_f32 v77, v77, v73
cv 230,72,73
maav 104,168,252
v_exp_f32 v74, v174
maav 72,168,248
dma 1,48,77,1024
ra 136,2,20480
v_add_f32 v77, v77, v74
maav 40,168,244
v_exp_f32 v75, v175
maav 8,168,240
v_add_f32 v77, v77, v75
cv 231,74,75
maav 108,172,252
v_exp_f32 v72, v160
maav 76,172,248
ra 140,2,22528
v_max3_f32 v88, v79, v78, v77
v_add_f32 v84, v84, v80
maav 44,172,244
s_waitcnt lgkmcnt(4)
v_exp_f32 v73, v161
maav 12,172,240
v_add_f32 v76, v72, v73
cv 224,72,73
maav 112,176,252
v_exp_f32 v74, v162
maav 80,176,248
dma 1,48,77,2048
ra 144,2,17408
v_add_f32 v76, v76, v74
maav 48,176,244
v_exp_f32 v75, v163
maav 16,176,240
v_add_f32 v76, v76, v75
cv 225,74,75
maav 116,180,252
v_exp_f32 v72, v164
maav 84,180,248
ra 148,2,19456
v_add_f32 v76, v76, v72
maav 52,180,244
v_exp_f32 v73, v165
maav 20,180,240
v_add_f32 v76, v76, v73
cv 226,72,73
maav 120,184,252
v_exp_f32 v74, v166
maav 88,184,248
dma 1,48,77,3072
ra 152,2,21504
v_add_f32 v76, v76, v74
maav 56,184,244
s_add_u32 s77, s77, 16384
v_exp_f32 v75, v167
maav 24,184,240
v_add_f32 v76, v76, v75
cv 227,74,75
maav 124,188,252
v_exp_f32 v72, v216
maav 92,188,248
ra 156,2,23552
v_max_f32 v88, v88, v76
v_cmp_lt_f32 vcc, s90, v88
maav 60,188,244
s_waitcnt lgkmcnt(4)
v_exp_f32 v73, v217
maav 28,188,240
s_cbranch_vccnz L_DF_1_fb
L_DF_1_ret:
v_add_f32 v83, v72, v73
cv 252,72,73
v_add_f32 v67, s11, v36
v_fma_f32 v64, v48, s10, v67
v_fma_f32 v65, v49, s10, v67
v_fma_f32 v66, v50, s10, v67
v_fma_f32 v67, v51, s10, v67
v_add_f32 v71, s13, v36
v_fma_f32 v68, v48, s12, v71
v_fma_f32 v69, v49, s12, v71
v_fma_f32 v70, v50, s12, v71
v_fma_f32 v71, v51, s12, v71
s_nop 1
cvav 184,128,144,44
s_and_b32 s59, s76, 0xc000
s_add_u32 m0, s59, s78
v_exp_f32 v74, v218
mvav 184,132,148
dma 1,44,76,0
ra 160,3,0
v_add_f32 v83, v83, v74
v_exp_f32 v75, v219
v_add_f32 v87, v87, v79
mvav 184,136,152
v_add_f32 v83, v83, v75
cv 253,74,75
mvav 184,140,156
v_exp_f32 v72, v220
cvav 176,140,140,40
ra 164,3,1024
v_add_f32 v83, v83, v72
mvav 176,136,136
v_exp_f32 v73, v221
mvav 176,132,132
v_add_f32 v83, v83, v73
cv 254,72,73
v_exp_f32 v74, v222
mvav 176,128,128
dma 1,44,76,1024
ra 168,3,2048
v_add_f32 v83, v83, v74
cvav 168,128,112,64
v_exp_f32 v75, v223
mvav 168,132,116
v_add_f32 v83, v83, v75
cv 255,74,75
mvav 168,136,120
s_waitcnt lgkmcnt(3)
ra 172,3,3072
v_exp_f32 v72, v208
mvav 168,140,124
cvav 188,144,144,44
v_exp_f32 v73, v209
mvav 188,148,148
dma 1,44,76,2048
ra 176,3,4096
v_add_f32 v82, v72, v73
cv 248,72,73
v_exp_f32 v74, v210
v_add_f32 v86, v86, v78
mvav 188,152,152
v_add_f32 v82, v82, v74
mvav 188,156,156
v_exp_f32 v75, v211
cvav 180,156,140,40
ra 180,3,5120
v_add_f32 v82, v82, v75
cv 249,74,75
mvav 180,152,136
v_exp_f32 v72, v212
mvav 180,148,132
v_add_f32 v82, v82, v72
mvav 180,144,128
dma 1,44,76,3072
ra 184,3,6144
v_exp_f32 v73, v213
cvav 172,144,112,68
s_add_u32 s76, s76, 16384
v_add_f32 v82, v82, v73
cv 250,72,73
v_exp_f32 v74, v214
mvav 172,148,116
v_add_f32 v82, v82, v74
mvav 172,152,120
s_waitcnt lgkmcnt(3)
ra 188,3,7168
v_exp_f32 v75, v215
mvav 172,156,124
v_add_f32 v82, v82, v75
cv 251,74,75
maav 96,160,236
v_exp_f32 v72, v200
maav 64,160,232
ra 128,2,24576
maav 32,160,228
v_exp_f32 v73, v201
maav 0,160,224
v_add_f32 v81, v72, v73
cv 244,72,73
v_exp_f32 v74, v202
maav 100,164,236
v_add_f32 v81, v81, v74
maav 68,164,232
ra 132,2,26624
v_exp_f32 v75, v203
v_add_f32 v85, v85, v77
maav 36,164,228
v_add_f32 v81, v81, v75
cv 245,74,75
maav 4,164,224
v_exp_f32 v72, v204
maav 104,168,236
v_add_f32 v81, v81, v72
v_exp_f32 v73, v205
maav 72,168,232
ra 136,2,28672
v_add_f32 v81, v81, v73
cv 246,72,73
maav 40,168,228
v_exp_f32 v74, v206
maav 8,168,224
v_add_f32 v81, v81, v74
maav 108,172,236
v_exp_f32 v75, v207
maav 76,172,232
ra 140,2,30720
v_add_f32 v81, v81, v75
cv 247,74,75
maav 44,172,228
s_waitcnt lgkmcnt(4)
v_exp_f32 v72, v192
maav 12,172,224
v_exp_f32 v73, v193
v_max3_f32 v88, v83, v82, v81
maav 112,176,236
v_add_f32 v80, v72, v73
cv 240,72,73
maav 80,176,232
ra 144,2,25600
v_exp_f32 v74, v194
maav 48,176,228
v_add_f32 v80, v80, v74
maav 16,176,224
v_exp_f32 v75, v195
maav 116,180,236
v_add_f32 v80, v80, v75
cv 241,74,75
maav 84,180,232
ra 148,2,27648
v_exp_f32 v72, v196
v_add_f32 v84, v84, v76
maav 52,180,228
v_add_f32 v80, v80, v72
v_exp_f32 v73, v197
maav 20,180,224
v_add_f32 v80, v80, v73
cv 242,72,73
maav 120,184,236
v_exp_f32 v74, v198
maav 88,184,232
ra 152,2,29696
v_add_f32 v80, v80, v74
maav 56,184,228
v_exp_f32 v75, v199
maav 24,184,224
v_add_f32 v80, v80, v75
cv 243,74,75
maav 124,188,236
v_exp_f32 v72, v184
maav 92,188,232
ra 156,2,31744
v_max_f32 v88, v88, v80
v_cmp_lt_f32 vcc, s90, v88
maav 60,188,228
s_waitcnt lgkmcnt(4)
v_exp_f32 v73, v185
maav 28,188,224
s_cbranch_vccnz L_DF_2_fb
L_DF_2_ret:
v_add_f32 v79, v72, v73
cv 236,72,73
v_add_f32 v67, s15, v36
v_fma_f32 v64, v48, s14, v67
v_fma_f32 v65, v49, s14, v67
v_fma_f32 v66, v50, s14, v67
v_fma_f32 v67, v51, s14, v67
v_add_f32 v71, s17, v36
v_fma_f32 v68, v48, s16, v71
v_fma_f32 v69, v49, s16, v71
v_fma_f32 v70, v50, s16, v71
v_fma_f32 v71, v51, s16, v71
s_nop 1
cvav 216,128,144,44
v_exp_f32 v74, v186
mvav 216,132,148
ra 160,3,8192
v_add_f32 v79, v79, v74
v_add_f32 v87, v87, v83
mvav 216,136,152
v_exp_f32 v75, v187
mvav 216,140,156
v_add_f32 v79, v79, v75
cv 237,74,75
cvav 208,140,140,40
ra 164,3,9216
v_exp_f32 v72, v188
mvav 208,136,136
v_xor_b32 v2, 0x8000, v2
v_add_f32 v79, v79, v72
mvav 208,132,132
v_exp_f32 v73, v189
mvav 208,128,128
ra 168,3,10240
v_add_f32 v79, v79, v73
cv 238,72,73
cvav 200,128,112,64
v_exp_f32 v74, v190
mvav 200,132,116
v_add_f32 v79, v79, v74
mvav 200,136,120
s_waitcnt lgkmcnt(3)
ra 172,3,11264
v_exp_f32 v75, v191
mvav 200,140,124
v_add_f32 v79, v79, v75
cv 239,74,75
cvav 220,144,144,44
mvav 220,148,148
ra 176,3,12288
v_add_u32 v2, s89, v2
v_add_f32 v86, v86, v82
mvav 220,152,152
v_exp_f32 v72, v176
mvav 220,156,156
cvav 212,156,140,40
ra 180,3,13312
v_exp_f32 v73, v177
mvav 212,152,136
v_add_f32 v78, v72, v73
cv 232,72,73
mvav 212,148,132
v_exp_f32 v74, v178
mvav 212,144,128
ra 184,3,14336
v_add_f32 v78, v78, v74
cvav 204,144,112,68
s_and_b32 s59, s77, 0xc000
s_add_u32 m0, s59, s79
v_exp_f32 v75, v179
mvav 204,148,116
v_add_f32 v78, v78, v75
cv 233,74,75
mvav 204,152,120
s_waitcnt lgkmcnt(3)
ra 188,3,15360
v_exp_f32 v72, v180
mvav 204,156,124
v_add_f32 v78, v78, v72
maav 96,160,252
s_waitcnt vmcnt(12)
s_barrier
maav 64,160,248
dma 1,48,77,0
ra 128,2,0
maav 32,160,244
v_exp_f32 v73, v181
maav 0,160,240
v_add_f32 v78, v78, v73
cv 234,72,73
maav 100,164,252
v_exp_f32 v74, v182
maav 68,164,248
ra 132,2,2048
v_add_f32 v78, v78, v74
v_add_f32 v85, v85, v81
maav 36,164,244
v_exp_f32 v75, v183
maav 4,164,240
v_add_f32 v78, v78, v75
cv 235,74,75
maav 104,168,252
v_exp_f32 v72, v168
maav 72,168,248
dma 1,48,77,1024
ra 136,2,4096
maav 40,168,244
v_exp_f32 v73, v169
maav 8,168,240
v_add_f32 v77, v72, v73
cv 228,72,73
maav 108,172,252
v_exp_f32 v74, v170
maav 76,172,248
ra 140,2,6144
v_add_f32 v77, v77, v74
maav 44,172,244
s_waitcnt lgkmcnt(4)
maav 12,172,240
maav 112,176,252
v_exp_f32 v75, v171
maav 80,176,248
dma 1,48,77,2048
ra 144,2,1024
v_add_f32 v77, v77, v75
cv 229,74,75
maav 48,176,244
v_exp_f32 v72, v172
maav 16,176,240
v_add_f32 v77, v77, v72
maav 116,180,252
v_exp_f32 v73, v173
maav 84,180,248
ra 148,2,3072
v_add_f32 v77, v77, v73
cv 230,72,73
v_add_f32 v84, v84, v80
maav 52,180,244
v_exp_f32 v74, v174
maav 20,180,240
v_add_f32 v77, v77, v74
maav 120,184,252
v_exp_f32 v75, v175
maav 88,184,248
dma 1,48,77,3072
ra 152,2,5120
v_add_f32 v77, v77, v75
cv 231,74,75
maav 56,184,244
s_add_u32 s77, s77, 16384
maav 24,184,240
maav 124,188,252
v_exp_f32 v72, v216
maav 92,188,248
buffer_store_dword v23, v21, s[52:55], s73 offen sc1
ra 156,2,7168
v_max3_f32 v88, v79, v78, v77
v_cmp_lt_f32 vcc, s90, v88
maav 60,188,244
s_waitcnt lgkmcnt(4)
v_exp_f32 v73, v217
maav 28,188,240
s_cbranch_vccnz L_DF_3_fb
L_DF_3_ret:
v_add_f32 v83, v72, v73
cv 252,72,73
s_cmp_eq_u32 s5, 7
s_cbranch_scc1 L_TYD
L_TY:
v_mov_b32 v32, v6
v_mov_b32 v33, v6
v_mov_b32 v34, v6
v_mov_b32 v35, v6
v_mov_b32 v36, v7
v_mov_b32 v37, v7
v_mov_b32 v38, v7
v_mov_b32 v39, v7
cvav 184,128,144,44
s_and_b32 s59, s76, 0xc000
s_add_u32 m0, s59, s78
v_exp_f32 v74, v218
mvav 184,132,148
dma 1,44,76,0
ra 160,3,16384
v_add_f32 v83, v83, v74
v_add_f32 v87, v87, v79
mvav 184,136,152
v_exp_f32 v75, v219
mvav 184,140,156
v_add_f32 v83, v83, v75
cv 253,74,75
cvav 176,140,140,40
v_exp_f32 v72, v220
mvav 176,136,136
ra 164,3,17408
v_add_f32 v83, v83, v72
mvav 176,132,132
v_exp_f32 v73, v221
mvav 176,128,128
v_add_f32 v83, v83, v73
cv 254,72,73
cvaa 168,128,240,36
v_exp_f32 v74, v222
mvaa 168,132,244
dma 1,44,76,1024
ra 168,3,18432
v_add_f32 v83, v83, v74
mvaa 168,136,248
v_exp_f32 v75, v223
mvaa 168,140,252
v_add_f32 v83, v83, v75
cv 255,74,75
cvaa 160,140,236,32
mvaa 160,136,232
ra 172,3,19456
v_add_f32 v86, v86, v78
mvaa 160,132,228
s_waitcnt lgkmcnt(4)
v_exp_f32 v72, v208
mvaa 160,128,224
cvav 188,144,144,44
v_exp_f32 v73, v209
mvav 188,148,148
dma 1,44,76,2048
ra 176,3,20480
v_add_f32 v82, v72, v73
cv 248,72,73
mvav 188,152,152
v_exp_f32 v74, v210
mvav 188,156,156
v_add_f32 v82, v82, v74
cvav 180,156,140,40
v_exp_f32 v75, v211
mvav 180,152,136
ra 180,3,21504
v_add_f32 v82, v82, v75
cv 249,74,75
mvav 180,148,132
v_exp_f32 v72, v212
mvav 180,144,128
v_add_f32 v82, v82, v72
cvaa 172,144,240,36
mvaa 172,148,244
dma 1,44,76,3072
ra 184,3,22528
mvaa 172,152,248
s_add_u32 s76, s76, 16384
v_exp_f32 v73, v213
mvaa 172,156,252
v_add_f32 v82, v82, v73
cv 250,72,73
cvaa 164,156,236,32
v_exp_f32 v74, v214
mvaa 164,152,232
ra 188,3,23552
v_add_f32 v82, v82, v74
v_add_f32 v85, v85, v77
mvaa 164,148,228
s_waitcnt lgkmcnt(4)
v_exp_f32 v75, v215
mvaa 164,144,224
v_add_f32 v82, v82, v75
cv 251,74,75
maav 96,160,236
s_waitcnt vmcnt(12)
s_barrier
v_exp_f32 v72, v200
maav 64,160,232
ra 128,2,16384
maav 32,160,228
v_exp_f32 v73, v201
maav 100,164,236
v_add_f32 v81, v72, v73
cv 244,72,73
maav 68,164,232
ra 132,2,18432
v_exp_f32 v74, v202
maav 36,164,228
v_add_f32 v81, v81, v74
maav 104,168,236
maav 72,168,232
ra 136,2,20480
maav 40,168,228
v_exp_f32 v75, v203
maav 108,172,236
v_add_f32 v81, v81, v75
cv 245,74,75
maav 76,172,232
s_waitcnt lgkmcnt(3)
ra 140,2,22528
v_exp_f32 v72, v204
maav 44,172,228
v_add_f32 v81, v81, v72
maav 112,176,236
v_exp_f32 v73, v205
maav 80,176,232
ra 144,2,17408
v_add_f32 v81, v81, v73
cv 246,72,73
maav 48,176,228
v_exp_f32 v74, v206
maav 116,180,236
buffer_load_dword a192, v19, s[36:39], 0 offen
v_add_f32 v81, v81, v74
maav 84,180,232
ra 148,2,19456
v_exp_f32 v75, v207
maav 52,180,228
v_add_f32 v81, v81, v75
cv 247,74,75
maav 120,184,236
maav 88,184,232
buffer_load_dword a193, v20, s[40:43], 0 offen
ra 152,2,21504
maav 56,184,228
v_exp_f32 v72, v184
maav 124,188,236
v_max3_f32 v88, v83, v82, v81
v_cmp_lt_f32 vcc, s90, v88
maav 92,188,232
s_waitcnt lgkmcnt(3)
ra 156,2,23552
v_exp_f32 v73, v185
maav 60,188,228
s_cbranch_vccnz L_TY_0_fb
L_TY_0_ret:
v_add_f32 v79, v72, v73
cv 236,72,73
cvav 216,128,144,44
s_and_b32 s59, s76, 0xc000
s_add_u32 m0, s59, s78
v_exp_f32 v74, v186
mvav 216,132,148
dma 1,44,76,0
ra 160,3,24576
v_add_f32 v79, v79, v74
v_exp_f32 v75, v187
v_add_f32 v87, v87, v83
mvav 216,136,152
v_add_f32 v79, v79, v75
cv 237,74,75
mvav 216,140,156
v_exp_f32 v72, v188
cvav 208,140,140,40
v_add_f32 v79, v79, v72
mvav 208,136,136
ra 164,3,25600
v_xor_b32 v2, 0x8000, v2
v_exp_f32 v73, v189
mvav 208,132,132
v_add_f32 v79, v79, v73
cv 238,72,73
v_exp_f32 v74, v190
mvav 208,128,128
v_add_f32 v79, v79, v74
cvaa 200,128,240,36
v_exp_f32 v75, v191
mvaa 200,132,244
dma 1,44,76,1024
ra 168,3,26624
v_add_f32 v79, v79, v75
cv 239,74,75
mvaa 200,136,248
v_exp_f32 v72, v176
mvaa 200,140,252
cvaa 192,140,236,32
v_exp_f32 v73, v177
mvaa 192,136,232
ra 172,3,27648
v_add_f32 v78, v72, v73
cv 232,72,73
v_exp_f32 v74, v178
v_add_f32 v86, v86, v82
mvaa 192,132,228
s_waitcnt lgkmcnt(4)
v_add_f32 v78, v78, v74
mvaa 192,128,224
v_exp_f32 v75, v179
cvav 220,144,144,44
v_add_f32 v78, v78, v75
cv 233,74,75
mvav 220,148,148
dma 1,44,76,2048
ra 176,3,28672
v_exp_f32 v72, v180
mvav 220,152,152
v_add_f32 v78, v78, v72
mvav 220,156,156
v_exp_f32 v73, v181
cvav 212,156,140,40
v_add_f32 v78, v78, v73
cv 234,72,73
v_exp_f32 v74, v182
mvav 212,152,136
ra 180,3,29696
v_add_f32 v78, v78, v74
mvav 212,148,132
v_exp_f32 v75, v183
mvav 212,144,128
v_add_f32 v78, v78, v75
cv 235,74,75
cvaa 204,144,240,36
v_exp_f32 v72, v168
mvaa 204,148,244
dma 1,44,76,3072
ra 184,3,30720
mvaa 204,152,248
s_add_u32 s76, s76, 16384
v_exp_f32 v73, v169
mvaa 204,156,252
v_add_f32 v77, v72, v73
cv 228,72,73
v_exp_f32 v74, v170
cvaa 196,156,236,32
s_and_b32 s59, s77, 0xc000
s_add_u32 m0, s59, s79
v_add_f32 v77, v77, v74
mvaa 196,152,232
ra 188,3,31744
v_exp_f32 v75, v171
v_add_f32 v85, v85, v81
mvaa 196,148,228
s_waitcnt lgkmcnt(4)
v_add_f32 v77, v77, v75
cv 229,74,75
mvaa 196,144,224
v_exp_f32 v72, v172
maav 96,160,252
s_waitcnt vmcnt(12)
s_barrier
v_add_f32 v77, v77, v72
v_exp_f32 v73, v173
maav 64,160,248
dma 1,48,77,0
ra 128,2,0
v_add_f32 v77, v77, v73
cv 230,72,73
maav 32,160,244
v_exp_f32 v74, v174
maav 100,164,252
v_add_f32 v77, v77, v74
maav 68,164,248
ra 132,2,2048
v_xor_b32 v3, 0x8000, v3
v_exp_f32 v75, v175
maav 36,164,244
v_add_f32 v77, v77, v75
cv 231,74,75
maav 104,168,252
v_exp_f32 v72, v160
maav 72,168,248
dma 1,48,77,1024
ra 136,2,4096
v_exp_f32 v73, v161
v_max3_f32 v88, v79, v78, v77
maav 40,168,244
v_add_f32 v76, v72, v73
cv 224,72,73
maav 108,172,252
v_exp_f32 v74, v162
maav 76,172,248
s_waitcnt lgkmcnt(3)
ra 140,2,6144
v_add_f32 v76, v76, v74
maav 44,172,244
v_exp_f32 v75, v163
maav 112,176,252
v_add_u32 v3, s89, v3
v_add_f32 v76, v76, v75
cv 225,74,75
maav 80,176,248
dma 1,48,77,2048
ra 144,2,1024
v_exp_f32 v72, v164
maav 48,176,244
v_add_f32 v76, v76, v72
v_exp_f32 v73, v165
maav 116,180,252
v_add_f32 v76, v76, v73
cv 226,72,73
maav 84,180,248
ra 148,2,3072
v_exp_f32 v74, v166
maav 52,180,244
v_add_f32 v76, v76, v74
maav 120,184,252
v_exp_f32 v75, v167
maav 88,184,248
dma 1,48,77,3072
ra 152,2,5120
v_add_f32 v76, v76, v75
cv 227,74,75
maav 56,184,244
s_add_u32 s77, s77, 16384
v_exp_f32 v72, v216
maav 124,188,252
v_max_f32 v88, v88, v76
v_cmp_lt_f32 vcc, s90, v88
maav 92,188,248
s_waitcnt lgkmcnt(3)
ra 156,2,7168
v_exp_f32 v73, v217
maav 60,188,244
s_cbranch_vccnz L_TY_1_fb
L_TY_1_ret:
v_add_f32 v83, v72, v73
cv 252,72,73
s_nop 7
v_mov_b32 v89, v84
v_mov_b32 v90, v85
s_nop 1
v_permlane16_swap_b32 v84, v89
v_permlane16_swap_b32 v85, v90
s_nop 0
v_add_f32 v84, v84, v89
v_add_f32 v85, v85, v90
v_mov_b32 v89, v84
v_mov_b32 v90, v85
s_nop 1
v_permlane32_swap_b32 v84, v89
v_permlane32_swap_b32 v85, v90
s_nop 0
v_add_f32 v84, v84, v89
v_add_f32 v85, v85, v90
v_rcp_f32 v84, v84
v_rcp_f32 v85, v85
v_mov_b32 v94, v84
v_mov_b32 v95, v84
ar 90,0
ar 91,1
v_pk_mul_f32 v[90:91], v[90:91], v[94:95]
cv 96,90,91
ar 92,2
ar 93,3
v_pk_mul_f32 v[92:93], v[92:93], v[94:95]
cv 97,92,93
ar 90,4
ar 91,5
v_pk_mul_f32 v[90:91], v[90:91], v[94:95]
cv 98,90,91
ar 92,6
ar 93,7
v_pk_mul_f32 v[92:93], v[92:93], v[94:95]
cv 99,92,93
ar 90,8
ar 91,9
v_pk_mul_f32 v[90:91], v[90:91], v[94:95]
cv 100,90,91
ar 92,10
ar 93,11
v_pk_mul_f32 v[92:93], v[92:93], v[94:95]
cv 101,92,93
ar 90,12
ar 91,13
v_pk_mul_f32 v[90:91], v[90:91], v[94:95]
cv 102,90,91
ar 92,14
ar 93,15
v_pk_mul_f32 v[92:93], v[92:93], v[94:95]
cv 103,92,93
ar 90,16
ar 91,17
v_pk_mul_f32 v[90:91], v[90:91], v[94:95]
cv 104,90,91
ar 92,18
ar 93,19
v_pk_mul_f32 v[92:93], v[92:93], v[94:95]
cv 105,92,93
ar 90,20
ar 91,21
v_pk_mul_f32 v[90:91], v[90:91], v[94:95]
cv 106,90,91
ar 92,22
ar 93,23
v_pk_mul_f32 v[92:93], v[92:93], v[94:95]
cv 107,92,93
ar 90,24
ar 91,25
v_pk_mul_f32 v[90:91], v[90:91], v[94:95]
cv 108,90,91
ar 92,26
ar 93,27
v_pk_mul_f32 v[92:93], v[92:93], v[94:95]
cv 109,92,93
ar 90,28
ar 91,29
v_pk_mul_f32 v[90:91], v[90:91], v[94:95]
cv 110,90,91
ar 92,30
ar 93,31
v_pk_mul_f32 v[92:93], v[92:93], v[94:95]
cv 111,92,93
v_mov_b32 v94, v85
v_mov_b32 v95, v85
ar 90,32
ar 91,33
v_pk_mul_f32 v[90:91], v[90:91], v[94:95]
cv 112,90,91
ar 92,34
ar 93,35
v_pk_mul_f32 v[92:93], v[92:93], v[94:95]
cv 113,92,93
ar 90,36
ar 91,37
v_pk_mul_f32 v[90:91], v[90:91], v[94:95]
cv 114,90,91
ar 92,38
ar 93,39
v_pk_mul_f32 v[92:93], v[92:93], v[94:95]
cv 115,92,93
ar 90,40
ar 91,41
v_pk_mul_f32 v[90:91], v[90:91], v[94:95]
cv 116,90,91
ar 92,42
ar 93,43
v_pk_mul_f32 v[92:93], v[92:93], v[94:95]
cv 117,92,93
ar 90,44
ar 91,45
v_pk_mul_f32 v[90:91], v[90:91], v[94:95]
cv 118,90,91
ar 92,46
ar 93,47
v_pk_mul_f32 v[92:93], v[92:93], v[94:95]
cv 119,92,93
ar 90,48
ar 91,49
v_pk_mul_f32 v[90:91], v[90:91], v[94:95]
cv 120,90,91
ar 92,50
ar 93,51
v_pk_mul_f32 v[92:93], v[92:93], v[94:95]
cv 121,92,93
ar 90,52
ar 91,53
v_pk_mul_f32 v[90:91], v[90:91], v[94:95]
cv 122,90,91
ar 92,54
ar 93,55
v_pk_mul_f32 v[92:93], v[92:93], v[94:95]
cv 123,92,93
ar 90,56
ar 91,57
v_pk_mul_f32 v[90:91], v[90:91], v[94:95]
cv 124,90,91
ar 92,58
ar 93,59
v_pk_mul_f32 v[92:93], v[92:93], v[94:95]
cv 125,92,93
ar 90,60
ar 91,61
v_pk_mul_f32 v[90:91], v[90:91], v[94:95]
cv 126,90,91
ar 92,62
ar 93,63
v_pk_mul_f32 v[92:93], v[92:93], v[94:95]
cv 127,92,93
cvav 184,128,144,44
s_and_b32 s59, s76, 0xc000
s_add_u32 m0, s59, s78
v_exp_f32 v74, v218
mvav 184,132,148
dma 1,44,76,0
ra 160,3,0
v_add_f32 v83, v83, v74
v_add_f32 v87, v87, v79
mvav 184,136,152
v_exp_f32 v75, v219
mvav 184,140,156
v_add_f32 v83, v83, v75
cv 253,74,75
cvav 176,140,140,40
v_exp_f32 v72, v220
mvav 176,136,136
ra 164,3,1024
v_add_f32 v83, v83, v72
mvav 176,132,132
v_exp_f32 v73, v221
mvav 176,128,128
v_add_f32 v83, v83, v73
cv 254,72,73
cvaa 168,128,240,36
v_exp_f32 v74, v222
mvaa 168,132,244
dma 1,44,76,1024
ra 168,3,2048
v_add_f32 v83, v83, v74
mvaa 168,136,248
s_add_u32 s63, s94, 0
v_exp_f32 v75, v223
mvaa 168,140,252
buffer_store_dwordx4 v[96:99], v0, s[52:55], s63 offen sc1
v_add_f32 v83, v83, v75
cv 255,74,75
cvaa 160,140,236,32
v_exp_f32 v72, v208
mvaa 160,136,232
ra 172,3,3072
v_add_f32 v86, v86, v78
mvaa 160,132,228
s_waitcnt lgkmcnt(4)
v_exp_f32 v73, v209
mvaa 160,128,224
v_add_f32 v82, v72, v73
cv 248,72,73
cvav 188,144,144,44
v_exp_f32 v74, v210
mvav 188,148,148
dma 1,44,76,2048
ra 176,3,4096
v_add_f32 v82, v82, v74
mvav 188,152,152
v_exp_f32 v75, v211
mvav 188,156,156
v_add_f32 v82, v82, v75
cv 249,74,75
cvav 180,156,140,40
v_exp_f32 v72, v212
mvav 180,152,136
ra 180,3,5120
v_add_f32 v82, v82, v72
mvav 180,148,132
v_exp_f32 v73, v213
mvav 180,144,128
v_add_f32 v82, v82, v73
cv 250,72,73
cvaa 172,144,240,36
v_exp_f32 v74, v214
mvaa 172,148,244
dma 1,44,76,3072
ra 184,3,6144
v_add_f32 v82, v82, v74
mvaa 172,152,248
s_add_u32 s76, s76, 16384
v_exp_f32 v75, v215
mvaa 172,156,252
v_add_f32 v82, v82, v75
cv 251,74,75
cvaa 164,156,236,32
s_and_b32 s59, s77, 0xc000
s_add_u32 m0, s59, s79
v_exp_f32 v72, v200
mvaa 164,152,232
ra 188,3,7168
v_mov_b32 v85, v77
mvaa 164,148,228
s_waitcnt lgkmcnt(4)
v_exp_f32 v73, v201
mvaa 164,144,224
v_add_f32 v81, v72, v73
cv 244,72,73
maav 96,160,236
s_waitcnt vmcnt(12)
s_barrier
v_exp_f32 v74, v202
maav 64,160,232
dma 1,48,77,0
ra 128,2,16384
v_add_f32 v81, v81, v74
zaav 32,160,228
v_exp_f32 v75, v203
zaav 0,160,224
v_add_f32 v81, v81, v75
cv 245,74,75
maav 100,164,236
s_add_u32 s63, s94, 8192
v_exp_f32 v72, v204
maav 68,164,232
buffer_store_dwordx4 v[100:103], v0, s[52:55], s63 offen sc1
ra 132,2,18432
v_add_f32 v81, v81, v72
zaav 36,164,228
v_exp_f32 v73, v205
zaav 4,164,224
v_add_f32 v81, v81, v73
cv 246,72,73
maav 104,168,236
v_exp_f32 v74, v206
maav 72,168,232
dma 1,48,77,1024
ra 136,2,20480
v_add_f32 v81, v81, v74
zaav 40,168,228
v_exp_f32 v75, v207
zaav 8,168,224
v_add_f32 v81, v81, v75
cv 247,74,75
maav 108,172,236
v_exp_f32 v72, v192
maav 76,172,232
ra 140,2,22528
v_max3_f32 v88, v83, v82, v81
v_mov_b32 v84, v76
zaav 44,172,228
s_waitcnt lgkmcnt(4)
v_exp_f32 v73, v193
zaav 12,172,224
v_add_f32 v80, v72, v73
cv 240,72,73
maav 112,176,236
v_exp_f32 v74, v194
maav 80,176,232
dma 1,48,77,2048
ra 144,2,17408
v_add_f32 v80, v80, v74
zaav 48,176,228
v_exp_f32 v75, v195
zaav 16,176,224
v_add_f32 v80, v80, v75
cv 241,74,75
maav 116,180,236
v_exp_f32 v72, v196
maav 84,180,232
ra 148,2,19456
v_add_f32 v80, v80, v72
zaav 52,180,228
v_exp_f32 v73, v197
zaav 20,180,224
v_add_f32 v80, v80, v73
cv 242,72,73
maav 120,184,236
v_exp_f32 v74, v198
maav 88,184,232
dma 1,48,77,3072
ra 152,2,21504
v_add_f32 v80, v80, v74
zaav 56,184,228
s_add_u32 s77, s77, 16384
v_exp_f32 v75, v199
zaav 24,184,224
v_add_f32 v80, v80, v75
cv 243,74,75
maav 124,188,236
v_exp_f32 v72, v184
maav 92,188,232
ra 156,2,23552
v_max_f32 v88, v88, v80
v_cmp_lt_f32 vcc, s90, v88
zaav 60,188,228
s_waitcnt lgkmcnt(4)
v_exp_f32 v73, v185
zaav 28,188,224
s_cbranch_vccnz L_TY_2_fb
L_TY_2_ret:
v_add_f32 v79, v72, v73
cv 236,72,73
cvav 216,128,144,44
s_and_b32 s59, s76, 0xc000
s_add_u32 m0, s59, s78
v_exp_f32 v74, v186
mvav 216,132,148
dma 1,44,76,0
ra 160,3,16384
v_add_f32 v79, v79, v74
v_add_f32 v87, v87, v83
mvav 216,136,152
v_exp_f32 v75, v187
mvav 216,140,156
v_add_f32 v79, v79, v75
cv 237,74,75
cvav 208,140,140,40
v_exp_f32 v72, v188
mvav 208,136,136
ra 164,3,17408
v_xor_b32 v2, 0x8000, v2
v_add_f32 v79, v79, v72
mvav 208,132,132
v_exp_f32 v73, v189
mvav 208,128,128
v_add_f32 v79, v79, v73
cv 238,72,73
cvaa 200,128,240,36
v_exp_f32 v74, v190
mvaa 200,132,244
dma 1,44,76,1024
ra 168,3,18432
v_add_f32 v79, v79, v74
mvaa 200,136,248
s_add_u32 s63, s94, 16384
v_exp_f32 v75, v191
mvaa 200,140,252
buffer_store_dwordx4 v[104:107], v0, s[52:55], s63 offen sc1
v_add_f32 v79, v79, v75
cv 239,74,75
cvaa 192,140,236,32
v_exp_f32 v72, v176
mvaa 192,136,232
ra 172,3,19456
v_add_f32 v86, v86, v82
mvaa 192,132,228
s_waitcnt lgkmcnt(4)
v_exp_f32 v73, v177
mvaa 192,128,224
v_add_f32 v78, v72, v73
cv 232,72,73
cvav 220,144,144,44
v_exp_f32 v74, v178
mvav 220,148,148
dma 1,44,76,2048
ra 176,3,20480
v_add_f32 v78, v78, v74
mvav 220,152,152
v_exp_f32 v75, v179
mvav 220,156,156
v_add_f32 v78, v78, v75
cv 233,74,75
cvav 212,156,140,40
v_exp_f32 v72, v180
mvav 212,152,136
ra 180,3,21504
v_add_f32 v78, v78, v72
mvav 212,148,132
v_exp_f32 v73, v181
mvav 212,144,128
v_add_f32 v78, v78, v73
cv 234,72,73
cvaa 204,144,240,36
v_exp_f32 v74, v182
mvaa 204,148,244
dma 1,44,76,3072
ra 184,3,22528
v_add_f32 v78, v78, v74
mvaa 204,152,248
s_add_u32 s76, s76, 16384
v_exp_f32 v75, v183
mvaa 204,156,252
v_add_f32 v78, v78, v75
cv 235,74,75
cvaa 196,156,236,32
s_and_b32 s59, s77, 0xc000
s_add_u32 m0, s59, s79
v_exp_f32 v72, v168
mvaa 196,152,232
ra 188,3,23552
v_add_f32 v85, v85, v81
mvaa 196,148,228
s_waitcnt lgkmcnt(4)
v_exp_f32 v73, v169
mvaa 196,144,224
v_add_f32 v77, v72, v73
cv 228,72,73
maav 96,160,252
s_waitcnt vmcnt(12)
s_barrier
v_exp_f32 v74, v170
maav 64,160,248
dma 1,48,77,0
ra 128,2,0
v_add_f32 v77, v77, v74
maav 32,160,244
v_exp_f32 v75, v171
maav 0,160,240
v_add_f32 v77, v77, v75
cv 229,74,75
maav 100,164,252
s_add_u32 s63, s94, 24576
v_exp_f32 v72, v172
maav 68,164,248
buffer_store_dwordx4 v[108:111], v0, s[52:55], s63 offen sc1
ra 132,2,2048
v_xor_b32 v3, 0x8000, v3
v_add_f32 v77, v77, v72
maav 36,164,244
v_exp_f32 v73, v173
maav 4,164,240
v_add_f32 v77, v77, v73
cv 230,72,73
maav 104,168,252
v_exp_f32 v74, v174
maav 72,168,248
dma 1,48,77,1024
ra 136,2,4096
v_add_f32 v77, v77, v74
maav 40,168,244
v_exp_f32 v75, v175
maav 8,168,240
v_add_f32 v77, v77, v75
cv 231,74,75
maav 108,172,252
v_exp_f32 v72, v160
maav 76,172,248
ra 140,2,6144
v_max3_f32 v88, v79, v78, v77
v_add_f32 v84, v84, v80
maav 44,172,244
s_waitcnt lgkmcnt(4)
v_exp_f32 v73, v161
maav 12,172,240
v_add_f32 v76, v72, v73
cv 224,72,73
maav 112,176,252
v_exp_f32 v74, v162
maav 80,176,248
dma 1,48,77,2048
ra 144,2,1024
v_add_f32 v76, v76, v74
maav 48,176,244
v_exp_f32 v75, v163
maav 16,176,240
v_add_f32 v76, v76, v75
cv 225,74,75
maav 116,180,252
v_exp_f32 v72, v164
maav 84,180,248
ra 148,2,3072
v_add_f32 v76, v76, v72
maav 52,180,244
v_exp_f32 v73, v165
maav 20,180,240
v_add_f32 v76, v76, v73
cv 226,72,73
maav 120,184,252
v_exp_f32 v74, v166
maav 88,184,248
dma 1,48,77,3072
ra 152,2,5120
v_add_f32 v76, v76, v74
maav 56,184,244
s_add_u32 s77, s77, 16384
v_exp_f32 v75, v167
maav 24,184,240
v_add_f32 v76, v76, v75
cv 227,74,75
maav 124,188,252
v_exp_f32 v72, v216
maav 92,188,248
buffer_store_dword v23, v21, s[52:55], s73 offen sc1
ra 156,2,7168
v_max_f32 v88, v88, v76
v_cmp_lt_f32 vcc, s90, v88
maav 60,188,244
s_waitcnt lgkmcnt(4)
v_exp_f32 v73, v217
maav 28,188,240
s_cbranch_vccnz L_TY_3_fb
L_TY_3_ret:
v_add_f32 v83, v72, v73
cv 252,72,73
s_sub_u32 s91, 6, s5
s_cmp_eq_u32 s91, 0
s_cbranch_scc1 L_YD
L_YY:
cvav 184,128,144,44
s_and_b32 s59, s76, 0xc000
s_add_u32 m0, s59, s78
v_exp_f32 v74, v218
mvav 184,132,148
dma 1,44,76,0
ra 160,3,0
v_add_f32 v83, v83, v74
v_add_f32 v87, v87, v79
mvav 184,136,152
v_exp_f32 v75, v219
mvav 184,140,156
v_add_f32 v83, v83, v75
cv 253,74,75
cvav 176,140,140,40
v_exp_f32 v72, v220
mvav 176,136,136
ra 164,3,1024
v_add_f32 v83, v83, v72
mvav 176,132,132
v_exp_f32 v73, v221
mvav 176,128,128
v_add_f32 v83, v83, v73
cv 254,72,73
cvaa 168,128,240,36
v_exp_f32 v74, v222
mvaa 168,132,244
dma 1,44,76,1024
ra 168,3,2048
v_add_f32 v83, v83, v74
mvaa 168,136,248
v_exp_f32 v75, v223
mvaa 168,140,252
v_add_f32 v83, v83, v75
cv 255,74,75
cvaa 160,140,236,32
v_exp_f32 v72, v208
mvaa 160,136,232
ra 172,3,3072
v_add_f32 v86, v86, v78
mvaa 160,132,228
s_waitcnt lgkmcnt(4)
v_exp_f32 v73, v209
mvaa 160,128,224
v_add_f32 v82, v72, v73
cv 248,72,73
cvav 188,144,144,44
v_exp_f32 v74, v210
mvav 188,148,148
dma 1,44,76,2048
ra 176,3,4096
v_add_f32 v82, v82, v74
mvav 188,152,152
v_exp_f32 v75, v211
mvav 188,156,156
v_add_f32 v82, v82, v75
cv 249,74,75
cvav 180,156,140,40
v_exp_f32 v72, v212
mvav 180,152,136
ra 180,3,5120
v_add_f32 v82, v82, v72
mvav 180,148,132
v_exp_f32 v73, v213
mvav 180,144,128
v_add_f32 v82, v82, v73
cv 250,72,73
cvaa 172,144,240,36
v_exp_f32 v74, v214
mvaa 172,148,244
dma 1,44,76,3072
ra 184,3,6144
v_add_f32 v82, v82, v74
mvaa 172,152,248
s_add_u32 s76, s76, 16384
v_exp_f32 v75, v215
mvaa 172,156,252
v_add_f32 v82, v82, v75
cv 251,74,75
cvaa 164,156,236,32
s_and_b32 s59, s77, 0xc000
s_add_u32 m0, s59, s79
v_exp_f32 v72, v200
mvaa 164,152,232
ra 188,3,7168
v_add_f32 v85, v85, v77
mvaa 164,148,228
s_waitcnt lgkmcnt(4)
v_exp_f32 v73, v201
mvaa 164,144,224
v_add_f32 v81, v72, v73
cv 244,72,73
maav 96,160,236
s_waitcnt vmcnt(12)
s_barrier
v_exp_f32 v74, v202
maav 64,160,232
dma 1,48,77,0
ra 128,2,16384
v_add_f32 v81, v81, v74
maav 32,160,228
v_exp_f32 v75, v203
maav 0,160,224
v_add_f32 v81, v81, v75
cv 245,74,75
maav 100,164,236
v_exp_f32 v72, v204
maav 68,164,232
ra 132,2,18432
v_add_f32 v81, v81, v72
maav 36,164,228
v_exp_f32 v73, v205
maav 4,164,224
v_add_f32 v81, v81, v73
cv 246,72,73
maav 104,168,236
v_exp_f32 v74, v206
maav 72,168,232
dma 1,48,77,1024
ra 136,2,20480
v_add_f32 v81, v81, v74
maav 40,168,228
v_exp_f32 v75, v207
maav 8,168,224
v_add_f32 v81, v81, v75
cv 247,74,75
maav 108,172,236
v_exp_f32 v72, v192
maav 76,172,232
ra 140,2,22528
v_max3_f32 v88, v83, v82, v81
v_add_f32 v84, v84, v76
maav 44,172,228
s_waitcnt lgkmcnt(4)
v_exp_f32 v73, v193
maav 12,172,224
v_add_f32 v80, v72, v73
cv 240,72,73
maav 112,176,236
v_exp_f32 v74, v194
maav 80,176,232
dma 1,48,77,2048
ra 144,2,17408
v_add_f32 v80, v80, v74
maav 48,176,228
v_exp_f32 v75, v195
maav 16,176,224
v_add_f32 v80, v80, v75
cv 241,74,75
maav 116,180,236
v_exp_f32 v72, v196
maav 84,180,232
ra 148,2,19456
v_add_f32 v80, v80, v72
maav 52,180,228
v_exp_f32 v73, v197
maav 20,180,224
v_add_f32 v80, v80, v73
cv 242,72,73
maav 120,184,236
v_exp_f32 v74, v198
maav 88,184,232
dma 1,48,77,3072
ra 152,2,21504
v_add_f32 v80, v80, v74
maav 56,184,228
s_add_u32 s77, s77, 16384
v_exp_f32 v75, v199
maav 24,184,224
v_add_f32 v80, v80, v75
cv 243,74,75
maav 124,188,236
v_exp_f32 v72, v184
maav 92,188,232
ra 156,2,23552
v_max_f32 v88, v88, v80
v_cmp_lt_f32 vcc, s90, v88
maav 60,188,228
s_waitcnt lgkmcnt(4)
v_exp_f32 v73, v185
maav 28,188,224
s_cbranch_vccnz L_YY_0_fb
L_YY_0_ret:
v_add_f32 v79, v72, v73
cv 236,72,73
cvav 216,128,144,44
s_and_b32 s59, s76, 0xc000
s_add_u32 m0, s59, s78
v_exp_f32 v74, v186
mvav 216,132,148
dma 1,44,76,0
ra 160,3,16384
v_add_f32 v79, v79, v74
v_add_f32 v87, v87, v83
mvav 216,136,152
v_exp_f32 v75, v187
mvav 216,140,156
v_add_f32 v79, v79, v75
cv 237,74,75
cvav 208,140,140,40
v_exp_f32 v72, v188
mvav 208,136,136
ra 164,3,17408
v_xor_b32 v2, 0x8000, v2
v_add_f32 v79, v79, v72
mvav 208,132,132
v_exp_f32 v73, v189
mvav 208,128,128
v_add_f32 v79, v79, v73
cv 238,72,73
cvaa 200,128,240,36
v_exp_f32 v74, v190
mvaa 200,132,244
dma 1,44,76,1024
ra 168,3,18432
v_add_f32 v79, v79, v74
mvaa 200,136,248
v_exp_f32 v75, v191
mvaa 200,140,252
v_add_f32 v79, v79, v75
cv 239,74,75
cvaa 192,140,236,32
v_exp_f32 v72, v176
mvaa 192,136,232
ra 172,3,19456
v_add_f32 v86, v86, v82
mvaa 192,132,228
s_waitcnt lgkmcnt(4)
v_exp_f32 v73, v177
mvaa 192,128,224
v_add_f32 v78, v72, v73
cv 232,72,73
cvav 220,144,144,44
v_exp_f32 v74, v178
mvav 220,148,148
dma 1,44,76,2048
ra 176,3,20480
v_add_f32 v78, v78, v74
mvav 220,152,152
v_exp_f32 v75, v179
mvav 220,156,156
v_add_f32 v78, v78, v75
cv 233,74,75
cvav 212,156,140,40
v_exp_f32 v72, v180
mvav 212,152,136
ra 180,3,21504
v_add_f32 v78, v78, v72
mvav 212,148,132
v_exp_f32 v73, v181
mvav 212,144,128
v_add_f32 v78, v78, v73
cv 234,72,73
cvaa 204,144,240,36
v_exp_f32 v74, v182
mvaa 204,148,244
dma 1,44,76,3072
ra 184,3,22528
v_add_f32 v78, v78, v74
mvaa 204,152,248
s_add_u32 s76, s76, 16384
v_exp_f32 v75, v183
mvaa 204,156,252
v_add_f32 v78, v78, v75
cv 235,74,75
cvaa 196,156,236,32
s_and_b32 s59, s77, 0xc000
s_add_u32 m0, s59, s79
v_exp_f32 v72, v168
mvaa 196,152,232
ra 188,3,23552
v_add_f32 v85, v85, v81
mvaa 196,148,228
s_waitcnt lgkmcnt(4)
v_exp_f32 v73, v169
mvaa 196,144,224
v_add_f32 v77, v72, v73
cv 228,72,73
maav 96,160,252
s_waitcnt vmcnt(12)
s_barrier
v_exp_f32 v74, v170
maav 64,160,248
dma 1,48,77,0
ra 128,2,0
v_add_f32 v77, v77, v74
maav 32,160,244
v_exp_f32 v75, v171
maav 0,160,240
v_add_f32 v77, v77, v75
cv 229,74,75
maav 100,164,252
v_exp_f32 v72, v172
maav 68,164,248
ra 132,2,2048
v_xor_b32 v3, 0x8000, v3
v_add_f32 v77, v77, v72
maav 36,164,244
v_exp_f32 v73, v173
maav 4,164,240
v_add_f32 v77, v77, v73
cv 230,72,73
maav 104,168,252
v_exp_f32 v74, v174
maav 72,168,248
dma 1,48,77,1024
ra 136,2,4096
v_add_f32 v77, v77, v74
maav 40,168,244
v_exp_f32 v75, v175
maav 8,168,240
v_add_f32 v77, v77, v75
cv 231,74,75
maav 108,172,252
v_exp_f32 v72, v160
maav 76,172,248
ra 140,2,6144
v_max3_f32 v88, v79, v78, v77
v_add_f32 v84, v84, v80
maav 44,172,244
s_waitcnt lgkmcnt(4)
v_exp_f32 v73, v161
maav 12,172,240
v_add_f32 v76, v72, v73
cv 224,72,73
maav 112,176,252
v_exp_f32 v74, v162
maav 80,176,248
dma 1,48,77,2048
ra 144,2,1024
v_add_f32 v76, v76, v74
maav 48,176,244
v_exp_f32 v75, v163
maav 16,176,240
v_add_f32 v76, v76, v75
cv 225,74,75
maav 116,180,252
v_exp_f32 v72, v164
maav 84,180,248
ra 148,2,3072
v_add_f32 v76, v76, v72
maav 52,180,244
v_exp_f32 v73, v165
maav 20,180,240
v_add_f32 v76, v76, v73
cv 226,72,73
maav 120,184,252
v_exp_f32 v74, v166
maav 88,184,248
dma 1,48,77,3072
ra 152,2,5120
v_add_f32 v76, v76, v74
maav 56,184,244
s_add_u32 s77, s77, 16384
v_exp_f32 v75, v167
maav 24,184,240
v_add_f32 v76, v76, v75
cv 227,74,75
maav 124,188,252
v_exp_f32 v72, v216
maav 92,188,248
ra 156,2,7168
v_max_f32 v88, v88, v76
v_cmp_lt_f32 vcc, s90, v88
maav 60,188,244
s_waitcnt lgkmcnt(4)
v_exp_f32 v73, v217
maav 28,188,240
s_cbranch_vccnz L_YY_1_fb
L_YY_1_ret:
v_add_f32 v83, v72, v73
cv 252,72,73
cvav 184,128,144,44
s_and_b32 s59, s76, 0xc000
s_add_u32 m0, s59, s78
v_exp_f32 v74, v218
mvav 184,132,148
dma 1,44,76,0
ra 160,3,0
v_add_f32 v83, v83, v74
v_add_f32 v87, v87, v79
mvav 184,136,152
v_exp_f32 v75, v219
mvav 184,140,156
v_add_f32 v83, v83, v75
cv 253,74,75
cvav 176,140,140,40
v_exp_f32 v72, v220
mvav 176,136,136
ra 164,3,1024
v_add_f32 v83, v83, v72
mvav 176,132,132
v_exp_f32 v73, v221
mvav 176,128,128
v_add_f32 v83, v83, v73
cv 254,72,73
cvaa 168,128,240,36
v_exp_f32 v74, v222
mvaa 168,132,244
dma 1,44,76,1024
ra 168,3,2048
v_add_f32 v83, v83, v74
mvaa 168,136,248
v_exp_f32 v75, v223
mvaa 168,140,252
v_add_f32 v83, v83, v75
cv 255,74,75
cvaa 160,140,236,32
v_exp_f32 v72, v208
mvaa 160,136,232
ra 172,3,3072
v_add_f32 v86, v86, v78
mvaa 160,132,228
s_waitcnt lgkmcnt(4)
v_exp_f32 v73, v209
mvaa 160,128,224
v_add_f32 v82, v72, v73
cv 248,72,73
cvav 188,144,144,44
v_exp_f32 v74, v210
mvav 188,148,148
dma 1,44,76,2048
ra 176,3,4096
v_add_f32 v82, v82, v74
mvav 188,152,152
v_exp_f32 v75, v211
mvav 188,156,156
v_add_f32 v82, v82, v75
cv 249,74,75
cvav 180,156,140,40
v_exp_f32 v72, v212
mvav 180,152,136
ra 180,3,5120
v_add_f32 v82, v82, v72
mvav 180,148,132
v_exp_f32 v73, v213
mvav 180,144,128
v_add_f32 v82, v82, v73
cv 250,72,73
cvaa 172,144,240,36
v_exp_f32 v74, v214
mvaa 172,148,244
dma 1,44,76,3072
ra 184,3,6144
v_add_f32 v82, v82, v74
mvaa 172,152,248
s_add_u32 s76, s76, 16384
v_exp_f32 v75, v215
mvaa 172,156,252
v_add_f32 v82, v82, v75
cv 251,74,75
cvaa 164,156,236,32
s_and_b32 s59, s77, 0xc000
s_add_u32 m0, s59, s79
v_exp_f32 v72, v200
mvaa 164,152,232
ra 188,3,7168
v_add_f32 v85, v85, v77
mvaa 164,148,228
s_waitcnt lgkmcnt(4)
v_exp_f32 v73, v201
mvaa 164,144,224
v_add_f32 v81, v72, v73
cv 244,72,73
maav 96,160,236
s_waitcnt vmcnt(12)
s_barrier
v_exp_f32 v74, v202
maav 64,160,232
dma 1,48,77,0
ra 128,2,16384
v_add_f32 v81, v81, v74
maav 32,160,228
v_exp_f32 v75, v203
maav 0,160,224
v_add_f32 v81, v81, v75
cv 245,74,75
maav 100,164,236
v_exp_f32 v72, v204
maav 68,164,232
ra 132,2,18432
v_add_f32 v81, v81, v72
maav 36,164,228
v_exp_f32 v73, v205
maav 4,164,224
v_add_f32 v81, v81, v73
cv 246,72,73
maav 104,168,236
v_exp_f32 v74, v206
maav 72,168,232
dma 1,48,77,1024
ra 136,2,20480
v_add_f32 v81, v81, v74
maav 40,168,228
v_exp_f32 v75, v207
maav 8,168,224
v_add_f32 v81, v81, v75
cv 247,74,75
maav 108,172,236
v_exp_f32 v72, v192
maav 76,172,232
ra 140,2,22528
v_max3_f32 v88, v83, v82, v81
v_add_f32 v84, v84, v76
maav 44,172,228
s_waitcnt lgkmcnt(4)
v_exp_f32 v73, v193
maav 12,172,224
v_add_f32 v80, v72, v73
cv 240,72,73
maav 112,176,236
v_exp_f32 v74, v194
maav 80,176,232
dma 1,48,77,2048
ra 144,2,17408
v_add_f32 v80, v80, v74
maav 48,176,228
v_exp_f32 v75, v195
maav 16,176,224
v_add_f32 v80, v80, v75
cv 241,74,75
maav 116,180,236
v_exp_f32 v72, v196
maav 84,180,232
ra 148,2,19456
v_add_f32 v80, v80, v72
maav 52,180,228
v_exp_f32 v73, v197
maav 20,180,224
v_add_f32 v80, v80, v73
cv 242,72,73
maav 120,184,236
v_exp_f32 v74, v198
maav 88,184,232
dma 1,48,77,3072
ra 152,2,21504
v_add_f32 v80, v80, v74
maav 56,184,228
s_add_u32 s77, s77, 16384
v_exp_f32 v75, v199
maav 24,184,224
v_add_f32 v80, v80, v75
cv 243,74,75
maav 124,188,236
v_exp_f32 v72, v184
maav 92,188,232
ra 156,2,23552
v_max_f32 v88, v88, v80
v_cmp_lt_f32 vcc, s90, v88
maav 60,188,228
s_waitcnt lgkmcnt(4)
v_exp_f32 v73, v185
maav 28,188,224
s_cbranch_vccnz L_YY_2_fb
L_YY_2_ret:
v_add_f32 v79, v72, v73
cv 236,72,73
cvav 216,128,144,44
s_and_b32 s59, s76, 0xc000
s_add_u32 m0, s59, s78
v_exp_f32 v74, v186
mvav 216,132,148
dma 1,44,76,0
ra 160,3,16384
v_add_f32 v79, v79, v74
v_add_f32 v87, v87, v83
mvav 216,136,152
v_exp_f32 v75, v187
mvav 216,140,156
v_add_f32 v79, v79, v75
cv 237,74,75
cvav 208,140,140,40
v_exp_f32 v72, v188
mvav 208,136,136
ra 164,3,17408
v_xor_b32 v2, 0x8000, v2
v_add_f32 v79, v79, v72
mvav 208,132,132
v_exp_f32 v73, v189
mvav 208,128,128
v_add_f32 v79, v79, v73
cv 238,72,73
cvaa 200,128,240,36
v_exp_f32 v74, v190
mvaa 200,132,244
dma 1,44,76,1024
ra 168,3,18432
v_add_f32 v79, v79, v74
mvaa 200,136,248
v_exp_f32 v75, v191
mvaa 200,140,252
v_add_f32 v79, v79, v75
cv 239,74,75
cvaa 192,140,236,32
v_exp_f32 v72, v176
mvaa 192,136,232
ra 172,3,19456
v_add_f32 v86, v86, v82
mvaa 192,132,228
s_waitcnt lgkmcnt(4)
v_exp_f32 v73, v177
mvaa 192,128,224
v_add_f32 v78, v72, v73
cv 232,72,73
cvav 220,144,144,44
v_exp_f32 v74, v178
mvav 220,148,148
dma 1,44,76,2048
ra 176,3,20480
v_add_f32 v78, v78, v74
mvav 220,152,152
v_exp_f32 v75, v179
mvav 220,156,156
v_add_f32 v78, v78, v75
cv 233,74,75
cvav 212,156,140,40
v_exp_f32 v72, v180
mvav 212,152,136
ra 180,3,21504
v_add_f32 v78, v78, v72
mvav 212,148,132
v_exp_f32 v73, v181
mvav 212,144,128
v_add_f32 v78, v78, v73
cv 234,72,73
cvaa 204,144,240,36
v_exp_f32 v74, v182
mvaa 204,148,244
dma 1,44,76,3072
ra 184,3,22528
v_add_f32 v78, v78, v74
mvaa 204,152,248
s_add_u32 s76, s76, 16384
v_exp_f32 v75, v183
mvaa 204,156,252
v_add_f32 v78, v78, v75
cv 235,74,75
cvaa 196,156,236,32
s_and_b32 s59, s77, 0xc000
s_add_u32 m0, s59, s79
v_exp_f32 v72, v168
mvaa 196,152,232
ra 188,3,23552
v_add_f32 v85, v85, v81
mvaa 196,148,228
s_waitcnt lgkmcnt(4)
v_exp_f32 v73, v169
mvaa 196,144,224
v_add_f32 v77, v72, v73
cv 228,72,73
maav 96,160,252
s_waitcnt vmcnt(12)
s_barrier
v_exp_f32 v74, v170
maav 64,160,248
dma 1,48,77,0
ra 128,2,0
v_add_f32 v77, v77, v74
maav 32,160,244
v_exp_f32 v75, v171
maav 0,160,240
v_add_f32 v77, v77, v75
cv 229,74,75
maav 100,164,252
v_exp_f32 v72, v172
maav 68,164,248
ra 132,2,2048
v_xor_b32 v3, 0x8000, v3
v_add_f32 v77, v77, v72
maav 36,164,244
v_exp_f32 v73, v173
maav 4,164,240
v_add_f32 v77, v77, v73
cv 230,72,73
maav 104,168,252
v_exp_f32 v74, v174
maav 72,168,248
dma 1,48,77,1024
ra 136,2,4096
v_add_f32 v77, v77, v74
maav 40,168,244
v_exp_f32 v75, v175
maav 8,168,240
v_add_f32 v77, v77, v75
cv 231,74,75
maav 108,172,252
v_exp_f32 v72, v160
maav 76,172,248
ra 140,2,6144
v_max3_f32 v88, v79, v78, v77
v_add_f32 v84, v84, v80
maav 44,172,244
s_waitcnt lgkmcnt(4)
v_exp_f32 v73, v161
maav 12,172,240
v_add_f32 v76, v72, v73
cv 224,72,73
maav 112,176,252
v_exp_f32 v74, v162
maav 80,176,248
dma 1,48,77,2048
ra 144,2,1024
v_add_f32 v76, v76, v74
maav 48,176,244
v_exp_f32 v75, v163
maav 16,176,240
v_add_f32 v76, v76, v75
cv 225,74,75
maav 116,180,252
v_exp_f32 v72, v164
maav 84,180,248
ra 148,2,3072
v_add_f32 v76, v76, v72
maav 52,180,244
v_exp_f32 v73, v165
maav 20,180,240
v_add_f32 v76, v76, v73
cv 226,72,73
maav 120,184,252
v_exp_f32 v74, v166
maav 88,184,248
dma 1,48,77,3072
ra 152,2,5120
v_add_f32 v76, v76, v74
maav 56,184,244
s_add_u32 s77, s77, 16384
v_exp_f32 v75, v167
maav 24,184,240
v_add_f32 v76, v76, v75
cv 227,74,75
maav 124,188,252
v_exp_f32 v72, v216
maav 92,188,248
ra 156,2,7168
v_max_f32 v88, v88, v76
v_cmp_lt_f32 vcc, s90, v88
maav 60,188,244
s_waitcnt lgkmcnt(4)
v_exp_f32 v73, v217
maav 28,188,240
s_cbranch_vccnz L_YY_3_fb
L_YY_3_ret:
v_add_f32 v83, v72, v73
cv 252,72,73
s_sub_u32 s91, s91, 1
s_cmp_lg_u32 s91, 0
s_cbranch_scc1 L_YY
L_YD:
v_add_f32 v67, s21, v40
v_fma_f32 v64, v48, s20, v67
v_fma_f32 v65, v49, s20, v67
v_fma_f32 v66, v50, s20, v67
v_fma_f32 v67, v51, s20, v67
v_add_f32 v71, s23, v40
v_fma_f32 v68, v48, s22, v71
v_fma_f32 v69, v49, s22, v71
v_fma_f32 v70, v50, s22, v71
v_fma_f32 v71, v51, s22, v71
v_add_f32 v55, s25, v32
v_fma_f32 v52, v48, s24, v55
v_fma_f32 v53, v49, s24, v55
v_fma_f32 v54, v50, s24, v55
v_fma_f32 v55, v51, s24, v55
v_add_f32 v59, s33, v32
v_fma_f32 v56, v48, s32, v59
v_fma_f32 v57, v49, s32, v59
v_fma_f32 v58, v50, s32, v59
v_fma_f32 v59, v51, s32, v59
s_nop 1
cvav 184,128,144,44
v_exp_f32 v74, v218
mvav 184,132,148
ra 160,3,0
v_add_f32 v83, v83, v74
v_add_f32 v87, v87, v79
mvav 184,136,152
v_exp_f32 v75, v219
mvav 184,140,156
v_add_f32 v83, v83, v75
cv 253,74,75
cvav 176,140,140,64
v_exp_f32 v72, v220
mvav 176,136,136
ra 164,3,1024
v_add_f32 v83, v83, v72
mvav 176,132,132
s_add_u32 s63, s94, 4096
v_exp_f32 v73, v221
mvav 176,128,128
buffer_store_dwordx4 v[112:115], v0, s[52:55], s63 offen sc1
v_add_f32 v83, v83, v73
cv 254,72,73
cvaa 168,128,240,36
v_exp_f32 v74, v222
mvaa 168,132,244
ra 168,3,2048
v_add_f32 v83, v83, v74
mvaa 168,136,248
v_exp_f32 v75, v223
mvaa 168,140,252
v_add_f32 v83, v83, v75
cv 255,74,75
cvaa 160,140,236,52
v_exp_f32 v72, v208
mvaa 160,136,232
ra 172,3,3072
v_add_f32 v86, v86, v78
mvaa 160,132,228
s_waitcnt lgkmcnt(4)
v_exp_f32 v73, v209
mvaa 160,128,224
v_add_f32 v82, v72, v73
cv 248,72,73
cvav 188,144,144,44
v_exp_f32 v74, v210
mvav 188,148,148
ra 176,3,4096
v_add_f32 v82, v82, v74
mvav 188,152,152
v_exp_f32 v75, v211
mvav 188,156,156
v_add_f32 v82, v82, v75
cv 249,74,75
cvav 180,156,140,68
v_exp_f32 v72, v212
mvav 180,152,136
ra 180,3,5120
v_add_f32 v82, v82, v72
mvav 180,148,132
v_exp_f32 v73, v213
mvav 180,144,128
v_add_f32 v82, v82, v73
cv 250,72,73
cvaa 172,144,240,36
v_exp_f32 v74, v214
mvaa 172,148,244
ra 184,3,6144
v_add_f32 v82, v82, v74
mvaa 172,152,248
v_exp_f32 v75, v215
mvaa 172,156,252
v_add_f32 v82, v82, v75
cv 251,74,75
cvaa 164,156,236,56
s_and_b32 s59, s77, 0xc000
s_add_u32 m0, s59, s79
v_exp_f32 v72, v200
mvaa 164,152,232
ra 188,3,7168
v_add_f32 v85, v85, v77
mvaa 164,148,228
s_waitcnt lgkmcnt(4)
s_add_u32 s63, s94, 12288
v_exp_f32 v73, v201
mvaa 164,144,224
buffer_store_dwordx4 v[116:119], v0, s[52:55], s63 offen sc1
v_add_f32 v81, v72, v73
cv 244,72,73
maav 96,160,236
s_waitcnt vmcnt(10)
s_barrier
v_exp_f32 v74, v202
maav 64,160,232
dma 1,48,77,0
ra 128,2,16384
v_add_f32 v81, v81, v74
maav 32,160,228
v_exp_f32 v75, v203
maav 0,160,224
v_add_f32 v81, v81, v75
cv 245,74,75
maav 100,164,236
v_exp_f32 v72, v204
maav 68,164,232
ra 132,2,18432
v_add_f32 v81, v81, v72
maav 36,164,228
v_exp_f32 v73, v205
maav 4,164,224
v_add_f32 v81, v81, v73
cv 246,72,73
maav 104,168,236
v_exp_f32 v74, v206
maav 72,168,232
dma 1,48,77,1024
ra 136,2,20480
v_add_f32 v81, v81, v74
maav 40,168,228
v_exp_f32 v75, v207
maav 8,168,224
v_add_f32 v81, v81, v75
cv 247,74,75
maav 108,172,236
v_exp_f32 v72, v192
maav 76,172,232
ra 140,2,22528
v_max3_f32 v88, v83, v82, v81
v_add_f32 v84, v84, v76
maav 44,172,228
s_waitcnt lgkmcnt(4)
v_exp_f32 v73, v193
maav 12,172,224
v_add_f32 v80, v72, v73
cv 240,72,73
maav 112,176,236
v_exp_f32 v74, v194
maav 80,176,232
dma 1,48,77,2048
ra 144,2,17408
v_add_f32 v80, v80, v74
maav 48,176,228
v_exp_f32 v75, v195
maav 16,176,224
v_add_f32 v80, v80, v75
cv 241,74,75
maav 116,180,236
v_exp_f32 v72, v196
maav 84,180,232
ra 148,2,19456
v_add_f32 v80, v80, v72
maav 52,180,228
v_exp_f32 v73, v197
maav 20,180,224
v_add_f32 v80, v80, v73
cv 242,72,73
maav 120,184,236
v_exp_f32 v74, v198
maav 88,184,232
dma 1,48,77,3072
ra 152,2,21504
v_add_f32 v80, v80, v74
maav 56,184,228
s_add_u32 s77, s77, 16384
v_exp_f32 v75, v199
maav 24,184,224
v_add_f32 v80, v80, v75
cv 243,74,75
maav 124,188,236
v_exp_f32 v72, v184
maav 92,188,232
ra 156,2,23552
v_max_f32 v88, v88, v80
v_cmp_lt_f32 vcc, s90, v88
maav 60,188,228
s_waitcnt lgkmcnt(4)
v_exp_f32 v73, v185
maav 28,188,224
s_cbranch_vccnz L_YD_0_fb
L_YD_0_ret:
v_add_f32 v79, v72, v73
cv 236,72,73
s_add_u32 s36, s34, s4
s_addc_u32 s37, s35, 0
s_and_b32 s37, s37, 0xffff
s_mov_b32 s38, 442368
s_mov_b32 s39, 0x20000
s_add_u32 s40, s34, s6
s_addc_u32 s41, s35, 0
s_and_b32 s41, s41, 0xffff
s_mov_b32 s42, 1048576
s_mov_b32 s43, 0x20000
s_mov_b32 s44, s26
s_and_b32 s45, s27, 0xffff
s_mov_b32 s46, 2211840
s_mov_b32 s47, 0x20000
s_mov_b32 s48, s18
s_and_b32 s49, s19, 0xffff
s_mov_b32 s50, 5242880
s_mov_b32 s51, 0x20000
v_add_u32 v12, 73728, v26
v_add_u32 v13, 73728, v27
s_lshr_b32 s58, s89, 1
s_add_u32 s56, s65, 1
s_and_b32 s56, s56, 3
s_lshl_b32 s57, s56, 10
s_add_u32 s57, s57, s58
v_add_u32 v4, s57, v0
v_add_u32 v8, 73728, v4
s_add_u32 s56, s65, 2
s_and_b32 s56, s56, 3
s_lshl_b32 s57, s56, 10
s_add_u32 s57, s57, s58
v_add_u32 v5, s57, v0
v_add_u32 v9, 73728, v5
s_add_u32 s56, s65, 3
s_and_b32 s56, s56, 3
s_lshl_b32 s57, s56, 10
s_add_u32 s57, s57, s58
v_add_u32 v6, s57, v0
v_add_u32 v10, 73728, v6
s_add_u32 s56, s65, 4
s_and_b32 s56, s56, 3
s_lshl_b32 s57, s56, 10
s_add_u32 s57, s57, s58
v_add_u32 v7, s57, v0
v_add_u32 v11, 73728, v7
v_add_f32 v67, s21, v44
v_fma_f32 v64, v48, s20, v67
v_fma_f32 v65, v49, s20, v67
v_fma_f32 v66, v50, s20, v67
v_fma_f32 v67, v51, s20, v67
v_add_f32 v71, s23, v44
v_fma_f32 v68, v48, s22, v71
v_fma_f32 v69, v49, s22, v71
v_fma_f32 v70, v50, s22, v71
v_fma_f32 v71, v51, s22, v71
v_add_f32 v55, s25, v36
v_fma_f32 v52, v48, s24, v55
v_fma_f32 v53, v49, s24, v55
v_fma_f32 v54, v50, s24, v55
v_fma_f32 v55, v51, s24, v55
v_add_f32 v59, s33, v36
v_fma_f32 v56, v48, s32, v59
v_fma_f32 v57, v49, s32, v59
v_fma_f32 v58, v50, s32, v59
v_fma_f32 v59, v51, s32, v59
s_nop 1
cvav 216,128,144,64
v_exp_f32 v74, v186
mvav 216,132,148
ra 160,3,16384
v_add_f32 v79, v79, v74
v_exp_f32 v75, v187
v_add_f32 v87, v87, v83
mvav 216,136,152
v_add_f32 v79, v79, v75
cv 237,74,75
v_exp_f32 v72, v188
mvav 216,140,156
buffer_load_dword v20, v30, s[52:55], s80 offen sc1
ra 164,3,17408
v_add_f32 v79, v79, v72
cvaa 200,140,252,52
v_exp_f32 v73, v189
mvaa 200,136,248
ra 168,3,18432
v_add_f32 v79, v79, v73
cv 238,72,73
v_exp_f32 v74, v190
mvaa 200,132,244
s_waitcnt lgkmcnt(3)
s_add_u32 s63, s94, 20480
v_add_f32 v79, v79, v74
mvaa 200,128,240
buffer_store_dwordx4 v[120:123], v0, s[52:55], s63 offen sc1
ra 172,3,19456
v_exp_f32 v75, v191
cvav 220,144,144,68
v_add_f32 v79, v79, v75
cv 239,74,75
v_exp_f32 v72, v176
mvav 220,148,148
ra 176,3,20480
mvav 220,152,152
v_exp_f32 v73, v177
mvav 220,156,156
ra 180,3,21504
v_add_f32 v78, v72, v73
cv 232,72,73
v_exp_f32 v74, v178
cvaa 204,156,252,56
v_add_f32 v78, v78, v74
mvaa 204,152,248
ra 184,3,22528
v_exp_f32 v75, v179
v_add_f32 v86, v86, v82
mvaa 204,148,244
s_waitcnt lgkmcnt(3)
v_add_f32 v78, v78, v75
cv 233,74,75
v_exp_f32 v72, v180
mvaa 204,144,240
ra 188,3,23552
v_add_f32 v78, v78, v72
maav 96,160,252
s_waitcnt vmcnt(8)
s_barrier
v_xor_b32 v3, 0x8000, v3
v_exp_f32 v73, v181
maav 64,160,248
ra 128,3,0
v_add_f32 v78, v78, v73
cv 234,72,73
v_exp_f32 v74, v182
maav 32,160,244
v_add_f32 v78, v78, v74
maav 0,160,240
v_exp_f32 v75, v183
maav 100,164,252
v_add_f32 v78, v78, v75
cv 235,74,75
v_exp_f32 v72, v168
maav 68,164,248
ra 132,3,1024
maav 36,164,244
s_add_u32 s63, s94, 28672
v_exp_f32 v73, v169
maav 4,164,240
buffer_store_dwordx4 v[124:127], v0, s[52:55], s63 offen sc1
v_add_f32 v77, v72, v73
cv 228,72,73
v_exp_f32 v74, v170
maav 104,168,252
v_add_f32 v77, v77, v74
v_exp_f32 v75, v171
maav 72,168,248
ra 136,3,2048
v_add_f32 v77, v77, v75
cv 229,74,75
maav 40,168,244
v_exp_f32 v72, v172
maav 8,168,240
v_add_f32 v77, v77, v72
v_exp_f32 v73, v173
maav 108,172,252
v_add_f32 v77, v77, v73
cv 230,72,73
maav 76,172,248
ra 140,3,3072
v_exp_f32 v74, v174
v_add_f32 v85, v85, v81
maav 44,172,244
s_waitcnt lgkmcnt(4)
v_add_f32 v77, v77, v74
v_exp_f32 v75, v175
maav 12,172,240
v_add_f32 v77, v77, v75
cv 231,74,75
maav 112,176,252
v_exp_f32 v72, v160
maav 80,176,248
ra 144,3,4096
v_exp_f32 v73, v161
v_max3_f32 v88, v79, v78, v77
maav 48,176,244
v_add_f32 v76, v72, v73
cv 224,72,73
maav 16,176,240
v_exp_f32 v74, v162
maav 116,180,252
v_add_f32 v76, v76, v74
v_exp_f32 v75, v163
maav 84,180,248
ra 148,3,5120
v_add_f32 v76, v76, v75
cv 225,74,75
maav 52,180,244
v_exp_f32 v72, v164
maav 20,180,240
v_add_f32 v76, v76, v72
v_exp_f32 v73, v165
maav 120,184,252
v_add_f32 v76, v76, v73
cv 226,72,73
maav 88,184,248
ra 152,3,6144
v_exp_f32 v74, v166
maav 56,184,244
v_add_f32 v76, v76, v74
v_exp_f32 v75, v167
maav 24,184,240
v_add_f32 v76, v76, v75
cv 227,74,75
v_add_f32 v84, v84, v80
maav 124,188,252
v_exp_f32 v72, v216
maav 92,188,248
ra 156,3,7168
v_max_f32 v88, v88, v76
v_cmp_lt_f32 vcc, s90, v88
maav 60,188,244
s_waitcnt lgkmcnt(4)
v_exp_f32 v73, v217
maav 28,188,240
s_cbranch_vccnz L_YD_1_fb
L_YD_1_ret:
v_add_f32 v83, v72, v73
cv 252,72,73
maav 96,128,236
s_waitcnt vmcnt(2)
v_cmp_ne_u32 vcc, s71, v20
s_cbranch_vccz L_hYD_ok
s_mov_b32 s62, 1000000
L_hYD:
buffer_load_dword v20, v30, s[52:55], s80 offen sc1
s_waitcnt vmcnt(0)
v_cmp_ne_u32 vcc, s71, v20
s_cbranch_vccz L_hYD_ok
s_sub_u32 s62, s62, 1
s_cmp_eq_u32 s62, 0
s_cbranch_scc1 L_hYD_ok
s_sleep 4
s_branch L_hYD
L_hYD_ok:
s_waitcnt vmcnt(3) lgkmcnt(0)
s_barrier
v_exp_f32 v74, v218
maav 64,128,232
ra 160,3,16384
v_add_f32 v83, v83, v74
v_add_f32 v87, v87, v79
maav 32,128,228
s_add_u32 s57, s68, 0
s_add_u32 m0, s82, 0
v_exp_f32 v75, v219
maav 0,128,224
dma 14,44,57,0
v_add_f32 v83, v83, v75
cv 253,74,75
maav 100,132,236
v_exp_f32 v72, v220
maav 68,132,232
dma 15,44,57,1024
ra 164,3,17408
v_add_f32 v83, v83, v72
maav 36,132,228
v_exp_f32 v73, v221
maav 4,132,224
dma 16,44,57,2048
v_add_f32 v83, v83, v73
cv 254,72,73
maav 104,136,236
v_exp_f32 v74, v222
maav 72,136,232
dma 17,44,57,3072
ra 168,3,18432
v_add_f32 v83, v83, v74
maav 40,136,228
s_add_u32 m0, s82, 4096
v_exp_f32 v75, v223
maav 8,136,224
dma 18,44,57,0
v_add_f32 v83, v83, v75
cv 255,74,75
maav 108,140,236
s_add_u32 s56, s66, 0
s_add_u32 m0, s78, 0
v_exp_f32 v72, v200
maav 76,140,232
dma 0,36,56,0
ra 172,3,19456
v_add_f32 v86, v86, v78
maav 44,140,228
v_exp_f32 v73, v201
maav 12,140,224
dma 0,36,56,1024
v_add_f32 v81, v72, v73
cv 244,72,73
maav 112,144,236
v_exp_f32 v74, v202
maav 80,144,232
dma 0,36,56,2048
ra 176,3,20480
v_add_f32 v81, v81, v74
maav 48,144,228
v_exp_f32 v75, v203
maav 16,144,224
dma 0,36,56,3072
v_add_f32 v81, v81, v75
cv 245,74,75
maav 116,148,236
v_exp_f32 v72, v204
maav 84,148,232
ra 180,3,21504
v_add_f32 v81, v81, v72
maav 52,148,228
v_exp_f32 v73, v205
maav 20,148,224
v_add_f32 v81, v81, v73
cv 246,72,73
maav 120,152,236
v_exp_f32 v74, v206
maav 88,152,232
ra 184,3,22528
v_add_f32 v81, v81, v74
maav 56,152,228
v_exp_f32 v75, v207
maav 24,152,224
v_add_f32 v81, v81, v75
cv 247,74,75
v_add_f32 v85, v85, v77
v_add_f32 v84, v84, v76
maav 124,156,236
maav 92,156,232
ra 188,3,23552
v_max_f32 v88, v83, v81
v_cmp_lt_f32 vcc, s90, v88
maav 60,156,228
s_waitcnt lgkmcnt(4)
maav 28,156,224
s_cbranch_vccnz L_YD_2_fb
L_YD_2_ret:
maav 96,160,252
maav 32,160,244
ds_write_b128 v60, a[0:3] offset:0
v_add_f32 v87, v87, v83
maav 100,164,252
maav 36,164,244
ds_write_b128 v60, a[4:7] offset:1024
maav 104,168,252
maav 40,168,244
ds_write_b128 v60, a[8:11] offset:2048
maav 108,172,252
s_waitcnt lgkmcnt(3)
maav 44,172,244
ds_write_b128 v60, a[12:15] offset:3072
maav 112,176,252
maav 48,176,244
ds_write_b128 v60, a[16:19] offset:4096
maav 116,180,252
maav 52,180,244
ds_write_b128 v60, a[20:23] offset:5120
v_add_f32 v85, v85, v81
maav 120,184,252
maav 56,184,244
ds_write_b128 v60, a[24:27] offset:6144
maav 124,188,252
maav 60,188,244
ds_write_b128 v60, a[28:31] offset:7168
s_waitcnt vmcnt(0)
L_fin:
L_p5:
v_mov_b32 v72, v84
v_mov_b32 v73, v85
v_mov_b32 v74, v32
v_mov_b32 v75, v36
s_nop 3
ds_write_b128 v62, v[72:75]
ds_write_b128 v60, a[32:35] offset:8192
ds_write_b128 v60, a[36:39] offset:9216
ds_write_b128 v60, a[40:43] offset:10240
ds_write_b128 v60, a[44:47] offset:11264
ds_write_b128 v60, a[48:51] offset:12288
ds_write_b128 v60, a[52:55] offset:13312
s_waitcnt lgkmcnt(11)
ds_write_b128 v60, a[56:59] offset:14336
ds_write_b128 v60, a[60:63] offset:15360
s_waitcnt lgkmcnt(0)
s_barrier
ds_read_b128 v[72:75], v63
rv 160,61,0
rv 164,61,1024
rv 168,61,2048
rv 172,61,3072
rv 176,61,4096
rv 180,61,5120
rv 184,61,6144
rv 188,61,7168
rv 192,61,8192
rv 196,61,9216
rv 200,61,10240
rv 204,61,11264
rv 208,61,12288
rv 212,61,13312
s_add_u32 s57, s68, 81920
s_add_u32 m0, s82, 73728
s_nop 0
dma 14,44,57,0
dma 15,44,57,1024
dma 16,44,57,2048
dma 17,44,57,3072
s_add_u32 m0, s82, 77824
s_nop 0
dma 18,44,57,0
s_add_u32 s56, s66, 16384
s_add_u32 m0, s78, 73728
s_nop 0
dma 0,36,56,0
dma 0,36,56,1024
dma 0,36,56,2048
dma 0,36,56,3072
s_waitcnt lgkmcnt(14)
rv 216,61,14336
s_waitcnt lgkmcnt(11)
rv 220,61,15360
v_min_f32 v89, v74, v40
v_sub_f32 v64, v89, v40
v_sub_f32 v68, v89, v74
v_min_f32 v89, v75, v44
v_sub_f32 v66, v89, v44
v_sub_f32 v70, v89, v75
v_exp_f32 v64, v64
v_exp_f32 v68, v68
v_exp_f32 v66, v66
v_exp_f32 v70, v70
v_mul_f32 v86, v86, v64
v_mul_f32 v87, v87, v66
v_fmac_f32 v86, v72, v68
v_fmac_f32 v87, v73, v70
v_mov_b32 v89, v86
v_mov_b32 v90, v87
s_nop 1
v_permlane16_swap_b32 v86, v89
v_permlane16_swap_b32 v87, v90
s_nop 0
v_add_f32 v86, v86, v89
v_add_f32 v87, v87, v90
v_mov_b32 v89, v86
v_mov_b32 v90, v87
s_nop 1
v_permlane32_swap_b32 v86, v89
v_permlane32_swap_b32 v87, v90
s_nop 0
v_add_f32 v86, v86, v89
v_add_f32 v87, v87, v90
v_rcp_f32 v86, v86
v_rcp_f32 v87, v87
s_nop 0
v_mul_f32 v64, v64, v86
v_mov_b32 v65, v64
v_mul_f32 v68, v68, v86
v_mov_b32 v69, v68
v_mul_f32 v66, v66, v87
v_mov_b32 v67, v66
v_mul_f32 v70, v70, v87
v_mov_b32 v71, v70
ar 90,64
ar 91,65
v_pk_mul_f32 v[90:91], v[90:91], v[64:65]
v_pk_fma_f32 v[90:91], v[160:161], v[68:69], v[90:91]
cv 128,90,91
ar 92,66
ar 93,67
v_pk_mul_f32 v[92:93], v[92:93], v[64:65]
v_pk_fma_f32 v[92:93], v[162:163], v[68:69], v[92:93]
cv 129,92,93
ar 90,68
ar 91,69
v_pk_mul_f32 v[90:91], v[90:91], v[64:65]
v_pk_fma_f32 v[90:91], v[164:165], v[68:69], v[90:91]
cv 130,90,91
ar 92,70
ar 93,71
v_pk_mul_f32 v[92:93], v[92:93], v[64:65]
v_pk_fma_f32 v[92:93], v[166:167], v[68:69], v[92:93]
cv 131,92,93
s_add_u32 s63, s95, 0
buffer_store_dwordx4 v[128:131], v0, s[52:55], s63 offen sc1
ar 90,72
ar 91,73
v_pk_mul_f32 v[90:91], v[90:91], v[64:65]
v_pk_fma_f32 v[90:91], v[168:169], v[68:69], v[90:91]
cv 132,90,91
ar 92,74
ar 93,75
v_pk_mul_f32 v[92:93], v[92:93], v[64:65]
v_pk_fma_f32 v[92:93], v[170:171], v[68:69], v[92:93]
cv 133,92,93
ar 90,76
ar 91,77
v_pk_mul_f32 v[90:91], v[90:91], v[64:65]
v_pk_fma_f32 v[90:91], v[172:173], v[68:69], v[90:91]
cv 134,90,91
ar 92,78
ar 93,79
v_pk_mul_f32 v[92:93], v[92:93], v[64:65]
v_pk_fma_f32 v[92:93], v[174:175], v[68:69], v[92:93]
cv 135,92,93
s_add_u32 s63, s95, 8192
buffer_store_dwordx4 v[132:135], v0, s[52:55], s63 offen sc1
ar 90,80
ar 91,81
v_pk_mul_f32 v[90:91], v[90:91], v[64:65]
s_waitcnt lgkmcnt(11)
v_pk_fma_f32 v[90:91], v[176:177], v[68:69], v[90:91]
cv 136,90,91
ar 92,82
ar 93,83
v_pk_mul_f32 v[92:93], v[92:93], v[64:65]
v_pk_fma_f32 v[92:93], v[178:179], v[68:69], v[92:93]
cv 137,92,93
ar 90,84
ar 91,85
v_pk_mul_f32 v[90:91], v[90:91], v[64:65]
s_waitcnt lgkmcnt(10)
v_pk_fma_f32 v[90:91], v[180:181], v[68:69], v[90:91]
cv 138,90,91
ar 92,86
ar 93,87
v_pk_mul_f32 v[92:93], v[92:93], v[64:65]
v_pk_fma_f32 v[92:93], v[182:183], v[68:69], v[92:93]
cv 139,92,93
s_add_u32 s63, s95, 16384
buffer_store_dwordx4 v[136:139], v0, s[52:55], s63 offen sc1
ar 90,88
ar 91,89
v_pk_mul_f32 v[90:91], v[90:91], v[64:65]
s_waitcnt lgkmcnt(9)
v_pk_fma_f32 v[90:91], v[184:185], v[68:69], v[90:91]
cv 140,90,91
ar 92,90
ar 93,91
v_pk_mul_f32 v[92:93], v[92:93], v[64:65]
v_pk_fma_f32 v[92:93], v[186:187], v[68:69], v[92:93]
cv 141,92,93
ar 90,92
ar 91,93
v_pk_mul_f32 v[90:91], v[90:91], v[64:65]
s_waitcnt lgkmcnt(8)
v_pk_fma_f32 v[90:91], v[188:189], v[68:69], v[90:91]
cv 142,90,91
ar 92,94
ar 93,95
v_pk_mul_f32 v[92:93], v[92:93], v[64:65]
v_pk_fma_f32 v[92:93], v[190:191], v[68:69], v[92:93]
cv 143,92,93
s_add_u32 s63, s95, 24576
buffer_store_dwordx4 v[140:143], v0, s[52:55], s63 offen sc1
ar 90,96
ar 91,97
v_pk_mul_f32 v[90:91], v[90:91], v[66:67]
s_waitcnt lgkmcnt(7)
v_pk_fma_f32 v[90:91], v[192:193], v[70:71], v[90:91]
cv 144,90,91
ta 0,26,0
ta 2,26,5120
ar 92,98
ar 93,99
v_pk_mul_f32 v[92:93], v[92:93], v[66:67]
v_pk_fma_f32 v[92:93], v[194:195], v[70:71], v[92:93]
cv 145,92,93
ta 36,26,10240
ta 38,26,15360
ar 90,100
ar 91,101
v_pk_mul_f32 v[90:91], v[90:91], v[66:67]
s_waitcnt lgkmcnt(10)
v_pk_fma_f32 v[90:91], v[196:197], v[70:71], v[90:91]
cv 146,90,91
ra 20,4,0
ra 56,4,8192
ar 92,102
ar 93,103
v_pk_mul_f32 v[92:93], v[92:93], v[66:67]
v_pk_fma_f32 v[92:93], v[198:199], v[70:71], v[92:93]
cv 147,92,93
s_add_u32 s63, s95, 4096
buffer_store_dwordx4 v[144:147], v0, s[52:55], s63 offen sc1
ra 24,5,0
ra 60,5,8192
ar 90,104
ar 91,105
v_pk_mul_f32 v[90:91], v[90:91], v[66:67]
s_waitcnt lgkmcnt(13)
v_pk_fma_f32 v[90:91], v[200:201], v[70:71], v[90:91]
cv 148,90,91
ra 28,6,0
ra 64,6,8192
ar 92,106
ar 93,107
v_pk_mul_f32 v[92:93], v[92:93], v[66:67]
v_pk_fma_f32 v[92:93], v[202:203], v[70:71], v[92:93]
cv 149,92,93
s_waitcnt lgkmcnt(11)
ra 32,7,0
ra 68,7,8192
ar 90,108
ar 91,109
v_pk_mul_f32 v[90:91], v[90:91], v[66:67]
v_pk_fma_f32 v[90:91], v[204:205], v[70:71], v[90:91]
cv 150,90,91
ta 4,27,32
ta 6,27,5152
ar 92,110
ar 93,111
v_pk_mul_f32 v[92:93], v[92:93], v[66:67]
v_pk_fma_f32 v[92:93], v[206:207], v[70:71], v[92:93]
cv 151,92,93
s_add_u32 s63, s95, 12288
buffer_store_dwordx4 v[148:151], v0, s[52:55], s63 offen sc1
s_waitcnt lgkmcnt(11)
ta 40,27,10272
ta 42,27,15392
ar 90,112
ar 91,113
v_pk_mul_f32 v[90:91], v[90:91], v[66:67]
v_pk_fma_f32 v[90:91], v[208:209], v[70:71], v[90:91]
cv 152,90,91
ta 8,26,64
ta 10,26,5184
ar 92,114
ar 93,115
v_pk_mul_f32 v[92:93], v[92:93], v[66:67]
v_pk_fma_f32 v[92:93], v[210:211], v[70:71], v[92:93]
cv 153,92,93
s_waitcnt lgkmcnt(11)
ta 44,26,10304
ta 46,26,15424
ar 90,116
ar 91,117
v_pk_mul_f32 v[90:91], v[90:91], v[66:67]
v_pk_fma_f32 v[90:91], v[212:213], v[70:71], v[90:91]
cv 154,90,91
ta 12,27,96
ta 14,27,5216
ar 92,118
ar 93,119
v_pk_mul_f32 v[92:93], v[92:93], v[66:67]
v_pk_fma_f32 v[92:93], v[214:215], v[70:71], v[92:93]
cv 155,92,93
s_add_u32 s63, s95, 20480
buffer_store_dwordx4 v[152:155], v0, s[52:55], s63 offen sc1
s_waitcnt lgkmcnt(11)
ta 48,27,10336
ta 50,27,15456
ar 90,120
ar 91,121
v_pk_mul_f32 v[90:91], v[90:91], v[66:67]
v_pk_fma_f32 v[90:91], v[216:217], v[70:71], v[90:91]
cv 156,90,91
ta 16,26,128
ta 18,26,5248
ar 92,122
ar 93,123
v_pk_mul_f32 v[92:93], v[92:93], v[66:67]
v_pk_fma_f32 v[92:93], v[218:219], v[70:71], v[92:93]
cv 157,92,93
s_waitcnt lgkmcnt(11)
ta 52,26,10368
ta 54,26,15488
ar 90,124
ar 91,125
v_pk_mul_f32 v[90:91], v[90:91], v[66:67]
v_pk_fma_f32 v[90:91], v[220:221], v[70:71], v[90:91]
cv 158,90,91
ar 92,126
ar 93,127
v_pk_mul_f32 v[92:93], v[92:93], v[66:67]
v_pk_fma_f32 v[92:93], v[222:223], v[70:71], v[92:93]
cv 159,92,93
s_add_u32 s63, s95, 28672
buffer_store_dwordx4 v[156:159], v0, s[52:55], s63 offen sc1
s_mov_b32 s7, 1
s_cmp_eq_u32 s3, 0
s_cbranch_scc1 HOP_b_0
s_cmp_eq_u32 s3, 1
s_cbranch_scc1 HOP_b_1
s_cmp_eq_u32 s3, 2
s_cbranch_scc1 HOP_b_2
s_branch HOP_b_3
HOP_b_ret:
s_mov_b32 s7, 0
s_add_u32 s58, s73, 32768
s_waitcnt vmcnt(0) lgkmcnt(0)
s_barrier
L_p5loop:
buffer_store_dword v23, v21, s[52:55], s58 offen sc1
zvaa 32,0,20
mvaa 32,36,56
s_add_u32 s57, s68, 163840
s_add_u32 m0, s82, 36864
ta 72,12,0
zvaa 52,36,60
dma 14,44,57,0
ta 74,12,5120
mvaa 52,0,24
ta 108,12,10240
zvaa 72,0,28
dma 15,44,57,1024
ta 110,12,15360
mvaa 72,36,64
zvaa 92,36,68
dma 16,44,57,2048
ra 92,8,0
mvaa 92,0,32
ra 128,8,8192
zvaa 36,4,20
dma 17,44,57,3072
ra 96,9,0
mvaa 36,40,56
s_add_u32 m0, s82, 40960
ra 132,9,8192
zvaa 56,40,60
dma 18,44,57,0
mvaa 56,4,24
s_add_u32 s56, s66, 32768
s_add_u32 m0, s78, 36864
ra 100,10,0
zvaa 76,4,28
dma 0,36,56,0
ra 136,10,8192
mvaa 76,40,64
ra 104,11,0
zvaa 96,40,68
dma 0,36,56,1024
ra 140,11,8192
mvaa 96,4,32
zvaa 40,8,20
dma 0,36,56,2048
ta 76,13,32
mvaa 40,44,56
ta 78,13,5152
zvaa 60,44,60
dma 0,36,56,3072
ta 112,13,10272
mvaa 60,8,24
s_add_u32 s57, s68, 245760
s_add_u32 m0, s82, 110592
s_waitcnt lgkmcnt(11)
ta 114,13,15392
zvaa 80,8,28
dma 14,44,57,0
mvaa 80,44,64
ta 80,12,64
zvaa 100,44,68
dma 15,44,57,1024
ta 82,12,5184
mvaa 100,8,32
ta 116,12,10304
zvaa 44,12,20
dma 16,44,57,2048
s_waitcnt lgkmcnt(11)
ta 118,12,15424
mvaa 44,48,56
zvaa 64,48,60
dma 17,44,57,3072
ta 84,13,96
mvaa 64,12,24
s_add_u32 m0, s82, 114688
ta 86,13,5216
zvaa 84,12,28
dma 18,44,57,0
ta 120,13,10336
mvaa 84,48,64
s_add_u32 s56, s66, 49152
s_add_u32 m0, s78, 110592
s_waitcnt lgkmcnt(11)
ta 122,13,15456
zvaa 104,48,68
dma 0,36,56,0
mvaa 104,12,32
ta 88,12,128
zvaa 48,16,20
dma 0,36,56,1024
ta 90,12,5248
mvaa 48,52,56
ta 124,12,10368
zvaa 68,52,60
dma 0,36,56,2048
s_waitcnt lgkmcnt(11)
ta 126,12,15488
mvaa 68,16,24
zvaa 88,16,28
dma 0,36,56,3072
mvaa 88,52,64
zvaa 108,52,68
mvaa 108,16,32
mvaa 32,72,92
s_waitcnt vmcnt(9) lgkmcnt(0)
s_barrier
mvaa 32,108,128
s_add_u32 s57, s68, 327680
s_add_u32 m0, s82, 0
ta 0,26,36864
mvaa 52,108,132
dma 14,44,57,0
ta 2,26,41984
mvaa 52,72,96
ta 36,26,47104
mvaa 72,72,100
dma 15,44,57,1024
ta 38,26,52224
mvaa 72,108,136
mvaa 92,108,140
dma 16,44,57,2048
ra 20,4,36864
mvaa 92,72,104
ra 56,4,45056
mvaa 36,76,92
dma 17,44,57,3072
ra 24,5,36864
mvaa 36,112,128
s_add_u32 m0, s82, 4096
ra 60,5,45056
mvaa 56,112,132
dma 18,44,57,0
mvaa 56,76,96
s_add_u32 s56, s66, 65536
s_add_u32 m0, s78, 0
ra 28,6,36864
mvaa 76,76,100
dma 0,36,56,0
ra 64,6,45056
mvaa 76,112,136
ra 32,7,36864
mvaa 96,112,140
dma 0,36,56,1024
ra 68,7,45056
mvaa 96,76,104
mvaa 40,80,92
dma 0,36,56,2048
ta 4,27,36896
mvaa 40,116,128
ta 6,27,42016
mvaa 60,116,132
dma 0,36,56,3072
HOP_b_0:
HS_b_0:
s_cmp_eq_u32 s7, 1
s_cbranch_scc1 HS_b_4
ta 40,27,47136
mvaa 60,80,96
s_add_u32 s57, s68, 409600
s_add_u32 m0, s82, 73728
s_waitcnt lgkmcnt(11)
ta 42,27,52256
mvaa 80,80,100
dma 14,44,57,0
mvaa 80,116,136
ta 8,26,36928
mvaa 100,116,140
dma 15,44,57,1024
ta 10,26,42048
mvaa 100,80,104
ta 44,26,47168
mvaa 44,84,92
dma 16,44,57,2048
s_waitcnt lgkmcnt(11)
ta 46,26,52288
mvaa 44,120,128
mvaa 64,120,132
dma 17,44,57,3072
ta 12,27,36960
mvaa 64,84,96
s_add_u32 m0, s82, 77824
ta 14,27,42080
mvaa 84,84,100
dma 18,44,57,0
ta 48,27,47200
mvaa 84,120,136
s_add_u32 s56, s66, 81920
s_add_u32 m0, s78, 73728
s_waitcnt lgkmcnt(11)
ta 50,27,52320
mvaa 104,120,140
dma 0,36,56,0
mvaa 104,84,104
ta 16,26,36992
mvaa 48,88,92
dma 0,36,56,1024
ta 18,26,42112
mvaa 48,124,128
ta 52,26,47232
mvaa 68,124,132
dma 0,36,56,2048
s_waitcnt lgkmcnt(11)
ta 54,26,52352
mvaa 68,88,96
mvaa 88,88,100
dma 0,36,56,3072
mvaa 88,124,136
mvaa 108,124,140
mvaa 108,88,104
mvaa 32,0,20
s_waitcnt vmcnt(18) lgkmcnt(0)
s_barrier
mvaa 32,36,56
ta 72,12,36864
mvaa 52,36,60
s_add_u32 s57, s68, 491520
s_add_u32 m0, s82, 36864
ta 74,12,41984
mvaa 52,0,24
dma 14,44,57,0
ta 108,12,47104
mvaa 72,0,28
ta 110,12,52224
mvaa 72,36,64
mvaa 92,36,68
ra 92,8,36864
mvaa 92,0,32
dma 15,44,57,1024
ra 128,8,45056
mvaa 36,4,20
ra 96,9,36864
mvaa 36,40,56
ra 132,9,45056
mvaa 56,40,60
mvaa 56,4,24
dma 16,44,57,2048
ra 100,10,36864
mvaa 76,4,28
ra 136,10,45056
mvaa 76,40,64
ra 104,11,36864
mvaa 96,40,68
ra 140,11,45056
mvaa 96,4,32
dma 17,44,57,3072
mvaa 40,8,20
ta 76,13,36896
mvaa 40,44,56
ta 78,13,42016
mvaa 60,44,60
s_add_u32 m0, s82, 40960
ta 112,13,47136
mvaa 60,8,24
dma 18,44,57,0
s_waitcnt lgkmcnt(11)
ta 114,13,52256
mvaa 80,8,28
mvaa 80,44,64
ta 80,12,36928
mvaa 100,44,68
s_add_u32 s56, s66, 98304
s_add_u32 m0, s78, 36864
ta 82,12,42048
mvaa 100,8,32
dma 0,36,56,0
ta 116,12,47168
mvaa 44,12,20
s_waitcnt lgkmcnt(11)
ta 118,12,52288
mvaa 44,48,56
mvaa 64,48,60
ta 84,13,36960
mvaa 64,12,24
dma 0,36,56,1024
ta 86,13,42080
mvaa 84,12,28
ta 120,13,47200
mvaa 84,48,64
s_waitcnt lgkmcnt(11)
ta 122,13,52320
mvaa 104,48,68
mvaa 104,12,32
dma 0,36,56,2048
ta 88,12,36992
mvaa 48,16,20
ta 90,12,42112
mvaa 48,52,56
ta 124,12,47232
mvaa 68,52,60
s_waitcnt lgkmcnt(11)
ta 126,12,52352
mvaa 68,16,24
dma 0,36,56,3072
mvaa 88,16,28
mvaa 88,52,64
mvaa 108,52,68
mvaa 108,16,32
mvaa 32,72,92
s_waitcnt vmcnt(18) lgkmcnt(0)
s_barrier
mvaa 32,108,128
ta 0,26,0
mvaa 52,108,132
s_add_u32 s57, s69, 0
s_add_u32 m0, s82, 110592
ta 2,26,5120
mvaa 52,72,96
dma 14,48,57,0
ta 36,26,10240
mvaa 72,72,100
ta 38,26,15360
mvaa 72,108,136
mvaa 92,108,140
ra 20,4,0
mvaa 92,72,104
ra 56,4,8192
mvaa 36,76,92
ra 24,5,0
mvaa 36,112,128
ra 60,5,8192
mvaa 56,112,132
dma 15,48,57,1024
mvaa 56,76,96
ra 28,6,0
mvaa 76,76,100
ra 64,6,8192
mvaa 76,112,136
ra 32,7,0
mvaa 96,112,140
ra 68,7,8192
mvaa 96,76,104
mvaa 40,80,92
ta 4,27,32
mvaa 40,116,128
dma 16,48,57,2048
ta 6,27,5152
mvaa 60,116,132
ta 40,27,10272
mvaa 60,80,96
s_waitcnt lgkmcnt(11)
ta 42,27,15392
mvaa 80,80,100
mvaa 80,116,136
ta 8,26,64
mvaa 100,116,140
ta 10,26,5184
mvaa 100,80,104
ta 44,26,10304
mvaa 44,84,92
dma 17,48,57,3072
s_waitcnt lgkmcnt(11)
ta 46,26,15424
mvaa 44,120,128
mvaa 64,120,132
ta 12,27,96
mvaa 64,84,96
ta 14,27,5216
mvaa 84,84,100
ta 48,27,10336
mvaa 84,120,136
s_waitcnt lgkmcnt(11)
ta 50,27,15456
mvaa 104,120,140
s_add_u32 m0, s82, 114688
mvaa 104,84,104
dma 18,48,57,0
ta 16,26,128
mvaa 48,88,92
ta 18,26,5248
mvaa 48,124,128
ta 52,26,10368
mvaa 68,124,132
s_waitcnt lgkmcnt(11)
ta 54,26,15488
mvaa 68,88,96
mvaa 88,88,100
mvaa 88,124,136
mvaa 108,124,140
mvaa 108,88,104
mvaa 32,0,20
s_waitcnt vmcnt(14) lgkmcnt(0)
s_barrier
mvaa 32,36,56
ta 72,12,0
mvaa 52,36,60
s_add_u32 s57, s69, 81920
s_add_u32 m0, s82, 0
ta 74,12,5120
mvaa 52,0,24
dma 14,48,57,0
ta 108,12,10240
mvaa 72,0,28
ta 110,12,15360
mvaa 72,36,64
mvaa 92,36,68
ra 92,8,0
mvaa 92,0,32
ra 128,8,8192
mvaa 36,4,20
ra 96,9,0
mvaa 36,40,56
ra 132,9,8192
mvaa 56,40,60
dma 15,48,57,1024
mvaa 56,4,24
ra 100,10,0
mvaa 76,4,28
ra 136,10,8192
mvaa 76,40,64
ra 104,11,0
mvaa 96,40,68
ra 140,11,8192
mvaa 96,4,32
mvaa 40,8,20
ta 76,13,32
mvaa 40,44,56
dma 16,48,57,2048
ta 78,13,5152
mvaa 60,44,60
ta 112,13,10272
mvaa 60,8,24
s_waitcnt lgkmcnt(11)
ta 114,13,15392
mvaa 80,8,28
mvaa 80,44,64
ta 80,12,64
mvaa 100,44,68
ta 82,12,5184
mvaa 100,8,32
ta 116,12,10304
mvaa 44,12,20
dma 17,48,57,3072
s_waitcnt lgkmcnt(11)
ta 118,12,15424
mvaa 44,48,56
mvaa 64,48,60
ta 84,13,96
mvaa 64,12,24
ta 86,13,5216
mvaa 84,12,28
ta 120,13,10336
mvaa 84,48,64
s_waitcnt lgkmcnt(11)
ta 122,13,15456
mvaa 104,48,68
s_add_u32 m0, s82, 4096
mvaa 104,12,32
dma 18,48,57,0
ta 88,12,128
mvaa 48,16,20
ta 90,12,5248
mvaa 48,52,56
ta 124,12,10368
mvaa 68,52,60
s_waitcnt lgkmcnt(11)
ta 126,12,15488
mvaa 68,16,24
mvaa 88,16,28
mvaa 88,52,64
mvaa 108,52,68
mvaa 108,16,32
mvaa 32,72,92
s_waitcnt vmcnt(10) lgkmcnt(0)
s_barrier
mvaa 32,108,128
s_add_u32 s57, s69, 163840
s_add_u32 m0, s82, 73728
buffer_load_dword v20, v31, s[52:55], s81 offen sc1
ta 0,26,36864
mvaa 52,108,132
dma 14,48,57,0
ta 2,26,41984
mvaa 52,72,96
ta 36,26,47104
mvaa 72,72,100
dma 15,48,57,1024
ta 38,26,52224
mvaa 72,108,136
mvaa 92,108,140
dma 16,48,57,2048
ra 20,4,36864
mvaa 92,72,104
ra 56,4,45056
mvaa 36,76,92
dma 17,48,57,3072
ra 24,5,36864
mvaa 36,112,128
s_add_u32 m0, s82, 77824
ra 60,5,45056
mvaa 56,112,132
dma 18,48,57,0
mvaa 56,76,96
ra 28,6,36864
mvaa 76,76,100
s_waitcnt vmcnt(5)
v_cmp_ne_u32 vcc, s71, v20
s_cbranch_vccz L_p5c_ok
s_mov_b32 s62, 1000000
L_p5c:
buffer_load_dword v20, v31, s[52:55], s81 offen sc1
s_waitcnt vmcnt(0)
v_cmp_ne_u32 vcc, s71, v20
s_cbranch_vccz L_p5c_ok
s_sub_u32 s62, s62, 1
s_cmp_eq_u32 s62, 0
s_cbranch_scc1 L_p5c_ok
s_sleep 4
s_branch L_p5c
L_p5c_ok:
s_barrier
ra 64,6,45056
mvaa 76,112,136
s_add_u32 s56, s67, 0
s_add_u32 m0, s78, 110592
ra 32,7,36864
mvaa 96,112,140
dma 0,40,56,0
ra 68,7,45056
mvaa 96,76,104
mvaa 40,80,92
dma 0,40,56,1024
ta 4,27,36896
mvaa 40,116,128
ta 6,27,42016
mvaa 60,116,132
dma 0,40,56,2048
ta 40,27,47136
mvaa 60,80,96
s_waitcnt lgkmcnt(11)
ta 42,27,52256
mvaa 80,80,100
dma 0,40,56,3072
mvaa 80,116,136
s_add_u32 s56, s67, 16384
s_add_u32 m0, s78, 0
ta 8,26,36928
mvaa 100,116,140
dma 0,40,56,0
ta 10,26,42048
mvaa 100,80,104
ta 44,26,47168
mvaa 44,84,92
dma 0,40,56,1024
s_waitcnt lgkmcnt(11)
ta 46,26,52288
mvaa 44,120,128
mvaa 64,120,132
dma 0,40,56,2048
ta 12,27,36960
mvaa 64,84,96
ta 14,27,42080
mvaa 84,84,100
dma 0,40,56,3072
ta 48,27,47200
mvaa 84,120,136
s_add_u32 s56, s67, 32768
s_add_u32 m0, s78, 73728
s_waitcnt lgkmcnt(11)
ta 50,27,52320
mvaa 104,120,140
dma 0,40,56,0
mvaa 104,84,104
ta 16,26,36992
mvaa 48,88,92
dma 0,40,56,1024
ta 18,26,42112
mvaa 48,124,128
ta 52,26,47232
mvaa 68,124,132
dma 0,40,56,2048
s_waitcnt lgkmcnt(11)
ta 54,26,52352
mvaa 68,88,96
mvaa 88,88,100
dma 0,40,56,3072
mvaa 88,124,136
mvaa 108,124,140
mvaa 108,88,104
mvaa 32,0,20
s_waitcnt vmcnt(8) lgkmcnt(0)
s_barrier
mvaa 32,36,56
ta 72,12,36864
mvaa 52,36,60
s_add_u32 s57, s69, 245760
s_add_u32 m0, s82, 36864
ta 74,12,41984
mvaa 52,0,24
dma 14,48,57,0
ta 108,12,47104
mvaa 72,0,28
ta 110,12,52224
mvaa 72,36,64
mvaa 92,36,68
ra 92,8,36864
mvaa 92,0,32
dma 15,48,57,1024
ra 128,8,45056
mvaa 36,4,20
ra 96,9,36864
mvaa 36,40,56
ra 132,9,45056
mvaa 56,40,60
mvaa 56,4,24
dma 16,48,57,2048
ra 100,10,36864
mvaa 76,4,28
ra 136,10,45056
mvaa 76,40,64
ra 104,11,36864
mvaa 96,40,68
ra 140,11,45056
mvaa 96,4,32
dma 17,48,57,3072
mvaa 40,8,20
ta 76,13,36896
mvaa 40,44,56
ta 78,13,42016
mvaa 60,44,60
s_add_u32 m0, s82, 40960
ta 112,13,47136
mvaa 60,8,24
dma 18,48,57,0
s_waitcnt lgkmcnt(11)
ta 114,13,52256
mvaa 80,8,28
mvaa 80,44,64
ta 80,12,36928
mvaa 100,44,68
s_add_u32 s56, s67, 49152
s_add_u32 m0, s78, 36864
ta 82,12,42048
mvaa 100,8,32
dma 0,40,56,0
ta 116,12,47168
mvaa 44,12,20
s_waitcnt lgkmcnt(11)
ta 118,12,52288
mvaa 44,48,56
mvaa 64,48,60
ta 84,13,36960
mvaa 64,12,24
dma 0,40,56,1024
ta 86,13,42080
mvaa 84,12,28
ta 120,13,47200
mvaa 84,48,64
s_waitcnt lgkmcnt(11)
ta 122,13,52320
mvaa 104,48,68
mvaa 104,12,32
dma 0,40,56,2048
ta 88,12,36992
mvaa 48,16,20
ta 90,12,42112
mvaa 48,52,56
ta 124,12,47232
mvaa 68,52,60
s_waitcnt lgkmcnt(11)
ta 126,12,52352
mvaa 68,16,24
dma 0,40,56,3072
mvaa 88,16,28
mvaa 88,52,64
mvaa 108,52,68
mvaa 108,16,32
mvaa 32,72,92
s_waitcnt vmcnt(13) lgkmcnt(0)
s_barrier
mvaa 32,108,128
ta 0,26,0
mvaa 52,108,132
s_add_u32 s57, s69, 327680
s_add_u32 m0, s82, 110592
ta 2,26,5120
mvaa 52,72,96
dma 14,48,57,0
ta 36,26,10240
mvaa 72,72,100
ta 38,26,15360
mvaa 72,108,136
mvaa 92,108,140
ra 20,4,0
mvaa 92,72,104
dma 15,48,57,1024
ra 56,4,8192
mvaa 36,76,92
ra 24,5,0
mvaa 36,112,128
ra 60,5,8192
mvaa 56,112,132
mvaa 56,76,96
dma 16,48,57,2048
ra 28,6,0
mvaa 76,76,100
HOP_b_1:
HS_b_1:
s_cmp_eq_u32 s7, 1
s_cbranch_scc1 HOP_b_ret
ra 64,6,8192
mvaa 76,112,136
ra 32,7,0
mvaa 96,112,140
ra 68,7,8192
mvaa 96,76,104
dma 17,48,57,3072
mvaa 40,80,92
ta 4,27,32
mvaa 40,116,128
ta 6,27,5152
mvaa 60,116,132
s_add_u32 m0, s82, 114688
ta 40,27,10272
mvaa 60,80,96
dma 18,48,57,0
s_waitcnt lgkmcnt(11)
ta 42,27,15392
mvaa 80,80,100
mvaa 80,116,136
ta 8,26,64
mvaa 100,116,140
s_add_u32 s56, s67, 65536
s_add_u32 m0, s78, 110592
ta 10,26,5184
mvaa 100,80,104
dma 0,40,56,0
ta 44,26,10304
mvaa 44,84,92
s_waitcnt lgkmcnt(11)
ta 46,26,15424
mvaa 44,120,128
mvaa 64,120,132
ta 12,27,96
mvaa 64,84,96
dma 0,40,56,1024
ta 14,27,5216
mvaa 84,84,100
ta 48,27,10336
mvaa 84,120,136
s_waitcnt lgkmcnt(11)
ta 50,27,15456
mvaa 104,120,140
mvaa 104,84,104
dma 0,40,56,2048
ta 16,26,128
mvaa 48,88,92
ta 18,26,5248
mvaa 48,124,128
ta 52,26,10368
mvaa 68,124,132
s_waitcnt lgkmcnt(11)
ta 54,26,15488
mvaa 68,88,96
dma 0,40,56,3072
mvaa 88,88,100
mvaa 88,124,136
mvaa 108,124,140
mvaa 108,88,104
mvaa 32,0,20
s_waitcnt vmcnt(18) lgkmcnt(0)
s_barrier
mvaa 32,36,56
ta 72,12,0
mvaa 52,36,60
s_add_u32 s57, s69, 409600
s_add_u32 m0, s82, 0
ta 74,12,5120
mvaa 52,0,24
dma 14,48,57,0
ta 108,12,10240
mvaa 72,0,28
ta 110,12,15360
mvaa 72,36,64
mvaa 92,36,68
ra 92,8,0
mvaa 92,0,32
dma 15,48,57,1024
ra 128,8,8192
mvaa 36,4,20
ra 96,9,0
mvaa 36,40,56
ra 132,9,8192
mvaa 56,40,60
mvaa 56,4,24
dma 16,48,57,2048
ra 100,10,0
mvaa 76,4,28
ra 136,10,8192
mvaa 76,40,64
ra 104,11,0
mvaa 96,40,68
ra 140,11,8192
mvaa 96,4,32
dma 17,48,57,3072
mvaa 40,8,20
ta 76,13,32
mvaa 40,44,56
ta 78,13,5152
mvaa 60,44,60
s_add_u32 m0, s82, 4096
ta 112,13,10272
mvaa 60,8,24
dma 18,48,57,0
s_waitcnt lgkmcnt(11)
ta 114,13,15392
mvaa 80,8,28
mvaa 80,44,64
ta 80,12,64
mvaa 100,44,68
s_add_u32 s56, s67, 81920
s_add_u32 m0, s78, 0
ta 82,12,5184
mvaa 100,8,32
dma 0,40,56,0
ta 116,12,10304
mvaa 44,12,20
s_waitcnt lgkmcnt(11)
ta 118,12,15424
mvaa 44,48,56
mvaa 64,48,60
ta 84,13,96
mvaa 64,12,24
dma 0,40,56,1024
ta 86,13,5216
mvaa 84,12,28
ta 120,13,10336
mvaa 84,48,64
s_waitcnt lgkmcnt(11)
ta 122,13,15456
mvaa 104,48,68
mvaa 104,12,32
dma 0,40,56,2048
ta 88,12,128
mvaa 48,16,20
ta 90,12,5248
mvaa 48,52,56
ta 124,12,10368
mvaa 68,52,60
s_waitcnt lgkmcnt(11)
ta 126,12,15488
mvaa 68,16,24
dma 0,40,56,3072
mvaa 88,16,28
mvaa 88,52,64
mvaa 108,52,68
mvaa 108,16,32
mvaa 32,72,92
s_waitcnt vmcnt(18) lgkmcnt(0)
s_barrier
mvaa 32,108,128
ta 0,26,36864
mvaa 52,108,132
s_add_u32 s57, s69, 491520
s_add_u32 m0, s82, 73728
ta 2,26,41984
mvaa 52,72,96
dma 14,48,57,0
ta 36,26,47104
mvaa 72,72,100
ta 38,26,52224
mvaa 72,108,136
mvaa 92,108,140
ra 20,4,36864
mvaa 92,72,104
dma 15,48,57,1024
ra 56,4,45056
mvaa 36,76,92
ra 24,5,36864
mvaa 36,112,128
ra 60,5,45056
mvaa 56,112,132
mvaa 56,76,96
dma 16,48,57,2048
ra 28,6,36864
mvaa 76,76,100
ra 64,6,45056
mvaa 76,112,136
ra 32,7,36864
mvaa 96,112,140
ra 68,7,45056
mvaa 96,76,104
dma 17,48,57,3072
mvaa 40,80,92
ta 4,27,36896
mvaa 40,116,128
ta 6,27,42016
mvaa 60,116,132
s_add_u32 m0, s82, 77824
ta 40,27,47136
mvaa 60,80,96
dma 18,48,57,0
s_waitcnt lgkmcnt(11)
ta 42,27,52256
mvaa 80,80,100
mvaa 80,116,136
ta 8,26,36928
mvaa 100,116,140
s_add_u32 s56, s67, 98304
s_add_u32 m0, s78, 73728
ta 10,26,42048
mvaa 100,80,104
dma 0,40,56,0
ta 44,26,47168
mvaa 44,84,92
s_waitcnt lgkmcnt(11)
ta 46,26,52288
mvaa 44,120,128
mvaa 64,120,132
ta 12,27,36960
mvaa 64,84,96
dma 0,40,56,1024
ta 14,27,42080
mvaa 84,84,100
ta 48,27,47200
mvaa 84,120,136
s_waitcnt lgkmcnt(11)
ta 50,27,52320
mvaa 104,120,140
mvaa 104,84,104
dma 0,40,56,2048
ta 16,26,36992
mvaa 48,88,92
ta 18,26,42112
mvaa 48,124,128
ta 52,26,47232
mvaa 68,124,132
s_waitcnt lgkmcnt(11)
ta 54,26,52352
mvaa 68,88,96
dma 0,40,56,3072
mvaa 88,88,100
mvaa 88,124,136
mvaa 108,124,140
mvaa 108,88,104
mvaa 32,0,20
s_waitcnt vmcnt(18) lgkmcnt(0)
s_barrier
mvaa 32,36,56
ta 72,12,36864
mvaa 52,36,60
s_add_u32 s57, s69, 573440
s_add_u32 m0, s82, 36864
ta 74,12,41984
mvaa 52,0,24
dma 14,48,57,0
ta 108,12,47104
mvaa 72,0,28
ta 110,12,52224
mvaa 72,36,64
mvaa 92,36,68
ra 92,8,36864
mvaa 92,0,32
dma 15,48,57,1024
ra 128,8,45056
mvaa 36,4,20
ra 96,9,36864
mvaa 36,40,56
ra 132,9,45056
mvaa 56,40,60
mvaa 56,4,24
dma 16,48,57,2048
ra 100,10,36864
mvaa 76,4,28
ra 136,10,45056
mvaa 76,40,64
ra 104,11,36864
mvaa 96,40,68
ra 140,11,45056
mvaa 96,4,32
dma 17,48,57,3072
mvaa 40,8,20
ta 76,13,36896
mvaa 40,44,56
ta 78,13,42016
mvaa 60,44,60
s_add_u32 m0, s82, 40960
ta 112,13,47136
mvaa 60,8,24
dma 18,48,57,0
s_waitcnt lgkmcnt(11)
ta 114,13,52256
mvaa 80,8,28
mvaa 80,44,64
ta 80,12,36928
mvaa 100,44,68
s_add_u32 s56, s67, 114688
s_add_u32 m0, s78, 36864
ta 82,12,42048
mvaa 100,8,32
dma 0,40,56,0
ta 116,12,47168
mvaa 44,12,20
s_waitcnt lgkmcnt(11)
ta 118,12,52288
mvaa 44,48,56
mvaa 64,48,60
ta 84,13,36960
mvaa 64,12,24
dma 0,40,56,1024
ta 86,13,42080
mvaa 84,12,28
ta 120,13,47200
mvaa 84,48,64
s_waitcnt lgkmcnt(11)
ta 122,13,52320
mvaa 104,48,68
mvaa 104,12,32
dma 0,40,56,2048
ta 88,12,36992
mvaa 48,16,20
ta 90,12,42112
mvaa 48,52,56
ta 124,12,47232
mvaa 68,52,60
s_waitcnt lgkmcnt(11)
ta 126,12,52352
mvaa 68,16,24
dma 0,40,56,3072
mvaa 88,16,28
mvaa 88,52,64
mvaa 108,52,68
mvaa 108,16,32
mvaa 32,72,92
s_waitcnt vmcnt(18) lgkmcnt(0)
s_barrier
mvaa 32,108,128
ta 0,26,0
mvaa 52,108,132
s_add_u32 s57, s69, 655360
s_add_u32 m0, s82, 110592
ta 2,26,5120
mvaa 52,72,96
dma 14,48,57,0
ta 36,26,10240
mvaa 72,72,100
ta 38,26,15360
mvaa 72,108,136
mvaa 92,108,140
ra 20,4,0
mvaa 92,72,104
dma 15,48,57,1024
ra 56,4,8192
mvaa 36,76,92
ra 24,5,0
mvaa 36,112,128
ra 60,5,8192
mvaa 56,112,132
mvaa 56,76,96
dma 16,48,57,2048
ra 28,6,0
mvaa 76,76,100
ra 64,6,8192
mvaa 76,112,136
ra 32,7,0
mvaa 96,112,140
ra 68,7,8192
mvaa 96,76,104
dma 17,48,57,3072
mvaa 40,80,92
ta 4,27,32
mvaa 40,116,128
ta 6,27,5152
mvaa 60,116,132
s_add_u32 m0, s82, 114688
ta 40,27,10272
mvaa 60,80,96
dma 18,48,57,0
s_waitcnt lgkmcnt(11)
ta 42,27,15392
mvaa 80,80,100
mvaa 80,116,136
ta 8,26,64
mvaa 100,116,140
s_add_u32 s56, s67, 131072
s_add_u32 m0, s78, 110592
ta 10,26,5184
mvaa 100,80,104
dma 0,40,56,0
ta 44,26,10304
mvaa 44,84,92
s_waitcnt lgkmcnt(11)
ta 46,26,15424
mvaa 44,120,128
mvaa 64,120,132
ta 12,27,96
mvaa 64,84,96
dma 0,40,56,1024
ta 14,27,5216
mvaa 84,84,100
ta 48,27,10336
mvaa 84,120,136
s_waitcnt lgkmcnt(11)
ta 50,27,15456
mvaa 104,120,140
mvaa 104,84,104
dma 0,40,56,2048
ta 16,26,128
mvaa 48,88,92
ta 18,26,5248
mvaa 48,124,128
ta 52,26,10368
mvaa 68,124,132
s_waitcnt lgkmcnt(11)
ta 54,26,15488
mvaa 68,88,96
dma 0,40,56,3072
mvaa 88,88,100
mvaa 88,124,136
mvaa 108,124,140
mvaa 108,88,104
mvaa 32,0,20
s_waitcnt vmcnt(18) lgkmcnt(0)
s_barrier
mvaa 32,36,56
ta 72,12,0
mvaa 52,36,60
s_add_u32 s57, s69, 737280
s_add_u32 m0, s82, 0
ta 74,12,5120
mvaa 52,0,24
dma 14,48,57,0
ta 108,12,10240
mvaa 72,0,28
ta 110,12,15360
mvaa 72,36,64
mvaa 92,36,68
ra 92,8,0
mvaa 92,0,32
dma 15,48,57,1024
ra 128,8,8192
mvaa 36,4,20
ra 96,9,0
mvaa 36,40,56
ra 132,9,8192
mvaa 56,40,60
mvaa 56,4,24
dma 16,48,57,2048
ra 100,10,0
mvaa 76,4,28
ra 136,10,8192
mvaa 76,40,64
ra 104,11,0
mvaa 96,40,68
ra 140,11,8192
mvaa 96,4,32
dma 17,48,57,3072
mvaa 40,8,20
ta 76,13,32
mvaa 40,44,56
ta 78,13,5152
mvaa 60,44,60
s_add_u32 m0, s82, 4096
ta 112,13,10272
mvaa 60,8,24
dma 18,48,57,0
s_waitcnt lgkmcnt(11)
ta 114,13,15392
mvaa 80,8,28
mvaa 80,44,64
ta 80,12,64
mvaa 100,44,68
s_add_u32 s56, s67, 147456
s_add_u32 m0, s78, 0
ta 82,12,5184
mvaa 100,8,32
dma 0,40,56,0
ta 116,12,10304
mvaa 44,12,20
s_waitcnt lgkmcnt(11)
ta 118,12,15424
mvaa 44,48,56
mvaa 64,48,60
ta 84,13,96
mvaa 64,12,24
dma 0,40,56,1024
ta 86,13,5216
mvaa 84,12,28
ta 120,13,10336
mvaa 84,48,64
s_waitcnt lgkmcnt(11)
ta 122,13,15456
mvaa 104,48,68
mvaa 104,12,32
dma 0,40,56,2048
ta 88,12,128
mvaa 48,16,20
ta 90,12,5248
mvaa 48,52,56
ta 124,12,10368
mvaa 68,52,60
s_waitcnt lgkmcnt(11)
ta 126,12,15488
mvaa 68,16,24
dma 0,40,56,3072
mvaa 88,16,28
mvaa 88,52,64
mvaa 108,52,68
mvaa 108,16,32
mvaa 32,72,92
s_waitcnt vmcnt(18) lgkmcnt(0)
s_barrier
mvaa 32,108,128
ta 0,26,36864
mvaa 52,108,132
s_add_u32 s57, s69, 819200
s_add_u32 m0, s82, 73728
ta 2,26,41984
mvaa 52,72,96
dma 14,48,57,0
ta 36,26,47104
mvaa 72,72,100
ta 38,26,52224
mvaa 72,108,136
mvaa 92,108,140
ra 20,4,36864
mvaa 92,72,104
dma 15,48,57,1024
ra 56,4,45056
mvaa 36,76,92
ra 24,5,36864
mvaa 36,112,128
ra 60,5,45056
mvaa 56,112,132
mvaa 56,76,96
dma 16,48,57,2048
ra 28,6,36864
mvaa 76,76,100
ra 64,6,45056
mvaa 76,112,136
ra 32,7,36864
HOP_b_2:
HS_b_2:
s_cmp_eq_u32 s7, 1
s_cbranch_scc1 HOP_b_ret
mvaa 96,112,140
ra 68,7,45056
mvaa 96,76,104
dma 17,48,57,3072
mvaa 40,80,92
ta 4,27,36896
mvaa 40,116,128
ta 6,27,42016
mvaa 60,116,132
s_add_u32 m0, s82, 77824
ta 40,27,47136
mvaa 60,80,96
dma 18,48,57,0
s_waitcnt lgkmcnt(11)
ta 42,27,52256
mvaa 80,80,100
mvaa 80,116,136
ta 8,26,36928
mvaa 100,116,140
s_add_u32 s56, s67, 163840
s_add_u32 m0, s78, 73728
ta 10,26,42048
mvaa 100,80,104
dma 0,40,56,0
ta 44,26,47168
mvaa 44,84,92
s_waitcnt lgkmcnt(11)
ta 46,26,52288
mvaa 44,120,128
mvaa 64,120,132
ta 12,27,36960
mvaa 64,84,96
dma 0,40,56,1024
ta 14,27,42080
mvaa 84,84,100
ta 48,27,47200
mvaa 84,120,136
s_waitcnt lgkmcnt(11)
ta 50,27,52320
mvaa 104,120,140
mvaa 104,84,104
dma 0,40,56,2048
ta 16,26,36992
mvaa 48,88,92
ta 18,26,42112
mvaa 48,124,128
ta 52,26,47232
mvaa 68,124,132
s_waitcnt lgkmcnt(11)
ta 54,26,52352
mvaa 68,88,96
dma 0,40,56,3072
mvaa 88,88,100
mvaa 88,124,136
mvaa 108,124,140
mvaa 108,88,104
mvaa 32,0,20
s_waitcnt vmcnt(18) lgkmcnt(0)
s_barrier
mvaa 32,36,56
ta 72,12,36864
mvaa 52,36,60
s_add_u32 s57, s69, 901120
s_add_u32 m0, s82, 36864
ta 74,12,41984
mvaa 52,0,24
dma 14,48,57,0
ta 108,12,47104
mvaa 72,0,28
ta 110,12,52224
mvaa 72,36,64
mvaa 92,36,68
ra 92,8,36864
mvaa 92,0,32
dma 15,48,57,1024
ra 128,8,45056
mvaa 36,4,20
ra 96,9,36864
mvaa 36,40,56
ra 132,9,45056
mvaa 56,40,60
mvaa 56,4,24
dma 16,48,57,2048
ra 100,10,36864
mvaa 76,4,28
ra 136,10,45056
mvaa 76,40,64
ra 104,11,36864
mvaa 96,40,68
ra 140,11,45056
mvaa 96,4,32
dma 17,48,57,3072
mvaa 40,8,20
ta 76,13,36896
mvaa 40,44,56
ta 78,13,42016
mvaa 60,44,60
s_add_u32 m0, s82, 40960
ta 112,13,47136
mvaa 60,8,24
dma 18,48,57,0
s_waitcnt lgkmcnt(11)
ta 114,13,52256
mvaa 80,8,28
mvaa 80,44,64
ta 80,12,36928
mvaa 100,44,68
s_add_u32 s56, s67, 180224
s_add_u32 m0, s78, 36864
ta 82,12,42048
mvaa 100,8,32
dma 0,40,56,0
ta 116,12,47168
mvaa 44,12,20
s_waitcnt lgkmcnt(11)
ta 118,12,52288
mvaa 44,48,56
mvaa 64,48,60
ta 84,13,36960
mvaa 64,12,24
dma 0,40,56,1024
ta 86,13,42080
mvaa 84,12,28
ta 120,13,47200
mvaa 84,48,64
s_waitcnt lgkmcnt(11)
ta 122,13,52320
mvaa 104,48,68
mvaa 104,12,32
dma 0,40,56,2048
ta 88,12,36992
mvaa 48,16,20
ta 90,12,42112
mvaa 48,52,56
ta 124,12,47232
mvaa 68,52,60
s_waitcnt lgkmcnt(11)
ta 126,12,52352
mvaa 68,16,24
dma 0,40,56,3072
mvaa 88,16,28
mvaa 88,52,64
mvaa 108,52,68
mvaa 108,16,32
mvaa 32,72,92
s_waitcnt vmcnt(18) lgkmcnt(0)
s_barrier
mvaa 32,108,128
ta 0,26,0
mvaa 52,108,132
s_add_u32 s57, s69, 983040
s_add_u32 m0, s82, 110592
ta 2,26,5120
mvaa 52,72,96
dma 14,48,57,0
ta 36,26,10240
mvaa 72,72,100
ta 38,26,15360
mvaa 72,108,136
mvaa 92,108,140
ra 20,4,0
mvaa 92,72,104
dma 15,48,57,1024
ra 56,4,8192
mvaa 36,76,92
ra 24,5,0
mvaa 36,112,128
ra 60,5,8192
mvaa 56,112,132
mvaa 56,76,96
dma 16,48,57,2048
ra 28,6,0
mvaa 76,76,100
ra 64,6,8192
mvaa 76,112,136
ra 32,7,0
mvaa 96,112,140
ra 68,7,8192
mvaa 96,76,104
dma 17,48,57,3072
mvaa 40,80,92
ta 4,27,32
mvaa 40,116,128
ta 6,27,5152
mvaa 60,116,132
s_add_u32 m0, s82, 114688
ta 40,27,10272
mvaa 60,80,96
dma 18,48,57,0
s_waitcnt lgkmcnt(11)
ta 42,27,15392
mvaa 80,80,100
mvaa 80,116,136
ta 8,26,64
mvaa 100,116,140
s_add_u32 s56, s67, 196608
s_add_u32 m0, s78, 110592
ta 10,26,5184
mvaa 100,80,104
dma 0,40,56,0
ta 44,26,10304
mvaa 44,84,92
s_waitcnt lgkmcnt(11)
ta 46,26,15424
mvaa 44,120,128
mvaa 64,120,132
ta 12,27,96
mvaa 64,84,96
dma 0,40,56,1024
ta 14,27,5216
mvaa 84,84,100
ta 48,27,10336
mvaa 84,120,136
s_waitcnt lgkmcnt(11)
ta 50,27,15456
mvaa 104,120,140
mvaa 104,84,104
dma 0,40,56,2048
ta 16,26,128
mvaa 48,88,92
ta 18,26,5248
mvaa 48,124,128
ta 52,26,10368
mvaa 68,124,132
s_waitcnt lgkmcnt(11)
ta 54,26,15488
mvaa 68,88,96
dma 0,40,56,3072
mvaa 88,88,100
mvaa 88,124,136
mvaa 108,124,140
mvaa 108,88,104
mvaa 32,0,20
s_waitcnt vmcnt(18) lgkmcnt(0)
s_barrier
mvaa 32,36,56
ta 72,12,0
mvaa 52,36,60
s_add_u32 s57, s69, 1064960
s_add_u32 m0, s82, 0
ta 74,12,5120
mvaa 52,0,24
dma 14,48,57,0
ta 108,12,10240
mvaa 72,0,28
ta 110,12,15360
mvaa 72,36,64
mvaa 92,36,68
ra 92,8,0
mvaa 92,0,32
dma 15,48,57,1024
ra 128,8,8192
mvaa 36,4,20
ra 96,9,0
mvaa 36,40,56
ra 132,9,8192
mvaa 56,40,60
mvaa 56,4,24
dma 16,48,57,2048
ra 100,10,0
mvaa 76,4,28
ra 136,10,8192
mvaa 76,40,64
ra 104,11,0
mvaa 96,40,68
ra 140,11,8192
mvaa 96,4,32
dma 17,48,57,3072
mvaa 40,8,20
ta 76,13,32
mvaa 40,44,56
ta 78,13,5152
mvaa 60,44,60
s_add_u32 m0, s82, 4096
ta 112,13,10272
mvaa 60,8,24
dma 18,48,57,0
s_waitcnt lgkmcnt(11)
ta 114,13,15392
mvaa 80,8,28
mvaa 80,44,64
ta 80,12,64
mvaa 100,44,68
s_add_u32 s56, s67, 212992
s_add_u32 m0, s78, 0
ta 82,12,5184
mvaa 100,8,32
dma 0,40,56,0
ta 116,12,10304
mvaa 44,12,20
s_waitcnt lgkmcnt(11)
ta 118,12,15424
mvaa 44,48,56
mvaa 64,48,60
ta 84,13,96
mvaa 64,12,24
dma 0,40,56,1024
ta 86,13,5216
mvaa 84,12,28
ta 120,13,10336
mvaa 84,48,64
s_waitcnt lgkmcnt(11)
ta 122,13,15456
mvaa 104,48,68
mvaa 104,12,32
dma 0,40,56,2048
ta 88,12,128
mvaa 48,16,20
ta 90,12,5248
mvaa 48,52,56
ta 124,12,10368
mvaa 68,52,60
s_waitcnt lgkmcnt(11)
ta 126,12,15488
mvaa 68,16,24
dma 0,40,56,3072
mvaa 88,16,28
mvaa 88,52,64
mvaa 108,52,68
mvaa 108,16,32
mvaa 32,72,92
s_waitcnt vmcnt(18) lgkmcnt(0)
s_barrier
mvaa 32,108,128
ta 0,26,36864
mvaa 52,108,132
s_add_u32 s57, s69, 1146880
s_add_u32 m0, s82, 73728
ta 2,26,41984
mvaa 52,72,96
dma 14,48,57,0
ta 36,26,47104
mvaa 72,72,100
ta 38,26,52224
mvaa 72,108,136
mvaa 92,108,140
ra 20,4,36864
mvaa 92,72,104
dma 15,48,57,1024
ra 56,4,45056
mvaa 36,76,92
ra 24,5,36864
mvaa 36,112,128
ra 60,5,45056
mvaa 56,112,132
mvaa 56,76,96
dma 16,48,57,2048
ra 28,6,36864
mvaa 76,76,100
ra 64,6,45056
mvaa 76,112,136
ra 32,7,36864
mvaa 96,112,140
ra 68,7,45056
mvaa 96,76,104
dma 17,48,57,3072
mvaa 40,80,92
ta 4,27,36896
mvaa 40,116,128
ta 6,27,42016
mvaa 60,116,132
s_add_u32 m0, s82, 77824
ta 40,27,47136
mvaa 60,80,96
dma 18,48,57,0
s_waitcnt lgkmcnt(11)
ta 42,27,52256
mvaa 80,80,100
mvaa 80,116,136
ta 8,26,36928
mvaa 100,116,140
s_add_u32 s56, s67, 229376
s_add_u32 m0, s78, 73728
ta 10,26,42048
mvaa 100,80,104
dma 0,40,56,0
ta 44,26,47168
mvaa 44,84,92
s_waitcnt lgkmcnt(11)
ta 46,26,52288
mvaa 44,120,128
mvaa 64,120,132
ta 12,27,36960
mvaa 64,84,96
dma 0,40,56,1024
ta 14,27,42080
mvaa 84,84,100
ta 48,27,47200
mvaa 84,120,136
s_waitcnt lgkmcnt(11)
ta 50,27,52320
mvaa 104,120,140
mvaa 104,84,104
dma 0,40,56,2048
ta 16,26,36992
mvaa 48,88,92
ta 18,26,42112
mvaa 48,124,128
ta 52,26,47232
mvaa 68,124,132
s_waitcnt lgkmcnt(11)
ta 54,26,52352
mvaa 68,88,96
dma 0,40,56,3072
mvaa 88,88,100
mvaa 88,124,136
mvaa 108,124,140
mvaa 108,88,104
mvaa 32,0,20
s_waitcnt vmcnt(18) lgkmcnt(0)
s_barrier
mvaa 32,36,56
ta 72,12,36864
mvaa 52,36,60
s_add_u32 s57, s69, 1228800
s_add_u32 m0, s82, 36864
ta 74,12,41984
mvaa 52,0,24
dma 14,48,57,0
ta 108,12,47104
mvaa 72,0,28
ta 110,12,52224
v_mov_b32 v179, s88
mvaa 72,36,64
mvaa 92,36,68
ra 92,8,36864
v_mov_b32 v183, s88
mvaa 92,0,32
dma 15,48,57,1024
ra 128,8,45056
mvaa 36,4,20
ra 96,9,36864
v_mov_b32 v187, s88
mvaa 36,40,56
ra 132,9,45056
mvaa 56,40,60
v_mov_b32 v189, s88
mvaa 56,4,24
dma 16,48,57,2048
ra 100,10,36864
mvaa 76,4,28
ra 136,10,45056
v_mov_b32 v195, s88
mvaa 76,40,64
ra 104,11,36864
mvaa 96,40,68
ra 140,11,45056
v_mov_b32 v199, s88
mvaa 96,4,32
dma 17,48,57,3072
mvaa 40,8,20
ta 76,13,36896
v_mov_b32 v203, s88
mvaa 40,44,56
ta 78,13,42016
mvaa 60,44,60
s_add_u32 m0, s82, 40960
ta 112,13,47136
v_mov_b32 v205, s88
mvaa 60,8,24
dma 18,48,57,0
s_waitcnt lgkmcnt(11)
ta 114,13,52256
mvaa 80,8,28
v_mov_b32 v211, s88
mvaa 80,44,64
ta 80,12,36928
mvaa 100,44,68
s_add_u32 s56, s67, 245760
s_add_u32 m0, s78, 36864
ta 82,12,42048
v_mov_b32 v215, s88
mvaa 100,8,32
dma 0,40,56,0
ta 116,12,47168
mvaa 44,12,20
s_waitcnt lgkmcnt(11)
ta 118,12,52288
v_mov_b32 v219, s88
mvaa 44,48,56
mvaa 64,48,60
ta 84,13,36960
v_mov_b32 v221, s88
mvaa 64,12,24
dma 0,40,56,1024
ta 86,13,42080
mvaa 84,12,28
ta 120,13,47200
mvaa 84,48,64
s_waitcnt lgkmcnt(11)
ta 122,13,52320
mvaa 104,48,68
v_lshrrev_b32 v139, 1, v0
mvaa 104,12,32
dma 0,40,56,2048
ta 88,12,36992
mvaa 48,16,20
ta 90,12,42112
mvaa 48,52,56
ta 124,12,47232
mvaa 68,52,60
s_waitcnt lgkmcnt(11)
ta 126,12,52352
mvaa 68,16,24
dma 0,40,56,3072
mvaa 88,16,28
mvaa 88,52,64
mvaa 108,52,68
mvaa 108,16,32
mvaa 32,72,92
s_waitcnt vmcnt(18) lgkmcnt(0)
s_barrier
s_mov_b32 s36, s8
s_and_b32 s37, s9, 0xffff
s_mov_b32 s38, 2621440
s_mov_b32 s39, 0x20000
s_mov_b32 s44, s28
s_and_b32 s45, s29, 0xffff
s_mov_b32 s46, 1280
s_mov_b32 s47, 0x20000
mvaa 32,108,128
ta 0,26,0
mvaa 52,108,132
buffer_load_dwordx2 v[112:113], v28, s[36:39], s70 offen offset:0
ta 2,26,5120
mvaa 52,72,96
ta 36,26,10240
mvaa 72,72,100
ta 38,26,15360
mvaa 72,108,136
buffer_load_dwordx2 v[114:115], v28, s[36:39], s70 offen offset:32
mvaa 92,108,140
ra 20,4,0
mvaa 92,72,104
ra 56,4,8192
mvaa 36,76,92
buffer_load_dwordx2 v[116:117], v28, s[36:39], s70 offen offset:64
ra 24,5,0
HOP_b_3:
HS_b_3:
s_cmp_eq_u32 s7, 1
s_cbranch_scc1 HOP_b_ret
mvaa 36,112,128
ra 60,5,8192
mvaa 56,112,132
mvaa 56,76,96
buffer_load_dwordx2 v[118:119], v28, s[36:39], s70 offen offset:96
ra 28,6,0
mvaa 76,76,100
ra 64,6,8192
mvaa 76,112,136
ra 32,7,0
mvaa 96,112,140
buffer_load_dwordx2 v[120:121], v28, s[36:39], s70 offen offset:128
ra 68,7,8192
mvaa 96,76,104
mvaa 40,80,92
ta 4,27,32
mvaa 40,116,128
ta 6,27,5152
mvaa 60,116,132
ta 40,27,10272
mvaa 60,80,96
s_waitcnt lgkmcnt(11)
ta 42,27,15392
mvaa 80,80,100
buffer_load_dwordx2 v[122:123], v29, s[44:47], s84 offen offset:0
mvaa 80,116,136
ta 8,26,64
mvaa 100,116,140
ta 10,26,5184
mvaa 100,80,104
buffer_load_dwordx2 v[124:125], v29, s[44:47], s84 offen offset:32
ta 44,26,10304
mvaa 44,84,92
s_waitcnt lgkmcnt(11)
ta 46,26,15424
mvaa 44,120,128
mvaa 64,120,132
buffer_load_dwordx2 v[126:127], v29, s[44:47], s84 offen offset:64
ta 12,27,96
mvaa 64,84,96
ta 14,27,5216
mvaa 84,84,100
ta 48,27,10336
mvaa 84,120,136
buffer_load_dwordx2 v[128:129], v29, s[44:47], s84 offen offset:96
s_waitcnt lgkmcnt(11)
ta 50,27,15456
mvaa 104,120,140
mvaa 104,84,104
ta 16,26,128
mvaa 48,88,92
buffer_load_dwordx2 v[130:131], v29, s[44:47], s84 offen offset:128
ta 18,26,5248
mvaa 48,124,128
ta 52,26,10368
mvaa 68,124,132
s_waitcnt lgkmcnt(11)
ta 54,26,15488
mvaa 68,88,96
mvaa 88,88,100
mvaa 88,124,136
mvaa 108,124,140
mvaa 108,88,104
mvaa 32,0,20
s_waitcnt vmcnt(19) lgkmcnt(0)
s_barrier
mvaa 32,36,56
ta 72,12,0
mvaa 52,36,60
ta 74,12,5120
v_mov_b32 v20, 0
mvaa 52,0,24
ta 108,12,10240
v_mov_b32 v132, 0x10000000
mvaa 72,0,28
ta 110,12,15360
v_cmp_eq_u32 vcc, 0, v0
s_lshl_b32 s10, s65, 7
s_xor_b32 s11, s10, 128
v_cndmask_b32 v132, v132, v20, vcc
mvaa 72,36,64
v_lshlrev_b32 v133, 3, v0
mvaa 92,36,68
ra 92,8,0
v_and_b32 v133, 384, v133
mvaa 92,0,32
ra 128,8,8192
v_mov_b32 v138, s11
mvaa 36,4,20
ta 76,13,32
v_cmp_eq_u32 vcc, s10, v133
s_nop 1
v_cndmask_b32 v133, v133, v138, vcc
mvaa 36,40,56
ta 78,13,5152
s_add_u32 s10, s10, s72
v_and_b32 v154, 8, v29
mvaa 56,40,60
v_mul_u32_u24 v154, 3, v154
mvaa 56,4,24
ta 112,13,10272
v_add_u32 v154, v154, v28
mvaa 76,4,28
ta 114,13,15392
mvaa 76,40,64
ta 80,12,64
mvaa 96,40,68
ta 82,12,5184
mvaa 96,4,32
mvaa 40,8,20
ta 116,12,10304
mvaa 40,44,56
ta 118,12,15424
mvaa 60,44,60
ta 84,13,96
mvaa 60,8,24
s_waitcnt lgkmcnt(11)
ta 86,13,5216
mvaa 80,8,28
s_add_u32 s12, s65, 1
s_and_b32 s12, s12, 3
mvaa 80,44,64
ta 120,13,10336
s_mul_i32 s12, s12, 20480
s_add_u32 s12, s12, s64
mvaa 100,44,68
ta 122,13,15456
s_add_u32 s13, s65, 2
s_and_b32 s13, s13, 3
mvaa 100,8,32
ta 88,12,128
s_mul_i32 s13, s13, 20480
s_add_u32 s13, s13, s64
mvaa 44,12,20
s_waitcnt lgkmcnt(11)
ta 90,12,5248
s_add_u32 s14, s65, 3
s_and_b32 s14, s14, 3
mvaa 44,48,56
s_mul_i32 s14, s14, 20480
s_add_u32 s14, s14, s64
mvaa 64,48,60
ta 124,12,10368
s_mov_b32 s36, s30
s_and_b32 s37, s31, 0xffff
mvaa 64,12,24
ta 126,12,15488
s_mov_b32 s38, 2621440
s_mov_b32 s39, 0x20000
mvaa 84,12,28
ra 96,9,0
mvaa 84,48,64
s_waitcnt lgkmcnt(11)
ra 132,9,8192
mvaa 104,48,68
mvaa 104,12,32
ra 100,10,0
mvaa 48,16,20
ra 136,10,8192
mvaa 48,52,56
ra 104,11,0
mvaa 68,52,60
s_waitcnt lgkmcnt(11)
ra 140,11,8192
mvaa 68,16,24
mvaa 88,16,28
mvaa 88,52,64
mvaa 108,52,68
mvaa 108,16,32
mvaa 32,72,92
s_waitcnt vmcnt(10) lgkmcnt(0)
s_barrier
ta 0,26,36864
ta 2,26,41984
mvaa 32,108,128
ta 36,26,47104
ta 38,26,52224
mvaa 36,112,128
ra 20,4,36864
ra 56,4,45056
mvaa 36,76,92
ta 4,27,36896
ta 6,27,42016
mvaa 40,80,92
ta 40,27,47136
ta 42,27,52256
mvaa 40,116,128
ta 8,26,36928
ta 10,26,42048
mvaa 44,120,128
ta 44,26,47168
ta 46,26,52288
mvaa 44,84,92
ta 12,27,36960
s_waitcnt lgkmcnt(11)
ta 14,27,42080
mvaa 48,88,92
ta 48,27,47200
ta 50,27,52320
mvaa 48,124,128
s_waitcnt lgkmcnt(13)
ta 16,26,36992
ta 18,26,42112
mvaa 32,0,20
s_waitcnt lgkmcnt(14)
ta 52,26,47232
s_waitcnt lgkmcnt(11)
ta 54,26,52352
mvaa 32,36,56
ra 24,5,36864
mvaa 36,40,56
ra 60,5,45056
mvaa 36,4,20
s_waitcnt lgkmcnt(12)
ra 28,6,36864
mvaa 40,8,20
s_waitcnt lgkmcnt(11)
ra 64,6,45056
mvaa 40,44,56
s_waitcnt lgkmcnt(8)
ra 32,7,36864
mvaa 44,48,56
ra 68,7,45056
mvaa 44,12,20
s_waitcnt lgkmcnt(8)
mvaa 48,16,20
s_waitcnt lgkmcnt(6)
mvaa 48,52,56
s_waitcnt lgkmcnt(4)
mvaa 52,36,60
mvaa 52,0,24
mvaa 52,108,132
mvaa 52,72,96
mvaa 56,76,96
mvaa 56,112,132
cv 176,32,33
mvaa 56,4,24
cv 177,34,35
mvaa 56,40,60
cv 178,36,37
mvaa 60,44,60
buffer_store_dwordx4 v[176:179], v0, s[52:55], s85 offen offset:0 sc1
mvaa 60,8,24
cv 180,38,39
mvaa 60,116,132
cv 181,40,41
mvaa 60,80,96
cv 182,42,43
mvaa 64,84,96
buffer_store_dwordx4 v[180:183], v0, s[52:55], s85 offen offset:1024 sc1
mvaa 64,120,132
cv 184,44,45
mvaa 64,12,24
cv 185,46,47
mvaa 64,48,60
cv 186,48,49
mvaa 68,52,60
buffer_store_dwordx4 v[184:187], v0, s[52:55], s85 offen offset:2048 sc1
mvaa 68,16,24
cv 188,50,51
mvaa 68,124,132
buffer_store_dwordx2 v[188:189], v139, s[52:55], s85 offen offset:3072 sc1
mvaa 68,88,96
mvaa 72,72,100
mvaa 72,108,136
s_waitcnt lgkmcnt(3)
mvaa 72,0,28
s_waitcnt lgkmcnt(2)
mvaa 72,36,64
mvaa 76,40,64
mvaa 76,4,28
cv 192,52,53
mvaa 76,112,136
cv 193,54,55
mvaa 76,76,100
cv 194,56,57
mvaa 80,80,100
buffer_store_dwordx4 v[192:195], v0, s[52:55], s86 offen offset:0 sc1
mvaa 80,116,136
cv 196,58,59
mvaa 80,8,28
cv 197,60,61
mvaa 80,44,64
cv 198,62,63
mvaa 84,48,64
buffer_store_dwordx4 v[196:199], v0, s[52:55], s86 offen offset:1024 sc1
mvaa 84,12,28
cv 200,64,65
mvaa 84,120,136
cv 201,66,67
mvaa 84,84,100
cv 202,68,69
mvaa 88,88,100
buffer_store_dwordx4 v[200:203], v0, s[52:55], s86 offen offset:2048 sc1
mvaa 88,124,136
cv 204,70,71
mvaa 88,16,28
buffer_store_dwordx2 v[204:205], v139, s[52:55], s86 offen offset:3072 sc1
mvaa 88,52,64
s_waitcnt lgkmcnt(0)
mvaa 92,36,68
mvaa 92,0,32
mvaa 92,108,140
mvaa 92,72,104
mvaa 96,76,104
mvaa 96,112,140
cv 208,72,73
mvaa 96,4,32
buffer_store_dword v23, v132, s[52:55], s10 offen sc1
cv 209,74,75
mvaa 96,40,68
cv 210,76,77
mvaa 100,44,68
buffer_store_dwordx4 v[208:211], v0, s[52:55], s87 offen offset:0 sc1
mvaa 100,8,32
cv 212,78,79
mvaa 100,116,140
cv 213,80,81
mvaa 100,80,104
cv 214,82,83
mvaa 104,84,104
buffer_store_dwordx4 v[212:215], v0, s[52:55], s87 offen offset:1024 sc1
mvaa 104,120,140
cv 216,84,85
mvaa 104,12,32
cv 217,86,87
mvaa 104,48,68
cv 218,88,89
mvaa 108,52,68
buffer_store_dwordx4 v[216:219], v0, s[52:55], s87 offen offset:2048 sc1
mvaa 108,16,32
cv 220,90,91
mvaa 108,124,140
buffer_store_dwordx2 v[220:221], v139, s[52:55], s87 offen offset:3072 sc1
mvaa 108,88,104
s_nop 3
s_waitcnt vmcnt(13)
v_lshlrev_b32 v134, 16, v112
v_and_b32 v135, 0xffff0000, v112
v_lshlrev_b32 v136, 16, v122
v_and_b32 v137, 0xffff0000, v122
v_pk_add_f32 v[134:135], v[134:135], v[136:137]
v_pk_add_f32 v[92:93], v[92:93], v[134:135]
v_lshlrev_b32 v134, 16, v113
v_and_b32 v135, 0xffff0000, v113
v_lshlrev_b32 v136, 16, v123
v_and_b32 v137, 0xffff0000, v123
v_pk_add_f32 v[134:135], v[134:135], v[136:137]
v_pk_add_f32 v[94:95], v[94:95], v[134:135]
v_lshlrev_b32 v134, 16, v114
v_and_b32 v135, 0xffff0000, v114
v_lshlrev_b32 v136, 16, v124
v_and_b32 v137, 0xffff0000, v124
v_pk_add_f32 v[134:135], v[134:135], v[136:137]
v_pk_add_f32 v[96:97], v[96:97], v[134:135]
v_lshlrev_b32 v134, 16, v115
v_and_b32 v135, 0xffff0000, v115
v_lshlrev_b32 v136, 16, v125
v_and_b32 v137, 0xffff0000, v125
v_pk_add_f32 v[134:135], v[134:135], v[136:137]
v_pk_add_f32 v[98:99], v[98:99], v[134:135]
v_lshlrev_b32 v134, 16, v116
v_and_b32 v135, 0xffff0000, v116
v_lshlrev_b32 v136, 16, v126
v_and_b32 v137, 0xffff0000, v126
v_pk_add_f32 v[134:135], v[134:135], v[136:137]
v_pk_add_f32 v[100:101], v[100:101], v[134:135]
v_lshlrev_b32 v134, 16, v117
v_and_b32 v135, 0xffff0000, v117
v_lshlrev_b32 v136, 16, v127
v_and_b32 v137, 0xffff0000, v127
v_pk_add_f32 v[134:135], v[134:135], v[136:137]
v_pk_add_f32 v[102:103], v[102:103], v[134:135]
v_lshlrev_b32 v134, 16, v118
v_and_b32 v135, 0xffff0000, v118
v_lshlrev_b32 v136, 16, v128
v_and_b32 v137, 0xffff0000, v128
v_pk_add_f32 v[134:135], v[134:135], v[136:137]
v_pk_add_f32 v[104:105], v[104:105], v[134:135]
v_lshlrev_b32 v134, 16, v119
v_and_b32 v135, 0xffff0000, v119
v_lshlrev_b32 v136, 16, v129
v_and_b32 v137, 0xffff0000, v129
v_pk_add_f32 v[134:135], v[134:135], v[136:137]
v_pk_add_f32 v[106:107], v[106:107], v[134:135]
v_lshlrev_b32 v134, 16, v120
v_and_b32 v135, 0xffff0000, v120
v_lshlrev_b32 v136, 16, v130
v_and_b32 v137, 0xffff0000, v130
v_pk_add_f32 v[134:135], v[134:135], v[136:137]
v_pk_add_f32 v[108:109], v[108:109], v[134:135]
v_lshlrev_b32 v134, 16, v121
v_and_b32 v135, 0xffff0000, v121
v_lshlrev_b32 v136, 16, v131
v_and_b32 v137, 0xffff0000, v131
v_pk_add_f32 v[134:135], v[134:135], v[136:137]
v_pk_add_f32 v[110:111], v[110:111], v[134:135]
s_mov_b32 s62, 1000000
L_p5hint:
buffer_load_dword v20, v133, s[52:55], s72 offen sc1
s_waitcnt vmcnt(0)
v_cmp_ne_u32 vcc, s88, v20
s_cbranch_vccz L_p5hint_ok
s_sub_u32 s62, s62, 1
s_cmp_eq_u32 s62, 0
s_cbranch_scc1 L_p5hint_ok
s_sleep 8
s_branch L_p5hint
L_p5hint_ok:
buffer_load_dwordx4 v[224:227], v0, s[52:55], s12 offen offset:0 sc1
buffer_load_dwordx4 v[228:231], v0, s[52:55], s12 offen offset:1024 sc1
buffer_load_dwordx4 v[232:235], v0, s[52:55], s12 offen offset:2048 sc1
buffer_load_dwordx2 v[236:237], v139, s[52:55], s12 offen offset:3072 sc1
buffer_load_dwordx4 v[240:243], v0, s[52:55], s13 offen offset:0 sc1
buffer_load_dwordx4 v[244:247], v0, s[52:55], s13 offen offset:1024 sc1
buffer_load_dwordx4 v[248:251], v0, s[52:55], s13 offen offset:2048 sc1
buffer_load_dwordx2 v[252:253], v139, s[52:55], s13 offen offset:3072 sc1
buffer_load_dwordx4 v[140:143], v0, s[52:55], s14 offen offset:0 sc1
buffer_load_dwordx4 v[144:147], v0, s[52:55], s14 offen offset:1024 sc1
buffer_load_dwordx4 v[148:151], v0, s[52:55], s14 offen offset:2048 sc1
buffer_load_dwordx2 v[152:153], v139, s[52:55], s14 offen offset:3072 sc1
s_waitcnt vmcnt(0)
v_max3_u32 v134, v227, v231, v235
v_max3_u32 v134, v134, v237, v243
v_max3_u32 v134, v134, v247, v251
v_max3_u32 v134, v134, v253, v143
v_max3_u32 v134, v134, v147, v151
v_max3_u32 v134, v134, v153, v153
v_min3_u32 v135, v227, v231, v235
v_min3_u32 v135, v135, v237, v243
v_min3_u32 v135, v135, v247, v251
v_min3_u32 v135, v135, v253, v143
v_min3_u32 v135, v135, v147, v151
v_min3_u32 v135, v135, v153, v153
v_xor_b32 v134, s88, v134
v_xor_b32 v135, s88, v135
v_or_b32 v134, v134, v135
v_cmp_ne_u32 vcc, 0, v134
s_cbranch_vccz L_p5x_ok
s_mov_b32 s62, 1000000
L_p5x:
buffer_load_dwordx4 v[224:227], v0, s[52:55], s12 offen offset:0 sc1
buffer_load_dwordx4 v[228:231], v0, s[52:55], s12 offen offset:1024 sc1
buffer_load_dwordx4 v[232:235], v0, s[52:55], s12 offen offset:2048 sc1
buffer_load_dwordx2 v[236:237], v139, s[52:55], s12 offen offset:3072 sc1
buffer_load_dwordx4 v[240:243], v0, s[52:55], s13 offen offset:0 sc1
buffer_load_dwordx4 v[244:247], v0, s[52:55], s13 offen offset:1024 sc1
buffer_load_dwordx4 v[248:251], v0, s[52:55], s13 offen offset:2048 sc1
buffer_load_dwordx2 v[252:253], v139, s[52:55], s13 offen offset:3072 sc1
buffer_load_dwordx4 v[140:143], v0, s[52:55], s14 offen offset:0 sc1
buffer_load_dwordx4 v[144:147], v0, s[52:55], s14 offen offset:1024 sc1
buffer_load_dwordx4 v[148:151], v0, s[52:55], s14 offen offset:2048 sc1
buffer_load_dwordx2 v[152:153], v139, s[52:55], s14 offen offset:3072 sc1
s_waitcnt vmcnt(0)
v_max3_u32 v134, v227, v231, v235
v_max3_u32 v134, v134, v237, v243
v_max3_u32 v134, v134, v247, v251
v_max3_u32 v134, v134, v253, v143
v_max3_u32 v134, v134, v147, v151
v_max3_u32 v134, v134, v153, v153
v_min3_u32 v135, v227, v231, v235
v_min3_u32 v135, v135, v237, v243
v_min3_u32 v135, v135, v247, v251
v_min3_u32 v135, v135, v253, v143
v_min3_u32 v135, v135, v147, v151
v_min3_u32 v135, v135, v153, v153
v_xor_b32 v134, s88, v134
v_xor_b32 v135, s88, v135
v_or_b32 v134, v134, v135
v_cmp_ne_u32 vcc, 0, v134
s_cbranch_vccz L_p5x_ok
s_sub_u32 s62, s62, 1
s_cmp_eq_u32 s62, 0
s_cbranch_scc1 L_p5x_ok
s_sleep 1
s_branch L_p5x
L_p5x_ok:
s_cmp_eq_u32 s2, 0
s_cselect_b32 s56, 88080384, 0
s_cmp_eq_u32 s56, 0
s_cselect_b32 s56, 94371840, s56
buffer_store_dword v23, v21, s[52:55], s56 offen sc1
v_lshlrev_b32 v134, 16, v224
v_and_b32 v135, 0xffff0000, v224
v_pk_add_f32 v[92:93], v[92:93], v[134:135]
v_lshlrev_b32 v136, 16, v240
v_and_b32 v137, 0xffff0000, v240
v_pk_add_f32 v[92:93], v[92:93], v[136:137]
v_lshlrev_b32 v134, 16, v140
v_and_b32 v135, 0xffff0000, v140
v_pk_add_f32 v[92:93], v[92:93], v[134:135]
cv 112,92,93
v_lshlrev_b32 v134, 16, v225
v_and_b32 v135, 0xffff0000, v225
v_pk_add_f32 v[94:95], v[94:95], v[134:135]
v_lshlrev_b32 v136, 16, v241
v_and_b32 v137, 0xffff0000, v241
v_pk_add_f32 v[94:95], v[94:95], v[136:137]
v_lshlrev_b32 v134, 16, v141
v_and_b32 v135, 0xffff0000, v141
v_pk_add_f32 v[94:95], v[94:95], v[134:135]
cv 113,94,95
v_lshlrev_b32 v134, 16, v226
v_and_b32 v135, 0xffff0000, v226
v_pk_add_f32 v[96:97], v[96:97], v[134:135]
v_lshlrev_b32 v136, 16, v242
v_and_b32 v137, 0xffff0000, v242
v_pk_add_f32 v[96:97], v[96:97], v[136:137]
v_lshlrev_b32 v134, 16, v142
v_and_b32 v135, 0xffff0000, v142
v_pk_add_f32 v[96:97], v[96:97], v[134:135]
cv 114,96,97
v_lshlrev_b32 v134, 16, v228
v_and_b32 v135, 0xffff0000, v228
v_pk_add_f32 v[98:99], v[98:99], v[134:135]
v_lshlrev_b32 v136, 16, v244
v_and_b32 v137, 0xffff0000, v244
v_pk_add_f32 v[98:99], v[98:99], v[136:137]
v_lshlrev_b32 v134, 16, v144
v_and_b32 v135, 0xffff0000, v144
v_pk_add_f32 v[98:99], v[98:99], v[134:135]
cv 115,98,99
s_nop 1
v_permlane16_swap_b32 v112, v114
v_permlane16_swap_b32 v113, v115
buffer_store_dwordx4 v[112:115], v154, s[36:39], s70 offen offset:0
v_lshlrev_b32 v134, 16, v229
v_and_b32 v135, 0xffff0000, v229
v_pk_add_f32 v[100:101], v[100:101], v[134:135]
v_lshlrev_b32 v136, 16, v245
v_and_b32 v137, 0xffff0000, v245
v_pk_add_f32 v[100:101], v[100:101], v[136:137]
v_lshlrev_b32 v134, 16, v145
v_and_b32 v135, 0xffff0000, v145
v_pk_add_f32 v[100:101], v[100:101], v[134:135]
cv 116,100,101
v_lshlrev_b32 v134, 16, v230
v_and_b32 v135, 0xffff0000, v230
v_pk_add_f32 v[102:103], v[102:103], v[134:135]
v_lshlrev_b32 v136, 16, v246
v_and_b32 v137, 0xffff0000, v246
v_pk_add_f32 v[102:103], v[102:103], v[136:137]
v_lshlrev_b32 v134, 16, v146
v_and_b32 v135, 0xffff0000, v146
v_pk_add_f32 v[102:103], v[102:103], v[134:135]
cv 117,102,103
v_lshlrev_b32 v134, 16, v232
v_and_b32 v135, 0xffff0000, v232
v_pk_add_f32 v[104:105], v[104:105], v[134:135]
v_lshlrev_b32 v136, 16, v248
v_and_b32 v137, 0xffff0000, v248
v_pk_add_f32 v[104:105], v[104:105], v[136:137]
v_lshlrev_b32 v134, 16, v148
v_and_b32 v135, 0xffff0000, v148
v_pk_add_f32 v[104:105], v[104:105], v[134:135]
cv 118,104,105
v_lshlrev_b32 v134, 16, v233
v_and_b32 v135, 0xffff0000, v233
v_pk_add_f32 v[106:107], v[106:107], v[134:135]
v_lshlrev_b32 v136, 16, v249
v_and_b32 v137, 0xffff0000, v249
v_pk_add_f32 v[106:107], v[106:107], v[136:137]
v_lshlrev_b32 v134, 16, v149
v_and_b32 v135, 0xffff0000, v149
v_pk_add_f32 v[106:107], v[106:107], v[134:135]
cv 119,106,107
s_nop 1
v_permlane16_swap_b32 v116, v118
v_permlane16_swap_b32 v117, v119
buffer_store_dwordx4 v[116:119], v154, s[36:39], s70 offen offset:64
v_lshlrev_b32 v134, 16, v234
v_and_b32 v135, 0xffff0000, v234
v_pk_add_f32 v[108:109], v[108:109], v[134:135]
v_lshlrev_b32 v136, 16, v250
v_and_b32 v137, 0xffff0000, v250
v_pk_add_f32 v[108:109], v[108:109], v[136:137]
v_lshlrev_b32 v134, 16, v150
v_and_b32 v135, 0xffff0000, v150
v_pk_add_f32 v[108:109], v[108:109], v[134:135]
cv 120,108,109
HS_b_4:
s_cmp_eq_u32 s7, 1
s_cbranch_scc1 HOP_b_ret
v_lshlrev_b32 v134, 16, v236
v_and_b32 v135, 0xffff0000, v236
v_pk_add_f32 v[110:111], v[110:111], v[134:135]
v_lshlrev_b32 v136, 16, v252
v_and_b32 v137, 0xffff0000, v252
v_pk_add_f32 v[110:111], v[110:111], v[136:137]
v_lshlrev_b32 v134, 16, v152
v_and_b32 v135, 0xffff0000, v152
v_pk_add_f32 v[110:111], v[110:111], v[134:135]
cv 121,110,111
buffer_store_dwordx2 v[120:121], v28, s[36:39], s70 offen offset:128
L_exit:
s_endpgm
L_qhNK:
L_qhNV:
zvav 96,0,224
s_waitcnt lgkmcnt(7)
ta 16,4,49152
ar 26,42
ar 27,43
mvav 96,4,240
s_waitcnt lgkmcnt(5)
s_mov_b32 s57, 1048576
s_add_u32 m0, s66, 12288
cv 29,26,27
s_add_u32 s63, s70, 8192
ar 24,44
zvav 128,4,244
dma 18,36,57,0
ta 18,4,50176
ar 25,45
cv 30,24,25
mvav 128,0,228
ar 26,46
ar 27,47
zvav 160,0,232
s_waitcnt lgkmcnt(5)
ta 20,4,61440
cv 31,26,27
mvav 160,4,248
s_waitcnt lgkmcnt(3)
dma 19,36,57,1024
zvav 192,4,252
ta 22,4,62464
buffer_store_dwordx4 v[28:31], v0, s[52:55], s63 offen offset:1024 sc1
mvav 192,0,236
s_mov_b32 s57, 1310720
s_add_u32 m0, s66, 0
ar 24,48
ar 25,49
zvav 100,8,224
dma 18,36,57,0
ta 0,5,49152
cv 28,24,25
ar 26,50
mvav 100,12,240
ar 27,51
cv 29,26,27
zvav 132,12,244
ta 2,5,50176
s_add_u32 s63, s70, 16384
ar 24,52
ar 25,53
mvav 132,8,228
dma 19,36,57,1024
cv 30,24,25
ar 26,54
zvav 164,8,232
ta 4,5,61440
ar 27,55
cv 31,26,27
mvav 164,12,248
buffer_store_dwordx4 v[28:31], v0, s[52:55], s63 offen offset:1024 sc1
zvav 196,12,252
ta 6,5,62464
ar 24,56
ar 25,57
mvav 196,8,236
s_waitcnt lgkmcnt(6)
cv 28,24,25
ar 26,58
zvav 104,16,224
s_waitcnt lgkmcnt(4)
ta 8,6,49152
ar 27,59
cv 29,26,27
mvav 104,20,240
s_add_u32 s63, s70, 24576
ar 24,60
ar 25,61
zvav 136,20,244
ta 10,6,50176
cv 30,24,25
ar 26,62
mvav 136,16,228
ar 27,63
cv 31,26,27
zvav 168,16,232
ta 12,6,61440
buffer_store_dwordx4 v[28:31], v0, s[52:55], s63 offen offset:1024 sc1
mvav 168,20,248
s_mov_b32 s56, 69632
ar 24,64
ar 25,65
zvav 200,20,252
buffer_load_dwordx4 a[32:35], v14, s[52:55], s56 offen offset:0
ta 14,6,62464
cv 28,24,25
ar 26,66
mvav 200,16,236
s_waitcnt lgkmcnt(6)
ar 27,67
cv 29,26,27
zvav 108,0,224
s_waitcnt lgkmcnt(4)
ta 16,7,49152
s_add_u32 s63, s70, 0
ar 24,68
ar 25,69
mvav 108,4,240
buffer_load_dwordx4 a[36:39], v15, s[52:55], s56 offen offset:1024
cv 30,24,25
ar 26,70
zvav 140,4,244
ta 18,7,50176
ar 27,71
cv 31,26,27
mvav 140,0,228
buffer_store_dwordx4 v[28:31], v0, s[52:55], s63 offen offset:2048 sc1
zvav 172,0,232
buffer_load_dwordx4 a[40:43], v16, s[52:55], s56 offen offset:2048
ta 20,7,61440
ar 24,72
ar 25,73
mvav 172,4,248
cv 28,24,25
ar 26,74
zvav 204,4,252
ta 22,7,62464
ar 27,75
cv 29,26,27
mvav 204,0,236
s_waitcnt lgkmcnt(6)
buffer_load_dwordx4 a[44:47], v17, s[52:55], s56 offen offset:3072
s_add_u32 s63, s70, 8192
ar 24,76
ar 25,77
zvav 112,8,224
s_waitcnt lgkmcnt(4)
ta 0,8,49152
cv 30,24,25
ar 26,78
mvav 112,12,240
s_mov_b32 s56, 70656
ar 27,79
cv 31,26,27
zvav 144,12,244
buffer_load_dwordx4 a[48:51], v14, s[52:55], s56 offen offset:0
ta 2,8,50176
mvav 144,8,228
buffer_store_dwordx4 v[28:31], v0, s[52:55], s63 offen offset:2048 sc1
zvav 176,8,232
ta 4,8,61440
ar 24,80
ar 25,81
mvav 176,12,248
buffer_load_dwordx4 a[52:55], v15, s[52:55], s56 offen offset:1024
cv 28,24,25
ar 26,82
zvav 208,12,252
ta 6,8,62464
ar 27,83
cv 29,26,27
mvav 208,8,236
s_waitcnt lgkmcnt(6)
s_add_u32 s63, s70, 16384
ar 24,84
ar 25,85
zvav 116,16,224
s_waitcnt lgkmcnt(4)
buffer_load_dwordx4 a[56:59], v16, s[52:55], s56 offen offset:2048
ta 8,9,49152
cv 30,24,25
ar 26,86
mvav 116,20,240
ar 27,87
cv 31,26,27
zvav 148,20,244
ta 10,9,50176
buffer_store_dwordx4 v[28:31], v0, s[52:55], s63 offen offset:2048 sc1
mvav 148,16,228
buffer_load_dwordx4 a[60:63], v17, s[52:55], s56 offen offset:3072
ar 24,88
ar 25,89
zvav 180,16,232
ta 12,9,61440
cv 28,24,25
ar 26,90
mvav 180,20,248
ar 27,91
cv 29,26,27
zvav 212,20,252
ta 14,9,62464
s_add_u32 s63, s70, 24576
ar 24,92
ar 25,93
mvav 212,16,236
s_waitcnt lgkmcnt(6)
s_waitcnt vmcnt(23) lgkmcnt(0)
s_barrier
cv 30,24,25
ar 26,94
zvav 120,0,224
ta 16,2,36864
ar 27,95
cv 31,26,27
mvav 120,4,240
s_mov_b32 s57, 1572864
s_add_u32 m0, s66, 49152
buffer_store_dwordx4 v[28:31], v0, s[52:55], s63 offen offset:2048 sc1
zvav 152,4,244
dma 18,36,57,0
ta 18,2,37888
ar 24,96
ar 25,97
mvav 152,0,228
cv 28,24,25
ar 26,98
zvav 184,0,232
ta 20,2,24576
ar 27,99
cv 29,26,27
mvav 184,4,248
s_add_u32 s63, s70, 0
ar 24,100
ar 25,101
zvav 216,4,252
dma 19,36,57,1024
ta 22,2,25600
cv 30,24,25
ar 26,102
mvav 216,0,236
ar 27,103
cv 31,26,27
zvav 124,8,224
ta 0,3,36864
rv 224,1,32768
buffer_store_dwordx4 v[28:31], v0, s[52:55], s63 offen offset:3072 sc1
mvav 124,12,240
s_mov_b32 s57, 1835008
s_add_u32 m0, s66, 61440
rv 240,1,49152
ar 24,104
ar 25,105
zvav 156,12,244
dma 18,36,57,0
ta 2,3,37888
rv 244,1,50176
cv 28,24,25
ar 26,106
mvav 156,8,228
rv 228,1,33792
ar 27,107
cv 29,26,27
zvav 188,8,232
ta 4,3,24576
rv 232,1,34816
s_add_u32 s63, s70, 8192
ar 24,108
ar 25,109
mvav 188,12,248
rv 248,1,51200
cv 30,24,25
ar 26,110
zvav 220,12,252
dma 19,36,57,1024
ta 6,3,25600
rv 252,1,52224
ar 27,111
cv 31,26,27
mvav 220,8,236
s_waitcnt lgkmcnt(9)
rv 236,1,35840
buffer_store_dwordx4 v[28:31], v0, s[52:55], s63 offen offset:3072 sc1
mvav 96,16,224
s_waitcnt lgkmcnt(9)
ta 8,4,36864
ar 24,112
ar 25,113
mvav 96,20,240
s_waitcnt lgkmcnt(8)
cv 28,24,25
ar 26,114
mvav 128,20,244
s_waitcnt lgkmcnt(7)
ta 10,4,37888
ar 27,115
cv 29,26,27
mvav 128,16,228
s_waitcnt lgkmcnt(6)
s_add_u32 s63, s70, 16384
ar 24,116
ar 25,117
mvav 160,16,232
s_waitcnt lgkmcnt(5)
ta 12,4,24576
cv 30,24,25
ar 26,118
mvav 160,20,248
s_waitcnt lgkmcnt(4)
ar 27,119
cv 31,26,27
mvav 192,20,252
s_waitcnt lgkmcnt(3)
ta 14,4,25600
buffer_store_dwordx4 v[28:31], v0, s[52:55], s63 offen offset:3072 sc1
mvav 192,16,236
ar 24,120
ar 25,121
mvav 100,0,224
ta 16,5,36864
cv 28,24,25
ar 26,122
mvav 100,4,240
ar 27,123
cv 29,26,27
mvav 132,4,244
ta 18,5,37888
s_add_u32 s63, s70, 24576
ar 24,124
ar 25,125
mvav 132,0,228
cv 30,24,25
ar 26,126
mvav 164,0,232
ta 20,5,24576
ar 27,127
cv 31,26,27
mvav 164,4,248
buffer_store_dwordx4 v[28:31], v0, s[52:55], s63 offen offset:3072 sc1
mvav 196,4,252
ta 22,5,25600
ar 24,128
ar 25,129
mvav 196,0,236
s_waitcnt lgkmcnt(6)
cv 28,24,25
ar 26,130
mvav 104,8,224
s_waitcnt lgkmcnt(4)
ta 0,6,36864
ar 27,131
cv 29,26,27
mvav 104,12,240
s_add_u32 s63, s70, 4096
ar 24,132
ar 25,133
mvav 136,12,244
ta 2,6,37888
cv 30,24,25
ar 26,134
mvav 136,8,228
ar 27,135
cv 31,26,27
mvav 168,8,232
ta 4,6,24576
buffer_store_dwordx4 v[28:31], v0, s[52:55], s63 offen offset:0 sc1
mvav 168,12,248
s_mov_b32 s56, 71680
ar 24,136
ar 25,137
mvav 200,12,252
buffer_load_dwordx4 a[64:67], v14, s[52:55], s56 offen offset:0
ta 6,6,25600
cv 28,24,25
ar 26,138
mvav 200,8,236
s_waitcnt lgkmcnt(6)
ar 27,139
cv 29,26,27
mvav 108,16,224
s_waitcnt lgkmcnt(4)
ta 8,7,36864
s_add_u32 s63, s70, 12288
ar 24,140
ar 25,141
mvav 108,20,240
buffer_load_dwordx4 a[68:71], v15, s[52:55], s56 offen offset:1024
cv 30,24,25
ar 26,142
mvav 140,20,244
ta 10,7,37888
ar 27,143
cv 31,26,27
mvav 140,16,228
buffer_store_dwordx4 v[28:31], v0, s[52:55], s63 offen offset:0 sc1
mvav 172,16,232
buffer_load_dwordx4 a[72:75], v16, s[52:55], s56 offen offset:2048
ta 12,7,24576
ar 24,144
ar 25,145
mvav 172,20,248
cv 28,24,25
ar 26,146
mvav 204,20,252
ta 14,7,25600
ar 27,147
cv 29,26,27
mvav 204,16,236
s_waitcnt lgkmcnt(6)
buffer_load_dwordx4 a[76:79], v17, s[52:55], s56 offen offset:3072
s_add_u32 s63, s70, 20480
ar 24,148
ar 25,149
mvav 112,0,224
s_waitcnt lgkmcnt(4)
ta 16,8,36864
cv 30,24,25
ar 26,150
mvav 112,4,240
s_mov_b32 s56, 72704
ar 27,151
cv 31,26,27
mvav 144,4,244
buffer_load_dwordx4 a[80:83], v14, s[52:55], s56 offen offset:0
ta 18,8,37888
mvav 144,0,228
buffer_store_dwordx4 v[28:31], v0, s[52:55], s63 offen offset:0 sc1
mvav 176,0,232
ta 20,8,24576
ar 24,152
ar 25,153
mvav 176,4,248
buffer_load_dwordx4 a[84:87], v15, s[52:55], s56 offen offset:1024
cv 28,24,25
ar 26,154
mvav 208,4,252
ta 22,8,25600
ar 27,155
cv 29,26,27
mvav 208,0,236
s_waitcnt lgkmcnt(6)
s_add_u32 s63, s70, 28672
ar 24,156
ar 25,157
mvav 116,8,224
s_waitcnt lgkmcnt(4)
buffer_load_dwordx4 a[88:91], v16, s[52:55], s56 offen offset:2048
ta 0,9,36864
cv 30,24,25
ar 26,158
mvav 116,12,240
ar 27,159
cv 31,26,27
mvav 148,12,244
ta 2,9,37888
buffer_store_dwordx4 v[28:31], v0, s[52:55], s63 offen offset:0 sc1
mvav 148,8,228
buffer_load_dwordx4 a[92:95], v17, s[52:55], s56 offen offset:3072
ar 24,160
ar 25,161
mvav 180,8,232
ta 4,9,24576
cv 28,24,25
ar 26,162
mvav 180,12,248
ar 27,163
cv 29,26,27
mvav 212,12,252
ta 6,9,25600
s_add_u32 s63, s70, 4096
ar 24,164
ar 25,165
mvav 212,8,236
s_waitcnt lgkmcnt(6)
s_waitcnt vmcnt(34) lgkmcnt(0)
s_barrier
cv 30,24,25
ar 26,166
mvav 120,16,224
ta 8,2,12288
ar 27,167
cv 31,26,27
mvav 120,20,240
s_mov_b32 s57, 2097152
s_add_u32 m0, s66, 36864
buffer_store_dwordx4 v[28:31], v0, s[52:55], s63 offen offset:1024 sc1
mvav 152,20,244
dma 18,36,57,0
ta 10,2,13312
ar 24,168
ar 25,169
mvav 152,16,228
cv 28,24,25
ar 26,170
mvav 184,16,232
ta 12,2,0
ar 27,171
cv 29,26,27
mvav 184,20,248
s_add_u32 s63, s70, 12288
ar 24,172
ar 25,173
mvav 216,20,252
dma 19,36,57,1024
ta 14,2,1024
cv 30,24,25
ar 26,174
mvav 216,16,236
ar 27,175
cv 31,26,27
mvav 124,0,224
ta 16,3,12288
buffer_store_dwordx4 v[28:31], v0, s[52:55], s63 offen offset:1024 sc1
mvav 124,4,240
s_mov_b32 s57, 2359296
s_add_u32 m0, s66, 24576
ar 24,176
ar 25,177
mvav 156,4,244
dma 18,36,57,0
ta 18,3,13312
cv 28,24,25
ar 26,178
mvav 156,0,228
ar 27,179
cv 29,26,27
mvav 188,0,232
ta 20,3,0
s_add_u32 s63, s70, 20480
ar 24,180
ar 25,181
mvav 188,4,248
cv 30,24,25
ar 26,182
mvav 220,4,252
dma 19,36,57,1024
ta 22,3,1024
ar 27,183
cv 31,26,27
mvav 220,0,236
s_waitcnt vmcnt(37) lgkmcnt(6)
buffer_store_dwordx4 v[28:31], v0, s[52:55], s63 offen offset:1024 sc1
mvaa 96,8,32
s_waitcnt vmcnt(33) lgkmcnt(4)
ta 0,4,12288
ar 24,184
ar 25,185
mvaa 96,12,48
s_waitcnt vmcnt(31)
cv 28,24,25
ar 26,186
mvaa 128,12,52
ta 2,4,13312
ar 27,187
cv 29,26,27
mvaa 128,8,36
s_add_u32 s63, s70, 28672
ar 24,188
ar 25,189
mvaa 160,8,40
s_waitcnt vmcnt(30)
ta 4,4,0
cv 30,24,25
ar 26,190
mvaa 160,12,56
s_waitcnt vmcnt(28)
ar 27,191
cv 31,26,27
mvaa 192,12,60
ta 6,4,1024
buffer_store_dwordx4 v[28:31], v0, s[52:55], s63 offen offset:1024 sc1
mvaa 192,8,44
s_waitcnt lgkmcnt(6)
ar 24,192
ar 25,193
mvaa 100,16,32
s_waitcnt lgkmcnt(4)
ta 8,5,12288
cv 28,24,25
ar 26,194
mvaa 100,20,48
ar 27,195
cv 29,26,27
mvaa 132,20,52
ta 10,5,13312
s_add_u32 s63, s70, 4096
ar 24,196
ar 25,197
mvaa 132,16,36
cv 30,24,25
ar 26,198
mvaa 164,16,40
ta 12,5,0
ar 27,199
cv 31,26,27
mvaa 164,20,56
buffer_store_dwordx4 v[28:31], v0, s[52:55], s63 offen offset:2048 sc1
mvaa 196,20,60
ta 14,5,1024
ar 24,200
ar 25,201
mvaa 196,16,44
s_waitcnt lgkmcnt(6)
cv 28,24,25
ar 26,202
mvaa 104,0,32
s_waitcnt lgkmcnt(4)
ta 16,6,12288
ar 27,203
cv 29,26,27
mvaa 104,4,48
s_add_u32 s63, s70, 12288
ar 24,204
ar 25,205
mvaa 136,4,52
ta 18,6,13312
cv 30,24,25
ar 26,206
mvaa 136,0,36
ar 27,207
cv 31,26,27
mvaa 168,0,40
ta 20,6,0
buffer_store_dwordx4 v[28:31], v0, s[52:55], s63 offen offset:2048 sc1
mvaa 168,4,56
s_mov_b32 s56, 73728
ar 24,208
ar 25,209
mvaa 200,4,60
buffer_load_dwordx4 a[96:99], v14, s[52:55], s56 offen offset:0
ta 22,6,1024
cv 28,24,25
ar 26,210
mvaa 200,0,44
s_waitcnt lgkmcnt(6)
ar 27,211
cv 29,26,27
mvaa 108,8,32
s_waitcnt lgkmcnt(4)
ta 0,7,12288
s_add_u32 s63, s70, 20480
ar 24,212
ar 25,213
mvaa 108,12,48
buffer_load_dwordx4 a[100:103], v15, s[52:55], s56 offen offset:1024
cv 30,24,25
ar 26,214
mvaa 140,12,52
ta 2,7,13312
ar 27,215
cv 31,26,27
mvaa 140,8,36
buffer_store_dwordx4 v[28:31], v0, s[52:55], s63 offen offset:2048 sc1
mvaa 172,8,40
buffer_load_dwordx4 a[104:107], v16, s[52:55], s56 offen offset:2048
ta 4,7,0
ar 24,216
ar 25,217
mvaa 172,12,56
cv 28,24,25
ar 26,218
mvaa 204,12,60
ta 6,7,1024
ar 27,219
cv 29,26,27
mvaa 204,8,44
s_waitcnt lgkmcnt(6)
buffer_load_dwordx4 a[108:111], v17, s[52:55], s56 offen offset:3072
s_add_u32 s63, s70, 28672
ar 24,220
ar 25,221
mvaa 112,16,32
s_waitcnt lgkmcnt(4)
ta 8,8,12288
cv 30,24,25
ar 26,222
mvaa 112,20,48
s_mov_b32 s56, 74752
ar 27,223
cv 31,26,27
mvaa 144,20,52
buffer_load_dwordx4 a[112:115], v14, s[52:55], s56 offen offset:0
ta 10,8,13312
mvaa 144,16,36
buffer_store_dwordx4 v[28:31], v0, s[52:55], s63 offen offset:2048 sc1
mvaa 176,16,40
ta 12,8,0
ar 24,224
ar 25,225
mvaa 176,20,56
buffer_load_dwordx4 a[116:119], v15, s[52:55], s56 offen offset:1024
cv 28,24,25
ar 26,226
mvaa 208,20,60
ta 14,8,1024
ar 27,227
cv 29,26,27
mvaa 208,16,44
s_waitcnt lgkmcnt(6)
s_add_u32 s63, s70, 4096
ar 24,228
ar 25,229
mvaa 116,0,32
s_waitcnt lgkmcnt(4)
buffer_load_dwordx4 a[120:123], v16, s[52:55], s56 offen offset:2048
ta 16,9,12288
cv 30,24,25
ar 26,230
mvaa 116,4,48
ar 27,231
cv 31,26,27
mvaa 148,4,52
ta 18,9,13312
buffer_store_dwordx4 v[28:31], v0, s[52:55], s63 offen offset:3072 sc1
mvaa 148,0,36
buffer_load_dwordx4 a[124:127], v17, s[52:55], s56 offen offset:3072
ar 24,232
ar 25,233
mvaa 180,0,40
ta 20,9,0
cv 28,24,25
ar 26,234
mvaa 180,4,56
ar 27,235
cv 29,26,27
mvaa 212,4,60
ta 22,9,1024
s_add_u32 s63, s70, 12288
ar 24,236
ar 25,237
mvaa 212,0,44
s_waitcnt lgkmcnt(6)
s_waitcnt vmcnt(36) lgkmcnt(0)
s_barrier
cv 30,24,25
ar 26,238
mvaa 120,8,32
ta 0,2,49152
ar 27,239
cv 31,26,27
mvaa 120,12,48
s_mov_b32 s57, 2621440
s_add_u32 m0, s66, 12288
buffer_store_dwordx4 v[28:31], v0, s[52:55], s63 offen offset:3072 sc1
mvaa 152,12,52
dma 18,36,57,0
ta 2,2,50176
ar 24,240
ar 25,241
mvaa 152,8,36
cv 28,24,25
ar 26,242
mvaa 184,8,40
ta 4,2,61440
ar 27,243
cv 29,26,27
mvaa 184,12,56
s_add_u32 s63, s70, 20480
ar 24,244
ar 25,245
mvaa 216,12,60
dma 19,36,57,1024
ta 6,2,62464
cv 30,24,25
ar 26,246
mvaa 216,8,44
ar 27,247
cv 31,26,27
mvaa 124,16,32
ta 8,3,49152
buffer_store_dwordx4 v[28:31], v0, s[52:55], s63 offen offset:3072 sc1
mvaa 124,20,48
s_mov_b32 s57, 2883584
s_add_u32 m0, s66, 0
ar 24,248
ar 25,249
mvaa 156,20,52
dma 18,36,57,0
ta 10,3,50176
cv 28,24,25
ar 26,250
mvaa 156,16,36
ar 27,251
cv 29,26,27
mvaa 188,16,40
ta 12,3,61440
s_add_u32 s63, s70, 28672
ar 24,252
ar 25,253
mvaa 188,20,56
cv 30,24,25
ar 26,254
mvaa 220,20,60
dma 19,36,57,1024
ta 14,3,62464
ar 27,255
cv 31,26,27
mvaa 220,16,44
s_waitcnt vmcnt(37) lgkmcnt(6)
buffer_store_dwordx4 v[28:31], v0, s[52:55], s63 offen offset:3072 sc1
mvaa 96,0,64
s_waitcnt vmcnt(33) lgkmcnt(4)
ta 16,4,49152
mvaa 96,4,80
s_waitcnt vmcnt(31)
mvaa 128,4,84
ta 18,4,50176
mvaa 128,0,68
mvaa 160,0,72
s_waitcnt vmcnt(30)
ta 20,4,61440
mvaa 160,4,88
s_waitcnt vmcnt(28)
mvaa 192,4,92
ta 22,4,62464
mvaa 192,0,76
s_waitcnt lgkmcnt(6)
mvaa 100,8,64
s_waitcnt lgkmcnt(4)
ta 0,5,49152
mvaa 100,12,80
mvaa 132,12,84
ta 2,5,50176
mvaa 132,8,68
mvaa 164,8,72
ta 4,5,61440
mvaa 164,12,88
mvaa 196,12,92
ta 6,5,62464
mvaa 196,8,76
s_waitcnt lgkmcnt(6)
mvaa 104,16,64
s_waitcnt lgkmcnt(4)
ta 8,6,49152
mvaa 104,20,80
mvaa 136,20,84
ta 10,6,50176
mvaa 136,16,68
mvaa 168,16,72
ta 12,6,61440
mvaa 168,20,88
s_mov_b32 s56, 75776
mvaa 200,20,92
buffer_load_dwordx4 a[32:35], v14, s[52:55], s56 offen offset:0
ta 14,6,62464
mvaa 200,16,76
s_waitcnt lgkmcnt(6)
mvaa 108,0,64
s_waitcnt lgkmcnt(4)
ta 16,7,49152
mvaa 108,4,80
buffer_load_dwordx4 a[36:39], v15, s[52:55], s56 offen offset:1024
mvaa 140,4,84
ta 18,7,50176
mvaa 140,0,68
mvaa 172,0,72
buffer_load_dwordx4 a[40:43], v16, s[52:55], s56 offen offset:2048
ta 20,7,61440
mvaa 172,4,88
mvaa 204,4,92
ta 22,7,62464
mvaa 204,0,76
s_waitcnt lgkmcnt(6)
buffer_load_dwordx4 a[44:47], v17, s[52:55], s56 offen offset:3072
mvaa 112,8,64
s_waitcnt lgkmcnt(4)
ta 0,8,49152
mvaa 112,12,80
s_mov_b32 s56, 76800
mvaa 144,12,84
buffer_load_dwordx4 a[48:51], v14, s[52:55], s56 offen offset:0
ta 2,8,50176
mvaa 144,8,68
mvaa 176,8,72
ta 4,8,61440
mvaa 176,12,88
buffer_load_dwordx4 a[52:55], v15, s[52:55], s56 offen offset:1024
mvaa 208,12,92
ta 6,8,62464
mvaa 208,8,76
s_waitcnt lgkmcnt(6)
mvaa 116,16,64
s_waitcnt lgkmcnt(4)
buffer_load_dwordx4 a[56:59], v16, s[52:55], s56 offen offset:2048
ta 8,9,49152
mvaa 116,20,80
mvaa 148,20,84
ta 10,9,50176
mvaa 148,16,68
buffer_load_dwordx4 a[60:63], v17, s[52:55], s56 offen offset:3072
mvaa 180,16,72
ta 12,9,61440
mvaa 180,20,88
mvaa 212,20,92
ta 14,9,62464
mvaa 212,16,76
s_waitcnt lgkmcnt(6)
s_waitcnt vmcnt(30) lgkmcnt(0)
s_barrier
mvaa 120,0,64
ta 16,2,36864
mvaa 120,4,80
s_mov_b32 s57, 3145728
s_add_u32 m0, s66, 49152
mvaa 152,4,84
dma 18,36,57,0
ta 18,2,37888
mvaa 152,0,68
mvaa 184,0,72
ta 20,2,24576
mvaa 184,4,88
mvaa 216,4,92
dma 19,36,57,1024
ta 22,2,25600
mvaa 216,0,76
mvaa 124,8,64
ta 0,3,36864
mvaa 124,12,80
s_mov_b32 s57, 3407872
s_add_u32 m0, s66, 61440
mvaa 156,12,84
dma 18,36,57,0
ta 2,3,37888
mvaa 156,8,68
mvaa 188,8,72
ta 4,3,24576
mvaa 188,12,88
mvaa 220,12,92
dma 19,36,57,1024
ta 6,3,25600
mvaa 220,8,76
s_waitcnt vmcnt(29) lgkmcnt(6)
mvaa 96,16,96
s_waitcnt vmcnt(24) lgkmcnt(4)
ta 8,4,36864
mvaa 96,20,112
s_waitcnt vmcnt(22)
mvaa 128,20,116
ta 10,4,37888
mvaa 128,16,100
mvaa 160,16,104
s_waitcnt vmcnt(21)
ta 12,4,24576
mvaa 160,20,120
s_waitcnt vmcnt(19)
mvaa 192,20,124
ta 14,4,25600
mvaa 192,16,108
s_waitcnt lgkmcnt(6)
mvaa 100,0,96
s_waitcnt lgkmcnt(4)
ta 16,5,36864
mvaa 100,4,112
mvaa 132,4,116
ta 18,5,37888
mvaa 132,0,100
mvaa 164,0,104
ta 20,5,24576
mvaa 164,4,120
mvaa 196,4,124
ta 22,5,25600
mvaa 196,0,108
s_waitcnt lgkmcnt(6)
mvaa 104,8,96
s_waitcnt lgkmcnt(4)
ta 0,6,36864
mvaa 104,12,112
mvaa 136,12,116
ta 2,6,37888
mvaa 136,8,100
mvaa 168,8,104
ta 4,6,24576
mvaa 168,12,120
s_mov_b32 s56, 77824
mvaa 200,12,124
buffer_load_dwordx4 a[64:67], v14, s[52:55], s56 offen offset:0
ta 6,6,25600
mvaa 200,8,108
s_waitcnt lgkmcnt(6)
mvaa 108,16,96
s_waitcnt lgkmcnt(4)
ta 8,7,36864
mvaa 108,20,112
buffer_load_dwordx4 a[68:71], v15, s[52:55], s56 offen offset:1024
mvaa 140,20,116
ta 10,7,37888
mvaa 140,16,100
mvaa 172,16,104
buffer_load_dwordx4 a[72:75], v16, s[52:55], s56 offen offset:2048
ta 12,7,24576
mvaa 172,20,120
mvaa 204,20,124
ta 14,7,25600
mvaa 204,16,108
s_waitcnt lgkmcnt(6)
buffer_load_dwordx4 a[76:79], v17, s[52:55], s56 offen offset:3072
mvaa 112,0,96
s_waitcnt lgkmcnt(4)
ta 16,8,36864
mvaa 112,4,112
s_mov_b32 s56, 78848
mvaa 144,4,116
buffer_load_dwordx4 a[80:83], v14, s[52:55], s56 offen offset:0
ta 18,8,37888
mvaa 144,0,100
mvaa 176,0,104
ta 20,8,24576
mvaa 176,4,120
buffer_load_dwordx4 a[84:87], v15, s[52:55], s56 offen offset:1024
mvaa 208,4,124
ta 22,8,25600
mvaa 208,0,108
s_waitcnt lgkmcnt(6)
mvaa 116,8,96
s_waitcnt lgkmcnt(4)
buffer_load_dwordx4 a[88:91], v16, s[52:55], s56 offen offset:2048
ta 0,9,36864
mvaa 116,12,112
mvaa 148,12,116
ta 2,9,37888
mvaa 148,8,100
buffer_load_dwordx4 a[92:95], v17, s[52:55], s56 offen offset:3072
mvaa 180,8,104
ta 4,9,24576
mvaa 180,12,120
mvaa 212,12,124
ta 6,9,25600
mvaa 212,8,108
s_waitcnt lgkmcnt(6)
s_waitcnt vmcnt(21) lgkmcnt(0)
s_barrier
mvaa 120,16,96
ta 8,2,12288
mvaa 120,20,112
s_mov_b32 s57, 3670016
s_add_u32 m0, s66, 36864
mvaa 152,20,116
dma 18,36,57,0
ta 10,2,13312
mvaa 152,16,100
mvaa 184,16,104
ta 12,2,0
mvaa 184,20,120
mvaa 216,20,124
dma 19,36,57,1024
ta 14,2,1024
mvaa 216,16,108
mvaa 124,0,96
ta 16,3,12288
mvaa 124,4,112
s_mov_b32 s57, 3932160
s_add_u32 m0, s66, 24576
mvaa 156,4,116
dma 18,36,57,0
ta 18,3,13312
mvaa 156,0,100
mvaa 188,0,104
ta 20,3,0
mvaa 188,4,120
mvaa 220,4,124
dma 19,36,57,1024
ta 22,3,1024
mvaa 220,0,108
s_waitcnt vmcnt(23) lgkmcnt(6)
mvaa 96,8,32
s_waitcnt vmcnt(19) lgkmcnt(4)
ta 0,4,12288
mvaa 96,12,48
s_waitcnt vmcnt(18)
mvaa 128,12,52
ta 2,4,13312
mvaa 128,8,36
mvaa 160,8,40
s_waitcnt vmcnt(17)
ta 4,4,0
mvaa 160,12,56
s_waitcnt vmcnt(16)
mvaa 192,12,60
ta 6,4,1024
mvaa 192,8,44
s_waitcnt lgkmcnt(6)
mvaa 100,16,32
s_waitcnt lgkmcnt(4)
ta 8,5,12288
mvaa 100,20,48
mvaa 132,20,52
ta 10,5,13312
mvaa 132,16,36
mvaa 164,16,40
ta 12,5,0
mvaa 164,20,56
mvaa 196,20,60
ta 14,5,1024
mvaa 196,16,44
s_waitcnt lgkmcnt(6)
mvaa 104,0,32
s_waitcnt lgkmcnt(4)
ta 16,6,12288
mvaa 104,4,48
mvaa 136,4,52
ta 18,6,13312
mvaa 136,0,36
mvaa 168,0,40
ta 20,6,0
mvaa 168,4,56
s_mov_b32 s56, 79872
mvaa 200,4,60
buffer_load_dwordx4 a[96:99], v14, s[52:55], s56 offen offset:0
ta 22,6,1024
mvaa 200,0,44
s_waitcnt lgkmcnt(6)
mvaa 108,8,32
s_waitcnt lgkmcnt(4)
ta 0,7,12288
mvaa 108,12,48
buffer_load_dwordx4 a[100:103], v15, s[52:55], s56 offen offset:1024
mvaa 140,12,52
ta 2,7,13312
mvaa 140,8,36
mvaa 172,8,40
buffer_load_dwordx4 a[104:107], v16, s[52:55], s56 offen offset:2048
ta 4,7,0
mvaa 172,12,56
mvaa 204,12,60
ta 6,7,1024
mvaa 204,8,44
s_waitcnt lgkmcnt(6)
buffer_load_dwordx4 a[108:111], v17, s[52:55], s56 offen offset:3072
mvaa 112,16,32
s_waitcnt lgkmcnt(4)
ta 8,8,12288
mvaa 112,20,48
s_mov_b32 s56, 80896
mvaa 144,20,52
buffer_load_dwordx4 a[112:115], v14, s[52:55], s56 offen offset:0
ta 10,8,13312
mvaa 144,16,36
mvaa 176,16,40
ta 12,8,0
mvaa 176,20,56
buffer_load_dwordx4 a[116:119], v15, s[52:55], s56 offen offset:1024
mvaa 208,20,60
ta 14,8,1024
mvaa 208,16,44
s_waitcnt lgkmcnt(6)
mvaa 116,0,32
s_waitcnt lgkmcnt(4)
buffer_load_dwordx4 a[120:123], v16, s[52:55], s56 offen offset:2048
ta 16,9,12288
mvaa 116,4,48
mvaa 148,4,52
ta 18,9,13312
mvaa 148,0,36
buffer_load_dwordx4 a[124:127], v17, s[52:55], s56 offen offset:3072
mvaa 180,0,40
ta 20,9,0
mvaa 180,4,56
mvaa 212,4,60
ta 22,9,1024
mvaa 212,0,44
s_waitcnt lgkmcnt(6)
s_waitcnt vmcnt(20) lgkmcnt(0)
s_barrier
mvaa 120,8,32
ta 0,2,49152
mvaa 120,12,48
s_mov_b32 s57, 4194304
s_add_u32 m0, s66, 12288
mvaa 152,12,52
dma 18,36,57,0
ta 2,2,50176
mvaa 152,8,36
mvaa 184,8,40
ta 4,2,61440
mvaa 184,12,56
mvaa 216,12,60
dma 19,36,57,1024
ta 6,2,62464
mvaa 216,8,44
mvaa 124,16,32
ta 8,3,49152
mvaa 124,20,48
s_mov_b32 s57, 4456448
s_add_u32 m0, s66, 0
mvaa 156,20,52
dma 18,36,57,0
ta 10,3,50176
mvaa 156,16,36
mvaa 188,16,40
ta 12,3,61440
mvaa 188,20,56
mvaa 220,20,60
dma 19,36,57,1024
ta 14,3,62464
mvaa 220,16,44
s_waitcnt vmcnt(23) lgkmcnt(6)
mvaa 96,0,64
s_waitcnt vmcnt(19) lgkmcnt(4)
ta 16,4,49152
mvaa 96,4,80
s_waitcnt vmcnt(18)
mvaa 128,4,84
ta 18,4,50176
mvaa 128,0,68
mvaa 160,0,72
s_waitcnt vmcnt(17)
ta 20,4,61440
mvaa 160,4,88
s_waitcnt vmcnt(16)
mvaa 192,4,92
ta 22,4,62464
mvaa 192,0,76
s_waitcnt lgkmcnt(6)
mvaa 100,8,64
s_waitcnt lgkmcnt(4)
ta 0,5,49152
mvaa 100,12,80
mvaa 132,12,84
ta 2,5,50176
mvaa 132,8,68
mvaa 164,8,72
ta 4,5,61440
mvaa 164,12,88
mvaa 196,12,92
ta 6,5,62464
mvaa 196,8,76
s_waitcnt lgkmcnt(6)
mvaa 104,16,64
s_waitcnt lgkmcnt(4)
ta 8,6,49152
mvaa 104,20,80
mvaa 136,20,84
ta 10,6,50176
mvaa 136,16,68
mvaa 168,16,72
ta 12,6,61440
mvaa 168,20,88
s_mov_b32 s56, 81920
mvaa 200,20,92
buffer_load_dwordx4 a[32:35], v14, s[52:55], s56 offen offset:0
ta 14,6,62464
mvaa 200,16,76
s_waitcnt lgkmcnt(6)
mvaa 108,0,64
s_waitcnt lgkmcnt(4)
ta 16,7,49152
mvaa 108,4,80
buffer_load_dwordx4 a[36:39], v15, s[52:55], s56 offen offset:1024
mvaa 140,4,84
ta 18,7,50176
mvaa 140,0,68
mvaa 172,0,72
buffer_load_dwordx4 a[40:43], v16, s[52:55], s56 offen offset:2048
ta 20,7,61440
mvaa 172,4,88
mvaa 204,4,92
ta 22,7,62464
mvaa 204,0,76
s_waitcnt lgkmcnt(6)
buffer_load_dwordx4 a[44:47], v17, s[52:55], s56 offen offset:3072
mvaa 112,8,64
s_waitcnt lgkmcnt(4)
ta 0,8,49152
mvaa 112,12,80
s_mov_b32 s56, 82944
mvaa 144,12,84
buffer_load_dwordx4 a[48:51], v14, s[52:55], s56 offen offset:0
ta 2,8,50176
mvaa 144,8,68
mvaa 176,8,72
ta 4,8,61440
mvaa 176,12,88
buffer_load_dwordx4 a[52:55], v15, s[52:55], s56 offen offset:1024
mvaa 208,12,92
ta 6,8,62464
mvaa 208,8,76
s_waitcnt lgkmcnt(6)
mvaa 116,16,64
s_waitcnt lgkmcnt(4)
buffer_load_dwordx4 a[56:59], v16, s[52:55], s56 offen offset:2048
ta 8,9,49152
mvaa 116,20,80
mvaa 148,20,84
ta 10,9,50176
mvaa 148,16,68
buffer_load_dwordx4 a[60:63], v17, s[52:55], s56 offen offset:3072
mvaa 180,16,72
ta 12,9,61440
mvaa 180,20,88
mvaa 212,20,92
ta 14,9,62464
mvaa 212,16,76
s_waitcnt lgkmcnt(6)
s_waitcnt vmcnt(20) lgkmcnt(0)
s_barrier
mvaa 120,0,64
ta 16,2,36864
mvaa 120,4,80
s_mov_b32 s57, 4718592
s_add_u32 m0, s66, 49152
mvaa 152,4,84
dma 18,36,57,0
ta 18,2,37888
mvaa 152,0,68
mvaa 184,0,72
ta 20,2,24576
mvaa 184,4,88
mvaa 216,4,92
dma 19,36,57,1024
ta 22,2,25600
mvaa 216,0,76
mvaa 124,8,64
ta 0,3,36864
mvaa 124,12,80
s_mov_b32 s57, 4980736
s_add_u32 m0, s66, 61440
mvaa 156,12,84
dma 18,36,57,0
ta 2,3,37888
mvaa 156,8,68
mvaa 188,8,72
ta 4,3,24576
mvaa 188,12,88
mvaa 220,12,92
dma 19,36,57,1024
ta 6,3,25600
mvaa 220,8,76
s_waitcnt vmcnt(23) lgkmcnt(6)
mvaa 96,16,96
s_waitcnt vmcnt(19) lgkmcnt(4)
ta 8,4,36864
mvaa 96,20,112
s_waitcnt vmcnt(18)
mvaa 128,20,116
ta 10,4,37888
mvaa 128,16,100
mvaa 160,16,104
s_waitcnt vmcnt(17)
ta 12,4,24576
mvaa 160,20,120
s_waitcnt vmcnt(16)
mvaa 192,20,124
ta 14,4,25600
mvaa 192,16,108
s_waitcnt lgkmcnt(6)
mvaa 100,0,96
s_waitcnt lgkmcnt(4)
ta 16,5,36864
mvaa 100,4,112
mvaa 132,4,116
ta 18,5,37888
mvaa 132,0,100
mvaa 164,0,104
ta 20,5,24576
mvaa 164,4,120
mvaa 196,4,124
ta 22,5,25600
mvaa 196,0,108
s_waitcnt lgkmcnt(6)
mvaa 104,8,96
s_waitcnt lgkmcnt(4)
ta 0,6,36864
mvaa 104,12,112
mvaa 136,12,116
ta 2,6,37888
mvaa 136,8,100
mvaa 168,8,104
ta 4,6,24576
mvaa 168,12,120
s_mov_b32 s56, 83968
mvaa 200,12,124
buffer_load_dwordx4 a[64:67], v14, s[52:55], s56 offen offset:0
ta 6,6,25600
mvaa 200,8,108
s_waitcnt lgkmcnt(6)
mvaa 108,16,96
s_waitcnt lgkmcnt(4)
ta 8,7,36864
mvaa 108,20,112
buffer_load_dwordx4 a[68:71], v15, s[52:55], s56 offen offset:1024
mvaa 140,20,116
ta 10,7,37888
mvaa 140,16,100
mvaa 172,16,104
buffer_load_dwordx4 a[72:75], v16, s[52:55], s56 offen offset:2048
ta 12,7,24576
mvaa 172,20,120
mvaa 204,20,124
ta 14,7,25600
mvaa 204,16,108
s_waitcnt lgkmcnt(6)
buffer_load_dwordx4 a[76:79], v17, s[52:55], s56 offen offset:3072
mvaa 112,0,96
s_waitcnt lgkmcnt(4)
ta 16,8,36864
mvaa 112,4,112
s_mov_b32 s56, 84992
mvaa 144,4,116
buffer_load_dwordx4 a[80:83], v14, s[52:55], s56 offen offset:0
ta 18,8,37888
mvaa 144,0,100
mvaa 176,0,104
ta 20,8,24576
mvaa 176,4,120
buffer_load_dwordx4 a[84:87], v15, s[52:55], s56 offen offset:1024
mvaa 208,4,124
ta 22,8,25600
mvaa 208,0,108
s_waitcnt lgkmcnt(6)
mvaa 116,8,96
s_waitcnt lgkmcnt(4)
buffer_load_dwordx4 a[88:91], v16, s[52:55], s56 offen offset:2048
ta 0,9,36864
mvaa 116,12,112
mvaa 148,12,116
ta 2,9,37888
mvaa 148,8,100
buffer_load_dwordx4 a[92:95], v17, s[52:55], s56 offen offset:3072
mvaa 180,8,104
ta 4,9,24576
mvaa 180,12,120
mvaa 212,12,124
ta 6,9,25600
mvaa 212,8,108
s_waitcnt lgkmcnt(6)
s_waitcnt vmcnt(20) lgkmcnt(0)
s_barrier
mvaa 120,16,96
ta 8,2,12288
mvaa 120,20,112
buffer_store_dword v23, v21, s[52:55], s72 offen sc1
mvaa 152,20,116
ta 10,2,13312
mvaa 152,16,100
mvaa 184,16,104
ta 12,2,0
mvaa 184,20,120
mvaa 216,20,124
ta 14,2,1024
mvaa 216,16,108
mvaa 124,0,96
ta 16,3,12288
mvaa 124,4,112
mvaa 156,4,116
ta 18,3,13312
mvaa 156,0,100
mvaa 188,0,104
ta 20,3,0
mvaa 188,4,120
mvaa 220,4,124
ta 22,3,1024
mvaa 220,0,108
s_waitcnt vmcnt(20) lgkmcnt(6)
mvaa 96,8,32
s_waitcnt vmcnt(16) lgkmcnt(4)
ta 0,4,12288
mvaa 96,12,48
s_waitcnt vmcnt(15)
mvaa 128,12,52
s_mul_i32 s60, s4, 524288
s_add_u32 s61, s60, 4194304
s_add_u32 s44, s34, s61
s_addc_u32 s45, s35, 0
s_and_b32 s45, s45, 0xffff
s_sub_u32 s46, 16, s5
s_lshl_b32 s46, s46, 15
s_mov_b32 s47, 0x20000
ta 2,4,13312
mvaa 128,8,36
mvaa 160,8,40
s_waitcnt vmcnt(14)
ta 4,4,0
mvaa 160,12,56
s_waitcnt vmcnt(13)
mvaa 192,12,60
s_add_u32 s61, s60, 22020096
s_add_u32 s48, s34, s61
s_addc_u32 s49, s35, 0
s_and_b32 s49, s49, 0xffff
s_mov_b32 s50, s46
s_mov_b32 s51, 0x20000
ta 6,4,1024
mvaa 192,8,44
s_waitcnt lgkmcnt(6)
mvaa 100,16,32
s_waitcnt lgkmcnt(4)
ta 8,5,12288
mvaa 100,20,48
mvaa 132,20,52
s_mov_b32 s76, 0
s_mov_b32 s77, 0
s_lshl_b32 s78, s3, 12
s_add_u32 s79, s78, 0x10000
s_mul_i32 s83, s4, 1024
s_add_u32 s83, s83, 88145920
ta 10,5,13312
mvaa 132,16,36
mvaa 164,16,40
ta 12,5,0
mvaa 164,20,56
mvaa 196,20,60
s_mov_b32 s74, 94371840
s_mov_b32 s75, 94371840
ta 14,5,1024
mvaa 196,16,44
s_waitcnt lgkmcnt(6)
mvaa 104,0,32
s_waitcnt lgkmcnt(4)
ta 16,6,12288
mvaa 104,4,48
mvaa 136,4,52
ta 18,6,13312
mvaa 136,0,36
mvaa 168,0,40
ta 20,6,0
mvaa 168,4,56
mvaa 200,4,60
ta 22,6,1024
mvaa 200,0,44
s_waitcnt lgkmcnt(6)
mvaa 108,8,32
s_waitcnt lgkmcnt(4)
ta 0,7,12288
mvaa 108,12,48
mvaa 140,12,52
ta 2,7,13312
mvaa 140,8,36
mvaa 172,8,40
ta 4,7,0
mvaa 172,12,56
mvaa 204,12,60
ta 6,7,1024
mvaa 204,8,44
s_waitcnt lgkmcnt(6)
mvaa 112,16,32
s_waitcnt lgkmcnt(4)
ta 8,8,12288
mvaa 112,20,48
mvaa 144,20,52
ta 10,8,13312
mvaa 144,16,36
mvaa 176,16,40
ta 12,8,0
mvaa 176,20,56
mvaa 208,20,60
ta 14,8,1024
mvaa 208,16,44
s_waitcnt lgkmcnt(6)
mvaa 116,0,32
s_waitcnt lgkmcnt(4)
ta 16,9,12288
mvaa 116,4,48
mvaa 148,4,52
ta 18,9,13312
mvaa 148,0,36
mvaa 180,0,40
ta 20,9,0
mvaa 180,4,56
mvaa 212,4,60
ta 22,9,1024
mvaa 212,0,44
s_waitcnt lgkmcnt(6)
s_waitcnt vmcnt(9) lgkmcnt(0)
s_barrier
mvaa 120,8,32
ta 0,2,49152
mvaa 120,12,48
mvaa 152,12,52
ta 2,2,50176
mvaa 152,8,36
mvaa 184,8,40
ta 4,2,61440
mvaa 184,12,56
mvaa 216,12,60
ta 6,2,62464
mvaa 216,8,44
mvaa 124,16,32
ta 8,3,49152
mvaa 124,20,48
mvaa 156,20,52
ta 10,3,50176
mvaa 156,16,36
mvaa 188,16,40
ta 12,3,61440
mvaa 188,20,56
mvaa 220,20,60
ta 14,3,62464
mvaa 220,16,44
s_waitcnt vmcnt(8) lgkmcnt(6)
mvaa 96,0,64
s_waitcnt vmcnt(4) lgkmcnt(4)
ta 16,4,49152
mvaa 96,4,80
s_waitcnt vmcnt(3)
mvaa 128,4,84
ta 18,4,50176
mvaa 128,0,68
mvaa 160,0,72
s_waitcnt vmcnt(2)
ta 20,4,61440
mvaa 160,4,88
s_waitcnt vmcnt(1)
mvaa 192,4,92
ta 22,4,62464
mvaa 192,0,76
s_waitcnt lgkmcnt(6)
mvaa 100,8,64
s_waitcnt lgkmcnt(4)
ta 0,5,49152
mvaa 100,12,80
mvaa 132,12,84
ta 2,5,50176
mvaa 132,8,68
mvaa 164,8,72
ta 4,5,61440
mvaa 164,12,88
mvaa 196,12,92
ta 6,5,62464
mvaa 196,8,76
s_waitcnt lgkmcnt(6)
mvaa 104,16,64
s_waitcnt lgkmcnt(4)
ta 8,6,49152
mvaa 104,20,80
mvaa 136,20,84
ta 10,6,50176
mvaa 136,16,68
mvaa 168,16,72
ta 12,6,61440
mvaa 168,20,88
mvaa 200,20,92
ta 14,6,62464
mvaa 200,16,76
s_waitcnt lgkmcnt(6)
mvaa 108,0,64
s_waitcnt lgkmcnt(4)
ta 16,7,49152
mvaa 108,4,80
mvaa 140,4,84
ta 18,7,50176
mvaa 140,0,68
mvaa 172,0,72
ta 20,7,61440
mvaa 172,4,88
mvaa 204,4,92
ta 22,7,62464
mvaa 204,0,76
s_waitcnt lgkmcnt(6)
mvaa 112,8,64
s_waitcnt lgkmcnt(4)
ta 0,8,49152
mvaa 112,12,80
mvaa 144,12,84
ta 2,8,50176
v_lshlrev_b32 v24, 3, v0
mvaa 144,8,68
mvaa 176,8,72
ta 4,8,61440
mvaa 176,12,88
mvaa 208,12,92
ta 6,8,62464
v_and_b32 v24, 896, v24
mvaa 208,8,76
s_waitcnt lgkmcnt(6)
mvaa 116,16,64
s_waitcnt lgkmcnt(4)
ta 8,9,49152
mvaa 116,20,80
mvaa 148,20,84
ta 10,9,50176
mvaa 148,16,68
mvaa 180,16,72
ta 12,9,61440
mvaa 180,20,88
mvaa 212,20,92
ta 14,9,62464
mvaa 212,16,76
s_waitcnt lgkmcnt(6)
mvaa 120,0,64
s_waitcnt lgkmcnt(4)
mvaa 120,4,80
mvaa 152,4,84
mvaa 152,0,68
mvaa 184,0,72
mvaa 184,4,88
mvaa 216,4,92
mvaa 216,0,76
s_waitcnt lgkmcnt(2)
mvaa 124,8,64
s_waitcnt lgkmcnt(0)
mvaa 124,12,80
mvaa 156,12,84
mvaa 156,8,68
mvaa 188,8,72
mvaa 188,12,88
mvaa 220,12,92
mvaa 220,8,76
buffer_load_dword v25, v24, s[52:55], s83 offen sc1
s_lshl_b32 s58, s4, 15
s_lshl_b32 s60, s3, 10
s_add_u32 s58, s58, s60
s_add_u32 s58, s58, 48234496
s_lshl_b32 s94, s5, 20
s_add_u32 s94, s94, s58
s_sub_u32 s95, 15, s5
s_lshl_b32 s95, s95, 20
s_add_u32 s95, s95, s58
s_mov_b32 s90, 0x53800000
s_and_b32 s58, s3, 1
s_lshl_b32 s89, s58, 13
s_xor_b32 s60, s3, 1
s_lshl_b32 s58, s58, 1
s_sub_i32 s61, s3, 0
s_cmp_eq_u32 s61, 0
s_cselect_b32 s10, 1.0, 0
s_cmp_lt_i32 s61, 0
s_cselect_b32 s11, 0xf149f2ca, 0
s_sub_i32 s61, s3, 1
s_cmp_eq_u32 s61, 0
s_cselect_b32 s12, 1.0, 0
s_cmp_lt_i32 s61, 0
s_cselect_b32 s13, 0xf149f2ca, 0
s_sub_i32 s61, s3, 2
s_cmp_eq_u32 s61, 0
s_cselect_b32 s14, 1.0, 0
s_cmp_lt_i32 s61, 0
s_cselect_b32 s15, 0xf149f2ca, 0
s_sub_i32 s61, s3, 3
s_cmp_eq_u32 s61, 0
s_cselect_b32 s16, 1.0, 0
s_cmp_lt_i32 s61, 0
s_cselect_b32 s17, 0xf149f2ca, 0
s_sub_i32 s61, s3, s58
s_sub_i32 s61, s61, 0
s_cmp_eq_u32 s61, 0
s_cselect_b32 s20, 1.0, 0
s_cmp_lt_i32 s61, 0
s_cselect_b32 s21, 0xf149f2ca, 0
s_sub_i32 s61, s3, s58
s_sub_i32 s61, s61, 1
s_cmp_eq_u32 s61, 0
s_cselect_b32 s22, 1.0, 0
s_cmp_lt_i32 s61, 0
s_cselect_b32 s23, 0xf149f2ca, 0
s_sub_i32 s61, s60, s58
s_sub_i32 s61, s61, 0
s_cmp_eq_u32 s61, 0
s_cselect_b32 s24, 1.0, 0
s_cmp_lt_i32 s61, 0
s_cselect_b32 s25, 0xf149f2ca, 0
s_sub_i32 s61, s60, s58
s_sub_i32 s61, s61, 1
s_cmp_eq_u32 s61, 0
s_cselect_b32 s32, 1.0, 0
s_cmp_lt_i32 s61, 0
s_cselect_b32 s33, 0xf149f2ca, 0
s_mov_b32 s36, s18
s_and_b32 s37, s19, 0xffff
s_mov_b32 s38, 5242880
s_mov_b32 s39, 0x20000
s_mov_b32 s40, s26
s_and_b32 s41, s27, 0xffff
s_mov_b32 s42, 2211840
s_mov_b32 s43, 0x20000
v_lshrrev_b32 v28, 4, v0
s_lshl_b32 s58, s2, 2
s_add_u32 s58, s58, s3
s_mul_i32 s60, s58, 40
v_min_u32 v19, 39, v28
v_add_u32 v19, s60, v19
v_lshlrev_b32 v19, 7, v19
s_mul_i32 s60, s58, 17
v_min_u32 v20, 16, v28
v_add_u32 v20, s60, v20
v_lshlrev_b32 v20, 7, v20
s_lshr_b32 s56, s6, 2
s_lshl_b32 s56, s56, 3
s_lshr_b32 s58, s2, 3
s_and_b32 s58, s58, 7
s_add_u32 s56, s56, s58
s_lshr_b32 s57, s2, 6
s_and_b32 s65, s6, 3
s_sub_u32 s60, 15, s56
s_min_u32 s58, s56, s60
s_mul_i32 s58, s58, 4096
s_add_u32 s80, s58, 88178688
s_mul_i32 s60, s65, 1024
s_add_u32 s81, s58, s60
s_add_u32 s81, s81, 88211456
s_cmp_eq_u32 s3, 0
s_cselect_b32 s80, s80, 94371840
s_cselect_b32 s81, s81, 94371840
s_mul_i32 s4, s56, 442368
s_add_u32 s4, s4, 39845888
s_lshl_b32 s6, s56, 20
s_add_u32 s6, s6, 48234496
s_lshl_b32 s58, s3, 12
s_lshr_b32 s66, s65, 1
s_mul_i32 s66, s66, 28
s_and_b32 s68, s65, 1
s_mul_i32 s68, s68, 14
s_add_u32 s68, s68, s66
s_lshl_b32 s66, s68, 13
s_add_u32 s66, s66, s58
s_lshl_b32 s67, s65, 18
s_add_u32 s67, s67, s58
s_mul_i32 s82, s3, 5120
s_add_u32 s82, s82, 16384
s_mul_i32 s58, s3, 20480
s_mul_i32 s84, s57, 320
s_add_u32 s58, s58, s84
s_mul_i32 s68, s68, 40960
s_add_u32 s68, s68, s58
s_mul_i32 s69, s65, 1310720
s_add_u32 s69, s69, s58
v_add_u32 v26, 0, v28
v_mul_u32_u24 v27, 3277, v26
v_lshrrev_b32 v27, 16, v27
v_mul_u32_u24 v29, 20, v27
v_sub_u32 v26, v26, v29
v_lshrrev_b32 v29, 1, v27
v_and_b32 v29, 2, v29
v_xor_b32 v26, v26, v29
v_mul_u32_u24 v27, 1280, v27
v_lshl_add_u32 v14, v26, 4, v27
v_add_u32 v26, 64, v28
v_mul_u32_u24 v27, 3277, v26
v_lshrrev_b32 v27, 16, v27
v_mul_u32_u24 v29, 20, v27
v_sub_u32 v26, v26, v29
v_lshrrev_b32 v29, 1, v27
v_and_b32 v29, 2, v29
v_xor_b32 v26, v26, v29
v_mul_u32_u24 v27, 1280, v27
v_lshl_add_u32 v15, v26, 4, v27
v_subrev_u32 v15, 1024, v15
v_add_u32 v26, 128, v28
v_mul_u32_u24 v27, 3277, v26
v_lshrrev_b32 v27, 16, v27
v_mul_u32_u24 v29, 20, v27
v_sub_u32 v26, v26, v29
v_lshrrev_b32 v29, 1, v27
v_and_b32 v29, 2, v29
v_xor_b32 v26, v26, v29
v_mul_u32_u24 v27, 1280, v27
v_lshl_add_u32 v16, v26, 4, v27
v_subrev_u32 v16, 2048, v16
v_add_u32 v26, 192, v28
v_mul_u32_u24 v27, 3277, v26
v_lshrrev_b32 v27, 16, v27
v_mul_u32_u24 v29, 20, v27
v_sub_u32 v26, v26, v29
v_lshrrev_b32 v29, 1, v27
v_and_b32 v29, 2, v29
v_xor_b32 v26, v26, v29
v_mul_u32_u24 v27, 1280, v27
v_lshl_add_u32 v17, v26, 4, v27
v_subrev_u32 v17, 3072, v17
v_add_u32 v26, 256, v28
v_mul_u32_u24 v27, 3277, v26
v_lshrrev_b32 v27, 16, v27
v_mul_u32_u24 v29, 20, v27
v_sub_u32 v26, v26, v29
v_lshrrev_b32 v29, 1, v27
v_and_b32 v29, 2, v29
v_xor_b32 v26, v26, v29
v_mul_u32_u24 v27, 1280, v27
v_lshl_add_u32 v18, v26, 4, v27
s_lshr_b32 s60, s3, 1
s_mul_i32 s61, s60, 160
s_add_u32 s84, s84, s61
s_add_u32 s61, s61, 16384
v_lshrrev_b32 v26, 2, v28
v_mul_u32_u24 v26, 320, v26
v_and_b32 v27, 3, v28
v_lshl_add_u32 v26, v27, 3, v26
v_add_u32 v26, s61, v26
v_lshlrev_b32 v29, 1, v28
v_and_b32 v29, 32, v29
s_cmp_eq_u32 s60, 0
s_cselect_b32 s58, 1, -1
v_mul_i32_i24 v29, s58, v29
v_sub_u32 v27, v26, v29
v_add_u32 v26, v26, v29
s_and_b32 s58, s3, 1
s_lshl_b32 s70, s56, 3
s_lshl_b32 s58, s58, 2
s_add_u32 s70, s70, s58
s_add_u32 s70, s70, s65
s_mul_i32 s70, s70, 20480
s_add_u32 s70, s70, s84
v_lshrrev_b32 v29, 4, v28
v_lshlrev_b32 v29, 3, v29
v_and_b32 v28, 15, v28
v_mul_u32_u24 v28, 1280, v28
v_add_u32 v28, v28, v29
v_lshlrev_b32 v30, 3, v0
v_and_b32 v31, 896, v30
v_and_b32 v30, 3968, v30
s_lshl_b32 s58, s56, 2
s_add_u32 s58, s58, s57
s_lshl_b32 s72, s58, 2
s_add_u32 s72, s72, s3
s_mul_i32 s72, s72, 512
s_add_u32 s72, s72, 88604672
s_mul_i32 s58, s58, 327680
s_mul_i32 s60, s3, 5120
s_add_u32 s58, s58, s60
s_add_u32 s58, s58, 66060288
s_mul_i32 s60, s65, 20480
s_add_u32 s56, s58, s60
s_lshl_b32 s60, s60, 2
s_add_u32 s64, s58, s60
s_add_u32 s58, s65, 1
s_and_b32 s58, s58, 3
s_mul_i32 s58, s58, 81920
s_add_u32 s85, s56, s58
s_add_u32 s58, s65, 2
s_and_b32 s58, s58, 3
s_mul_i32 s58, s58, 81920
s_add_u32 s86, s56, s58
s_add_u32 s58, s65, 3
s_and_b32 s58, s58, 3
s_mul_i32 s58, s58, 81920
s_add_u32 s87, s56, s58
cv 96,96,97
cv 97,98,99
cv 98,100,101
cv 99,102,103
cv 100,104,105
cv 101,106,107
cv 102,108,109
cv 103,110,111
cv 104,112,113
cv 105,114,115
cv 106,116,117
cv 107,118,119
cv 108,120,121
cv 109,122,123
cv 110,124,125
cv 111,126,127
cv 112,128,129
cv 113,130,131
cv 114,132,133
cv 115,134,135
cv 116,136,137
cv 117,138,139
cv 118,140,141
cv 119,142,143
cv 120,144,145
cv 121,146,147
cv 122,148,149
cv 123,150,151
cv 124,152,153
cv 125,154,155
cv 126,156,157
cv 127,158,159
cv 128,160,161
cv 129,162,163
cv 130,164,165
cv 131,166,167
cv 132,168,169
cv 133,170,171
cv 134,172,173
cv 135,174,175
cv 136,176,177
cv 137,178,179
cv 138,180,181
cv 139,182,183
cv 140,184,185
cv 141,186,187
cv 142,188,189
cv 143,190,191
cv 144,192,193
cv 145,194,195
cv 146,196,197
cv 147,198,199
cv 148,200,201
cv 149,202,203
cv 150,204,205
cv 151,206,207
cv 152,208,209
cv 153,210,211
cv 154,212,213
cv 155,214,215
cv 156,216,217
cv 157,218,219
cv 158,220,221
cv 159,222,223
s_waitcnt vmcnt(0)
v_cmp_ne_u32 vcc, s88, v25
s_cbranch_vccz L_skN_ok
s_mov_b32 s62, 1000000
L_skN:
buffer_load_dword v25, v24, s[52:55], s83 offen sc1
s_waitcnt vmcnt(0)
v_cmp_ne_u32 vcc, s88, v25
s_cbranch_vccz L_skN_ok
s_sub_u32 s62, s62, 1
s_cmp_eq_u32 s62, 0
s_cbranch_scc1 L_skN_ok
s_sleep 4
s_branch L_skN
L_skN_ok:
s_and_b32 s59, s76, 0xc000
s_add_u32 m0, s59, s78
v_lshrrev_b32 v89, 4, v0
dma 1,44,76,0
v_and_b32 v90, 15, v89
v_lshrrev_b32 v89, 4, v89
v_lshlrev_b32 v89, 2, v89
v_sub_u32 v89, v89, v90
v_mov_b32 v90, 0xf149f2ca
v_mov_b32 v91, 0
v_mov_b32 v2, v0
v_add_u32 v3, 0x18000, v0
dma 1,44,76,1024
v_cmp_ge_i32 vcc, 0, v89
s_nop 1
v_cndmask_b32 v48, v90, v91, vcc
v_cmp_ge_i32 vcc, -1, v89
s_nop 1
v_cndmask_b32 v49, v90, v91, vcc
v_cmp_ge_i32 vcc, -2, v89
s_nop 1
v_cndmask_b32 v50, v90, v91, vcc
v_cmp_ge_i32 vcc, -3, v89
s_nop 1
v_cndmask_b32 v51, v90, v91, vcc
dma 1,44,76,2048
s_lshl_b32 s58, s3, 13
s_add_u32 s58, s58, 0x20000
v_add_u32 v8, s58, v0
v_xor_b32 v9, 0x2000, v8
s_lshl_b32 s58, s3, 9
s_add_u32 s58, s58, 114688
v_lshrrev_b32 v12, 1, v0
v_add_u32 v12, s58, v12
dma 1,44,76,3072
s_add_u32 s76, s76, 16384
v_xor_b32 v13, 0x200, v12
s_lshr_b32 s58, s3, 1
s_mul_i32 s58, s58, 94208
s_add_u32 s58, s58, 36864
s_lshl_b32 s60, s89, 1
s_add_u32 s61, s58, s60
v_add_u32 v60, s61, v0
s_and_b32 s59, s77, 0xc000
s_add_u32 m0, s59, s79
s_xor_b32 s60, s60, 0x4000
dma 1,48,77,0
s_add_u32 s61, s58, s60
v_add_u32 v61, s61, v0
s_lshl_b32 s58, s3, 10
s_add_u32 s58, s58, 69632
v_add_u32 v62, s58, v0
v_xor_b32 v63, 0x400, v62
dma 1,48,77,1024
dma 1,48,77,2048
dma 1,48,77,3072
s_add_u32 s77, s77, 16384
s_and_b32 s59, s76, 0xc000
s_add_u32 m0, s59, s78
s_nop 0
dma 1,44,76,0
dma 1,44,76,1024
dma 1,44,76,2048
dma 1,44,76,3072
s_add_u32 s76, s76, 16384
s_and_b32 s59, s76, 0xc000
s_add_u32 m0, s59, s78
s_nop 0
dma 1,44,76,0
dma 1,44,76,1024
dma 1,44,76,2048
dma 1,44,76,3072
s_add_u32 s76, s76, 16384
s_and_b32 s59, s77, 0xc000
s_add_u32 m0, s59, s79
s_nop 0
dma 1,48,77,0
dma 1,48,77,1024
dma 1,48,77,2048
dma 1,48,77,3072
s_add_u32 s77, s77, 16384
s_and_b32 s59, s76, 0xc000
s_add_u32 m0, s59, s78
s_nop 0
dma 1,44,76,0
dma 1,44,76,1024
dma 1,44,76,2048
dma 1,44,76,3072
s_add_u32 s76, s76, 16384
s_waitcnt vmcnt(20)
s_barrier
ra 128,2,0
ra 132,2,2048
ra 136,2,4096
ra 140,2,6144
ra 144,2,1024
ra 148,2,3072
ra 152,2,5120
ra 156,2,7168
s_branch L_attn
L_fDF:
s_waitcnt lgkmcnt(4)
v_mov_b32 v67, s11
v_fma_f32 v64, v48, s10, v67
v_fma_f32 v65, v49, s10, v67
v_fma_f32 v66, v50, s10, v67
v_fma_f32 v67, v51, s10, v67
v_mov_b32 v71, s13
v_fma_f32 v68, v48, s12, v71
v_fma_f32 v69, v49, s12, v71
v_fma_f32 v70, v50, s12, v71
v_fma_f32 v71, v51, s12, v71
s_nop 1
zvav 184,128,144
mvav 184,132,148
ds_write_b128 v8, v[128:131] offset:0
mvav 184,136,152
mvav 184,140,156
zvav 176,140,140
mvav 176,136,136
ds_write_b128 v8, v[132:135] offset:1024
mvav 176,132,132
mvav 176,128,128
zvav 168,128,112
mvav 168,132,116
ds_write_b128 v8, v[136:139] offset:2048
mvav 168,136,120
mvav 168,140,124
cvav 160,140,108,64
mvav 160,136,104
ds_write_b128 v8, v[140:143] offset:3072
mvav 160,132,100
mvav 160,128,96
s_waitcnt lgkmcnt(7)
zvav 188,144,144
s_waitcnt lgkmcnt(6)
mvav 188,148,148
s_waitcnt lgkmcnt(5)
ra 128,2,8192
ds_write_b128 v8, v[144:147] offset:4096
mvav 188,152,152
s_waitcnt lgkmcnt(6)
mvav 188,156,156
ra 132,2,10240
zvav 180,156,140
mvav 180,152,136
ra 136,2,12288
ds_write_b128 v8, v[148:151] offset:5120
mvav 180,148,132
mvav 180,144,128
ra 140,2,14336
zvav 172,144,112
mvav 172,148,116
ds_write_b128 v8, v[152:155] offset:6144
mvav 172,152,120
mvav 172,156,124
cvav 164,156,108,68
mvav 164,152,104
ds_write_b128 v8, v[156:159] offset:7168
mvav 164,148,100
mvav 164,144,96
ra 144,2,9216
ra 148,2,11264
ra 152,2,13312
s_waitcnt lgkmcnt(11)
ra 156,2,15360
s_nop 7
v_max3_f32 v32, v160, v161, v162
v_max3_f32 v32, v32, v163, v164
v_max3_f32 v32, v32, v165, v166
v_max_f32 v32, v32, v167
v_max3_f32 v36, v168, v169, v170
v_max3_f32 v36, v36, v171, v172
v_max3_f32 v36, v36, v173, v174
v_max_f32 v36, v36, v175
v_max3_f32 v40, v176, v177, v178
v_max3_f32 v40, v40, v179, v180
v_max3_f32 v40, v40, v181, v182
v_max_f32 v40, v40, v183
v_max3_f32 v44, v184, v185, v186
v_max3_f32 v44, v44, v187, v188
v_max3_f32 v44, v44, v189, v190
v_max_f32 v44, v44, v191
v_mov_b32 v33, v32
v_mov_b32 v37, v36
v_mov_b32 v41, v40
v_mov_b32 v45, v44
s_nop 1
v_permlane16_swap_b32 v32, v33
v_permlane16_swap_b32 v36, v37
v_permlane16_swap_b32 v40, v41
v_permlane16_swap_b32 v44, v45
s_nop 0
v_max_f32 v32, v32, v33
v_max_f32 v36, v36, v37
v_max_f32 v40, v40, v41
v_max_f32 v44, v44, v45
v_mov_b32 v33, v32
v_mov_b32 v37, v36
v_mov_b32 v41, v40
v_mov_b32 v45, v44
s_nop 1
v_permlane32_swap_b32 v32, v33
v_permlane32_swap_b32 v36, v37
v_permlane32_swap_b32 v40, v41
v_permlane32_swap_b32 v44, v45
s_nop 0
v_max_f32 v32, v32, v33
v_max_f32 v36, v36, v37
v_max_f32 v40, v40, v41
v_max_f32 v44, v44, v45
v_sub_f32 v32, 0, v32
v_mov_b32 v33, v32
v_mov_b32 v34, v32
v_mov_b32 v35, v32
v_sub_f32 v36, 0, v36
v_mov_b32 v37, v36
v_mov_b32 v38, v36
v_mov_b32 v39, v36
v_sub_f32 v40, 0, v40
v_mov_b32 v41, v40
v_mov_b32 v42, v40
v_mov_b32 v43, v40
v_sub_f32 v44, 0, v44
v_mov_b32 v45, v44
v_mov_b32 v46, v44
v_mov_b32 v47, v44
v_mov_b32 v10, v40
v_mov_b32 v11, v44
ds_write_b64 v12, v[10:11]
v_add_f32 v184, v184, v44
v_add_f32 v185, v185, v44
v_add_f32 v186, v186, v44
v_add_f32 v187, v187, v44
v_add_f32 v188, v188, v44
v_add_f32 v189, v189, v44
v_add_f32 v190, v190, v44
v_add_f32 v191, v191, v44
v_add_f32 v176, v176, v40
v_add_f32 v177, v177, v40
v_add_f32 v178, v178, v40
v_add_f32 v179, v179, v40
v_add_f32 v180, v180, v40
v_add_f32 v181, v181, v40
v_add_f32 v182, v182, v40
v_add_f32 v183, v183, v40
v_add_f32 v168, v168, v36
v_add_f32 v169, v169, v36
v_add_f32 v170, v170, v36
v_add_f32 v171, v171, v36
v_add_f32 v172, v172, v36
v_add_f32 v173, v173, v36
v_add_f32 v174, v174, v36
v_add_f32 v175, v175, v36
v_add_f32 v160, v160, v32
v_add_f32 v161, v161, v32
v_add_f32 v162, v162, v32
v_add_f32 v163, v163, v32
v_add_f32 v164, v164, v32
v_add_f32 v165, v165, v32
v_add_f32 v166, v166, v32
v_add_f32 v167, v167, v32
v_exp_f32 v72, v184
v_exp_f32 v73, v185
s_nop 0
v_add_f32 v79, v72, v73
cv 236,72,73
s_waitcnt vmcnt(12) lgkmcnt(0)
s_barrier
v_add_f32 v67, s15, v32
v_fma_f32 v64, v48, s14, v67
v_fma_f32 v65, v49, s14, v67
v_fma_f32 v66, v50, s14, v67
v_fma_f32 v67, v51, s14, v67
v_add_f32 v71, s17, v32
v_fma_f32 v68, v48, s16, v71
v_fma_f32 v69, v49, s16, v71
v_fma_f32 v70, v50, s16, v71
v_fma_f32 v71, v51, s16, v71
s_nop 1
cvav 216,128,144,44
s_and_b32 s59, s77, 0xc000
s_add_u32 m0, s59, s79
v_exp_f32 v74, v186
v_exp_f32 v75, v187
mvav 216,132,148
dma 1,48,77,0
v_xor_b32 v3, 0x8000, v3
v_add_f32 v79, v79, v74
v_add_f32 v79, v79, v75
cv 237,74,75
v_exp_f32 v72, v188
mvav 216,136,152
ds_read_b64 v[6:7], v13
v_add_f32 v79, v79, v72
v_exp_f32 v73, v189
mvav 216,140,156
v_add_f32 v79, v79, v73
cv 238,72,73
v_exp_f32 v74, v190
cvav 208,140,140,40
v_add_f32 v79, v79, v74
v_exp_f32 v75, v191
mvav 208,136,136
v_add_f32 v79, v79, v75
cv 239,74,75
v_exp_f32 v72, v176
mvav 208,132,132
v_exp_f32 v73, v177
mvav 208,128,128
v_add_f32 v78, v72, v73
cv 232,72,73
v_exp_f32 v74, v178
cvav 200,128,112,36
v_add_f32 v78, v78, v74
v_exp_f32 v75, v179
mvav 200,132,116
dma 1,48,77,1024
v_add_f32 v78, v78, v75
cv 233,74,75
v_exp_f32 v72, v180
mvav 200,136,120
v_add_f32 v78, v78, v72
v_exp_f32 v73, v181
mvav 200,140,124
v_add_f32 v78, v78, v73
cv 234,72,73
v_exp_f32 v74, v182
cvav 192,140,108,64
v_add_f32 v78, v78, v74
v_exp_f32 v75, v183
mvav 192,136,104
v_add_f32 v78, v78, v75
cv 235,74,75
v_exp_f32 v72, v168
mvav 192,132,100
v_exp_f32 v73, v169
v_exp_f32 v74, v170
mvav 192,128,96
v_add_f32 v77, v72, v73
cv 228,72,73
v_add_f32 v77, v77, v74
v_exp_f32 v75, v171
cvav 220,144,144,44
v_add_f32 v77, v77, v75
cv 229,74,75
v_exp_f32 v72, v172
mvav 220,148,148
dma 1,48,77,2048
ra 128,2,16384
v_add_f32 v77, v77, v72
v_exp_f32 v73, v173
mvav 220,152,152
v_add_f32 v77, v77, v73
cv 230,72,73
v_exp_f32 v74, v174
mvav 220,156,156
ra 132,2,18432
v_add_f32 v77, v77, v74
v_exp_f32 v75, v175
cvav 212,156,140,40
v_add_f32 v77, v77, v75
cv 231,74,75
v_exp_f32 v72, v160
mvav 212,152,136
ra 136,2,20480
v_exp_f32 v73, v161
mvav 212,148,132
v_add_f32 v76, v72, v73
cv 224,72,73
v_exp_f32 v74, v162
v_max3_f32 v88, v79, v78, v77
mvav 212,144,128
ra 140,2,22528
v_add_f32 v76, v76, v74
v_exp_f32 v75, v163
cvav 204,144,112,36
v_add_f32 v76, v76, v75
cv 225,74,75
v_exp_f32 v72, v164
mvav 204,148,116
dma 1,48,77,3072
v_add_f32 v76, v76, v72
v_exp_f32 v73, v165
mvav 204,152,120
s_add_u32 s77, s77, 16384
v_add_f32 v76, v76, v73
cv 226,72,73
v_exp_f32 v74, v166
mvav 204,156,124
v_add_f32 v76, v76, v74
v_exp_f32 v75, v167
cvav 196,156,108,68
v_add_f32 v76, v76, v75
cv 227,74,75
v_exp_f32 v72, v216
mvav 196,152,104
v_max_f32 v88, v88, v76
v_cmp_lt_f32 vcc, s90, v88
mvav 196,148,100
v_exp_f32 v73, v217
mvav 196,144,96
s_cbranch_vccnz L_fDF_1_fb
L_fDF_1_ret:
v_add_f32 v83, v72, v73
cv 252,72,73
ra 144,2,17408
ra 148,2,19456
ra 152,2,21504
ra 156,2,23552
v_add_f32 v67, s11, v36
v_fma_f32 v64, v48, s10, v67
v_fma_f32 v65, v49, s10, v67
v_fma_f32 v66, v50, s10, v67
v_fma_f32 v67, v51, s10, v67
v_add_f32 v71, s13, v36
v_fma_f32 v68, v48, s12, v71
v_fma_f32 v69, v49, s12, v71
v_fma_f32 v70, v50, s12, v71
v_fma_f32 v71, v51, s12, v71
s_nop 1
s_waitcnt lgkmcnt(7)
cvav 184,128,144,44
s_waitcnt lgkmcnt(6)
s_and_b32 s59, s76, 0xc000
s_add_u32 m0, s59, s78
v_exp_f32 v74, v218
mvav 184,132,148
s_waitcnt lgkmcnt(5)
dma 1,44,76,0
ra 160,3,0
v_add_f32 v83, v83, v74
v_exp_f32 v75, v219
v_mov_b32 v87, v79
mvav 184,136,152
s_waitcnt lgkmcnt(5)
v_add_f32 v83, v83, v75
cv 253,74,75
mvav 184,140,156
ra 224,9,0
v_exp_f32 v72, v220
cvav 176,140,140,40
s_add_u32 s63, s74, 0
ra 164,3,1024
v_add_f32 v83, v83, v72
mvav 176,136,136
buffer_store_dwordx4 a[192:195], v0, s[52:55], s63 offen sc1
v_exp_f32 v73, v221
mvav 176,132,132
ra 228,9,1024
v_add_f32 v83, v83, v73
cv 254,72,73
v_exp_f32 v74, v222
mvav 176,128,128
dma 1,44,76,1024
ra 168,3,2048
v_add_f32 v83, v83, v74
cvav 168,128,112,64
v_exp_f32 v75, v223
mvav 168,132,116
ra 232,9,2048
v_add_f32 v83, v83, v75
cv 255,74,75
mvav 168,136,120
s_waitcnt lgkmcnt(6)
ra 172,3,3072
v_exp_f32 v72, v208
mvav 168,140,124
cvav 188,144,144,44
ra 236,9,3072
v_exp_f32 v73, v209
mvav 188,148,148
dma 1,44,76,2048
ra 176,3,4096
v_add_f32 v82, v72, v73
cv 248,72,73
v_exp_f32 v74, v210
v_mov_b32 v86, v78
mvav 188,152,152
v_add_f32 v82, v82, v74
mvav 188,156,156
ra 240,9,4096
v_exp_f32 v75, v211
cvav 180,156,140,40
s_add_u32 s63, s74, 8192
ra 180,3,5120
v_add_f32 v82, v82, v75
cv 249,74,75
mvav 180,152,136
buffer_store_dwordx4 a[196:199], v0, s[52:55], s63 offen sc1
v_exp_f32 v72, v212
mvav 180,148,132
ra 244,9,5120
v_add_f32 v82, v82, v72
mvav 180,144,128
dma 1,44,76,3072
ra 184,3,6144
v_exp_f32 v73, v213
cvav 172,144,112,68
s_add_u32 s76, s76, 16384
v_add_f32 v82, v82, v73
cv 250,72,73
v_exp_f32 v74, v214
mvav 172,148,116
ra 248,9,6144
v_add_f32 v82, v82, v74
mvav 172,152,120
s_waitcnt lgkmcnt(7)
ra 188,3,7168
v_exp_f32 v75, v215
mvav 172,156,124
v_add_f32 v82, v82, v75
cv 251,74,75
zaav 96,160,236
ra 252,9,7168
v_exp_f32 v72, v200
zaav 64,160,232
ra 128,2,24576
zaav 32,160,228
v_exp_f32 v73, v201
zaav 0,160,224
v_add_f32 v81, v72, v73
cv 244,72,73
v_exp_f32 v74, v202
zaav 100,164,236
s_add_u32 s63, s74, 4096
v_add_f32 v81, v81, v74
zaav 68,164,232
buffer_store_dwordx4 a[200:203], v0, s[52:55], s63 offen sc1
ra 132,2,26624
v_exp_f32 v75, v203
v_mov_b32 v85, v77
zaav 36,164,228
v_add_f32 v81, v81, v75
cv 245,74,75
zaav 4,164,224
v_exp_f32 v72, v204
zaav 104,168,236
v_add_f32 v81, v81, v72
v_exp_f32 v73, v205
zaav 72,168,232
ra 136,2,28672
v_add_f32 v81, v81, v73
cv 246,72,73
zaav 40,168,228
v_exp_f32 v74, v206
zaav 8,168,224
v_add_f32 v81, v81, v74
zaav 108,172,236
v_exp_f32 v75, v207
zaav 76,172,232
ra 140,2,30720
v_add_f32 v81, v81, v75
cv 247,74,75
zaav 44,172,228
s_waitcnt lgkmcnt(5)
v_exp_f32 v72, v192
zaav 12,172,224
v_exp_f32 v73, v193
v_max3_f32 v88, v83, v82, v81
zaav 112,176,236
s_add_u32 s63, s74, 12288
v_add_f32 v80, v72, v73
cv 240,72,73
zaav 80,176,232
buffer_store_dwordx4 a[204:207], v0, s[52:55], s63 offen sc1
ra 144,2,25600
v_exp_f32 v74, v194
zaav 48,176,228
v_add_f32 v80, v80, v74
zaav 16,176,224
v_exp_f32 v75, v195
zaav 116,180,236
v_add_f32 v80, v80, v75
cv 241,74,75
zaav 84,180,232
ra 148,2,27648
v_exp_f32 v72, v196
v_mov_b32 v84, v76
zaav 52,180,228
v_add_f32 v80, v80, v72
v_exp_f32 v73, v197
zaav 20,180,224
v_add_f32 v80, v80, v73
cv 242,72,73
zaav 120,184,236
v_exp_f32 v74, v198
zaav 88,184,232
ra 152,2,29696
v_add_f32 v80, v80, v74
zaav 56,184,228
v_exp_f32 v75, v199
zaav 24,184,224
v_add_f32 v80, v80, v75
cv 243,74,75
zaav 124,188,236
v_exp_f32 v72, v184
zaav 92,188,232
ra 156,2,31744
v_max_f32 v88, v88, v80
v_cmp_lt_f32 vcc, s90, v88
zaav 60,188,228
s_waitcnt lgkmcnt(4)
v_exp_f32 v73, v185
zaav 28,188,224
s_cbranch_vccnz L_fDF_2_fb
L_fDF_2_ret:
v_add_f32 v79, v72, v73
cv 236,72,73
v_add_f32 v67, s15, v36
v_fma_f32 v64, v48, s14, v67
v_fma_f32 v65, v49, s14, v67
v_fma_f32 v66, v50, s14, v67
v_fma_f32 v67, v51, s14, v67
v_add_f32 v71, s17, v36
v_fma_f32 v68, v48, s16, v71
v_fma_f32 v69, v49, s16, v71
v_fma_f32 v70, v50, s16, v71
v_fma_f32 v71, v51, s16, v71
s_nop 1
cvav 216,128,144,44
v_exp_f32 v74, v186
mvav 216,132,148
ra 160,3,8192
v_add_f32 v79, v79, v74
v_add_f32 v87, v87, v83
mvav 216,136,152
v_exp_f32 v75, v187
mvav 216,140,156
v_add_f32 v79, v79, v75
cv 237,74,75
cvav 208,140,140,40
s_add_u32 s63, s75, 0
ra 164,3,9216
v_exp_f32 v72, v188
mvav 208,136,136
buffer_store_dwordx4 a[208:211], v0, s[52:55], s63 offen sc1
v_xor_b32 v2, 0x8000, v2
v_add_f32 v79, v79, v72
mvav 208,132,132
v_exp_f32 v73, v189
mvav 208,128,128
ra 168,3,10240
v_add_f32 v79, v79, v73
cv 238,72,73
cvav 200,128,112,64
v_exp_f32 v74, v190
mvav 200,132,116
v_add_f32 v79, v79, v74
mvav 200,136,120
s_waitcnt lgkmcnt(3)
ra 172,3,11264
v_exp_f32 v75, v191
mvav 200,140,124
v_add_f32 v79, v79, v75
cv 239,74,75
cvav 220,144,144,44
mvav 220,148,148
ra 176,3,12288
v_add_u32 v2, s89, v2
v_add_f32 v86, v86, v82
mvav 220,152,152
v_exp_f32 v72, v176
mvav 220,156,156
cvav 212,156,140,40
s_add_u32 s63, s75, 8192
ra 180,3,13312
v_exp_f32 v73, v177
mvav 212,152,136
buffer_store_dwordx4 a[212:215], v0, s[52:55], s63 offen sc1
v_add_f32 v78, v72, v73
cv 232,72,73
mvav 212,148,132
v_exp_f32 v74, v178
mvav 212,144,128
ra 184,3,14336
v_add_f32 v78, v78, v74
cvav 204,144,112,68
s_and_b32 s59, s77, 0xc000
s_add_u32 m0, s59, s79
v_exp_f32 v75, v179
mvav 204,148,116
v_add_f32 v78, v78, v75
cv 233,74,75
mvav 204,152,120
s_waitcnt lgkmcnt(3)
ra 188,3,15360
v_exp_f32 v72, v180
mvav 204,156,124
v_add_f32 v78, v78, v72
maav 96,160,252
s_waitcnt vmcnt(18)
s_barrier
maav 64,160,248
dma 1,48,77,0
ra 128,2,0
maav 32,160,244
v_exp_f32 v73, v181
maav 0,160,240
v_add_f32 v78, v78, v73
cv 234,72,73
maav 100,164,252
s_add_u32 s63, s75, 4096
v_exp_f32 v74, v182
maav 68,164,248
buffer_store_dwordx4 a[216:219], v0, s[52:55], s63 offen sc1
ra 132,2,2048
v_add_f32 v78, v78, v74
v_add_f32 v85, v85, v81
maav 36,164,244
v_exp_f32 v75, v183
maav 4,164,240
v_add_f32 v78, v78, v75
cv 235,74,75
maav 104,168,252
v_exp_f32 v72, v168
maav 72,168,248
dma 1,48,77,1024
ra 136,2,4096
maav 40,168,244
v_exp_f32 v73, v169
maav 8,168,240
v_add_f32 v77, v72, v73
cv 228,72,73
maav 108,172,252
v_exp_f32 v74, v170
maav 76,172,248
ra 140,2,6144
v_add_f32 v77, v77, v74
maav 44,172,244
s_waitcnt lgkmcnt(4)
maav 12,172,240
maav 112,176,252
v_exp_f32 v75, v171
maav 80,176,248
dma 1,48,77,2048
ra 144,2,1024
v_add_f32 v77, v77, v75
cv 229,74,75
maav 48,176,244
s_add_u32 s63, s75, 12288
v_exp_f32 v72, v172
maav 16,176,240
buffer_store_dwordx4 a[220:223], v0, s[52:55], s63 offen sc1
v_add_f32 v77, v77, v72
maav 116,180,252
v_exp_f32 v73, v173
maav 84,180,248
ra 148,2,3072
v_add_f32 v77, v77, v73
cv 230,72,73
v_add_f32 v84, v84, v80
maav 52,180,244
v_exp_f32 v74, v174
maav 20,180,240
v_add_f32 v77, v77, v74
maav 120,184,252
v_exp_f32 v75, v175
maav 88,184,248
dma 1,48,77,3072
ra 152,2,5120
v_add_f32 v77, v77, v75
cv 231,74,75
maav 56,184,244
s_add_u32 s77, s77, 16384
maav 24,184,240
maav 124,188,252
v_exp_f32 v72, v216
maav 92,188,248
ra 156,2,7168
v_max3_f32 v88, v79, v78, v77
v_cmp_lt_f32 vcc, s90, v88
maav 60,188,244
s_waitcnt lgkmcnt(4)
v_exp_f32 v73, v217
maav 28,188,240
s_cbranch_vccnz L_fDF_3_fb
L_fDF_3_ret:
v_add_f32 v83, v72, v73
cv 252,72,73
s_branch L_TY
L_TYD:
v_mov_b32 v32, v6
v_mov_b32 v33, v6
v_mov_b32 v34, v6
v_mov_b32 v35, v6
v_mov_b32 v36, v7
v_mov_b32 v37, v7
v_mov_b32 v38, v7
v_mov_b32 v39, v7
v_add_f32 v67, s21, v40
v_fma_f32 v64, v48, s20, v67
v_fma_f32 v65, v49, s20, v67
v_fma_f32 v66, v50, s20, v67
v_fma_f32 v67, v51, s20, v67
v_add_f32 v71, s23, v40
v_fma_f32 v68, v48, s22, v71
v_fma_f32 v69, v49, s22, v71
v_fma_f32 v70, v50, s22, v71
v_fma_f32 v71, v51, s22, v71
v_add_f32 v55, s25, v32
v_fma_f32 v52, v48, s24, v55
v_fma_f32 v53, v49, s24, v55
v_fma_f32 v54, v50, s24, v55
v_fma_f32 v55, v51, s24, v55
v_add_f32 v59, s33, v32
v_fma_f32 v56, v48, s32, v59
v_fma_f32 v57, v49, s32, v59
v_fma_f32 v58, v50, s32, v59
v_fma_f32 v59, v51, s32, v59
s_nop 1
cvav 184,128,144,44
v_exp_f32 v74, v218
mvav 184,132,148
ra 160,3,16384
v_add_f32 v83, v83, v74
v_add_f32 v87, v87, v79
mvav 184,136,152
v_exp_f32 v75, v219
mvav 184,140,156
v_add_f32 v83, v83, v75
cv 253,74,75
cvav 176,140,140,64
v_exp_f32 v72, v220
mvav 176,136,136
ra 164,3,17408
v_add_f32 v83, v83, v72
mvav 176,132,132
v_exp_f32 v73, v221
mvav 176,128,128
v_add_f32 v83, v83, v73
cv 254,72,73
cvaa 168,128,240,36
v_exp_f32 v74, v222
mvaa 168,132,244
ra 168,3,18432
v_add_f32 v83, v83, v74
mvaa 168,136,248
v_exp_f32 v75, v223
mvaa 168,140,252
v_add_f32 v83, v83, v75
cv 255,74,75
cvaa 160,140,236,52
mvaa 160,136,232
ra 172,3,19456
v_add_f32 v86, v86, v78
mvaa 160,132,228
s_waitcnt lgkmcnt(4)
v_exp_f32 v72, v208
mvaa 160,128,224
cvav 188,144,144,44
v_exp_f32 v73, v209
mvav 188,148,148
ra 176,3,20480
v_add_f32 v82, v72, v73
cv 248,72,73
mvav 188,152,152
v_exp_f32 v74, v210
mvav 188,156,156
v_add_f32 v82, v82, v74
cvav 180,156,140,68
v_exp_f32 v75, v211
mvav 180,152,136
ra 180,3,21504
v_add_f32 v82, v82, v75
cv 249,74,75
mvav 180,148,132
v_exp_f32 v72, v212
mvav 180,144,128
v_add_f32 v82, v82, v72
cvaa 172,144,240,36
mvaa 172,148,244
ra 184,3,22528
mvaa 172,152,248
v_exp_f32 v73, v213
mvaa 172,156,252
v_add_f32 v82, v82, v73
cv 250,72,73
cvaa 164,156,236,56
v_exp_f32 v74, v214
mvaa 164,152,232
ra 188,3,23552
v_add_f32 v82, v82, v74
v_add_f32 v85, v85, v77
mvaa 164,148,228
s_waitcnt lgkmcnt(4)
v_exp_f32 v75, v215
mvaa 164,144,224
v_add_f32 v82, v82, v75
cv 251,74,75
maav 96,160,236
s_waitcnt vmcnt(8)
s_barrier
v_exp_f32 v72, v200
maav 64,160,232
ra 128,2,16384
maav 32,160,228
v_exp_f32 v73, v201
maav 100,164,236
v_add_f32 v81, v72, v73
cv 244,72,73
maav 68,164,232
ra 132,2,18432
v_exp_f32 v74, v202
maav 36,164,228
v_add_f32 v81, v81, v74
maav 104,168,236
maav 72,168,232
ra 136,2,20480
maav 40,168,228
v_exp_f32 v75, v203
maav 108,172,236
v_add_f32 v81, v81, v75
cv 245,74,75
maav 76,172,232
s_waitcnt lgkmcnt(3)
ra 140,2,22528
v_exp_f32 v72, v204
maav 44,172,228
v_add_f32 v81, v81, v72
maav 112,176,236
v_exp_f32 v73, v205
maav 80,176,232
ra 144,2,17408
v_add_f32 v81, v81, v73
cv 246,72,73
maav 48,176,228
v_exp_f32 v74, v206
maav 116,180,236
v_add_f32 v81, v81, v74
maav 84,180,232
ra 148,2,19456
v_exp_f32 v75, v207
maav 52,180,228
v_add_f32 v81, v81, v75
cv 247,74,75
maav 120,184,236
maav 88,184,232
ra 152,2,21504
maav 56,184,228
v_exp_f32 v72, v184
maav 124,188,236
v_max3_f32 v88, v83, v82, v81
v_cmp_lt_f32 vcc, s90, v88
maav 92,188,232
s_waitcnt lgkmcnt(3)
ra 156,2,23552
v_exp_f32 v73, v185
maav 60,188,228
s_cbranch_vccnz L_TYD_0_fb
L_TYD_0_ret:
v_add_f32 v79, v72, v73
cv 236,72,73
s_add_u32 s36, s34, s4
s_addc_u32 s37, s35, 0
s_and_b32 s37, s37, 0xffff
s_mov_b32 s38, 442368
s_mov_b32 s39, 0x20000
s_add_u32 s40, s34, s6
s_addc_u32 s41, s35, 0
s_and_b32 s41, s41, 0xffff
s_mov_b32 s42, 1048576
s_mov_b32 s43, 0x20000
s_mov_b32 s44, s26
s_and_b32 s45, s27, 0xffff
s_mov_b32 s46, 2211840
s_mov_b32 s47, 0x20000
s_mov_b32 s48, s18
s_and_b32 s49, s19, 0xffff
s_mov_b32 s50, 5242880
s_mov_b32 s51, 0x20000
v_add_u32 v12, 73728, v26
v_add_u32 v13, 73728, v27
s_lshr_b32 s58, s89, 1
s_add_u32 s56, s65, 1
s_and_b32 s56, s56, 3
s_lshl_b32 s57, s56, 10
s_add_u32 s57, s57, s58
v_add_u32 v4, s57, v0
v_add_u32 v8, 73728, v4
s_add_u32 s56, s65, 2
s_and_b32 s56, s56, 3
s_lshl_b32 s57, s56, 10
s_add_u32 s57, s57, s58
v_add_u32 v5, s57, v0
v_add_u32 v9, 73728, v5
s_add_u32 s56, s65, 3
s_and_b32 s56, s56, 3
s_lshl_b32 s57, s56, 10
s_add_u32 s57, s57, s58
v_add_u32 v6, s57, v0
v_add_u32 v10, 73728, v6
s_add_u32 s56, s65, 4
s_and_b32 s56, s56, 3
s_lshl_b32 s57, s56, 10
s_add_u32 s57, s57, s58
v_add_u32 v7, s57, v0
v_add_u32 v11, 73728, v7
v_add_f32 v67, s21, v44
v_fma_f32 v64, v48, s20, v67
v_fma_f32 v65, v49, s20, v67
v_fma_f32 v66, v50, s20, v67
v_fma_f32 v67, v51, s20, v67
v_add_f32 v71, s23, v44
v_fma_f32 v68, v48, s22, v71
v_fma_f32 v69, v49, s22, v71
v_fma_f32 v70, v50, s22, v71
v_fma_f32 v71, v51, s22, v71
v_add_f32 v55, s25, v36
v_fma_f32 v52, v48, s24, v55
v_fma_f32 v53, v49, s24, v55
v_fma_f32 v54, v50, s24, v55
v_fma_f32 v55, v51, s24, v55
v_add_f32 v59, s33, v36
v_fma_f32 v56, v48, s32, v59
v_fma_f32 v57, v49, s32, v59
v_fma_f32 v58, v50, s32, v59
v_fma_f32 v59, v51, s32, v59
s_nop 1
cvav 216,128,144,64
v_exp_f32 v74, v186
mvav 216,132,148
ra 160,3,24576
v_add_f32 v79, v79, v74
v_exp_f32 v75, v187
v_add_f32 v87, v87, v83
mvav 216,136,152
v_add_f32 v79, v79, v75
cv 237,74,75
v_exp_f32 v72, v188
mvav 216,140,156
buffer_load_dword v20, v30, s[52:55], s80 offen sc1
ra 164,3,25600
v_add_f32 v79, v79, v72
v_exp_f32 v73, v189
cvaa 200,140,252,52
v_add_f32 v79, v79, v73
cv 238,72,73
v_exp_f32 v74, v190
mvaa 200,136,248
ra 168,3,26624
v_add_f32 v79, v79, v74
mvaa 200,132,244
s_waitcnt lgkmcnt(3)
v_exp_f32 v75, v191
mvaa 200,128,240
ra 172,3,27648
v_add_f32 v79, v79, v75
cv 239,74,75
v_exp_f32 v72, v176
cvav 220,144,144,68
v_exp_f32 v73, v177
mvav 220,148,148
ra 176,3,28672
v_add_f32 v78, v72, v73
cv 232,72,73
v_exp_f32 v74, v178
mvav 220,152,152
v_add_f32 v78, v78, v74
v_exp_f32 v75, v179
mvav 220,156,156
ra 180,3,29696
v_add_f32 v78, v78, v75
cv 233,74,75
cvaa 204,156,252,56
v_exp_f32 v72, v180
mvaa 204,152,248
ra 184,3,30720
v_add_f32 v78, v78, v72
v_exp_f32 v73, v181
v_add_f32 v86, v86, v82
mvaa 204,148,244
s_waitcnt lgkmcnt(3)
v_add_f32 v78, v78, v73
cv 234,72,73
v_exp_f32 v74, v182
mvaa 204,144,240
ra 188,3,31744
v_add_f32 v78, v78, v74
v_exp_f32 v75, v183
maav 96,160,252
s_waitcnt vmcnt(1)
s_barrier
v_xor_b32 v3, 0x8000, v3
v_add_u32 v3, s89, v3
v_add_f32 v78, v78, v75
cv 235,74,75
v_exp_f32 v72, v168
maav 64,160,248
ra 128,3,0
maav 32,160,244
v_exp_f32 v73, v169
maav 100,164,252
v_add_f32 v77, v72, v73
cv 228,72,73
v_exp_f32 v74, v170
maav 68,164,248
ra 132,3,1024
v_add_f32 v77, v77, v74
v_exp_f32 v75, v171
maav 36,164,244
v_add_f32 v77, v77, v75
cv 229,74,75
v_exp_f32 v72, v172
maav 104,168,252
v_add_f32 v77, v77, v72
v_exp_f32 v73, v173
maav 72,168,248
ra 136,3,2048
v_add_f32 v77, v77, v73
cv 230,72,73
maav 40,168,244
v_exp_f32 v74, v174
maav 108,172,252
v_add_f32 v77, v77, v74
v_exp_f32 v75, v175
maav 76,172,248
s_waitcnt lgkmcnt(3)
ra 140,3,3072
v_add_f32 v77, v77, v75
cv 231,74,75
v_exp_f32 v72, v160
maav 44,172,244
v_exp_f32 v73, v161
maav 112,176,252
v_add_f32 v76, v72, v73
cv 224,72,73
v_exp_f32 v74, v162
v_max3_f32 v88, v79, v78, v77
maav 80,176,248
ra 144,3,4096
v_add_f32 v76, v76, v74
v_add_f32 v85, v85, v81
maav 48,176,244
v_exp_f32 v75, v163
maav 116,180,252
v_add_f32 v76, v76, v75
cv 225,74,75
v_exp_f32 v72, v164
maav 84,180,248
ra 148,3,5120
v_add_f32 v76, v76, v72
v_exp_f32 v73, v165
maav 52,180,244
v_add_f32 v76, v76, v73
cv 226,72,73
v_exp_f32 v74, v166
maav 120,184,252
v_add_f32 v76, v76, v74
v_exp_f32 v75, v167
maav 88,184,248
ra 152,3,6144
v_add_f32 v76, v76, v75
cv 227,74,75
maav 56,184,244
v_exp_f32 v72, v216
maav 124,188,252
v_max_f32 v88, v88, v76
v_cmp_lt_f32 vcc, s90, v88
maav 92,188,248
s_waitcnt lgkmcnt(3)
ra 156,3,7168
v_exp_f32 v73, v217
maav 60,188,244
s_cbranch_vccnz L_TYD_1_fb
L_TYD_1_ret:
v_add_f32 v83, v72, v73
cv 252,72,73
s_nop 7
v_mov_b32 v89, v84
v_mov_b32 v90, v85
s_nop 1
v_permlane16_swap_b32 v84, v89
v_permlane16_swap_b32 v85, v90
s_nop 0
v_add_f32 v84, v84, v89
v_add_f32 v85, v85, v90
v_mov_b32 v89, v84
v_mov_b32 v90, v85
s_nop 1
v_permlane32_swap_b32 v84, v89
v_permlane32_swap_b32 v85, v90
s_nop 0
v_add_f32 v84, v84, v89
v_add_f32 v85, v85, v90
v_rcp_f32 v84, v84
v_rcp_f32 v85, v85
v_mov_b32 v94, v84
v_mov_b32 v95, v84
ar 90,0
ar 91,1
v_pk_mul_f32 v[90:91], v[90:91], v[94:95]
cv 96,90,91
ar 92,2
ar 93,3
v_pk_mul_f32 v[92:93], v[92:93], v[94:95]
cv 97,92,93
ar 90,4
ar 91,5
v_pk_mul_f32 v[90:91], v[90:91], v[94:95]
cv 98,90,91
ar 92,6
ar 93,7
v_pk_mul_f32 v[92:93], v[92:93], v[94:95]
cv 99,92,93
ar 90,8
ar 91,9
v_pk_mul_f32 v[90:91], v[90:91], v[94:95]
cv 100,90,91
ar 92,10
ar 93,11
v_pk_mul_f32 v[92:93], v[92:93], v[94:95]
cv 101,92,93
ar 90,12
ar 91,13
v_pk_mul_f32 v[90:91], v[90:91], v[94:95]
cv 102,90,91
ar 92,14
ar 93,15
v_pk_mul_f32 v[92:93], v[92:93], v[94:95]
cv 103,92,93
ar 90,16
ar 91,17
v_pk_mul_f32 v[90:91], v[90:91], v[94:95]
cv 104,90,91
ar 92,18
ar 93,19
v_pk_mul_f32 v[92:93], v[92:93], v[94:95]
cv 105,92,93
ar 90,20
ar 91,21
v_pk_mul_f32 v[90:91], v[90:91], v[94:95]
cv 106,90,91
ar 92,22
ar 93,23
v_pk_mul_f32 v[92:93], v[92:93], v[94:95]
cv 107,92,93
ar 90,24
ar 91,25
v_pk_mul_f32 v[90:91], v[90:91], v[94:95]
cv 108,90,91
ar 92,26
ar 93,27
v_pk_mul_f32 v[92:93], v[92:93], v[94:95]
cv 109,92,93
ar 90,28
ar 91,29
v_pk_mul_f32 v[90:91], v[90:91], v[94:95]
cv 110,90,91
ar 92,30
ar 93,31
v_pk_mul_f32 v[92:93], v[92:93], v[94:95]
cv 111,92,93
v_mov_b32 v94, v85
v_mov_b32 v95, v85
ar 90,32
ar 91,33
v_pk_mul_f32 v[90:91], v[90:91], v[94:95]
cv 112,90,91
ar 92,34
ar 93,35
v_pk_mul_f32 v[92:93], v[92:93], v[94:95]
cv 113,92,93
ar 90,36
ar 91,37
v_pk_mul_f32 v[90:91], v[90:91], v[94:95]
cv 114,90,91
ar 92,38
ar 93,39
v_pk_mul_f32 v[92:93], v[92:93], v[94:95]
cv 115,92,93
ar 90,40
ar 91,41
v_pk_mul_f32 v[90:91], v[90:91], v[94:95]
cv 116,90,91
ar 92,42
ar 93,43
v_pk_mul_f32 v[92:93], v[92:93], v[94:95]
cv 117,92,93
ar 90,44
ar 91,45
v_pk_mul_f32 v[90:91], v[90:91], v[94:95]
cv 118,90,91
ar 92,46
ar 93,47
v_pk_mul_f32 v[92:93], v[92:93], v[94:95]
cv 119,92,93
ar 90,48
ar 91,49
v_pk_mul_f32 v[90:91], v[90:91], v[94:95]
cv 120,90,91
ar 92,50
ar 93,51
v_pk_mul_f32 v[92:93], v[92:93], v[94:95]
cv 121,92,93
ar 90,52
ar 91,53
v_pk_mul_f32 v[90:91], v[90:91], v[94:95]
cv 122,90,91
ar 92,54
ar 93,55
v_pk_mul_f32 v[92:93], v[92:93], v[94:95]
cv 123,92,93
ar 90,56
ar 91,57
v_pk_mul_f32 v[90:91], v[90:91], v[94:95]
cv 124,90,91
ar 92,58
ar 93,59
v_pk_mul_f32 v[92:93], v[92:93], v[94:95]
cv 125,92,93
ar 90,60
ar 91,61
v_pk_mul_f32 v[90:91], v[90:91], v[94:95]
cv 126,90,91
ar 92,62
ar 93,63
v_pk_mul_f32 v[92:93], v[92:93], v[94:95]
cv 127,92,93
maav 96,128,236
s_waitcnt vmcnt(0)
v_cmp_ne_u32 vcc, s71, v20
s_cbranch_vccz L_hTYD_ok
s_mov_b32 s62, 1000000
L_hTYD:
buffer_load_dword v20, v30, s[52:55], s80 offen sc1
s_waitcnt vmcnt(0)
v_cmp_ne_u32 vcc, s71, v20
s_cbranch_vccz L_hTYD_ok
s_sub_u32 s62, s62, 1
s_cmp_eq_u32 s62, 0
s_cbranch_scc1 L_hTYD_ok
s_sleep 4
s_branch L_hTYD
L_hTYD_ok:
s_waitcnt vmcnt(1) lgkmcnt(0)
s_barrier
v_exp_f32 v74, v218
maav 64,128,232
ra 160,3,16384
v_add_f32 v83, v83, v74
v_add_f32 v87, v87, v79
zaav 32,128,228
s_add_u32 s57, s68, 0
s_add_u32 m0, s82, 0
v_exp_f32 v75, v219
zaav 0,128,224
dma 14,44,57,0
v_add_f32 v83, v83, v75
cv 253,74,75
maav 100,132,236
v_exp_f32 v72, v220
maav 68,132,232
dma 15,44,57,1024
ra 164,3,17408
v_add_f32 v83, v83, v72
zaav 36,132,228
v_exp_f32 v73, v221
zaav 4,132,224
dma 16,44,57,2048
v_add_f32 v83, v83, v73
cv 254,72,73
maav 104,136,236
v_exp_f32 v74, v222
maav 72,136,232
dma 17,44,57,3072
ra 168,3,18432
v_add_f32 v83, v83, v74
zaav 40,136,228
s_add_u32 m0, s82, 4096
v_exp_f32 v75, v223
zaav 8,136,224
dma 18,44,57,0
v_add_f32 v83, v83, v75
cv 255,74,75
maav 108,140,236
s_add_u32 s56, s66, 0
s_add_u32 m0, s78, 0
v_exp_f32 v72, v200
maav 76,140,232
dma 0,36,56,0
ra 172,3,19456
v_add_f32 v86, v86, v78
zaav 44,140,228
v_exp_f32 v73, v201
zaav 12,140,224
dma 0,36,56,1024
v_add_f32 v81, v72, v73
cv 244,72,73
maav 112,144,236
v_exp_f32 v74, v202
maav 80,144,232
dma 0,36,56,2048
ra 176,3,20480
v_add_f32 v81, v81, v74
zaav 48,144,228
v_exp_f32 v75, v203
zaav 16,144,224
dma 0,36,56,3072
v_add_f32 v81, v81, v75
cv 245,74,75
maav 116,148,236
s_add_u32 s63, s94, 0
v_exp_f32 v72, v204
maav 84,148,232
buffer_store_dwordx4 v[96:99], v0, s[52:55], s63 offen sc1
ra 180,3,21504
v_add_f32 v81, v81, v72
zaav 52,148,228
s_add_u32 s63, s94, 8192
v_exp_f32 v73, v205
zaav 20,148,224
buffer_store_dwordx4 v[100:103], v0, s[52:55], s63 offen sc1
v_add_f32 v81, v81, v73
cv 246,72,73
maav 120,152,236
v_exp_f32 v74, v206
maav 88,152,232
ra 184,3,22528
v_add_f32 v81, v81, v74
zaav 56,152,228
s_add_u32 s63, s94, 16384
v_exp_f32 v75, v207
zaav 24,152,224
buffer_store_dwordx4 v[104:107], v0, s[52:55], s63 offen sc1
v_add_f32 v81, v81, v75
cv 247,74,75
v_mov_b32 v85, v77
v_mov_b32 v84, v76
maav 124,156,236
s_add_u32 s63, s94, 24576
maav 92,156,232
buffer_store_dwordx4 v[108:111], v0, s[52:55], s63 offen sc1
ra 188,3,23552
v_max_f32 v88, v83, v81
v_cmp_lt_f32 vcc, s90, v88
zaav 60,156,228
s_waitcnt lgkmcnt(4)
zaav 28,156,224
s_cbranch_vccnz L_TYD_2_fb
L_TYD_2_ret:
maav 96,160,252
maav 32,160,244
ds_write_b128 v60, a[0:3] offset:0
v_add_f32 v87, v87, v83
maav 100,164,252
maav 36,164,244
ds_write_b128 v60, a[4:7] offset:1024
maav 104,168,252
maav 40,168,244
ds_write_b128 v60, a[8:11] offset:2048
maav 108,172,252
s_waitcnt lgkmcnt(3)
maav 44,172,244
ds_write_b128 v60, a[12:15] offset:3072
maav 112,176,252
maav 48,176,244
ds_write_b128 v60, a[16:19] offset:4096
maav 116,180,252
maav 52,180,244
ds_write_b128 v60, a[20:23] offset:5120
v_add_f32 v85, v85, v81
maav 120,184,252
maav 56,184,244
ds_write_b128 v60, a[24:27] offset:6144
maav 124,188,252
maav 60,188,244
ds_write_b128 v60, a[28:31] offset:7168
s_waitcnt vmcnt(4)
s_add_u32 s63, s94, 4096
buffer_store_dwordx4 v[112:115], v0, s[52:55], s63 offen sc1
s_add_u32 s63, s94, 12288
buffer_store_dwordx4 v[116:119], v0, s[52:55], s63 offen sc1
s_add_u32 s63, s94, 20480
buffer_store_dwordx4 v[120:123], v0, s[52:55], s63 offen sc1
s_add_u32 s63, s94, 28672
buffer_store_dwordx4 v[124:127], v0, s[52:55], s63 offen sc1
s_branch L_fin
L_fFF_1_fb:
s_call_b64 s[92:93], FB0_3210
s_branch L_fFF_1_ret
L_fFF_2_fb:
s_call_b64 s[92:93], FB1_3210
s_branch L_fFF_2_ret
L_fFF_3_fb:
s_call_b64 s[92:93], FB0_3210
s_branch L_fFF_3_ret
L_FF_0_fb:
s_call_b64 s[92:93], FB1_3210
s_branch L_FF_0_ret
L_FF_1_fb:
s_call_b64 s[92:93], FB0_3210
s_branch L_FF_1_ret
L_FF_2_fb:
s_call_b64 s[92:93], FB1_3210
s_branch L_FF_2_ret
L_FF_3_fb:
s_call_b64 s[92:93], FB0_3210
s_branch L_FF_3_ret
L_DF_0_fb:
s_call_b64 s[92:93], FB1_3210
s_branch L_DF_0_ret
L_DF_1_fb:
s_call_b64 s[92:93], FB0_3210
s_branch L_DF_1_ret
L_DF_2_fb:
s_call_b64 s[92:93], FB1_3210
s_branch L_DF_2_ret
L_DF_3_fb:
s_call_b64 s[92:93], FB0_321
s_branch L_DF_3_ret
L_TY_0_fb:
s_call_b64 s[92:93], FB1_321l
s_branch L_TY_0_ret
L_TY_1_fb:
s_call_b64 s[92:93], FB0_321n0n
s_branch L_TY_1_ret
L_TY_2_fb:
s_call_b64 s[92:93], FB1_3210
s_branch L_TY_2_ret
L_TY_3_fb:
s_call_b64 s[92:93], FB0_3210
s_branch L_TY_3_ret
L_YY_0_fb:
s_call_b64 s[92:93], FB1_3210
s_branch L_YY_0_ret
L_YY_1_fb:
s_call_b64 s[92:93], FB0_3210
s_branch L_YY_1_ret
L_YY_2_fb:
s_call_b64 s[92:93], FB1_3210
s_branch L_YY_2_ret
L_YY_3_fb:
s_call_b64 s[92:93], FB0_3210
s_branch L_YY_3_ret
L_YD_0_fb:
s_call_b64 s[92:93], FB1_3210
s_branch L_YD_0_ret
L_YD_1_fb:
s_call_b64 s[92:93], FB0_3210
s_branch L_YD_1_ret
L_YD_2_fb:
s_call_b64 s[92:93], FB1_31
s_branch L_YD_2_ret
L_fDF_1_fb:
s_call_b64 s[92:93], FB0_3210
s_branch L_fDF_1_ret
L_fDF_2_fb:
s_call_b64 s[92:93], FB1_3210
s_branch L_fDF_2_ret
L_fDF_3_fb:
s_call_b64 s[92:93], FB0_321
s_branch L_fDF_3_ret
L_TYD_0_fb:
s_call_b64 s[92:93], FB1_321l
s_branch L_TYD_0_ret
L_TYD_1_fb:
s_call_b64 s[92:93], FB0_321n0n
s_branch L_TYD_1_ret
L_TYD_2_fb:
s_call_b64 s[92:93], FB1_31
s_branch L_TYD_2_ret
FB0_3210:
s_nop 15
v_max3_f32 v89, v184, v185, v186
v_max3_f32 v89, v89, v187, v188
v_max3_f32 v89, v89, v189, v190
v_max_f32 v89, v89, v191
v_mov_b32 v90, v89
s_nop 1
v_permlane16_swap_b32 v89, v90
s_nop 0
v_max_f32 v89, v89, v90
v_mov_b32 v90, v89
s_nop 1
v_permlane32_swap_b32 v89, v90
s_nop 0
v_max_f32 v89, v89, v90
v_max_f32 v89, 0, v89
v_sub_f32 v90, 0, v89
v_exp_f32 v90, v90
v_sub_f32 v184, v184, v89
v_sub_f32 v185, v185, v89
v_sub_f32 v186, v186, v89
v_sub_f32 v187, v187, v89
v_sub_f32 v188, v188, v89
v_sub_f32 v189, v189, v89
v_sub_f32 v190, v190, v89
v_sub_f32 v191, v191, v89
v_sub_f32 v44, v44, v89
v_sub_f32 v45, v45, v89
v_sub_f32 v46, v46, v89
v_sub_f32 v47, v47, v89
v_sub_f32 v216, v216, v89
v_sub_f32 v217, v217, v89
v_sub_f32 v218, v218, v89
v_sub_f32 v219, v219, v89
v_sub_f32 v220, v220, v89
v_sub_f32 v221, v221, v89
v_sub_f32 v222, v222, v89
v_sub_f32 v223, v223, v89
v_mul_f32 v87, v87, v90
ar 91,96
ar 92,97
v_mul_f32 v91, v91, v90
v_mul_f32 v92, v92, v90
aw 96,91
aw 97,92
ar 91,98
ar 92,99
v_mul_f32 v91, v91, v90
v_mul_f32 v92, v92, v90
aw 98,91
aw 99,92
ar 91,100
ar 92,101
v_mul_f32 v91, v91, v90
v_mul_f32 v92, v92, v90
aw 100,91
aw 101,92
ar 91,102
ar 92,103
v_mul_f32 v91, v91, v90
v_mul_f32 v92, v92, v90
aw 102,91
aw 103,92
ar 91,104
ar 92,105
v_mul_f32 v91, v91, v90
v_mul_f32 v92, v92, v90
aw 104,91
aw 105,92
ar 91,106
ar 92,107
v_mul_f32 v91, v91, v90
v_mul_f32 v92, v92, v90
aw 106,91
aw 107,92
ar 91,108
ar 92,109
v_mul_f32 v91, v91, v90
v_mul_f32 v92, v92, v90
aw 108,91
aw 109,92
ar 91,110
ar 92,111
v_mul_f32 v91, v91, v90
v_mul_f32 v92, v92, v90
aw 110,91
aw 111,92
ar 91,112
ar 92,113
v_mul_f32 v91, v91, v90
v_mul_f32 v92, v92, v90
aw 112,91
aw 113,92
ar 91,114
ar 92,115
v_mul_f32 v91, v91, v90
v_mul_f32 v92, v92, v90
aw 114,91
aw 115,92
ar 91,116
ar 92,117
v_mul_f32 v91, v91, v90
v_mul_f32 v92, v92, v90
aw 116,91
aw 117,92
ar 91,118
ar 92,119
v_mul_f32 v91, v91, v90
v_mul_f32 v92, v92, v90
aw 118,91
aw 119,92
ar 91,120
ar 92,121
v_mul_f32 v91, v91, v90
v_mul_f32 v92, v92, v90
aw 120,91
aw 121,92
ar 91,122
ar 92,123
v_mul_f32 v91, v91, v90
v_mul_f32 v92, v92, v90
aw 122,91
aw 123,92
ar 91,124
ar 92,125
v_mul_f32 v91, v91, v90
v_mul_f32 v92, v92, v90
aw 124,91
aw 125,92
ar 91,126
ar 92,127
v_mul_f32 v91, v91, v90
v_mul_f32 v92, v92, v90
aw 126,91
aw 127,92
v_max3_f32 v89, v176, v177, v178
v_max3_f32 v89, v89, v179, v180
v_max3_f32 v89, v89, v181, v182
v_max_f32 v89, v89, v183
v_mov_b32 v90, v89
s_nop 1
v_permlane16_swap_b32 v89, v90
s_nop 0
v_max_f32 v89, v89, v90
v_mov_b32 v90, v89
s_nop 1
v_permlane32_swap_b32 v89, v90
s_nop 0
v_max_f32 v89, v89, v90
v_max_f32 v89, 0, v89
v_sub_f32 v90, 0, v89
v_exp_f32 v90, v90
v_sub_f32 v176, v176, v89
v_sub_f32 v177, v177, v89
v_sub_f32 v178, v178, v89
v_sub_f32 v179, v179, v89
v_sub_f32 v180, v180, v89
v_sub_f32 v181, v181, v89
v_sub_f32 v182, v182, v89
v_sub_f32 v183, v183, v89
v_sub_f32 v40, v40, v89
v_sub_f32 v41, v41, v89
v_sub_f32 v42, v42, v89
v_sub_f32 v43, v43, v89
v_sub_f32 v208, v208, v89
v_sub_f32 v209, v209, v89
v_sub_f32 v210, v210, v89
v_sub_f32 v211, v211, v89
v_sub_f32 v212, v212, v89
v_sub_f32 v213, v213, v89
v_sub_f32 v214, v214, v89
v_sub_f32 v215, v215, v89
v_mul_f32 v86, v86, v90
ar 91,64
ar 92,65
v_mul_f32 v91, v91, v90
v_mul_f32 v92, v92, v90
aw 64,91
aw 65,92
ar 91,66
ar 92,67
v_mul_f32 v91, v91, v90
v_mul_f32 v92, v92, v90
aw 66,91
aw 67,92
ar 91,68
ar 92,69
v_mul_f32 v91, v91, v90
v_mul_f32 v92, v92, v90
aw 68,91
aw 69,92
ar 91,70
ar 92,71
v_mul_f32 v91, v91, v90
v_mul_f32 v92, v92, v90
aw 70,91
aw 71,92
ar 91,72
ar 92,73
v_mul_f32 v91, v91, v90
v_mul_f32 v92, v92, v90
aw 72,91
aw 73,92
ar 91,74
ar 92,75
v_mul_f32 v91, v91, v90
v_mul_f32 v92, v92, v90
aw 74,91
aw 75,92
ar 91,76
ar 92,77
v_mul_f32 v91, v91, v90
v_mul_f32 v92, v92, v90
aw 76,91
aw 77,92
ar 91,78
ar 92,79
v_mul_f32 v91, v91, v90
v_mul_f32 v92, v92, v90
aw 78,91
aw 79,92
ar 91,80
ar 92,81
v_mul_f32 v91, v91, v90
v_mul_f32 v92, v92, v90
aw 80,91
aw 81,92
ar 91,82
ar 92,83
v_mul_f32 v91, v91, v90
v_mul_f32 v92, v92, v90
aw 82,91
aw 83,92
ar 91,84
ar 92,85
v_mul_f32 v91, v91, v90
v_mul_f32 v92, v92, v90
aw 84,91
aw 85,92
ar 91,86
ar 92,87
v_mul_f32 v91, v91, v90
v_mul_f32 v92, v92, v90
aw 86,91
aw 87,92
ar 91,88
ar 92,89
v_mul_f32 v91, v91, v90
v_mul_f32 v92, v92, v90
aw 88,91
aw 89,92
ar 91,90
ar 92,91
v_mul_f32 v91, v91, v90
v_mul_f32 v92, v92, v90
aw 90,91
aw 91,92
ar 91,92
ar 92,93
v_mul_f32 v91, v91, v90
v_mul_f32 v92, v92, v90
aw 92,91
aw 93,92
ar 91,94
ar 92,95
v_mul_f32 v91, v91, v90
v_mul_f32 v92, v92, v90
aw 94,91
aw 95,92
v_max3_f32 v89, v168, v169, v170
v_max3_f32 v89, v89, v171, v172
v_max3_f32 v89, v89, v173, v174
v_max_f32 v89, v89, v175
v_mov_b32 v90, v89
s_nop 1
v_permlane16_swap_b32 v89, v90
s_nop 0
v_max_f32 v89, v89, v90
v_mov_b32 v90, v89
s_nop 1
v_permlane32_swap_b32 v89, v90
s_nop 0
v_max_f32 v89, v89, v90
v_max_f32 v89, 0, v89
v_sub_f32 v90, 0, v89
v_exp_f32 v90, v90
v_sub_f32 v168, v168, v89
v_sub_f32 v169, v169, v89
v_sub_f32 v170, v170, v89
v_sub_f32 v171, v171, v89
v_sub_f32 v172, v172, v89
v_sub_f32 v173, v173, v89
v_sub_f32 v174, v174, v89
v_sub_f32 v175, v175, v89
v_sub_f32 v36, v36, v89
v_sub_f32 v37, v37, v89
v_sub_f32 v38, v38, v89
v_sub_f32 v39, v39, v89
v_sub_f32 v200, v200, v89
v_sub_f32 v201, v201, v89
v_sub_f32 v202, v202, v89
v_sub_f32 v203, v203, v89
v_sub_f32 v204, v204, v89
v_sub_f32 v205, v205, v89
v_sub_f32 v206, v206, v89
v_sub_f32 v207, v207, v89
v_mul_f32 v85, v85, v90
ar 91,32
ar 92,33
v_mul_f32 v91, v91, v90
v_mul_f32 v92, v92, v90
aw 32,91
aw 33,92
ar 91,34
ar 92,35
v_mul_f32 v91, v91, v90
v_mul_f32 v92, v92, v90
aw 34,91
aw 35,92
ar 91,36
ar 92,37
v_mul_f32 v91, v91, v90
v_mul_f32 v92, v92, v90
aw 36,91
aw 37,92
ar 91,38
ar 92,39
v_mul_f32 v91, v91, v90
v_mul_f32 v92, v92, v90
aw 38,91
aw 39,92
ar 91,40
ar 92,41
v_mul_f32 v91, v91, v90
v_mul_f32 v92, v92, v90
aw 40,91
aw 41,92
ar 91,42
ar 92,43
v_mul_f32 v91, v91, v90
v_mul_f32 v92, v92, v90
aw 42,91
aw 43,92
ar 91,44
ar 92,45
v_mul_f32 v91, v91, v90
v_mul_f32 v92, v92, v90
aw 44,91
aw 45,92
ar 91,46
ar 92,47
v_mul_f32 v91, v91, v90
v_mul_f32 v92, v92, v90
aw 46,91
aw 47,92
ar 91,48
ar 92,49
v_mul_f32 v91, v91, v90
v_mul_f32 v92, v92, v90
aw 48,91
aw 49,92
ar 91,50
ar 92,51
v_mul_f32 v91, v91, v90
v_mul_f32 v92, v92, v90
aw 50,91
aw 51,92
ar 91,52
ar 92,53
v_mul_f32 v91, v91, v90
v_mul_f32 v92, v92, v90
aw 52,91
aw 53,92
ar 91,54
ar 92,55
v_mul_f32 v91, v91, v90
v_mul_f32 v92, v92, v90
aw 54,91
aw 55,92
ar 91,56
ar 92,57
v_mul_f32 v91, v91, v90
v_mul_f32 v92, v92, v90
aw 56,91
aw 57,92
ar 91,58
ar 92,59
v_mul_f32 v91, v91, v90
v_mul_f32 v92, v92, v90
aw 58,91
aw 59,92
ar 91,60
ar 92,61
v_mul_f32 v91, v91, v90
v_mul_f32 v92, v92, v90
aw 60,91
aw 61,92
ar 91,62
ar 92,63
v_mul_f32 v91, v91, v90
v_mul_f32 v92, v92, v90
aw 62,91
aw 63,92
v_max3_f32 v89, v160, v161, v162
v_max3_f32 v89, v89, v163, v164
v_max3_f32 v89, v89, v165, v166
v_max_f32 v89, v89, v167
v_mov_b32 v90, v89
s_nop 1
v_permlane16_swap_b32 v89, v90
s_nop 0
v_max_f32 v89, v89, v90
v_mov_b32 v90, v89
s_nop 1
v_permlane32_swap_b32 v89, v90
s_nop 0
v_max_f32 v89, v89, v90
v_max_f32 v89, 0, v89
v_sub_f32 v90, 0, v89
v_exp_f32 v90, v90
v_sub_f32 v160, v160, v89
v_sub_f32 v161, v161, v89
v_sub_f32 v162, v162, v89
v_sub_f32 v163, v163, v89
v_sub_f32 v164, v164, v89
v_sub_f32 v165, v165, v89
v_sub_f32 v166, v166, v89
v_sub_f32 v167, v167, v89
v_sub_f32 v32, v32, v89
v_sub_f32 v33, v33, v89
v_sub_f32 v34, v34, v89
v_sub_f32 v35, v35, v89
v_sub_f32 v192, v192, v89
v_sub_f32 v193, v193, v89
v_sub_f32 v194, v194, v89
v_sub_f32 v195, v195, v89
v_sub_f32 v196, v196, v89
v_sub_f32 v197, v197, v89
v_sub_f32 v198, v198, v89
v_sub_f32 v199, v199, v89
v_mul_f32 v84, v84, v90
ar 91,0
ar 92,1
v_mul_f32 v91, v91, v90
v_mul_f32 v92, v92, v90
aw 0,91
aw 1,92
ar 91,2
ar 92,3
v_mul_f32 v91, v91, v90
v_mul_f32 v92, v92, v90
aw 2,91
aw 3,92
ar 91,4
ar 92,5
v_mul_f32 v91, v91, v90
v_mul_f32 v92, v92, v90
aw 4,91
aw 5,92
ar 91,6
ar 92,7
v_mul_f32 v91, v91, v90
v_mul_f32 v92, v92, v90
aw 6,91
aw 7,92
ar 91,8
ar 92,9
v_mul_f32 v91, v91, v90
v_mul_f32 v92, v92, v90
aw 8,91
aw 9,92
ar 91,10
ar 92,11
v_mul_f32 v91, v91, v90
v_mul_f32 v92, v92, v90
aw 10,91
aw 11,92
ar 91,12
ar 92,13
v_mul_f32 v91, v91, v90
v_mul_f32 v92, v92, v90
aw 12,91
aw 13,92
ar 91,14
ar 92,15
v_mul_f32 v91, v91, v90
v_mul_f32 v92, v92, v90
aw 14,91
aw 15,92
ar 91,16
ar 92,17
v_mul_f32 v91, v91, v90
v_mul_f32 v92, v92, v90
aw 16,91
aw 17,92
ar 91,18
ar 92,19
v_mul_f32 v91, v91, v90
v_mul_f32 v92, v92, v90
aw 18,91
aw 19,92
ar 91,20
ar 92,21
v_mul_f32 v91, v91, v90
v_mul_f32 v92, v92, v90
aw 20,91
aw 21,92
ar 91,22
ar 92,23
v_mul_f32 v91, v91, v90
v_mul_f32 v92, v92, v90
aw 22,91
aw 23,92
ar 91,24
ar 92,25
v_mul_f32 v91, v91, v90
v_mul_f32 v92, v92, v90
aw 24,91
aw 25,92
ar 91,26
ar 92,27
v_mul_f32 v91, v91, v90
v_mul_f32 v92, v92, v90
aw 26,91
aw 27,92
ar 91,28
ar 92,29
v_mul_f32 v91, v91, v90
v_mul_f32 v92, v92, v90
aw 28,91
aw 29,92
ar 91,30
ar 92,31
v_mul_f32 v91, v91, v90
v_mul_f32 v92, v92, v90
aw 30,91
aw 31,92
v_exp_f32 v72, v184
s_nop 0
v_exp_f32 v73, v185
s_nop 0
v_add_f32 v79, v72, v73
cv 236,72,73
v_exp_f32 v74, v186
s_nop 0
v_add_f32 v79, v79, v74
v_exp_f32 v75, v187
s_nop 0
v_add_f32 v79, v79, v75
cv 237,74,75
v_exp_f32 v72, v188
s_nop 0
v_add_f32 v79, v79, v72
v_exp_f32 v73, v189
s_nop 0
v_add_f32 v79, v79, v73
cv 238,72,73
v_exp_f32 v74, v190
s_nop 0
v_add_f32 v79, v79, v74
v_exp_f32 v75, v191
s_nop 0
v_add_f32 v79, v79, v75
cv 239,74,75
v_exp_f32 v72, v176
s_nop 0
v_exp_f32 v73, v177
s_nop 0
v_add_f32 v78, v72, v73
cv 232,72,73
v_exp_f32 v74, v178
s_nop 0
v_add_f32 v78, v78, v74
v_exp_f32 v75, v179
s_nop 0
v_add_f32 v78, v78, v75
cv 233,74,75
v_exp_f32 v72, v180
s_nop 0
v_add_f32 v78, v78, v72
v_exp_f32 v73, v181
s_nop 0
v_add_f32 v78, v78, v73
cv 234,72,73
v_exp_f32 v74, v182
s_nop 0
v_add_f32 v78, v78, v74
v_exp_f32 v75, v183
s_nop 0
v_add_f32 v78, v78, v75
cv 235,74,75
v_exp_f32 v72, v168
s_nop 0
v_exp_f32 v73, v169
s_nop 0
v_add_f32 v77, v72, v73
cv 228,72,73
v_exp_f32 v74, v170
s_nop 0
v_add_f32 v77, v77, v74
v_exp_f32 v75, v171
s_nop 0
v_add_f32 v77, v77, v75
cv 229,74,75
v_exp_f32 v72, v172
s_nop 0
v_add_f32 v77, v77, v72
v_exp_f32 v73, v173
s_nop 0
v_add_f32 v77, v77, v73
cv 230,72,73
v_exp_f32 v74, v174
s_nop 0
v_add_f32 v77, v77, v74
v_exp_f32 v75, v175
s_nop 0
v_add_f32 v77, v77, v75
cv 231,74,75
v_exp_f32 v72, v160
s_nop 0
v_exp_f32 v73, v161
s_nop 0
v_add_f32 v76, v72, v73
cv 224,72,73
v_exp_f32 v74, v162
s_nop 0
v_add_f32 v76, v76, v74
v_exp_f32 v75, v163
s_nop 0
v_add_f32 v76, v76, v75
cv 225,74,75
v_exp_f32 v72, v164
s_nop 0
v_add_f32 v76, v76, v72
v_exp_f32 v73, v165
s_nop 0
v_add_f32 v76, v76, v73
cv 226,72,73
v_exp_f32 v74, v166
s_nop 0
v_add_f32 v76, v76, v74
v_exp_f32 v75, v167
s_nop 0
v_add_f32 v76, v76, v75
cv 227,74,75
v_exp_f32 v72, v216
v_exp_f32 v73, v217
s_nop 1
s_setpc_b64 s[92:93]
FB1_3210:
s_nop 15
v_max3_f32 v89, v216, v217, v218
v_max3_f32 v89, v89, v219, v220
v_max3_f32 v89, v89, v221, v222
v_max_f32 v89, v89, v223
v_mov_b32 v90, v89
s_nop 1
v_permlane16_swap_b32 v89, v90
s_nop 0
v_max_f32 v89, v89, v90
v_mov_b32 v90, v89
s_nop 1
v_permlane32_swap_b32 v89, v90
s_nop 0
v_max_f32 v89, v89, v90
v_max_f32 v89, 0, v89
v_sub_f32 v90, 0, v89
v_exp_f32 v90, v90
v_sub_f32 v216, v216, v89
v_sub_f32 v217, v217, v89
v_sub_f32 v218, v218, v89
v_sub_f32 v219, v219, v89
v_sub_f32 v220, v220, v89
v_sub_f32 v221, v221, v89
v_sub_f32 v222, v222, v89
v_sub_f32 v223, v223, v89
v_sub_f32 v44, v44, v89
v_sub_f32 v45, v45, v89
v_sub_f32 v46, v46, v89
v_sub_f32 v47, v47, v89
v_sub_f32 v184, v184, v89
v_sub_f32 v185, v185, v89
v_sub_f32 v186, v186, v89
v_sub_f32 v187, v187, v89
v_sub_f32 v188, v188, v89
v_sub_f32 v189, v189, v89
v_sub_f32 v190, v190, v89
v_sub_f32 v191, v191, v89
v_mul_f32 v87, v87, v90
ar 91,96
ar 92,97
v_mul_f32 v91, v91, v90
v_mul_f32 v92, v92, v90
aw 96,91
aw 97,92
ar 91,98
ar 92,99
v_mul_f32 v91, v91, v90
v_mul_f32 v92, v92, v90
aw 98,91
aw 99,92
ar 91,100
ar 92,101
v_mul_f32 v91, v91, v90
v_mul_f32 v92, v92, v90
aw 100,91
aw 101,92
ar 91,102
ar 92,103
v_mul_f32 v91, v91, v90
v_mul_f32 v92, v92, v90
aw 102,91
aw 103,92
ar 91,104
ar 92,105
v_mul_f32 v91, v91, v90
v_mul_f32 v92, v92, v90
aw 104,91
aw 105,92
ar 91,106
ar 92,107
v_mul_f32 v91, v91, v90
v_mul_f32 v92, v92, v90
aw 106,91
aw 107,92
ar 91,108
ar 92,109
v_mul_f32 v91, v91, v90
v_mul_f32 v92, v92, v90
aw 108,91
aw 109,92
ar 91,110
ar 92,111
v_mul_f32 v91, v91, v90
v_mul_f32 v92, v92, v90
aw 110,91
aw 111,92
ar 91,112
ar 92,113
v_mul_f32 v91, v91, v90
v_mul_f32 v92, v92, v90
aw 112,91
aw 113,92
ar 91,114
ar 92,115
v_mul_f32 v91, v91, v90
v_mul_f32 v92, v92, v90
aw 114,91
aw 115,92
ar 91,116
ar 92,117
v_mul_f32 v91, v91, v90
v_mul_f32 v92, v92, v90
aw 116,91
aw 117,92
ar 91,118
ar 92,119
v_mul_f32 v91, v91, v90
v_mul_f32 v92, v92, v90
aw 118,91
aw 119,92
ar 91,120
ar 92,121
v_mul_f32 v91, v91, v90
v_mul_f32 v92, v92, v90
aw 120,91
aw 121,92
ar 91,122
ar 92,123
v_mul_f32 v91, v91, v90
v_mul_f32 v92, v92, v90
aw 122,91
aw 123,92
ar 91,124
ar 92,125
v_mul_f32 v91, v91, v90
v_mul_f32 v92, v92, v90
aw 124,91
aw 125,92
ar 91,126
ar 92,127
v_mul_f32 v91, v91, v90
v_mul_f32 v92, v92, v90
aw 126,91
aw 127,92
v_max3_f32 v89, v208, v209, v210
v_max3_f32 v89, v89, v211, v212
v_max3_f32 v89, v89, v213, v214
v_max_f32 v89, v89, v215
v_mov_b32 v90, v89
s_nop 1
v_permlane16_swap_b32 v89, v90
s_nop 0
v_max_f32 v89, v89, v90
v_mov_b32 v90, v89
s_nop 1
v_permlane32_swap_b32 v89, v90
s_nop 0
v_max_f32 v89, v89, v90
v_max_f32 v89, 0, v89
v_sub_f32 v90, 0, v89
v_exp_f32 v90, v90
v_sub_f32 v208, v208, v89
v_sub_f32 v209, v209, v89
v_sub_f32 v210, v210, v89
v_sub_f32 v211, v211, v89
v_sub_f32 v212, v212, v89
v_sub_f32 v213, v213, v89
v_sub_f32 v214, v214, v89
v_sub_f32 v215, v215, v89
v_sub_f32 v40, v40, v89
v_sub_f32 v41, v41, v89
v_sub_f32 v42, v42, v89
v_sub_f32 v43, v43, v89
v_sub_f32 v176, v176, v89
v_sub_f32 v177, v177, v89
v_sub_f32 v178, v178, v89
v_sub_f32 v179, v179, v89
v_sub_f32 v180, v180, v89
v_sub_f32 v181, v181, v89
v_sub_f32 v182, v182, v89
v_sub_f32 v183, v183, v89
v_mul_f32 v86, v86, v90
ar 91,64
ar 92,65
v_mul_f32 v91, v91, v90
v_mul_f32 v92, v92, v90
aw 64,91
aw 65,92
ar 91,66
ar 92,67
v_mul_f32 v91, v91, v90
v_mul_f32 v92, v92, v90
aw 66,91
aw 67,92
ar 91,68
ar 92,69
v_mul_f32 v91, v91, v90
v_mul_f32 v92, v92, v90
aw 68,91
aw 69,92
ar 91,70
ar 92,71
v_mul_f32 v91, v91, v90
v_mul_f32 v92, v92, v90
aw 70,91
aw 71,92
ar 91,72
ar 92,73
v_mul_f32 v91, v91, v90
v_mul_f32 v92, v92, v90
aw 72,91
aw 73,92
ar 91,74
ar 92,75
v_mul_f32 v91, v91, v90
v_mul_f32 v92, v92, v90
aw 74,91
aw 75,92
ar 91,76
ar 92,77
v_mul_f32 v91, v91, v90
v_mul_f32 v92, v92, v90
aw 76,91
aw 77,92
ar 91,78
ar 92,79
v_mul_f32 v91, v91, v90
v_mul_f32 v92, v92, v90
aw 78,91
aw 79,92
ar 91,80
ar 92,81
v_mul_f32 v91, v91, v90
v_mul_f32 v92, v92, v90
aw 80,91
aw 81,92
ar 91,82
ar 92,83
v_mul_f32 v91, v91, v90
v_mul_f32 v92, v92, v90
aw 82,91
aw 83,92
ar 91,84
ar 92,85
v_mul_f32 v91, v91, v90
v_mul_f32 v92, v92, v90
aw 84,91
aw 85,92
ar 91,86
ar 92,87
v_mul_f32 v91, v91, v90
v_mul_f32 v92, v92, v90
aw 86,91
aw 87,92
ar 91,88
ar 92,89
v_mul_f32 v91, v91, v90
v_mul_f32 v92, v92, v90
aw 88,91
aw 89,92
ar 91,90
ar 92,91
v_mul_f32 v91, v91, v90
v_mul_f32 v92, v92, v90
aw 90,91
aw 91,92
ar 91,92
ar 92,93
v_mul_f32 v91, v91, v90
v_mul_f32 v92, v92, v90
aw 92,91
aw 93,92
ar 91,94
ar 92,95
v_mul_f32 v91, v91, v90
v_mul_f32 v92, v92, v90
aw 94,91
aw 95,92
v_max3_f32 v89, v200, v201, v202
v_max3_f32 v89, v89, v203, v204
v_max3_f32 v89, v89, v205, v206
v_max_f32 v89, v89, v207
v_mov_b32 v90, v89
s_nop 1
v_permlane16_swap_b32 v89, v90
s_nop 0
v_max_f32 v89, v89, v90
v_mov_b32 v90, v89
s_nop 1
v_permlane32_swap_b32 v89, v90
s_nop 0
v_max_f32 v89, v89, v90
v_max_f32 v89, 0, v89
v_sub_f32 v90, 0, v89
v_exp_f32 v90, v90
v_sub_f32 v200, v200, v89
v_sub_f32 v201, v201, v89
v_sub_f32 v202, v202, v89
v_sub_f32 v203, v203, v89
v_sub_f32 v204, v204, v89
v_sub_f32 v205, v205, v89
v_sub_f32 v206, v206, v89
v_sub_f32 v207, v207, v89
v_sub_f32 v36, v36, v89
v_sub_f32 v37, v37, v89
v_sub_f32 v38, v38, v89
v_sub_f32 v39, v39, v89
v_sub_f32 v168, v168, v89
v_sub_f32 v169, v169, v89
v_sub_f32 v170, v170, v89
v_sub_f32 v171, v171, v89
v_sub_f32 v172, v172, v89
v_sub_f32 v173, v173, v89
v_sub_f32 v174, v174, v89
v_sub_f32 v175, v175, v89
v_mul_f32 v85, v85, v90
ar 91,32
ar 92,33
v_mul_f32 v91, v91, v90
v_mul_f32 v92, v92, v90
aw 32,91
aw 33,92
ar 91,34
ar 92,35
v_mul_f32 v91, v91, v90
v_mul_f32 v92, v92, v90
aw 34,91
aw 35,92
ar 91,36
ar 92,37
v_mul_f32 v91, v91, v90
v_mul_f32 v92, v92, v90
aw 36,91
aw 37,92
ar 91,38
ar 92,39
v_mul_f32 v91, v91, v90
v_mul_f32 v92, v92, v90
aw 38,91
aw 39,92
ar 91,40
ar 92,41
v_mul_f32 v91, v91, v90
v_mul_f32 v92, v92, v90
aw 40,91
aw 41,92
ar 91,42
ar 92,43
v_mul_f32 v91, v91, v90
v_mul_f32 v92, v92, v90
aw 42,91
aw 43,92
ar 91,44
ar 92,45
v_mul_f32 v91, v91, v90
v_mul_f32 v92, v92, v90
aw 44,91
aw 45,92
ar 91,46
ar 92,47
v_mul_f32 v91, v91, v90
v_mul_f32 v92, v92, v90
aw 46,91
aw 47,92
ar 91,48
ar 92,49
v_mul_f32 v91, v91, v90
v_mul_f32 v92, v92, v90
aw 48,91
aw 49,92
ar 91,50
ar 92,51
v_mul_f32 v91, v91, v90
v_mul_f32 v92, v92, v90
aw 50,91
aw 51,92
ar 91,52
ar 92,53
v_mul_f32 v91, v91, v90
v_mul_f32 v92, v92, v90
aw 52,91
aw 53,92
ar 91,54
ar 92,55
v_mul_f32 v91, v91, v90
v_mul_f32 v92, v92, v90
aw 54,91
aw 55,92
ar 91,56
ar 92,57
v_mul_f32 v91, v91, v90
v_mul_f32 v92, v92, v90
aw 56,91
aw 57,92
ar 91,58
ar 92,59
v_mul_f32 v91, v91, v90
v_mul_f32 v92, v92, v90
aw 58,91
aw 59,92
ar 91,60
ar 92,61
v_mul_f32 v91, v91, v90
v_mul_f32 v92, v92, v90
aw 60,91
aw 61,92
ar 91,62
ar 92,63
v_mul_f32 v91, v91, v90
v_mul_f32 v92, v92, v90
aw 62,91
aw 63,92
v_max3_f32 v89, v192, v193, v194
v_max3_f32 v89, v89, v195, v196
v_max3_f32 v89, v89, v197, v198
v_max_f32 v89, v89, v199
v_mov_b32 v90, v89
s_nop 1
v_permlane16_swap_b32 v89, v90
s_nop 0
v_max_f32 v89, v89, v90
v_mov_b32 v90, v89
s_nop 1
v_permlane32_swap_b32 v89, v90
s_nop 0
v_max_f32 v89, v89, v90
v_max_f32 v89, 0, v89
v_sub_f32 v90, 0, v89
v_exp_f32 v90, v90
v_sub_f32 v192, v192, v89
v_sub_f32 v193, v193, v89
v_sub_f32 v194, v194, v89
v_sub_f32 v195, v195, v89
v_sub_f32 v196, v196, v89
v_sub_f32 v197, v197, v89
v_sub_f32 v198, v198, v89
v_sub_f32 v199, v199, v89
v_sub_f32 v32, v32, v89
v_sub_f32 v33, v33, v89
v_sub_f32 v34, v34, v89
v_sub_f32 v35, v35, v89
v_sub_f32 v160, v160, v89
v_sub_f32 v161, v161, v89
v_sub_f32 v162, v162, v89
v_sub_f32 v163, v163, v89
v_sub_f32 v164, v164, v89
v_sub_f32 v165, v165, v89
v_sub_f32 v166, v166, v89
v_sub_f32 v167, v167, v89
v_mul_f32 v84, v84, v90
ar 91,0
ar 92,1
v_mul_f32 v91, v91, v90
v_mul_f32 v92, v92, v90
aw 0,91
aw 1,92
ar 91,2
ar 92,3
v_mul_f32 v91, v91, v90
v_mul_f32 v92, v92, v90
aw 2,91
aw 3,92
ar 91,4
ar 92,5
v_mul_f32 v91, v91, v90
v_mul_f32 v92, v92, v90
aw 4,91
aw 5,92
ar 91,6
ar 92,7
v_mul_f32 v91, v91, v90
v_mul_f32 v92, v92, v90
aw 6,91
aw 7,92
ar 91,8
ar 92,9
v_mul_f32 v91, v91, v90
v_mul_f32 v92, v92, v90
aw 8,91
aw 9,92
ar 91,10
ar 92,11
v_mul_f32 v91, v91, v90
v_mul_f32 v92, v92, v90
aw 10,91
aw 11,92
ar 91,12
ar 92,13
v_mul_f32 v91, v91, v90
v_mul_f32 v92, v92, v90
aw 12,91
aw 13,92
ar 91,14
ar 92,15
v_mul_f32 v91, v91, v90
v_mul_f32 v92, v92, v90
aw 14,91
aw 15,92
ar 91,16
ar 92,17
v_mul_f32 v91, v91, v90
v_mul_f32 v92, v92, v90
aw 16,91
aw 17,92
ar 91,18
ar 92,19
v_mul_f32 v91, v91, v90
v_mul_f32 v92, v92, v90
aw 18,91
aw 19,92
ar 91,20
ar 92,21
v_mul_f32 v91, v91, v90
v_mul_f32 v92, v92, v90
aw 20,91
aw 21,92
ar 91,22
ar 92,23
v_mul_f32 v91, v91, v90
v_mul_f32 v92, v92, v90
aw 22,91
aw 23,92
ar 91,24
ar 92,25
v_mul_f32 v91, v91, v90
v_mul_f32 v92, v92, v90
aw 24,91
aw 25,92
ar 91,26
ar 92,27
v_mul_f32 v91, v91, v90
v_mul_f32 v92, v92, v90
aw 26,91
aw 27,92
ar 91,28
ar 92,29
v_mul_f32 v91, v91, v90
v_mul_f32 v92, v92, v90
aw 28,91
aw 29,92
ar 91,30
ar 92,31
v_mul_f32 v91, v91, v90
v_mul_f32 v92, v92, v90
aw 30,91
aw 31,92
v_exp_f32 v72, v216
s_nop 0
v_exp_f32 v73, v217
s_nop 0
v_add_f32 v83, v72, v73
cv 252,72,73
v_exp_f32 v74, v218
s_nop 0
v_add_f32 v83, v83, v74
v_exp_f32 v75, v219
s_nop 0
v_add_f32 v83, v83, v75
cv 253,74,75
v_exp_f32 v72, v220
s_nop 0
v_add_f32 v83, v83, v72
v_exp_f32 v73, v221
s_nop 0
v_add_f32 v83, v83, v73
cv 254,72,73
v_exp_f32 v74, v222
s_nop 0
v_add_f32 v83, v83, v74
v_exp_f32 v75, v223
s_nop 0
v_add_f32 v83, v83, v75
cv 255,74,75
v_exp_f32 v72, v208
s_nop 0
v_exp_f32 v73, v209
s_nop 0
v_add_f32 v82, v72, v73
cv 248,72,73
v_exp_f32 v74, v210
s_nop 0
v_add_f32 v82, v82, v74
v_exp_f32 v75, v211
s_nop 0
v_add_f32 v82, v82, v75
cv 249,74,75
v_exp_f32 v72, v212
s_nop 0
v_add_f32 v82, v82, v72
v_exp_f32 v73, v213
s_nop 0
v_add_f32 v82, v82, v73
cv 250,72,73
v_exp_f32 v74, v214
s_nop 0
v_add_f32 v82, v82, v74
v_exp_f32 v75, v215
s_nop 0
v_add_f32 v82, v82, v75
cv 251,74,75
v_exp_f32 v72, v200
s_nop 0
v_exp_f32 v73, v201
s_nop 0
v_add_f32 v81, v72, v73
cv 244,72,73
v_exp_f32 v74, v202
s_nop 0
v_add_f32 v81, v81, v74
v_exp_f32 v75, v203
s_nop 0
v_add_f32 v81, v81, v75
cv 245,74,75
v_exp_f32 v72, v204
s_nop 0
v_add_f32 v81, v81, v72
v_exp_f32 v73, v205
s_nop 0
v_add_f32 v81, v81, v73
cv 246,72,73
v_exp_f32 v74, v206
s_nop 0
v_add_f32 v81, v81, v74
v_exp_f32 v75, v207
s_nop 0
v_add_f32 v81, v81, v75
cv 247,74,75
v_exp_f32 v72, v192
s_nop 0
v_exp_f32 v73, v193
s_nop 0
v_add_f32 v80, v72, v73
cv 240,72,73
v_exp_f32 v74, v194
s_nop 0
v_add_f32 v80, v80, v74
v_exp_f32 v75, v195
s_nop 0
v_add_f32 v80, v80, v75
cv 241,74,75
v_exp_f32 v72, v196
s_nop 0
v_add_f32 v80, v80, v72
v_exp_f32 v73, v197
s_nop 0
v_add_f32 v80, v80, v73
cv 242,72,73
v_exp_f32 v74, v198
s_nop 0
v_add_f32 v80, v80, v74
v_exp_f32 v75, v199
s_nop 0
v_add_f32 v80, v80, v75
cv 243,74,75
v_exp_f32 v72, v184
v_exp_f32 v73, v185
s_nop 1
s_setpc_b64 s[92:93]
FB0_321:
s_nop 15
v_max3_f32 v89, v184, v185, v186
v_max3_f32 v89, v89, v187, v188
v_max3_f32 v89, v89, v189, v190
v_max_f32 v89, v89, v191
v_mov_b32 v90, v89
s_nop 1
v_permlane16_swap_b32 v89, v90
s_nop 0
v_max_f32 v89, v89, v90
v_mov_b32 v90, v89
s_nop 1
v_permlane32_swap_b32 v89, v90
s_nop 0
v_max_f32 v89, v89, v90
v_max_f32 v89, 0, v89
v_sub_f32 v90, 0, v89
v_exp_f32 v90, v90
v_sub_f32 v184, v184, v89
v_sub_f32 v185, v185, v89
v_sub_f32 v186, v186, v89
v_sub_f32 v187, v187, v89
v_sub_f32 v188, v188, v89
v_sub_f32 v189, v189, v89
v_sub_f32 v190, v190, v89
v_sub_f32 v191, v191, v89
v_sub_f32 v44, v44, v89
v_sub_f32 v45, v45, v89
v_sub_f32 v46, v46, v89
v_sub_f32 v47, v47, v89
v_sub_f32 v216, v216, v89
v_sub_f32 v217, v217, v89
v_sub_f32 v218, v218, v89
v_sub_f32 v219, v219, v89
v_sub_f32 v220, v220, v89
v_sub_f32 v221, v221, v89
v_sub_f32 v222, v222, v89
v_sub_f32 v223, v223, v89
v_mul_f32 v87, v87, v90
ar 91,96
ar 92,97
v_mul_f32 v91, v91, v90
v_mul_f32 v92, v92, v90
aw 96,91
aw 97,92
ar 91,98
ar 92,99
v_mul_f32 v91, v91, v90
v_mul_f32 v92, v92, v90
aw 98,91
aw 99,92
ar 91,100
ar 92,101
v_mul_f32 v91, v91, v90
v_mul_f32 v92, v92, v90
aw 100,91
aw 101,92
ar 91,102
ar 92,103
v_mul_f32 v91, v91, v90
v_mul_f32 v92, v92, v90
aw 102,91
aw 103,92
ar 91,104
ar 92,105
v_mul_f32 v91, v91, v90
v_mul_f32 v92, v92, v90
aw 104,91
aw 105,92
ar 91,106
ar 92,107
v_mul_f32 v91, v91, v90
v_mul_f32 v92, v92, v90
aw 106,91
aw 107,92
ar 91,108
ar 92,109
v_mul_f32 v91, v91, v90
v_mul_f32 v92, v92, v90
aw 108,91
aw 109,92
ar 91,110
ar 92,111
v_mul_f32 v91, v91, v90
v_mul_f32 v92, v92, v90
aw 110,91
aw 111,92
ar 91,112
ar 92,113
v_mul_f32 v91, v91, v90
v_mul_f32 v92, v92, v90
aw 112,91
aw 113,92
ar 91,114
ar 92,115
v_mul_f32 v91, v91, v90
v_mul_f32 v92, v92, v90
aw 114,91
aw 115,92
ar 91,116
ar 92,117
v_mul_f32 v91, v91, v90
v_mul_f32 v92, v92, v90
aw 116,91
aw 117,92
ar 91,118
ar 92,119
v_mul_f32 v91, v91, v90
v_mul_f32 v92, v92, v90
aw 118,91
aw 119,92
ar 91,120
ar 92,121
v_mul_f32 v91, v91, v90
v_mul_f32 v92, v92, v90
aw 120,91
aw 121,92
ar 91,122
ar 92,123
v_mul_f32 v91, v91, v90
v_mul_f32 v92, v92, v90
aw 122,91
aw 123,92
ar 91,124
ar 92,125
v_mul_f32 v91, v91, v90
v_mul_f32 v92, v92, v90
aw 124,91
aw 125,92
ar 91,126
ar 92,127
v_mul_f32 v91, v91, v90
v_mul_f32 v92, v92, v90
aw 126,91
aw 127,92
v_max3_f32 v89, v176, v177, v178
v_max3_f32 v89, v89, v179, v180
v_max3_f32 v89, v89, v181, v182
v_max_f32 v89, v89, v183
v_mov_b32 v90, v89
s_nop 1
v_permlane16_swap_b32 v89, v90
s_nop 0
v_max_f32 v89, v89, v90
v_mov_b32 v90, v89
s_nop 1
v_permlane32_swap_b32 v89, v90
s_nop 0
v_max_f32 v89, v89, v90
v_max_f32 v89, 0, v89
v_sub_f32 v90, 0, v89
v_exp_f32 v90, v90
v_sub_f32 v176, v176, v89
v_sub_f32 v177, v177, v89
v_sub_f32 v178, v178, v89
v_sub_f32 v179, v179, v89
v_sub_f32 v180, v180, v89
v_sub_f32 v181, v181, v89
v_sub_f32 v182, v182, v89
v_sub_f32 v183, v183, v89
v_sub_f32 v40, v40, v89
v_sub_f32 v41, v41, v89
v_sub_f32 v42, v42, v89
v_sub_f32 v43, v43, v89
v_sub_f32 v208, v208, v89
v_sub_f32 v209, v209, v89
v_sub_f32 v210, v210, v89
v_sub_f32 v211, v211, v89
v_sub_f32 v212, v212, v89
v_sub_f32 v213, v213, v89
v_sub_f32 v214, v214, v89
v_sub_f32 v215, v215, v89
v_mul_f32 v86, v86, v90
ar 91,64
ar 92,65
v_mul_f32 v91, v91, v90
v_mul_f32 v92, v92, v90
aw 64,91
aw 65,92
ar 91,66
ar 92,67
v_mul_f32 v91, v91, v90
v_mul_f32 v92, v92, v90
aw 66,91
aw 67,92
ar 91,68
ar 92,69
v_mul_f32 v91, v91, v90
v_mul_f32 v92, v92, v90
aw 68,91
aw 69,92
ar 91,70
ar 92,71
v_mul_f32 v91, v91, v90
v_mul_f32 v92, v92, v90
aw 70,91
aw 71,92
ar 91,72
ar 92,73
v_mul_f32 v91, v91, v90
v_mul_f32 v92, v92, v90
aw 72,91
aw 73,92
ar 91,74
ar 92,75
v_mul_f32 v91, v91, v90
v_mul_f32 v92, v92, v90
aw 74,91
aw 75,92
ar 91,76
ar 92,77
v_mul_f32 v91, v91, v90
v_mul_f32 v92, v92, v90
aw 76,91
aw 77,92
ar 91,78
ar 92,79
v_mul_f32 v91, v91, v90
v_mul_f32 v92, v92, v90
aw 78,91
aw 79,92
ar 91,80
ar 92,81
v_mul_f32 v91, v91, v90
v_mul_f32 v92, v92, v90
aw 80,91
aw 81,92
ar 91,82
ar 92,83
v_mul_f32 v91, v91, v90
v_mul_f32 v92, v92, v90
aw 82,91
aw 83,92
ar 91,84
ar 92,85
v_mul_f32 v91, v91, v90
v_mul_f32 v92, v92, v90
aw 84,91
aw 85,92
ar 91,86
ar 92,87
v_mul_f32 v91, v91, v90
v_mul_f32 v92, v92, v90
aw 86,91
aw 87,92
ar 91,88
ar 92,89
v_mul_f32 v91, v91, v90
v_mul_f32 v92, v92, v90
aw 88,91
aw 89,92
ar 91,90
ar 92,91
v_mul_f32 v91, v91, v90
v_mul_f32 v92, v92, v90
aw 90,91
aw 91,92
ar 91,92
ar 92,93
v_mul_f32 v91, v91, v90
v_mul_f32 v92, v92, v90
aw 92,91
aw 93,92
ar 91,94
ar 92,95
v_mul_f32 v91, v91, v90
v_mul_f32 v92, v92, v90
aw 94,91
aw 95,92
v_max3_f32 v89, v168, v169, v170
v_max3_f32 v89, v89, v171, v172
v_max3_f32 v89, v89, v173, v174
v_max_f32 v89, v89, v175
v_mov_b32 v90, v89
s_nop 1
v_permlane16_swap_b32 v89, v90
s_nop 0
v_max_f32 v89, v89, v90
v_mov_b32 v90, v89
s_nop 1
v_permlane32_swap_b32 v89, v90
s_nop 0
v_max_f32 v89, v89, v90
v_max_f32 v89, 0, v89
v_sub_f32 v90, 0, v89
v_exp_f32 v90, v90
v_sub_f32 v168, v168, v89
v_sub_f32 v169, v169, v89
v_sub_f32 v170, v170, v89
v_sub_f32 v171, v171, v89
v_sub_f32 v172, v172, v89
v_sub_f32 v173, v173, v89
v_sub_f32 v174, v174, v89
v_sub_f32 v175, v175, v89
v_sub_f32 v36, v36, v89
v_sub_f32 v37, v37, v89
v_sub_f32 v38, v38, v89
v_sub_f32 v39, v39, v89
v_sub_f32 v200, v200, v89
v_sub_f32 v201, v201, v89
v_sub_f32 v202, v202, v89
v_sub_f32 v203, v203, v89
v_sub_f32 v204, v204, v89
v_sub_f32 v205, v205, v89
v_sub_f32 v206, v206, v89
v_sub_f32 v207, v207, v89
v_mul_f32 v85, v85, v90
ar 91,32
ar 92,33
v_mul_f32 v91, v91, v90
v_mul_f32 v92, v92, v90
aw 32,91
aw 33,92
ar 91,34
ar 92,35
v_mul_f32 v91, v91, v90
v_mul_f32 v92, v92, v90
aw 34,91
aw 35,92
ar 91,36
ar 92,37
v_mul_f32 v91, v91, v90
v_mul_f32 v92, v92, v90
aw 36,91
aw 37,92
ar 91,38
ar 92,39
v_mul_f32 v91, v91, v90
v_mul_f32 v92, v92, v90
aw 38,91
aw 39,92
ar 91,40
ar 92,41
v_mul_f32 v91, v91, v90
v_mul_f32 v92, v92, v90
aw 40,91
aw 41,92
ar 91,42
ar 92,43
v_mul_f32 v91, v91, v90
v_mul_f32 v92, v92, v90
aw 42,91
aw 43,92
ar 91,44
ar 92,45
v_mul_f32 v91, v91, v90
v_mul_f32 v92, v92, v90
aw 44,91
aw 45,92
ar 91,46
ar 92,47
v_mul_f32 v91, v91, v90
v_mul_f32 v92, v92, v90
aw 46,91
aw 47,92
ar 91,48
ar 92,49
v_mul_f32 v91, v91, v90
v_mul_f32 v92, v92, v90
aw 48,91
aw 49,92
ar 91,50
ar 92,51
v_mul_f32 v91, v91, v90
v_mul_f32 v92, v92, v90
aw 50,91
aw 51,92
ar 91,52
ar 92,53
v_mul_f32 v91, v91, v90
v_mul_f32 v92, v92, v90
aw 52,91
aw 53,92
ar 91,54
ar 92,55
v_mul_f32 v91, v91, v90
v_mul_f32 v92, v92, v90
aw 54,91
aw 55,92
ar 91,56
ar 92,57
v_mul_f32 v91, v91, v90
v_mul_f32 v92, v92, v90
aw 56,91
aw 57,92
ar 91,58
ar 92,59
v_mul_f32 v91, v91, v90
v_mul_f32 v92, v92, v90
aw 58,91
aw 59,92
ar 91,60
ar 92,61
v_mul_f32 v91, v91, v90
v_mul_f32 v92, v92, v90
aw 60,91
aw 61,92
ar 91,62
ar 92,63
v_mul_f32 v91, v91, v90
v_mul_f32 v92, v92, v90
aw 62,91
aw 63,92
v_exp_f32 v72, v184
s_nop 0
v_exp_f32 v73, v185
s_nop 0
v_add_f32 v79, v72, v73
cv 236,72,73
v_exp_f32 v74, v186
s_nop 0
v_add_f32 v79, v79, v74
v_exp_f32 v75, v187
s_nop 0
v_add_f32 v79, v79, v75
cv 237,74,75
v_exp_f32 v72, v188
s_nop 0
v_add_f32 v79, v79, v72
v_exp_f32 v73, v189
s_nop 0
v_add_f32 v79, v79, v73
cv 238,72,73
v_exp_f32 v74, v190
s_nop 0
v_add_f32 v79, v79, v74
v_exp_f32 v75, v191
s_nop 0
v_add_f32 v79, v79, v75
cv 239,74,75
v_exp_f32 v72, v176
s_nop 0
v_exp_f32 v73, v177
s_nop 0
v_add_f32 v78, v72, v73
cv 232,72,73
v_exp_f32 v74, v178
s_nop 0
v_add_f32 v78, v78, v74
v_exp_f32 v75, v179
s_nop 0
v_add_f32 v78, v78, v75
cv 233,74,75
v_exp_f32 v72, v180
s_nop 0
v_add_f32 v78, v78, v72
v_exp_f32 v73, v181
s_nop 0
v_add_f32 v78, v78, v73
cv 234,72,73
v_exp_f32 v74, v182
s_nop 0
v_add_f32 v78, v78, v74
v_exp_f32 v75, v183
s_nop 0
v_add_f32 v78, v78, v75
cv 235,74,75
v_exp_f32 v72, v168
s_nop 0
v_exp_f32 v73, v169
s_nop 0
v_add_f32 v77, v72, v73
cv 228,72,73
v_exp_f32 v74, v170
s_nop 0
v_add_f32 v77, v77, v74
v_exp_f32 v75, v171
s_nop 0
v_add_f32 v77, v77, v75
cv 229,74,75
v_exp_f32 v72, v172
s_nop 0
v_add_f32 v77, v77, v72
v_exp_f32 v73, v173
s_nop 0
v_add_f32 v77, v77, v73
cv 230,72,73
v_exp_f32 v74, v174
s_nop 0
v_add_f32 v77, v77, v74
v_exp_f32 v75, v175
s_nop 0
v_add_f32 v77, v77, v75
cv 231,74,75
v_exp_f32 v72, v216
v_exp_f32 v73, v217
s_nop 1
s_setpc_b64 s[92:93]
FB1_321l:
s_nop 15
v_max3_f32 v89, v216, v217, v218
v_max3_f32 v89, v89, v219, v220
v_max3_f32 v89, v89, v221, v222
v_max_f32 v89, v89, v223
v_mov_b32 v90, v89
s_nop 1
v_permlane16_swap_b32 v89, v90
s_nop 0
v_max_f32 v89, v89, v90
v_mov_b32 v90, v89
s_nop 1
v_permlane32_swap_b32 v89, v90
s_nop 0
v_max_f32 v89, v89, v90
v_max_f32 v89, 0, v89
v_sub_f32 v90, 0, v89
v_exp_f32 v90, v90
v_sub_f32 v216, v216, v89
v_sub_f32 v217, v217, v89
v_sub_f32 v218, v218, v89
v_sub_f32 v219, v219, v89
v_sub_f32 v220, v220, v89
v_sub_f32 v221, v221, v89
v_sub_f32 v222, v222, v89
v_sub_f32 v223, v223, v89
v_sub_f32 v44, v44, v89
v_sub_f32 v45, v45, v89
v_sub_f32 v46, v46, v89
v_sub_f32 v47, v47, v89
v_sub_f32 v184, v184, v89
v_sub_f32 v185, v185, v89
v_sub_f32 v186, v186, v89
v_sub_f32 v187, v187, v89
v_sub_f32 v188, v188, v89
v_sub_f32 v189, v189, v89
v_sub_f32 v190, v190, v89
v_sub_f32 v191, v191, v89
v_mul_f32 v87, v87, v90
ar 91,96
ar 92,97
v_mul_f32 v91, v91, v90
v_mul_f32 v92, v92, v90
aw 96,91
aw 97,92
ar 91,98
ar 92,99
v_mul_f32 v91, v91, v90
v_mul_f32 v92, v92, v90
aw 98,91
aw 99,92
ar 91,100
ar 92,101
v_mul_f32 v91, v91, v90
v_mul_f32 v92, v92, v90
aw 100,91
aw 101,92
ar 91,102
ar 92,103
v_mul_f32 v91, v91, v90
v_mul_f32 v92, v92, v90
aw 102,91
aw 103,92
ar 91,104
ar 92,105
v_mul_f32 v91, v91, v90
v_mul_f32 v92, v92, v90
aw 104,91
aw 105,92
ar 91,106
ar 92,107
v_mul_f32 v91, v91, v90
v_mul_f32 v92, v92, v90
aw 106,91
aw 107,92
ar 91,108
ar 92,109
v_mul_f32 v91, v91, v90
v_mul_f32 v92, v92, v90
aw 108,91
aw 109,92
ar 91,110
ar 92,111
v_mul_f32 v91, v91, v90
v_mul_f32 v92, v92, v90
aw 110,91
aw 111,92
ar 91,112
ar 92,113
v_mul_f32 v91, v91, v90
v_mul_f32 v92, v92, v90
aw 112,91
aw 113,92
ar 91,114
ar 92,115
v_mul_f32 v91, v91, v90
v_mul_f32 v92, v92, v90
aw 114,91
aw 115,92
ar 91,116
ar 92,117
v_mul_f32 v91, v91, v90
v_mul_f32 v92, v92, v90
aw 116,91
aw 117,92
ar 91,118
ar 92,119
v_mul_f32 v91, v91, v90
v_mul_f32 v92, v92, v90
aw 118,91
aw 119,92
ar 91,120
ar 92,121
v_mul_f32 v91, v91, v90
v_mul_f32 v92, v92, v90
aw 120,91
aw 121,92
ar 91,122
ar 92,123
v_mul_f32 v91, v91, v90
v_mul_f32 v92, v92, v90
aw 122,91
aw 123,92
ar 91,124
ar 92,125
v_mul_f32 v91, v91, v90
v_mul_f32 v92, v92, v90
aw 124,91
aw 125,92
ar 91,126
ar 92,127
v_mul_f32 v91, v91, v90
v_mul_f32 v92, v92, v90
aw 126,91
aw 127,92
v_max3_f32 v89, v208, v209, v210
v_max3_f32 v89, v89, v211, v212
v_max3_f32 v89, v89, v213, v214
v_max_f32 v89, v89, v215
v_mov_b32 v90, v89
s_nop 1
v_permlane16_swap_b32 v89, v90
s_nop 0
v_max_f32 v89, v89, v90
v_mov_b32 v90, v89
s_nop 1
v_permlane32_swap_b32 v89, v90
s_nop 0
v_max_f32 v89, v89, v90
v_max_f32 v89, 0, v89
v_sub_f32 v90, 0, v89
v_exp_f32 v90, v90
v_sub_f32 v208, v208, v89
v_sub_f32 v209, v209, v89
v_sub_f32 v210, v210, v89
v_sub_f32 v211, v211, v89
v_sub_f32 v212, v212, v89
v_sub_f32 v213, v213, v89
v_sub_f32 v214, v214, v89
v_sub_f32 v215, v215, v89
v_sub_f32 v40, v40, v89
v_sub_f32 v41, v41, v89
v_sub_f32 v42, v42, v89
v_sub_f32 v43, v43, v89
v_sub_f32 v176, v176, v89
v_sub_f32 v177, v177, v89
v_sub_f32 v178, v178, v89
v_sub_f32 v179, v179, v89
v_sub_f32 v180, v180, v89
v_sub_f32 v181, v181, v89
v_sub_f32 v182, v182, v89
v_sub_f32 v183, v183, v89
v_mul_f32 v86, v86, v90
ar 91,64
ar 92,65
v_mul_f32 v91, v91, v90
v_mul_f32 v92, v92, v90
aw 64,91
aw 65,92
ar 91,66
ar 92,67
v_mul_f32 v91, v91, v90
v_mul_f32 v92, v92, v90
aw 66,91
aw 67,92
ar 91,68
ar 92,69
v_mul_f32 v91, v91, v90
v_mul_f32 v92, v92, v90
aw 68,91
aw 69,92
ar 91,70
ar 92,71
v_mul_f32 v91, v91, v90
v_mul_f32 v92, v92, v90
aw 70,91
aw 71,92
ar 91,72
ar 92,73
v_mul_f32 v91, v91, v90
v_mul_f32 v92, v92, v90
aw 72,91
aw 73,92
ar 91,74
ar 92,75
v_mul_f32 v91, v91, v90
v_mul_f32 v92, v92, v90
aw 74,91
aw 75,92
ar 91,76
ar 92,77
v_mul_f32 v91, v91, v90
v_mul_f32 v92, v92, v90
aw 76,91
aw 77,92
ar 91,78
ar 92,79
v_mul_f32 v91, v91, v90
v_mul_f32 v92, v92, v90
aw 78,91
aw 79,92
ar 91,80
ar 92,81
v_mul_f32 v91, v91, v90
v_mul_f32 v92, v92, v90
aw 80,91
aw 81,92
ar 91,82
ar 92,83
v_mul_f32 v91, v91, v90
v_mul_f32 v92, v92, v90
aw 82,91
aw 83,92
ar 91,84
ar 92,85
v_mul_f32 v91, v91, v90
v_mul_f32 v92, v92, v90
aw 84,91
aw 85,92
ar 91,86
ar 92,87
v_mul_f32 v91, v91, v90
v_mul_f32 v92, v92, v90
aw 86,91
aw 87,92
ar 91,88
ar 92,89
v_mul_f32 v91, v91, v90
v_mul_f32 v92, v92, v90
aw 88,91
aw 89,92
ar 91,90
ar 92,91
v_mul_f32 v91, v91, v90
v_mul_f32 v92, v92, v90
aw 90,91
aw 91,92
ar 91,92
ar 92,93
v_mul_f32 v91, v91, v90
v_mul_f32 v92, v92, v90
aw 92,91
aw 93,92
ar 91,94
ar 92,95
v_mul_f32 v91, v91, v90
v_mul_f32 v92, v92, v90
aw 94,91
aw 95,92
v_max3_f32 v89, v200, v201, v202
v_max3_f32 v89, v89, v203, v204
v_max3_f32 v89, v89, v205, v206
v_max_f32 v89, v89, v207
v_mov_b32 v90, v89
s_nop 1
v_permlane16_swap_b32 v89, v90
s_nop 0
v_max_f32 v89, v89, v90
v_mov_b32 v90, v89
s_nop 1
v_permlane32_swap_b32 v89, v90
s_nop 0
v_max_f32 v89, v89, v90
v_max_f32 v89, 0, v89
v_sub_f32 v90, 0, v89
v_exp_f32 v90, v90
v_sub_f32 v200, v200, v89
v_sub_f32 v201, v201, v89
v_sub_f32 v202, v202, v89
v_sub_f32 v203, v203, v89
v_sub_f32 v204, v204, v89
v_sub_f32 v205, v205, v89
v_sub_f32 v206, v206, v89
v_sub_f32 v207, v207, v89
v_mul_f32 v85, v85, v90
ar 91,32
ar 92,33
v_mul_f32 v91, v91, v90
v_mul_f32 v92, v92, v90
aw 32,91
aw 33,92
ar 91,34
ar 92,35
v_mul_f32 v91, v91, v90
v_mul_f32 v92, v92, v90
aw 34,91
aw 35,92
ar 91,36
ar 92,37
v_mul_f32 v91, v91, v90
v_mul_f32 v92, v92, v90
aw 36,91
aw 37,92
ar 91,38
ar 92,39
v_mul_f32 v91, v91, v90
v_mul_f32 v92, v92, v90
aw 38,91
aw 39,92
ar 91,40
ar 92,41
v_mul_f32 v91, v91, v90
v_mul_f32 v92, v92, v90
aw 40,91
aw 41,92
ar 91,42
ar 92,43
v_mul_f32 v91, v91, v90
v_mul_f32 v92, v92, v90
aw 42,91
aw 43,92
ar 91,44
ar 92,45
v_mul_f32 v91, v91, v90
v_mul_f32 v92, v92, v90
aw 44,91
aw 45,92
ar 91,46
ar 92,47
v_mul_f32 v91, v91, v90
v_mul_f32 v92, v92, v90
aw 46,91
aw 47,92
ar 91,48
ar 92,49
v_mul_f32 v91, v91, v90
v_mul_f32 v92, v92, v90
aw 48,91
aw 49,92
ar 91,50
ar 92,51
v_mul_f32 v91, v91, v90
v_mul_f32 v92, v92, v90
aw 50,91
aw 51,92
ar 91,52
ar 92,53
v_mul_f32 v91, v91, v90
v_mul_f32 v92, v92, v90
aw 52,91
aw 53,92
ar 91,54
ar 92,55
v_mul_f32 v91, v91, v90
v_mul_f32 v92, v92, v90
aw 54,91
aw 55,92
ar 91,56
ar 92,57
v_mul_f32 v91, v91, v90
v_mul_f32 v92, v92, v90
aw 56,91
aw 57,92
ar 91,58
ar 92,59
v_mul_f32 v91, v91, v90
v_mul_f32 v92, v92, v90
aw 58,91
aw 59,92
ar 91,60
ar 92,61
v_mul_f32 v91, v91, v90
v_mul_f32 v92, v92, v90
aw 60,91
aw 61,92
ar 91,62
ar 92,63
v_mul_f32 v91, v91, v90
v_mul_f32 v92, v92, v90
aw 62,91
aw 63,92
v_exp_f32 v72, v216
s_nop 0
v_exp_f32 v73, v217
s_nop 0
v_add_f32 v83, v72, v73
cv 252,72,73
v_exp_f32 v74, v218
s_nop 0
v_add_f32 v83, v83, v74
v_exp_f32 v75, v219
s_nop 0
v_add_f32 v83, v83, v75
cv 253,74,75
v_exp_f32 v72, v220
s_nop 0
v_add_f32 v83, v83, v72
v_exp_f32 v73, v221
s_nop 0
v_add_f32 v83, v83, v73
cv 254,72,73
v_exp_f32 v74, v222
s_nop 0
v_add_f32 v83, v83, v74
v_exp_f32 v75, v223
s_nop 0
v_add_f32 v83, v83, v75
cv 255,74,75
v_exp_f32 v72, v208
s_nop 0
v_exp_f32 v73, v209
s_nop 0
v_add_f32 v82, v72, v73
cv 248,72,73
v_exp_f32 v74, v210
s_nop 0
v_add_f32 v82, v82, v74
v_exp_f32 v75, v211
s_nop 0
v_add_f32 v82, v82, v75
cv 249,74,75
v_exp_f32 v72, v212
s_nop 0
v_add_f32 v82, v82, v72
v_exp_f32 v73, v213
s_nop 0
v_add_f32 v82, v82, v73
cv 250,72,73
v_exp_f32 v74, v214
s_nop 0
v_add_f32 v82, v82, v74
v_exp_f32 v75, v215
s_nop 0
v_add_f32 v82, v82, v75
cv 251,74,75
v_exp_f32 v72, v200
s_nop 0
v_exp_f32 v73, v201
s_nop 0
v_add_f32 v81, v72, v73
cv 244,72,73
v_exp_f32 v74, v202
s_nop 0
v_add_f32 v81, v81, v74
v_exp_f32 v75, v203
s_nop 0
v_add_f32 v81, v81, v75
cv 245,74,75
v_exp_f32 v72, v204
s_nop 0
v_add_f32 v81, v81, v72
v_exp_f32 v73, v205
s_nop 0
v_add_f32 v81, v81, v73
cv 246,72,73
v_exp_f32 v74, v206
s_nop 0
v_add_f32 v81, v81, v74
v_exp_f32 v75, v207
s_nop 0
v_add_f32 v81, v81, v75
cv 247,74,75
v_exp_f32 v72, v184
v_exp_f32 v73, v185
s_nop 1
s_setpc_b64 s[92:93]
FB0_321n0n:
s_nop 15
v_max3_f32 v89, v184, v185, v186
v_max3_f32 v89, v89, v187, v188
v_max3_f32 v89, v89, v189, v190
v_max_f32 v89, v89, v191
v_mov_b32 v90, v89
s_nop 1
v_permlane16_swap_b32 v89, v90
s_nop 0
v_max_f32 v89, v89, v90
v_mov_b32 v90, v89
s_nop 1
v_permlane32_swap_b32 v89, v90
s_nop 0
v_max_f32 v89, v89, v90
v_max_f32 v89, 0, v89
v_sub_f32 v90, 0, v89
v_exp_f32 v90, v90
v_sub_f32 v184, v184, v89
v_sub_f32 v185, v185, v89
v_sub_f32 v186, v186, v89
v_sub_f32 v187, v187, v89
v_sub_f32 v188, v188, v89
v_sub_f32 v189, v189, v89
v_sub_f32 v190, v190, v89
v_sub_f32 v191, v191, v89
v_sub_f32 v44, v44, v89
v_sub_f32 v45, v45, v89
v_sub_f32 v46, v46, v89
v_sub_f32 v47, v47, v89
v_sub_f32 v216, v216, v89
v_sub_f32 v217, v217, v89
v_sub_f32 v218, v218, v89
v_sub_f32 v219, v219, v89
v_sub_f32 v220, v220, v89
v_sub_f32 v221, v221, v89
v_sub_f32 v222, v222, v89
v_sub_f32 v223, v223, v89
v_mul_f32 v87, v87, v90
ar 91,96
ar 92,97
v_mul_f32 v91, v91, v90
v_mul_f32 v92, v92, v90
aw 96,91
aw 97,92
ar 91,98
ar 92,99
v_mul_f32 v91, v91, v90
v_mul_f32 v92, v92, v90
aw 98,91
aw 99,92
ar 91,100
ar 92,101
v_mul_f32 v91, v91, v90
v_mul_f32 v92, v92, v90
aw 100,91
aw 101,92
ar 91,102
ar 92,103
v_mul_f32 v91, v91, v90
v_mul_f32 v92, v92, v90
aw 102,91
aw 103,92
ar 91,104
ar 92,105
v_mul_f32 v91, v91, v90
v_mul_f32 v92, v92, v90
aw 104,91
aw 105,92
ar 91,106
ar 92,107
v_mul_f32 v91, v91, v90
v_mul_f32 v92, v92, v90
aw 106,91
aw 107,92
ar 91,108
ar 92,109
v_mul_f32 v91, v91, v90
v_mul_f32 v92, v92, v90
aw 108,91
aw 109,92
ar 91,110
ar 92,111
v_mul_f32 v91, v91, v90
v_mul_f32 v92, v92, v90
aw 110,91
aw 111,92
ar 91,112
ar 92,113
v_mul_f32 v91, v91, v90
v_mul_f32 v92, v92, v90
aw 112,91
aw 113,92
ar 91,114
ar 92,115
v_mul_f32 v91, v91, v90
v_mul_f32 v92, v92, v90
aw 114,91
aw 115,92
ar 91,116
ar 92,117
v_mul_f32 v91, v91, v90
v_mul_f32 v92, v92, v90
aw 116,91
aw 117,92
ar 91,118
ar 92,119
v_mul_f32 v91, v91, v90
v_mul_f32 v92, v92, v90
aw 118,91
aw 119,92
ar 91,120
ar 92,121
v_mul_f32 v91, v91, v90
v_mul_f32 v92, v92, v90
aw 120,91
aw 121,92
ar 91,122
ar 92,123
v_mul_f32 v91, v91, v90
v_mul_f32 v92, v92, v90
aw 122,91
aw 123,92
ar 91,124
ar 92,125
v_mul_f32 v91, v91, v90
v_mul_f32 v92, v92, v90
aw 124,91
aw 125,92
ar 91,126
ar 92,127
v_mul_f32 v91, v91, v90
v_mul_f32 v92, v92, v90
aw 126,91
aw 127,92
v_max3_f32 v89, v176, v177, v178
v_max3_f32 v89, v89, v179, v180
v_max3_f32 v89, v89, v181, v182
v_max_f32 v89, v89, v183
v_mov_b32 v90, v89
s_nop 1
v_permlane16_swap_b32 v89, v90
s_nop 0
v_max_f32 v89, v89, v90
v_mov_b32 v90, v89
s_nop 1
v_permlane32_swap_b32 v89, v90
s_nop 0
v_max_f32 v89, v89, v90
v_max_f32 v89, 0, v89
v_sub_f32 v90, 0, v89
v_exp_f32 v90, v90
v_sub_f32 v176, v176, v89
v_sub_f32 v177, v177, v89
v_sub_f32 v178, v178, v89
v_sub_f32 v179, v179, v89
v_sub_f32 v180, v180, v89
v_sub_f32 v181, v181, v89
v_sub_f32 v182, v182, v89
v_sub_f32 v183, v183, v89
v_sub_f32 v40, v40, v89
v_sub_f32 v41, v41, v89
v_sub_f32 v42, v42, v89
v_sub_f32 v43, v43, v89
v_sub_f32 v208, v208, v89
v_sub_f32 v209, v209, v89
v_sub_f32 v210, v210, v89
v_sub_f32 v211, v211, v89
v_sub_f32 v212, v212, v89
v_sub_f32 v213, v213, v89
v_sub_f32 v214, v214, v89
v_sub_f32 v215, v215, v89
v_mul_f32 v86, v86, v90
ar 91,64
ar 92,65
v_mul_f32 v91, v91, v90
v_mul_f32 v92, v92, v90
aw 64,91
aw 65,92
ar 91,66
ar 92,67
v_mul_f32 v91, v91, v90
v_mul_f32 v92, v92, v90
aw 66,91
aw 67,92
ar 91,68
ar 92,69
v_mul_f32 v91, v91, v90
v_mul_f32 v92, v92, v90
aw 68,91
aw 69,92
ar 91,70
ar 92,71
v_mul_f32 v91, v91, v90
v_mul_f32 v92, v92, v90
aw 70,91
aw 71,92
ar 91,72
ar 92,73
v_mul_f32 v91, v91, v90
v_mul_f32 v92, v92, v90
aw 72,91
aw 73,92
ar 91,74
ar 92,75
v_mul_f32 v91, v91, v90
v_mul_f32 v92, v92, v90
aw 74,91
aw 75,92
ar 91,76
ar 92,77
v_mul_f32 v91, v91, v90
v_mul_f32 v92, v92, v90
aw 76,91
aw 77,92
ar 91,78
ar 92,79
v_mul_f32 v91, v91, v90
v_mul_f32 v92, v92, v90
aw 78,91
aw 79,92
ar 91,80
ar 92,81
v_mul_f32 v91, v91, v90
v_mul_f32 v92, v92, v90
aw 80,91
aw 81,92
ar 91,82
ar 92,83
v_mul_f32 v91, v91, v90
v_mul_f32 v92, v92, v90
aw 82,91
aw 83,92
ar 91,84
ar 92,85
v_mul_f32 v91, v91, v90
v_mul_f32 v92, v92, v90
aw 84,91
aw 85,92
ar 91,86
ar 92,87
v_mul_f32 v91, v91, v90
v_mul_f32 v92, v92, v90
aw 86,91
aw 87,92
ar 91,88
ar 92,89
v_mul_f32 v91, v91, v90
v_mul_f32 v92, v92, v90
aw 88,91
aw 89,92
ar 91,90
ar 92,91
v_mul_f32 v91, v91, v90
v_mul_f32 v92, v92, v90
aw 90,91
aw 91,92
ar 91,92
ar 92,93
v_mul_f32 v91, v91, v90
v_mul_f32 v92, v92, v90
aw 92,91
aw 93,92
ar 91,94
ar 92,95
v_mul_f32 v91, v91, v90
v_mul_f32 v92, v92, v90
aw 94,91
aw 95,92
v_max3_f32 v89, v168, v169, v170
v_max3_f32 v89, v89, v171, v172
v_max3_f32 v89, v89, v173, v174
v_max_f32 v89, v89, v175
v_mov_b32 v90, v89
s_nop 1
v_permlane16_swap_b32 v89, v90
s_nop 0
v_max_f32 v89, v89, v90
v_mov_b32 v90, v89
s_nop 1
v_permlane32_swap_b32 v89, v90
s_nop 0
v_max_f32 v89, v89, v90
v_max_f32 v89, 0, v89
v_sub_f32 v90, 0, v89
v_exp_f32 v90, v90
v_sub_f32 v168, v168, v89
v_sub_f32 v169, v169, v89
v_sub_f32 v170, v170, v89
v_sub_f32 v171, v171, v89
v_sub_f32 v172, v172, v89
v_sub_f32 v173, v173, v89
v_sub_f32 v174, v174, v89
v_sub_f32 v175, v175, v89
v_sub_f32 v36, v36, v89
v_sub_f32 v37, v37, v89
v_sub_f32 v38, v38, v89
v_sub_f32 v39, v39, v89
v_sub_f32 v200, v200, v89
v_sub_f32 v201, v201, v89
v_sub_f32 v202, v202, v89
v_sub_f32 v203, v203, v89
v_sub_f32 v204, v204, v89
v_sub_f32 v205, v205, v89
v_sub_f32 v206, v206, v89
v_sub_f32 v207, v207, v89
v_max3_f32 v89, v160, v161, v162
v_max3_f32 v89, v89, v163, v164
v_max3_f32 v89, v89, v165, v166
v_max_f32 v89, v89, v167
v_mov_b32 v90, v89
s_nop 1
v_permlane16_swap_b32 v89, v90
s_nop 0
v_max_f32 v89, v89, v90
v_mov_b32 v90, v89
s_nop 1
v_permlane32_swap_b32 v89, v90
s_nop 0
v_max_f32 v89, v89, v90
v_max_f32 v89, 0, v89
v_sub_f32 v90, 0, v89
v_exp_f32 v90, v90
v_sub_f32 v160, v160, v89
v_sub_f32 v161, v161, v89
v_sub_f32 v162, v162, v89
v_sub_f32 v163, v163, v89
v_sub_f32 v164, v164, v89
v_sub_f32 v165, v165, v89
v_sub_f32 v166, v166, v89
v_sub_f32 v167, v167, v89
v_sub_f32 v32, v32, v89
v_sub_f32 v33, v33, v89
v_sub_f32 v34, v34, v89
v_sub_f32 v35, v35, v89
v_sub_f32 v192, v192, v89
v_sub_f32 v193, v193, v89
v_sub_f32 v194, v194, v89
v_sub_f32 v195, v195, v89
v_sub_f32 v196, v196, v89
v_sub_f32 v197, v197, v89
v_sub_f32 v198, v198, v89
v_sub_f32 v199, v199, v89
v_exp_f32 v72, v184
s_nop 0
v_exp_f32 v73, v185
s_nop 0
v_add_f32 v79, v72, v73
cv 236,72,73
v_exp_f32 v74, v186
s_nop 0
v_add_f32 v79, v79, v74
v_exp_f32 v75, v187
s_nop 0
v_add_f32 v79, v79, v75
cv 237,74,75
v_exp_f32 v72, v188
s_nop 0
v_add_f32 v79, v79, v72
v_exp_f32 v73, v189
s_nop 0
v_add_f32 v79, v79, v73
cv 238,72,73
v_exp_f32 v74, v190
s_nop 0
v_add_f32 v79, v79, v74
v_exp_f32 v75, v191
s_nop 0
v_add_f32 v79, v79, v75
cv 239,74,75
v_exp_f32 v72, v176
s_nop 0
v_exp_f32 v73, v177
s_nop 0
v_add_f32 v78, v72, v73
cv 232,72,73
v_exp_f32 v74, v178
s_nop 0
v_add_f32 v78, v78, v74
v_exp_f32 v75, v179
s_nop 0
v_add_f32 v78, v78, v75
cv 233,74,75
v_exp_f32 v72, v180
s_nop 0
v_add_f32 v78, v78, v72
v_exp_f32 v73, v181
s_nop 0
v_add_f32 v78, v78, v73
cv 234,72,73
v_exp_f32 v74, v182
s_nop 0
v_add_f32 v78, v78, v74
v_exp_f32 v75, v183
s_nop 0
v_add_f32 v78, v78, v75
cv 235,74,75
v_exp_f32 v72, v168
s_nop 0
v_exp_f32 v73, v169
s_nop 0
v_add_f32 v77, v72, v73
cv 228,72,73
v_exp_f32 v74, v170
s_nop 0
v_add_f32 v77, v77, v74
v_exp_f32 v75, v171
s_nop 0
v_add_f32 v77, v77, v75
cv 229,74,75
v_exp_f32 v72, v172
s_nop 0
v_add_f32 v77, v77, v72
v_exp_f32 v73, v173
s_nop 0
v_add_f32 v77, v77, v73
cv 230,72,73
v_exp_f32 v74, v174
s_nop 0
v_add_f32 v77, v77, v74
v_exp_f32 v75, v175
s_nop 0
v_add_f32 v77, v77, v75
cv 231,74,75
v_exp_f32 v72, v160
s_nop 0
v_exp_f32 v73, v161
s_nop 0
v_add_f32 v76, v72, v73
cv 224,72,73
v_exp_f32 v74, v162
s_nop 0
v_add_f32 v76, v76, v74
v_exp_f32 v75, v163
s_nop 0
v_add_f32 v76, v76, v75
cv 225,74,75
v_exp_f32 v72, v164
s_nop 0
v_add_f32 v76, v76, v72
v_exp_f32 v73, v165
s_nop 0
v_add_f32 v76, v76, v73
cv 226,72,73
v_exp_f32 v74, v166
s_nop 0
v_add_f32 v76, v76, v74
v_exp_f32 v75, v167
s_nop 0
v_add_f32 v76, v76, v75
cv 227,74,75
v_exp_f32 v72, v216
v_exp_f32 v73, v217
s_nop 1
s_setpc_b64 s[92:93]
FB1_31:
s_nop 15
v_max3_f32 v89, v216, v217, v218
v_max3_f32 v89, v89, v219, v220
v_max3_f32 v89, v89, v221, v222
v_max_f32 v89, v89, v223
v_mov_b32 v90, v89
s_nop 1
v_permlane16_swap_b32 v89, v90
s_nop 0
v_max_f32 v89, v89, v90
v_mov_b32 v90, v89
s_nop 1
v_permlane32_swap_b32 v89, v90
s_nop 0
v_max_f32 v89, v89, v90
v_max_f32 v89, 0, v89
v_sub_f32 v90, 0, v89
v_exp_f32 v90, v90
v_sub_f32 v216, v216, v89
v_sub_f32 v217, v217, v89
v_sub_f32 v218, v218, v89
v_sub_f32 v219, v219, v89
v_sub_f32 v220, v220, v89
v_sub_f32 v221, v221, v89
v_sub_f32 v222, v222, v89
v_sub_f32 v223, v223, v89
v_sub_f32 v44, v44, v89
v_sub_f32 v45, v45, v89
v_sub_f32 v46, v46, v89
v_sub_f32 v47, v47, v89
v_sub_f32 v184, v184, v89
v_sub_f32 v185, v185, v89
v_sub_f32 v186, v186, v89
v_sub_f32 v187, v187, v89
v_sub_f32 v188, v188, v89
v_sub_f32 v189, v189, v89
v_sub_f32 v190, v190, v89
v_sub_f32 v191, v191, v89
v_mul_f32 v87, v87, v90
ar 91,96
ar 92,97
v_mul_f32 v91, v91, v90
v_mul_f32 v92, v92, v90
aw 96,91
aw 97,92
ar 91,98
ar 92,99
v_mul_f32 v91, v91, v90
v_mul_f32 v92, v92, v90
aw 98,91
aw 99,92
ar 91,100
ar 92,101
v_mul_f32 v91, v91, v90
v_mul_f32 v92, v92, v90
aw 100,91
aw 101,92
ar 91,102
ar 92,103
v_mul_f32 v91, v91, v90
v_mul_f32 v92, v92, v90
aw 102,91
aw 103,92
ar 91,104
ar 92,105
v_mul_f32 v91, v91, v90
v_mul_f32 v92, v92, v90
aw 104,91
aw 105,92
ar 91,106
ar 92,107
v_mul_f32 v91, v91, v90
v_mul_f32 v92, v92, v90
aw 106,91
aw 107,92
ar 91,108
ar 92,109
v_mul_f32 v91, v91, v90
v_mul_f32 v92, v92, v90
aw 108,91
aw 109,92
ar 91,110
ar 92,111
v_mul_f32 v91, v91, v90
v_mul_f32 v92, v92, v90
aw 110,91
aw 111,92
ar 91,112
ar 92,113
v_mul_f32 v91, v91, v90
v_mul_f32 v92, v92, v90
aw 112,91
aw 113,92
ar 91,114
ar 92,115
v_mul_f32 v91, v91, v90
v_mul_f32 v92, v92, v90
aw 114,91
aw 115,92
ar 91,116
ar 92,117
v_mul_f32 v91, v91, v90
v_mul_f32 v92, v92, v90
aw 116,91
aw 117,92
ar 91,118
ar 92,119
v_mul_f32 v91, v91, v90
v_mul_f32 v92, v92, v90
aw 118,91
aw 119,92
ar 91,120
ar 92,121
v_mul_f32 v91, v91, v90
v_mul_f32 v92, v92, v90
aw 120,91
aw 121,92
ar 91,122
ar 92,123
v_mul_f32 v91, v91, v90
v_mul_f32 v92, v92, v90
aw 122,91
aw 123,92
ar 91,124
ar 92,125
v_mul_f32 v91, v91, v90
v_mul_f32 v92, v92, v90
aw 124,91
aw 125,92
ar 91,126
ar 92,127
v_mul_f32 v91, v91, v90
v_mul_f32 v92, v92, v90
aw 126,91
aw 127,92
v_max3_f32 v89, v200, v201, v202
v_max3_f32 v89, v89, v203, v204
v_max3_f32 v89, v89, v205, v206
v_max_f32 v89, v89, v207
v_mov_b32 v90, v89
s_nop 1
v_permlane16_swap_b32 v89, v90
s_nop 0
v_max_f32 v89, v89, v90
v_mov_b32 v90, v89
s_nop 1
v_permlane32_swap_b32 v89, v90
s_nop 0
v_max_f32 v89, v89, v90
v_max_f32 v89, 0, v89
v_sub_f32 v90, 0, v89
v_exp_f32 v90, v90
v_sub_f32 v200, v200, v89
v_sub_f32 v201, v201, v89
v_sub_f32 v202, v202, v89
v_sub_f32 v203, v203, v89
v_sub_f32 v204, v204, v89
v_sub_f32 v205, v205, v89
v_sub_f32 v206, v206, v89
v_sub_f32 v207, v207, v89
v_sub_f32 v36, v36, v89
v_sub_f32 v37, v37, v89
v_sub_f32 v38, v38, v89
v_sub_f32 v39, v39, v89
v_sub_f32 v168, v168, v89
v_sub_f32 v169, v169, v89
v_sub_f32 v170, v170, v89
v_sub_f32 v171, v171, v89
v_sub_f32 v172, v172, v89
v_sub_f32 v173, v173, v89
v_sub_f32 v174, v174, v89
v_sub_f32 v175, v175, v89
v_mul_f32 v85, v85, v90
ar 91,32
ar 92,33
v_mul_f32 v91, v91, v90
v_mul_f32 v92, v92, v90
aw 32,91
aw 33,92
ar 91,34
ar 92,35
v_mul_f32 v91, v91, v90
v_mul_f32 v92, v92, v90
aw 34,91
aw 35,92
ar 91,36
ar 92,37
v_mul_f32 v91, v91, v90
v_mul_f32 v92, v92, v90
aw 36,91
aw 37,92
ar 91,38
ar 92,39
v_mul_f32 v91, v91, v90
v_mul_f32 v92, v92, v90
aw 38,91
aw 39,92
ar 91,40
ar 92,41
v_mul_f32 v91, v91, v90
v_mul_f32 v92, v92, v90
aw 40,91
aw 41,92
ar 91,42
ar 92,43
v_mul_f32 v91, v91, v90
v_mul_f32 v92, v92, v90
aw 42,91
aw 43,92
ar 91,44
ar 92,45
v_mul_f32 v91, v91, v90
v_mul_f32 v92, v92, v90
aw 44,91
aw 45,92
ar 91,46
ar 92,47
v_mul_f32 v91, v91, v90
v_mul_f32 v92, v92, v90
aw 46,91
aw 47,92
ar 91,48
ar 92,49
v_mul_f32 v91, v91, v90
v_mul_f32 v92, v92, v90
aw 48,91
aw 49,92
ar 91,50
ar 92,51
v_mul_f32 v91, v91, v90
v_mul_f32 v92, v92, v90
aw 50,91
aw 51,92
ar 91,52
ar 92,53
v_mul_f32 v91, v91, v90
v_mul_f32 v92, v92, v90
aw 52,91
aw 53,92
ar 91,54
ar 92,55
v_mul_f32 v91, v91, v90
v_mul_f32 v92, v92, v90
aw 54,91
aw 55,92
ar 91,56
ar 92,57
v_mul_f32 v91, v91, v90
v_mul_f32 v92, v92, v90
aw 56,91
aw 57,92
ar 91,58
ar 92,59
v_mul_f32 v91, v91, v90
v_mul_f32 v92, v92, v90
aw 58,91
aw 59,92
ar 91,60
ar 92,61
v_mul_f32 v91, v91, v90
v_mul_f32 v92, v92, v90
aw 60,91
aw 61,92
ar 91,62
ar 92,63
v_mul_f32 v91, v91, v90
v_mul_f32 v92, v92, v90
aw 62,91
aw 63,92
v_exp_f32 v72, v216
s_nop 0
v_exp_f32 v73, v217
s_nop 0
v_add_f32 v83, v72, v73
cv 252,72,73
v_exp_f32 v74, v218
s_nop 0
v_add_f32 v83, v83, v74
v_exp_f32 v75, v219
s_nop 0
v_add_f32 v83, v83, v75
cv 253,74,75
v_exp_f32 v72, v220
s_nop 0
v_add_f32 v83, v83, v72
v_exp_f32 v73, v221
s_nop 0
v_add_f32 v83, v83, v73
cv 254,72,73
v_exp_f32 v74, v222
s_nop 0
v_add_f32 v83, v83, v74
v_exp_f32 v75, v223
s_nop 0
v_add_f32 v83, v83, v75
cv 255,74,75
v_exp_f32 v72, v200
s_nop 0
v_exp_f32 v73, v201
s_nop 0
v_add_f32 v81, v72, v73
cv 244,72,73
v_exp_f32 v74, v202
s_nop 0
v_add_f32 v81, v81, v74
v_exp_f32 v75, v203
s_nop 0
v_add_f32 v81, v81, v75
cv 245,74,75
v_exp_f32 v72, v204
s_nop 0
v_add_f32 v81, v81, v72
v_exp_f32 v73, v205
s_nop 0
v_add_f32 v81, v81, v73
cv 246,72,73
v_exp_f32 v74, v206
s_nop 0
v_add_f32 v81, v81, v74
v_exp_f32 v75, v207
s_nop 0
v_add_f32 v81, v81, v75
cv 247,74,75
v_exp_f32 v72, v184
v_exp_f32 v73, v185
s_nop 1
s_setpc_b64 s[92:93]
L_code_end:

.section .rodata,"a"
.p2align 6
.amdhsa_kernel parallel_sum__compressed_kv_cla__dense_activation_gelu__prompt_kernel
  .amdhsa_next_free_vgpr 512
  .amdhsa_next_free_sgpr 102
  .amdhsa_accum_offset 256
  .amdhsa_group_segment_fixed_size 0
  .amdhsa_kernarg_size 112
  .amdhsa_user_sgpr_count 2
  .amdhsa_user_sgpr_kernarg_segment_ptr 1
  .amdhsa_system_sgpr_workgroup_id_x 1
.end_amdhsa_kernel
```
